```python
import torch

def _softmax(x, axis=-1):
    return torch.softmax(x, dim=axis)
def _gelu(x):
    return torch.nn.functional.gelu(x, approximate="tanh")
def _silu(x):
    return torch.nn.functional.silu(x)
def _sigmoid(x):
    return torch.sigmoid(x)
def _layernorm(x, axis=-1, eps=1e-5):
    m = x.mean(dim=axis, keepdim=True)
    v = x.var(dim=axis, keepdim=True, unbiased=False)
    return (x - m) / torch.sqrt(v + eps)
def _scatter_add(tgt, idx, src, axis=0):
    return tgt.clone().index_add_(axis, idx, src)
def _segment_sum(src, seg, n):
    out = torch.zeros((n,) + src.shape[1:], dtype=src.dtype)
    return out.index_add_(0, seg, src)
def _pad(x, pw):
    flat = tuple(v for pair in reversed(pw) for v in pair)
    return torch.nn.functional.pad(x, flat)

kernel_name = 'concat_heads__compressed_kv_cla__ssm_conv_h3__prompt'

def setup_inputs():

    _w = (lambda a: (lambda t: t.to(torch.bfloat16) if t.is_floating_point() else t)(torch.as_tensor(a)))
    def _A_setup():
        B, H, Sq, Sk, D, M = 1, 16, 2048, 2048, 256, 448
        Dc = 4 * D
        return {
            "x": _w((lambda *s: torch.randn(*s, dtype=torch.bfloat16) * 3.2)(B, Sq, M)),
            "c_kv": _w((lambda *s: torch.randn(*s, dtype=torch.bfloat16) * 0.05)(B, Sk, Dc)),
            "w_q": _w((lambda *s: torch.randn(*s, dtype=torch.bfloat16) * 3.2)(M, H, D) * (M ** -0.5)),
            "w_uk": _w((lambda *s: torch.randn(*s, dtype=torch.bfloat16) * 3.2)(Dc, H, D) * (Dc ** -0.5)),
            "w_uv": _w((lambda *s: torch.randn(*s, dtype=torch.bfloat16) * 0.05)(Dc, H, D) * (Dc ** -0.5)),
            "w_o": _w((lambda *s: torch.randn(*s, dtype=torch.bfloat16) * 0.05)(H, D, M) * ((H * D) ** -0.5)),
        }
    _A_in = _A_setup()

    def _B_setup():
        B, S, D = 1, 2048, 448
        ks = 4
        return {
            "q": _w((lambda *s: torch.randn(*s, dtype=torch.bfloat16) * 0.05)(B, S, D)),
            "k": _w((lambda *s: torch.randn(*s, dtype=torch.bfloat16) * 0.1)(B, S, D)),
            "v": _w((lambda *s: torch.randn(*s, dtype=torch.bfloat16) * 0.1)(B, S, D)),
            "shift_k": _w((lambda *s: torch.randn(*s, dtype=torch.bfloat16) * 0.1)(D, ks) * 0.5),
            "ssm_k": _w((lambda *s: torch.randn(*s, dtype=torch.bfloat16) * 0.1)(D, S) * (1.0 / S ** 0.5)),
            "ssm_D": _w((lambda *s: torch.randn(*s, dtype=torch.bfloat16) * 0.1)(D)),
        }
    _B_in = _B_setup()

    return {
        "A_x": _A_in["x"],
        "A_c_kv": _A_in["c_kv"],
        "A_w_q": _A_in["w_q"],
        "A_w_uk": _A_in["w_uk"],
        "A_w_uv": _A_in["w_uv"],
        "A_w_o": _A_in["w_o"],
        "B_q": _B_in["q"],
        "B_k": _B_in["k"],
        "B_v": _B_in["v"],
        "B_shift_k": _B_in["shift_k"],
        "B_ssm_k": _B_in["ssm_k"],
        "B_ssm_D": _B_in["ssm_D"],
    }

def reference(A_x, A_c_kv, A_w_q, A_w_uk, A_w_uv, A_w_o, B_q, B_k, B_v, B_shift_k, B_ssm_k, B_ssm_D):
    def _A_ref(x, c_kv, w_q, w_uk, w_uv, w_o):
        B, Sq, M = x.shape[0], x.shape[1], x.shape[2]
        Sk = c_kv.shape[1]
        H, D = w_q.shape[1], w_q.shape[2]
        q = torch.einsum("bqm,mhd->bhqd", x, w_q)
        k = torch.einsum("bkc,chd->bhkd", c_kv, w_uk)
        v = torch.einsum("bkc,chd->bhkd", c_kv, w_uv)
        scores = torch.einsum("bhqd,bhkd->bhqk", q, k) * (D ** -0.5)
        off = Sk - Sq
        qi = torch.arange(Sq)[:, None]
        kj = torch.arange(Sk)[None, :]
        cmask = kj <= (qi + off)
        scores = torch.where(cmask[None, None], scores, -1e9)
        p = _softmax(scores, axis=-1)
        ctx = torch.einsum("bhqk,bhkd->bhqd", p, v)
        return torch.einsum("bhqd,hdm->bqm", ctx, w_o)

    def _B_ref(q, k, v, shift_k, ssm_k, ssm_D):
        B, S, D = q.shape
        ks = shift_k.shape[-1]
        k_pad = _pad(k, ((0, 0), (ks - 1, 0), (0, 0)))
        k_shift = torch.zeros_like(k)
        for t in range(ks):
            k_shift = k_shift + k_pad[:, t:t + S, :] * shift_k[:, ks - 1 - t][None, None, :]
        kv = k_shift * v
        L = 2 * S
        kv_pad = _pad(kv, ((0, 0), (0, S), (0, 0)))
        kf_pad = _pad(ssm_k, ((0, 0), (0, S)))
        kv_f = (lambda x, axes=(-2,-1): torch.fft.rfft2(x.float(), dim=axes))(kv_pad[:, None, :, :], axes=(1, 2))
        kf_f = (lambda x, axes=(-2,-1): torch.fft.rfft2(x.float(), dim=axes))(kf_pad[:, None, :], axes=(1, 2))
        kf_f = (lambda x, *d: x.permute(*d))(kf_f, 1, 2, 0)
        y_f = kv_f * kf_f[None, :, :, :]
        y = (lambda x, s, axes=(-2,-1): torch.fft.irfft2(x, s=s, dim=axes).to(torch.bfloat16))(y_f, (1, L), axes=(1, 2))[:, 0, :S, :]
        y = y + kv * ssm_D[None, None, :]
        return q * y

    a = _A_ref(A_x, A_c_kv, A_w_q, A_w_uk, A_w_uv, A_w_o)
    b = _B_ref(B_q, B_k, B_v, B_shift_k, B_ssm_k, B_ssm_D)
    return torch.concatenate([a, b], axis=-1)
```

```asm
; @launch kernel=concat_heads__compressed_kv_cla__ssm_conv_h3__prompt_kernel grid=(256,1,1) block=(256,1,1) lds=163840
.amdgcn_target "amdgcn-amd-amdhsa--gfx950"
.text
.globl concat_heads__compressed_kv_cla__ssm_conv_h3__prompt_kernel
.p2align 8
.type concat_heads__compressed_kv_cla__ssm_conv_h3__prompt_kernel,@function
concat_heads__compressed_kv_cla__ssm_conv_h3__prompt_kernel:
    s_cmp_lt_u32 s2, 256
    s_cbranch_scc1 k1_go
    s_endpgm
k1_go:
    s_load_dwordx8 s[36:43], s[0:1], 0
    s_load_dwordx2 s[44:45], s[0:1], 32
    s_load_dwordx2 s[46:47], s[0:1], 112
    s_load_dwordx4 s[80:83], s[0:1], 56
    s_load_dwordx2 s[84:85], s[0:1], 72
    s_load_dwordx2 s[86:87], s[0:1], 112
    s_load_dwordx2 s[92:93], s[0:1], 104
    s_load_dwordx2 s[94:95], s[0:1], 80
    s_load_dwordx2 s[98:99], s[0:1], 40
    s_and_b32 s48, s2, 7
    s_lshr_b32 s49, s2, 3
    s_and_b32 s50, s49, 1
    s_lshl_b32 s48, s48, 1
    s_add_u32 s48, s48, s50
    s_lshr_b32 s51, s49, 1
    s_and_b32 s52, s51, 1
    s_lshr_b32 s53, s49, 2
    s_and_b32 s58, s51, 7
    s_sub_u32 s59, 15, s58
    s_cmp_lt_u32 s51, 8
    s_cselect_b32 s51, s58, s59
    v_and_b32 v39, 63, v0
    v_lshrrev_b32 v120, 6, v0
    s_nop 0
    v_readfirstlane_b32 s54, v120
    s_waitcnt lgkmcnt(0)
    s_lshl_b32 s32, s54, 12
    s_lshl_b32 s55, s53, 19
    s_add_u32 s8, s38, s55
    s_addc_u32 s9, s39, 0
    s_mov_b32 s10, 0x80000
    s_mov_b32 s11, 0x20000
    s_cmp_eq_u32 s52, 0
    s_cselect_b32 s56, s42, s44
    s_cselect_b32 s57, s43, s45
    s_lshl_b32 s55, s48, 9
    s_add_u32 s12, s56, s55
    s_addc_u32 s13, s57, 0
    s_sub_u32 s14, 0x800000, s55
    s_mov_b32 s15, 0x20000
    s_add_u32 s20, s40, s55
    s_addc_u32 s21, s41, 0
    s_sub_u32 s22, 3670016, s55
    s_mov_b32 s23, 0x20000
    s_mul_i32 s55, s51, 114688
    s_add_u32 s16, s36, s55
    s_addc_u32 s17, s37, 0
    s_mov_b32 s18, 114688
    s_mov_b32 s19, 0x20000
    s_add_u32 s55, s52, 1
    s_lshl_b32 s55, s55, 24
    s_lshl_b32 s56, s48, 20
    s_add_u32 s55, s55, s56
    s_lshl_b32 s57, s53, 17
    s_add_u32 s55, s55, s57
    s_add_u32 s24, s46, s55
    s_addc_u32 s25, s47, 0
    s_mov_b32 s26, 0x20000
    s_mov_b32 s27, 0x20000
    s_lshl_b32 s57, s51, 16
    s_add_u32 s55, s56, s57
    s_add_u32 s28, s46, s55
    s_addc_u32 s29, s47, 0
    s_mov_b32 s30, 0x10000
    s_mov_b32 s31, 0x20000
    s_mov_b32 s35, 0x3db8aa3b
    s_cmp_lt_u32 s51, 8
    s_cselect_b32 s30, 0, s30
    v_lshrrev_b32 v120, 3, v39
    v_and_b32 v121, 7, v39
    v_lshrrev_b32 v122, 4, v39
    s_lshl_b32 s55, s54, 5
    v_add_u32 v120, s55, v120
    s_movk_i32 s56, 896
    v_add_u32 v123, 0, v122
    v_xor_b32 v123, v121, v123
    v_lshlrev_b32 v123, 4, v123
    v_add_u32 v124, 0, v120
    v_lshlrev_b32 v125, 11, v124
    v_add_u32 v125, v125, v123
    v_subrev_u32 v1, 0, v125
    v_mul_lo_u32 v125, v124, s56
    v_add_u32 v125, v125, v123
    v_subrev_u32 v9, 0, v125
    v_add_u32 v123, 4, v122
    v_xor_b32 v123, v121, v123
    v_lshlrev_b32 v123, 4, v123
    v_add_u32 v124, 8, v120
    v_lshlrev_b32 v125, 11, v124
    v_add_u32 v125, v125, v123
    v_subrev_u32 v2, 1024, v125
    v_mul_lo_u32 v125, v124, s56
    v_add_u32 v125, v125, v123
    v_subrev_u32 v10, 1024, v125
    v_add_u32 v123, 0, v122
    v_xor_b32 v123, v121, v123
    v_lshlrev_b32 v123, 4, v123
    v_add_u32 v124, 16, v120
    v_lshlrev_b32 v125, 11, v124
    v_add_u32 v125, v125, v123
    v_subrev_u32 v3, 2048, v125
    v_mul_lo_u32 v125, v124, s56
    v_add_u32 v125, v125, v123
    v_subrev_u32 v11, 2048, v125
    v_add_u32 v123, 4, v122
    v_xor_b32 v123, v121, v123
    v_lshlrev_b32 v123, 4, v123
    v_add_u32 v124, 24, v120
    v_lshlrev_b32 v125, 11, v124
    v_add_u32 v125, v125, v123
    v_subrev_u32 v4, 3072, v125
    v_mul_lo_u32 v125, v124, s56
    v_add_u32 v125, v125, v123
    v_subrev_u32 v12, 3072, v125
    v_lshrrev_b32 v120, 5, v39
    v_and_b32 v121, 31, v39
    s_lshl_b32 s55, s54, 3
    v_add_u32 v123, 0, v120
    v_and_b32 v124, 3, v123
    v_lshlrev_b32 v124, 2, v124
    v_xor_b32 v124, v121, v124
    v_lshlrev_b32 v124, 4, v124
    v_add_u32 v123, s55, v123
    v_lshlrev_b32 v123, 13, v123
    v_add_u32 v123, v123, v124
    v_subrev_u32 v5, 0, v123
    v_add_u32 v123, 2, v120
    v_and_b32 v124, 3, v123
    v_lshlrev_b32 v124, 2, v124
    v_xor_b32 v124, v121, v124
    v_lshlrev_b32 v124, 4, v124
    v_add_u32 v123, s55, v123
    v_lshlrev_b32 v123, 13, v123
    v_add_u32 v123, v123, v124
    v_subrev_u32 v6, 1024, v123
    v_add_u32 v123, 4, v120
    v_and_b32 v124, 3, v123
    v_lshlrev_b32 v124, 2, v124
    v_xor_b32 v124, v121, v124
    v_lshlrev_b32 v124, 4, v124
    v_add_u32 v123, s55, v123
    v_lshlrev_b32 v123, 13, v123
    v_add_u32 v123, v123, v124
    v_subrev_u32 v7, 2048, v123
    v_add_u32 v123, 6, v120
    v_and_b32 v124, 3, v123
    v_lshlrev_b32 v124, 2, v124
    v_xor_b32 v124, v121, v124
    v_lshlrev_b32 v124, 4, v124
    v_add_u32 v123, s55, v123
    v_lshlrev_b32 v123, 13, v123
    v_add_u32 v123, v123, v124
    v_subrev_u32 v8, 3072, v123
    s_add_u32 m0, s32, 0
    s_mov_b32 s33, 0
    buffer_load_dwordx4 v9, s[16:19], s33 offen lds
    buffer_load_dwordx4 v10, s[16:19], s33 offen offset:1024 lds
    buffer_load_dwordx4 v11, s[16:19], s33 offen offset:2048 lds
    buffer_load_dwordx4 v12, s[16:19], s33 offen offset:3072 lds
    s_add_u32 m0, s32, 65536
    s_mov_b32 s33, 0
    buffer_load_dwordx4 v5, s[20:23], s33 offen lds
    buffer_load_dwordx4 v6, s[20:23], s33 offen offset:1024 lds
    buffer_load_dwordx4 v7, s[20:23], s33 offen offset:2048 lds
    buffer_load_dwordx4 v8, s[20:23], s33 offen offset:3072 lds
    s_add_u32 m0, s32, 81920
    s_mov_b32 s33, 262144
    buffer_load_dwordx4 v5, s[20:23], s33 offen lds
    buffer_load_dwordx4 v6, s[20:23], s33 offen offset:1024 lds
    buffer_load_dwordx4 v7, s[20:23], s33 offen offset:2048 lds
    buffer_load_dwordx4 v8, s[20:23], s33 offen offset:3072 lds
    v_and_b32 v104, 31, v39
    v_lshrrev_b32 v105, 5, v39
    v_bfe_u32 v106, v104, 1, 3
    v_lshlrev_b32 v104, 7, v104
    v_add_u32 v104, s32, v104
    v_add_u32 v107, 0, v105
    v_xor_b32 v107, v107, v106
    v_lshlrev_b32 v107, 4, v107
    v_add_u32 v13, v104, v107
    v_add_u32 v17, 0x10000, v13
    v_add_u32 v21, 0x20000, v13
    v_add_u32 v107, 2, v105
    v_xor_b32 v107, v107, v106
    v_lshlrev_b32 v107, 4, v107
    v_add_u32 v14, v104, v107
    v_add_u32 v18, 0x10000, v14
    v_add_u32 v22, 0x20000, v14
    v_add_u32 v107, 4, v105
    v_xor_b32 v107, v107, v106
    v_lshlrev_b32 v107, 4, v107
    v_add_u32 v15, v104, v107
    v_add_u32 v19, 0x10000, v15
    v_add_u32 v23, 0x20000, v15
    v_add_u32 v107, 6, v105
    v_xor_b32 v107, v107, v106
    v_lshlrev_b32 v107, 4, v107
    v_add_u32 v16, v104, v107
    v_add_u32 v20, 0x10000, v16
    v_add_u32 v24, 0x20000, v16
    v_lshrrev_b32 v104, 5, v39
    v_bfe_u32 v105, v39, 2, 2
    v_lshlrev_b32 v104, 3, v104
    v_add_u32 v104, v104, v105
    v_lshlrev_b32 v104, 9, v104
    v_bfe_u32 v106, v39, 4, 1
    v_lshlrev_b32 v106, 5, v106
    v_add_u32 v104, v104, v106
    v_and_b32 v106, 3, v39
    v_lshlrev_b32 v106, 3, v106
    v_add_u32 v104, v104, v106
    v_xor_b32 v107, 0, v105
    v_lshlrev_b32 v107, 6, v107
    v_add_u32 v25, v104, v107
    v_add_u32 v29, 0x10000, v25
    v_add_u32 v33, 0x20000, v25
    v_xor_b32 v107, 1, v105
    v_lshlrev_b32 v107, 6, v107
    v_add_u32 v26, v104, v107
    v_add_u32 v30, 0x10000, v26
    v_add_u32 v34, 0x20000, v26
    v_xor_b32 v107, 2, v105
    v_lshlrev_b32 v107, 6, v107
    v_add_u32 v27, v104, v107
    v_add_u32 v31, 0x10000, v27
    v_add_u32 v35, 0x20000, v27
    v_xor_b32 v107, 3, v105
    v_lshlrev_b32 v107, 6, v107
    v_add_u32 v28, v104, v107
    v_add_u32 v32, 0x10000, v28
    v_add_u32 v36, 0x20000, v28
    s_and_b32 s55, s54, 1
    s_lshl_b32 s55, s55, 16
    s_lshr_b32 s56, s54, 1
    s_cmp_eq_u32 s52, 0
    s_cselect_b32 s57, 13, 12
    s_lshl_b32 s56, s56, s57
    s_add_u32 s55, s55, s56
    v_lshlrev_b32 v104, 4, v39
    v_add_u32 v37, s55, v104
    s_lshl_b32 s55, s54, 14
    v_add_u32 v38, s55, v104
    s_getpc_b64 s[88:89]
    s_and_b32 s88, s88, 0xffffff00
    s_mov_b32 s90, 118000
    s_mov_b32 s91, 0x20000
    s_lshl_b32 s58, s49, 12
    v_lshlrev_b32 v113, 4, v0
    buffer_load_dword a255, v113, s[88:91], s58 offen
    s_mul_i32 s76, s2, 9363
    s_lshr_b32 s76, s76, 16
    s_mul_i32 s77, s76, 7
    s_sub_u32 s77, s2, s77
    s_mov_b32 s60, s80
    s_mov_b32 s61, s81
    s_mov_b32 s62, 1835008
    s_mov_b32 s63, 0x20000
    s_mov_b32 s64, s82
    s_mov_b32 s65, s83
    s_mov_b32 s66, 1835008
    s_mov_b32 s67, 0x20000
    s_mov_b32 s68, s84
    s_mov_b32 s69, s85
    s_mov_b32 s70, 3584
    s_mov_b32 s71, 0x20000
    s_add_u32 s72, s86, 88080384
    s_addc_u32 s73, s87, 0
    s_mov_b32 s74, 1835008
    s_mov_b32 s75, 0x20000
    s_cmp_lt_u32 s2, 224
    s_cselect_b32 s74, s74, 0
    s_lshl_b32 s78, s76, 6
    s_lshl_b32 s79, s77, 7
    s_lshl_b32 s77, s77, 9
    v_lshrrev_b32 v113, 3, v0
    v_and_b32 v114, 7, v0
    v_add_u32 v112, s78, v113
    v_mul_u32_u24 v112, 896, v112
    v_lshlrev_b32 v115, 4, v114
    v_add3_u32 v112, v112, v115, s79
    v_lshlrev_b32 v115, 6, v114
    v_add_u32 v115, s77, v115
    v_lshlrev_b32 v127, 9, v115
    v_add_u32 v114, s78, v113
    v_lshlrev_b32 v114, 4, v114
    v_add_u32 v127, v127, v114
    buffer_load_dwordx4 a[0:3], v115, s[68:71], 0 offen offset:0
    buffer_load_dwordx4 a[4:7], v115, s[68:71], 0 offen offset:16
    buffer_load_dwordx4 a[8:11], v115, s[68:71], 0 offen offset:32
    buffer_load_dwordx4 a[12:15], v115, s[68:71], 0 offen offset:48
    v_add_u32 v113, 0, v112
    buffer_load_dwordx4 a[16:19], v113, s[60:63], 0 offen
    v_add_u32 v113, 4294966400, v112
    buffer_load_dwordx4 a[20:23], v113, s[60:63], 0 offen
    v_add_u32 v113, 4294965504, v112
    buffer_load_dwordx4 a[24:27], v113, s[60:63], 0 offen
    v_add_u32 v113, 4294964608, v112
    buffer_load_dwordx4 a[28:31], v113, s[60:63], 0 offen
    v_add_u32 v113, 0, v112
    buffer_load_dwordx4 a[32:35], v113, s[64:67], 0 offen
    v_add_u32 v113, 28672, v112
    buffer_load_dwordx4 a[36:39], v113, s[60:63], 0 offen
    v_add_u32 v113, 27776, v112
    buffer_load_dwordx4 a[40:43], v113, s[60:63], 0 offen
    v_add_u32 v113, 26880, v112
    buffer_load_dwordx4 a[44:47], v113, s[60:63], 0 offen
    v_add_u32 v113, 25984, v112
    buffer_load_dwordx4 a[48:51], v113, s[60:63], 0 offen
    v_add_u32 v113, 28672, v112
    buffer_load_dwordx4 a[52:55], v113, s[64:67], 0 offen
    s_waitcnt vmcnt(18)
    s_barrier
    ds_read_b128 v[40:43], v13 offset:0
    ds_read_b64_tr_b16 v[44:45], v29 offset:0
    ds_read_b64_tr_b16 v[46:47], v29 offset:2048
    ds_read_b64_tr_b16 v[48:49], v30 offset:0
    ds_read_b64_tr_b16 v[50:51], v30 offset:2048
    ds_read_b64_tr_b16 v[52:53], v31 offset:0
    ds_read_b64_tr_b16 v[54:55], v31 offset:2048
    ds_read_b64_tr_b16 v[56:57], v32 offset:0
    ds_read_b64_tr_b16 v[58:59], v32 offset:2048
    ds_read_b64_tr_b16 v[60:61], v29 offset:256
    ds_read_b64_tr_b16 v[62:63], v29 offset:2304
    ds_read_b64_tr_b16 v[64:65], v30 offset:256
    ds_read_b64_tr_b16 v[66:67], v30 offset:2304
    ds_read_b64_tr_b16 v[68:69], v31 offset:256
    ds_read_b64_tr_b16 v[70:71], v31 offset:2304
    ds_read_b64_tr_b16 v[72:73], v32 offset:256
    ds_read_b64_tr_b16 v[74:75], v32 offset:2304
    s_waitcnt lgkmcnt(12)
    v_mfma_f32_32x32x16_bf16 v[128:143], v[44:47], v[40:43], 0
    ds_read_b128 v[76:79], v14 offset:0
    ds_read_b64_tr_b16 v[80:81], v29 offset:8192
    ds_read_b64_tr_b16 v[82:83], v29 offset:10240
    s_add_u32 m0, s32, 16384
    s_mov_b32 s33, 128
    buffer_load_dwordx4 v9, s[16:19], s33 offen lds
    v_mfma_f32_32x32x16_bf16 v[144:159], v[48:51], v[40:43], 0
    ds_read_b64_tr_b16 v[84:85], v30 offset:8192
    ds_read_b64_tr_b16 v[86:87], v30 offset:10240
    ds_read_b64_tr_b16 v[88:89], v31 offset:8192
    buffer_load_dwordx4 v10, s[16:19], s33 offen offset:1024 lds
    s_waitcnt lgkmcnt(14)
    v_mfma_f32_32x32x16_bf16 v[160:175], v[52:55], v[40:43], 0
    ds_read_b64_tr_b16 v[90:91], v31 offset:10240
    ds_read_b64_tr_b16 v[92:93], v32 offset:8192
    ds_read_b64_tr_b16 v[94:95], v32 offset:10240
    buffer_load_dwordx4 v11, s[16:19], s33 offen offset:2048 lds
    v_mfma_f32_32x32x16_bf16 v[176:191], v[56:59], v[40:43], 0
    ds_read_b64_tr_b16 v[96:97], v29 offset:8448
    ds_read_b64_tr_b16 v[98:99], v29 offset:10496
    ds_read_b64_tr_b16 v[100:101], v30 offset:8448
    buffer_load_dwordx4 v12, s[16:19], s33 offen offset:3072 lds
    s_waitcnt lgkmcnt(15)
    v_mfma_f32_32x32x16_bf16 v[192:207], v[60:63], v[40:43], 0
    ds_read_b64_tr_b16 v[102:103], v30 offset:10496
    ds_read_b64_tr_b16 v[104:105], v31 offset:8448
    ds_read_b64_tr_b16 v[106:107], v31 offset:10496
    s_add_u32 m0, s32, 32768
    s_mov_b32 s33, 524288
    buffer_load_dwordx4 v5, s[20:23], s33 offen lds
    v_mfma_f32_32x32x16_bf16 v[208:223], v[64:67], v[40:43], 0
    ds_read_b64_tr_b16 v[108:109], v32 offset:8448
    ds_read_b64_tr_b16 v[110:111], v32 offset:10496
    buffer_load_dwordx4 v6, s[20:23], s33 offen offset:1024 lds
    s_waitcnt lgkmcnt(15)
    v_mfma_f32_32x32x16_bf16 v[224:239], v[68:71], v[40:43], 0
    buffer_load_dwordx4 v7, s[20:23], s33 offen offset:2048 lds
    v_mfma_f32_32x32x16_bf16 v[240:255], v[72:75], v[40:43], 0
    buffer_load_dwordx4 v8, s[20:23], s33 offen offset:3072 lds
    s_waitcnt vmcnt(22) lgkmcnt(0)
    s_barrier
    v_mfma_f32_32x32x16_bf16 v[128:143], v[80:83], v[76:79], v[128:143]
    ds_read_b128 v[40:43], v15 offset:0
    ds_read_b64_tr_b16 v[44:45], v29 offset:16384
    ds_read_b64_tr_b16 v[46:47], v29 offset:18432
    s_add_u32 m0, s32, 98304
    s_mov_b32 s33, 786432
    buffer_load_dwordx4 v5, s[20:23], s33 offen lds
    v_mfma_f32_32x32x16_bf16 v[144:159], v[84:87], v[76:79], v[144:159]
    ds_read_b64_tr_b16 v[48:49], v30 offset:16384
    ds_read_b64_tr_b16 v[50:51], v30 offset:18432
    ds_read_b64_tr_b16 v[52:53], v31 offset:16384
    buffer_load_dwordx4 v6, s[20:23], s33 offen offset:1024 lds
    v_mfma_f32_32x32x16_bf16 v[160:175], v[88:91], v[76:79], v[160:175]
    ds_read_b64_tr_b16 v[54:55], v31 offset:18432
    ds_read_b64_tr_b16 v[56:57], v32 offset:16384
    ds_read_b64_tr_b16 v[58:59], v32 offset:18432
    buffer_load_dwordx4 v7, s[20:23], s33 offen offset:2048 lds
    v_mfma_f32_32x32x16_bf16 v[176:191], v[92:95], v[76:79], v[176:191]
    ds_read_b64_tr_b16 v[60:61], v29 offset:16640
    ds_read_b64_tr_b16 v[62:63], v29 offset:18688
    ds_read_b64_tr_b16 v[64:65], v30 offset:16640
    buffer_load_dwordx4 v8, s[20:23], s33 offen offset:3072 lds
    v_mfma_f32_32x32x16_bf16 v[192:207], v[96:99], v[76:79], v[192:207]
    ds_read_b64_tr_b16 v[66:67], v30 offset:18688
    ds_read_b64_tr_b16 v[68:69], v31 offset:16640
    ds_read_b64_tr_b16 v[70:71], v31 offset:18688
    s_add_u32 m0, s32, 114688
    s_mov_b32 s33, 256
    buffer_load_dwordx4 v9, s[16:19], s33 offen lds
    v_mfma_f32_32x32x16_bf16 v[208:223], v[100:103], v[76:79], v[208:223]
    ds_read_b64_tr_b16 v[72:73], v32 offset:16640
    ds_read_b64_tr_b16 v[74:75], v32 offset:18688
    buffer_load_dwordx4 v10, s[16:19], s33 offen offset:1024 lds
    v_mfma_f32_32x32x16_bf16 v[224:239], v[104:107], v[76:79], v[224:239]
    buffer_load_dwordx4 v11, s[16:19], s33 offen offset:2048 lds
    v_mfma_f32_32x32x16_bf16 v[240:255], v[108:111], v[76:79], v[240:255]
    buffer_load_dwordx4 v12, s[16:19], s33 offen offset:3072 lds
    s_waitcnt lgkmcnt(12)
    v_mfma_f32_32x32x16_bf16 v[128:143], v[44:47], v[40:43], v[128:143]
    ds_read_b128 v[76:79], v16 offset:0
    ds_read_b64_tr_b16 v[80:81], v29 offset:24576
    ds_read_b64_tr_b16 v[82:83], v29 offset:26624
    s_add_u32 m0, s32, 49152
    s_mov_b32 s33, 1048576
    buffer_load_dwordx4 v5, s[20:23], s33 offen lds
    v_mfma_f32_32x32x16_bf16 v[144:159], v[48:51], v[40:43], v[144:159]
    ds_read_b64_tr_b16 v[84:85], v30 offset:24576
    ds_read_b64_tr_b16 v[86:87], v30 offset:26624
    ds_read_b64_tr_b16 v[88:89], v31 offset:24576
    buffer_load_dwordx4 v6, s[20:23], s33 offen offset:1024 lds
    s_waitcnt lgkmcnt(14)
    v_mfma_f32_32x32x16_bf16 v[160:175], v[52:55], v[40:43], v[160:175]
    ds_read_b64_tr_b16 v[90:91], v31 offset:26624
    ds_read_b64_tr_b16 v[92:93], v32 offset:24576
    ds_read_b64_tr_b16 v[94:95], v32 offset:26624
    buffer_load_dwordx4 v7, s[20:23], s33 offen offset:2048 lds
    v_mfma_f32_32x32x16_bf16 v[176:191], v[56:59], v[40:43], v[176:191]
    ds_read_b64_tr_b16 v[96:97], v29 offset:24832
    ds_read_b64_tr_b16 v[98:99], v29 offset:26880
    ds_read_b64_tr_b16 v[100:101], v30 offset:24832
    buffer_load_dwordx4 v8, s[20:23], s33 offen offset:3072 lds
    s_waitcnt lgkmcnt(15)
    v_mfma_f32_32x32x16_bf16 v[192:207], v[60:63], v[40:43], v[192:207]
    ds_read_b64_tr_b16 v[102:103], v30 offset:26880
    ds_read_b64_tr_b16 v[104:105], v31 offset:24832
    ds_read_b64_tr_b16 v[106:107], v31 offset:26880
    s_add_u32 m0, s32, 131072
    s_mov_b32 s33, 1310720
    buffer_load_dwordx4 v5, s[20:23], s33 offen lds
    v_mfma_f32_32x32x16_bf16 v[208:223], v[64:67], v[40:43], v[208:223]
    ds_read_b64_tr_b16 v[108:109], v32 offset:24832
    ds_read_b64_tr_b16 v[110:111], v32 offset:26880
    buffer_load_dwordx4 v6, s[20:23], s33 offen offset:1024 lds
    s_waitcnt lgkmcnt(15)
    v_mfma_f32_32x32x16_bf16 v[224:239], v[68:71], v[40:43], v[224:239]
    buffer_load_dwordx4 v7, s[20:23], s33 offen offset:2048 lds
    v_mfma_f32_32x32x16_bf16 v[240:255], v[72:75], v[40:43], v[240:255]
    buffer_load_dwordx4 v8, s[20:23], s33 offen offset:3072 lds
    s_waitcnt vmcnt(16) lgkmcnt(0)
    s_barrier
    v_mfma_f32_32x32x16_bf16 v[128:143], v[80:83], v[76:79], v[128:143]
    ds_read_b128 v[40:43], v13 offset:16384
    ds_read_b64_tr_b16 v[44:45], v25 offset:32768
    ds_read_b64_tr_b16 v[46:47], v25 offset:34816
    s_add_u32 m0, s32, 147456
    s_mov_b32 s33, 384
    buffer_load_dwordx4 v9, s[16:19], s33 offen lds
    v_mfma_f32_32x32x16_bf16 v[144:159], v[84:87], v[76:79], v[144:159]
    ds_read_b64_tr_b16 v[48:49], v26 offset:32768
    ds_read_b64_tr_b16 v[50:51], v26 offset:34816
    ds_read_b64_tr_b16 v[52:53], v27 offset:32768
    buffer_load_dwordx4 v10, s[16:19], s33 offen offset:1024 lds
    v_mfma_f32_32x32x16_bf16 v[160:175], v[88:91], v[76:79], v[160:175]
    ds_read_b64_tr_b16 v[54:55], v27 offset:34816
    ds_read_b64_tr_b16 v[56:57], v28 offset:32768
    ds_read_b64_tr_b16 v[58:59], v28 offset:34816
    buffer_load_dwordx4 v11, s[16:19], s33 offen offset:2048 lds
    v_mfma_f32_32x32x16_bf16 v[176:191], v[92:95], v[76:79], v[176:191]
    ds_read_b64_tr_b16 v[60:61], v25 offset:33024
    ds_read_b64_tr_b16 v[62:63], v25 offset:35072
    ds_read_b64_tr_b16 v[64:65], v26 offset:33024
    buffer_load_dwordx4 v12, s[16:19], s33 offen offset:3072 lds
    v_mfma_f32_32x32x16_bf16 v[192:207], v[96:99], v[76:79], v[192:207]
    ds_read_b64_tr_b16 v[66:67], v26 offset:35072
    ds_read_b64_tr_b16 v[68:69], v27 offset:33024
    ds_read_b64_tr_b16 v[70:71], v27 offset:35072
    s_add_u32 m0, s32, 65536
    s_mov_b32 s33, 1572864
    buffer_load_dwordx4 v5, s[20:23], s33 offen lds
    v_mfma_f32_32x32x16_bf16 v[208:223], v[100:103], v[76:79], v[208:223]
    ds_read_b64_tr_b16 v[72:73], v28 offset:33024
    ds_read_b64_tr_b16 v[74:75], v28 offset:35072
    buffer_load_dwordx4 v6, s[20:23], s33 offen offset:1024 lds
    v_mfma_f32_32x32x16_bf16 v[224:239], v[104:107], v[76:79], v[224:239]
    buffer_load_dwordx4 v7, s[20:23], s33 offen offset:2048 lds
    v_mfma_f32_32x32x16_bf16 v[240:255], v[108:111], v[76:79], v[240:255]
    buffer_load_dwordx4 v8, s[20:23], s33 offen offset:3072 lds
    s_waitcnt lgkmcnt(12)
    v_mfma_f32_32x32x16_bf16 v[128:143], v[44:47], v[40:43], v[128:143]
    ds_read_b128 v[76:79], v14 offset:16384
    ds_read_b64_tr_b16 v[80:81], v25 offset:40960
    ds_read_b64_tr_b16 v[82:83], v25 offset:43008
    s_add_u32 m0, s32, 0
    s_mov_b32 s33, 1835008
    buffer_load_dwordx4 v5, s[20:23], s33 offen lds
    v_mfma_f32_32x32x16_bf16 v[144:159], v[48:51], v[40:43], v[144:159]
    ds_read_b64_tr_b16 v[84:85], v26 offset:40960
    ds_read_b64_tr_b16 v[86:87], v26 offset:43008
    ds_read_b64_tr_b16 v[88:89], v27 offset:40960
    buffer_load_dwordx4 v6, s[20:23], s33 offen offset:1024 lds
    s_waitcnt lgkmcnt(14)
    v_mfma_f32_32x32x16_bf16 v[160:175], v[52:55], v[40:43], v[160:175]
    ds_read_b64_tr_b16 v[90:91], v27 offset:43008
    ds_read_b64_tr_b16 v[92:93], v28 offset:40960
    ds_read_b64_tr_b16 v[94:95], v28 offset:43008
    buffer_load_dwordx4 v7, s[20:23], s33 offen offset:2048 lds
    v_mfma_f32_32x32x16_bf16 v[176:191], v[56:59], v[40:43], v[176:191]
    ds_read_b64_tr_b16 v[96:97], v25 offset:41216
    ds_read_b64_tr_b16 v[98:99], v25 offset:43264
    ds_read_b64_tr_b16 v[100:101], v26 offset:41216
    buffer_load_dwordx4 v8, s[20:23], s33 offen offset:3072 lds
    s_waitcnt lgkmcnt(15)
    v_mfma_f32_32x32x16_bf16 v[192:207], v[60:63], v[40:43], v[192:207]
    ds_read_b64_tr_b16 v[102:103], v26 offset:43264
    ds_read_b64_tr_b16 v[104:105], v27 offset:41216
    ds_read_b64_tr_b16 v[106:107], v27 offset:43264
    s_add_u32 m0, s32, 81920
    s_mov_b32 s33, 512
    buffer_load_dwordx4 v9, s[16:19], s33 offen lds
    v_mfma_f32_32x32x16_bf16 v[208:223], v[64:67], v[40:43], v[208:223]
    ds_read_b64_tr_b16 v[108:109], v28 offset:41216
    ds_read_b64_tr_b16 v[110:111], v28 offset:43264
    buffer_load_dwordx4 v10, s[16:19], s33 offen offset:1024 lds
    s_waitcnt lgkmcnt(15)
    v_mfma_f32_32x32x16_bf16 v[224:239], v[68:71], v[40:43], v[224:239]
    buffer_load_dwordx4 v11, s[16:19], s33 offen offset:2048 lds
    v_mfma_f32_32x32x16_bf16 v[240:255], v[72:75], v[40:43], v[240:255]
    buffer_load_dwordx4 v12, s[16:19], s33 offen offset:3072 lds
    s_waitcnt vmcnt(28) lgkmcnt(0)
    s_barrier
    v_mfma_f32_32x32x16_bf16 v[128:143], v[80:83], v[76:79], v[128:143]
    ds_read_b128 v[40:43], v15 offset:16384
    ds_read_b64_tr_b16 v[44:45], v29 offset:32768
    ds_read_b64_tr_b16 v[46:47], v29 offset:34816
    v_mfma_f32_32x32x16_bf16 v[144:159], v[84:87], v[76:79], v[144:159]
    ds_read_b64_tr_b16 v[48:49], v30 offset:32768
    ds_read_b64_tr_b16 v[50:51], v30 offset:34816
    ds_read_b64_tr_b16 v[52:53], v31 offset:32768
    v_mfma_f32_32x32x16_bf16 v[160:175], v[88:91], v[76:79], v[160:175]
    ds_read_b64_tr_b16 v[54:55], v31 offset:34816
    ds_read_b64_tr_b16 v[56:57], v32 offset:32768
    ds_read_b64_tr_b16 v[58:59], v32 offset:34816
    s_add_u32 m0, s32, 32768
    s_mov_b32 s33, 2097152
    buffer_load_dwordx4 v5, s[20:23], s33 offen lds
    v_mfma_f32_32x32x16_bf16 v[176:191], v[92:95], v[76:79], v[176:191]
    ds_read_b64_tr_b16 v[60:61], v29 offset:33024
    ds_read_b64_tr_b16 v[62:63], v29 offset:35072
    ds_read_b64_tr_b16 v[64:65], v30 offset:33024
    v_mfma_f32_32x32x16_bf16 v[192:207], v[96:99], v[76:79], v[192:207]
    ds_read_b64_tr_b16 v[66:67], v30 offset:35072
    ds_read_b64_tr_b16 v[68:69], v31 offset:33024
    ds_read_b64_tr_b16 v[70:71], v31 offset:35072
    v_mfma_f32_32x32x16_bf16 v[208:223], v[100:103], v[76:79], v[208:223]
    ds_read_b64_tr_b16 v[72:73], v32 offset:33024
    ds_read_b64_tr_b16 v[74:75], v32 offset:35072
    v_mfma_f32_32x32x16_bf16 v[224:239], v[104:107], v[76:79], v[224:239]
    buffer_load_dwordx4 v6, s[20:23], s33 offen offset:1024 lds
    v_mfma_f32_32x32x16_bf16 v[240:255], v[108:111], v[76:79], v[240:255]
    s_waitcnt lgkmcnt(12)
    v_mfma_f32_32x32x16_bf16 v[128:143], v[44:47], v[40:43], v[128:143]
    ds_read_b128 v[76:79], v16 offset:16384
    ds_read_b64_tr_b16 v[80:81], v29 offset:40960
    ds_read_b64_tr_b16 v[82:83], v29 offset:43008
    v_accvgpr_read_b32 v125, a1
    v_accvgpr_read_b32 v126, a3
    v_and_b32 v125, 0xffff0000, v125
    v_mfma_f32_32x32x16_bf16 v[144:159], v[48:51], v[40:43], v[144:159]
    ds_read_b64_tr_b16 v[84:85], v30 offset:40960
    ds_read_b64_tr_b16 v[86:87], v30 offset:43008
    ds_read_b64_tr_b16 v[88:89], v31 offset:40960
    v_and_b32 v126, 0xffff0000, v126
    v_accvgpr_read_b32 v124, a28
    v_lshlrev_b32 v122, 16, v124
    s_waitcnt lgkmcnt(14)
    v_mfma_f32_32x32x16_bf16 v[160:175], v[52:55], v[40:43], v[160:175]
    ds_read_b64_tr_b16 v[90:91], v31 offset:43008
    ds_read_b64_tr_b16 v[92:93], v32 offset:40960
    ds_read_b64_tr_b16 v[94:95], v32 offset:43008
    buffer_load_dwordx4 v7, s[20:23], s33 offen offset:2048 lds
    v_and_b32 v123, 0xffff0000, v124
    v_mul_f32 v120, v122, v125
    v_mul_f32 v121, v123, v126
    v_mfma_f32_32x32x16_bf16 v[176:191], v[56:59], v[40:43], v[176:191]
    ds_read_b64_tr_b16 v[96:97], v29 offset:41216
    ds_read_b64_tr_b16 v[98:99], v29 offset:43264
    ds_read_b64_tr_b16 v[100:101], v30 offset:41216
    v_cvt_pk_bf16_f32 v124, v120, v121
    v_lshlrev_b32 v116, 16, v124
    v_and_b32 v117, 0xffff0000, v124
    s_waitcnt lgkmcnt(15)
    v_mfma_f32_32x32x16_bf16 v[192:207], v[60:63], v[40:43], v[192:207]
    ds_read_b64_tr_b16 v[102:103], v30 offset:43264
    ds_read_b64_tr_b16 v[104:105], v31 offset:41216
    ds_read_b64_tr_b16 v[106:107], v31 offset:43264
    v_accvgpr_read_b32 v124, a48
    v_lshlrev_b32 v122, 16, v124
    v_and_b32 v123, 0xffff0000, v124
    v_mfma_f32_32x32x16_bf16 v[208:223], v[64:67], v[40:43], v[208:223]
    ds_read_b64_tr_b16 v[108:109], v32 offset:41216
    ds_read_b64_tr_b16 v[110:111], v32 offset:43264
    v_mul_f32 v120, v122, v125
    v_mul_f32 v121, v123, v126
    v_cvt_pk_bf16_f32 v124, v120, v121
    s_waitcnt lgkmcnt(15)
    v_mfma_f32_32x32x16_bf16 v[224:239], v[68:71], v[40:43], v[224:239]
    buffer_load_dwordx4 v8, s[20:23], s33 offen offset:3072 lds
    v_lshlrev_b32 v118, 16, v124
    v_and_b32 v119, 0xffff0000, v124
    v_accvgpr_read_b32 v125, a1
    v_mfma_f32_32x32x16_bf16 v[240:255], v[72:75], v[40:43], v[240:255]
    v_accvgpr_read_b32 v126, a3
    v_lshlrev_b32 v125, 16, v125
    v_lshlrev_b32 v126, 16, v126
    s_waitcnt vmcnt(24) lgkmcnt(0)
    s_barrier
    v_mfma_f32_32x32x16_bf16 v[128:143], v[80:83], v[76:79], v[128:143]
    ds_read_b128 v[40:43], v17 offset:49152
    ds_read_b64_tr_b16 v[44:45], v25 offset:49152
    ds_read_b64_tr_b16 v[46:47], v25 offset:51200
    v_accvgpr_read_b32 v124, a24
    v_lshlrev_b32 v122, 16, v124
    v_and_b32 v123, 0xffff0000, v124
    v_mfma_f32_32x32x16_bf16 v[144:159], v[84:87], v[76:79], v[144:159]
    ds_read_b64_tr_b16 v[48:49], v26 offset:49152
    ds_read_b64_tr_b16 v[50:51], v26 offset:51200
    ds_read_b64_tr_b16 v[52:53], v27 offset:49152
    s_add_u32 m0, s32, 16384
    s_mov_b32 s33, 2359296
    buffer_load_dwordx4 v5, s[20:23], s33 offen lds
    v_mul_f32 v120, v122, v125
    v_mul_f32 v121, v123, v126
    v_cvt_pk_bf16_f32 v124, v120, v121
    v_mfma_f32_32x32x16_bf16 v[160:175], v[88:91], v[76:79], v[160:175]
    ds_read_b64_tr_b16 v[54:55], v27 offset:51200
    ds_read_b64_tr_b16 v[56:57], v28 offset:49152
    ds_read_b64_tr_b16 v[58:59], v28 offset:51200
    v_lshlrev_b32 v120, 16, v124
    v_and_b32 v121, 0xffff0000, v124
    v_add_f32 v116, v116, v120
    v_mfma_f32_32x32x16_bf16 v[176:191], v[92:95], v[76:79], v[176:191]
    ds_read_b64_tr_b16 v[60:61], v25 offset:49408
    ds_read_b64_tr_b16 v[62:63], v25 offset:51456
    ds_read_b64_tr_b16 v[64:65], v26 offset:49408
    buffer_load_dwordx4 v6, s[20:23], s33 offen offset:1024 lds
    v_add_f32 v117, v117, v121
    v_cvt_pk_bf16_f32 v124, v116, v117
    v_lshlrev_b32 v116, 16, v124
    v_mfma_f32_32x32x16_bf16 v[192:207], v[96:99], v[76:79], v[192:207]
    ds_read_b64_tr_b16 v[66:67], v26 offset:51456
    ds_read_b64_tr_b16 v[68:69], v27 offset:49408
    ds_read_b64_tr_b16 v[70:71], v27 offset:51456
    v_and_b32 v117, 0xffff0000, v124
    v_accvgpr_read_b32 v124, a44
    v_lshlrev_b32 v122, 16, v124
    v_mfma_f32_32x32x16_bf16 v[208:223], v[100:103], v[76:79], v[208:223]
    ds_read_b64_tr_b16 v[72:73], v28 offset:49408
    ds_read_b64_tr_b16 v[74:75], v28 offset:51456
    buffer_load_dwordx4 v7, s[20:23], s33 offen offset:2048 lds
    v_and_b32 v123, 0xffff0000, v124
    v_mul_f32 v120, v122, v125
    v_mul_f32 v121, v123, v126
    v_mfma_f32_32x32x16_bf16 v[224:239], v[104:107], v[76:79], v[224:239]
    v_cvt_pk_bf16_f32 v124, v120, v121
    v_lshlrev_b32 v120, 16, v124
    v_and_b32 v121, 0xffff0000, v124
    v_mfma_f32_32x32x16_bf16 v[240:255], v[108:111], v[76:79], v[240:255]
    buffer_load_dwordx4 v8, s[20:23], s33 offen offset:3072 lds
    v_add_f32 v118, v118, v120
    v_add_f32 v119, v119, v121
    v_cvt_pk_bf16_f32 v124, v118, v119
    s_waitcnt lgkmcnt(12)
    v_mfma_f32_32x32x16_bf16 v[128:143], v[44:47], v[40:43], v[128:143]
    ds_read_b128 v[76:79], v18 offset:49152
    ds_read_b64_tr_b16 v[80:81], v25 offset:57344
    ds_read_b64_tr_b16 v[82:83], v25 offset:59392
    v_lshlrev_b32 v118, 16, v124
    v_and_b32 v119, 0xffff0000, v124
    v_accvgpr_read_b32 v125, a0
    v_mfma_f32_32x32x16_bf16 v[144:159], v[48:51], v[40:43], v[144:159]
    ds_read_b64_tr_b16 v[84:85], v26 offset:57344
    ds_read_b64_tr_b16 v[86:87], v26 offset:59392
    ds_read_b64_tr_b16 v[88:89], v27 offset:57344
    s_add_u32 m0, s32, 98304
    s_mov_b32 s33, 640
    buffer_load_dwordx4 v9, s[16:19], s33 offen lds
    v_accvgpr_read_b32 v126, a2
    v_and_b32 v125, 0xffff0000, v125
    v_and_b32 v126, 0xffff0000, v126
    s_waitcnt lgkmcnt(14)
    v_mfma_f32_32x32x16_bf16 v[160:175], v[52:55], v[40:43], v[160:175]
    ds_read_b64_tr_b16 v[90:91], v27 offset:59392
    ds_read_b64_tr_b16 v[92:93], v28 offset:57344
    ds_read_b64_tr_b16 v[94:95], v28 offset:59392
    v_accvgpr_read_b32 v124, a20
    v_lshlrev_b32 v122, 16, v124
    v_and_b32 v123, 0xffff0000, v124
    v_mfma_f32_32x32x16_bf16 v[176:191], v[56:59], v[40:43], v[176:191]
    ds_read_b64_tr_b16 v[96:97], v25 offset:57600
    ds_read_b64_tr_b16 v[98:99], v25 offset:59648
    ds_read_b64_tr_b16 v[100:101], v26 offset:57600
    buffer_load_dwordx4 v10, s[16:19], s33 offen offset:1024 lds
    v_mul_f32 v120, v122, v125
    v_mul_f32 v121, v123, v126
    v_cvt_pk_bf16_f32 v124, v120, v121
    s_waitcnt lgkmcnt(15)
    v_mfma_f32_32x32x16_bf16 v[192:207], v[60:63], v[40:43], v[192:207]
    ds_read_b64_tr_b16 v[102:103], v26 offset:59648
    ds_read_b64_tr_b16 v[104:105], v27 offset:57600
    ds_read_b64_tr_b16 v[106:107], v27 offset:59648
    v_lshlrev_b32 v120, 16, v124
    v_and_b32 v121, 0xffff0000, v124
    v_add_f32 v116, v116, v120
    v_mfma_f32_32x32x16_bf16 v[208:223], v[64:67], v[40:43], v[208:223]
    ds_read_b64_tr_b16 v[108:109], v28 offset:57600
    ds_read_b64_tr_b16 v[110:111], v28 offset:59648
    buffer_load_dwordx4 v11, s[16:19], s33 offen offset:2048 lds
    v_add_f32 v117, v117, v121
    v_cvt_pk_bf16_f32 v124, v116, v117
    v_lshlrev_b32 v116, 16, v124
    s_waitcnt lgkmcnt(15)
    v_mfma_f32_32x32x16_bf16 v[224:239], v[68:71], v[40:43], v[224:239]
    v_and_b32 v117, 0xffff0000, v124
    v_accvgpr_read_b32 v124, a40
    v_lshlrev_b32 v122, 16, v124
    v_mfma_f32_32x32x16_bf16 v[240:255], v[72:75], v[40:43], v[240:255]
    buffer_load_dwordx4 v12, s[16:19], s33 offen offset:3072 lds
    v_and_b32 v123, 0xffff0000, v124
    v_mul_f32 v120, v122, v125
    v_mul_f32 v121, v123, v126
    s_waitcnt vmcnt(28) lgkmcnt(0)
    s_barrier
    v_mfma_f32_32x32x16_bf16 v[128:143], v[80:83], v[76:79], v[128:143]
    ds_read_b128 v[40:43], v19 offset:49152
    ds_read_b64_tr_b16 v[44:45], v33 offset:0
    ds_read_b64_tr_b16 v[46:47], v33 offset:2048
    v_cvt_pk_bf16_f32 v124, v120, v121
    v_lshlrev_b32 v120, 16, v124
    v_and_b32 v121, 0xffff0000, v124
    v_mfma_f32_32x32x16_bf16 v[144:159], v[84:87], v[76:79], v[144:159]
    ds_read_b64_tr_b16 v[48:49], v34 offset:0
    ds_read_b64_tr_b16 v[50:51], v34 offset:2048
    ds_read_b64_tr_b16 v[52:53], v35 offset:0
    v_add_f32 v118, v118, v120
    v_add_f32 v119, v119, v121
    v_cvt_pk_bf16_f32 v124, v118, v119
    v_mfma_f32_32x32x16_bf16 v[160:175], v[88:91], v[76:79], v[160:175]
    ds_read_b64_tr_b16 v[54:55], v35 offset:2048
    ds_read_b64_tr_b16 v[56:57], v36 offset:0
    ds_read_b64_tr_b16 v[58:59], v36 offset:2048
    s_add_u32 m0, s32, 49152
    s_mov_b32 s33, 2621440
    buffer_load_dwordx4 v5, s[20:23], s33 offen lds
    v_lshlrev_b32 v118, 16, v124
    v_and_b32 v119, 0xffff0000, v124
    v_accvgpr_read_b32 v125, a0
    v_mfma_f32_32x32x16_bf16 v[176:191], v[92:95], v[76:79], v[176:191]
    ds_read_b64_tr_b16 v[60:61], v33 offset:256
    ds_read_b64_tr_b16 v[62:63], v33 offset:2304
    ds_read_b64_tr_b16 v[64:65], v34 offset:256
    v_accvgpr_read_b32 v126, a2
    v_lshlrev_b32 v125, 16, v125
    v_lshlrev_b32 v126, 16, v126
    v_mfma_f32_32x32x16_bf16 v[192:207], v[96:99], v[76:79], v[192:207]
    ds_read_b64_tr_b16 v[66:67], v34 offset:2304
    ds_read_b64_tr_b16 v[68:69], v35 offset:256
    ds_read_b64_tr_b16 v[70:71], v35 offset:2304
    v_accvgpr_read_b32 v124, a16
    v_lshlrev_b32 v122, 16, v124
    v_and_b32 v123, 0xffff0000, v124
    v_mfma_f32_32x32x16_bf16 v[208:223], v[100:103], v[76:79], v[208:223]
    ds_read_b64_tr_b16 v[72:73], v36 offset:256
    ds_read_b64_tr_b16 v[74:75], v36 offset:2304
    v_mul_f32 v120, v122, v125
    v_mul_f32 v121, v123, v126
    v_cvt_pk_bf16_f32 v124, v120, v121
    v_mfma_f32_32x32x16_bf16 v[224:239], v[104:107], v[76:79], v[224:239]
    buffer_load_dwordx4 v6, s[20:23], s33 offen offset:1024 lds
    v_lshlrev_b32 v120, 16, v124
    v_and_b32 v121, 0xffff0000, v124
    v_add_f32 v116, v116, v120
    v_mfma_f32_32x32x16_bf16 v[240:255], v[108:111], v[76:79], v[240:255]
    v_add_f32 v117, v117, v121
    v_cvt_pk_bf16_f32 v124, v116, v117
    v_lshlrev_b32 v116, 16, v124
    s_waitcnt lgkmcnt(12)
    v_mfma_f32_32x32x16_bf16 v[128:143], v[44:47], v[40:43], v[128:143]
    ds_read_b128 v[76:79], v20 offset:49152
    ds_read_b64_tr_b16 v[80:81], v33 offset:8192
    ds_read_b64_tr_b16 v[82:83], v33 offset:10240
    v_and_b32 v117, 0xffff0000, v124
    v_accvgpr_read_b32 v124, a36
    v_lshlrev_b32 v122, 16, v124
    v_mfma_f32_32x32x16_bf16 v[144:159], v[48:51], v[40:43], v[144:159]
    ds_read_b64_tr_b16 v[84:85], v34 offset:8192
    ds_read_b64_tr_b16 v[86:87], v34 offset:10240
    ds_read_b64_tr_b16 v[88:89], v35 offset:8192
    v_and_b32 v123, 0xffff0000, v124
    v_mul_f32 v120, v122, v125
    v_mul_f32 v121, v123, v126
    s_waitcnt lgkmcnt(14)
    v_mfma_f32_32x32x16_bf16 v[160:175], v[52:55], v[40:43], v[160:175]
    ds_read_b64_tr_b16 v[90:91], v35 offset:10240
    ds_read_b64_tr_b16 v[92:93], v36 offset:8192
    ds_read_b64_tr_b16 v[94:95], v36 offset:10240
    buffer_load_dwordx4 v7, s[20:23], s33 offen offset:2048 lds
    v_cvt_pk_bf16_f32 v124, v120, v121
    v_lshlrev_b32 v120, 16, v124
    v_and_b32 v121, 0xffff0000, v124
    v_mfma_f32_32x32x16_bf16 v[176:191], v[56:59], v[40:43], v[176:191]
    ds_read_b64_tr_b16 v[96:97], v33 offset:8448
    ds_read_b64_tr_b16 v[98:99], v33 offset:10496
    ds_read_b64_tr_b16 v[100:101], v34 offset:8448
    v_add_f32 v118, v118, v120
    v_add_f32 v119, v119, v121
    v_cvt_pk_bf16_f32 v124, v118, v119
    s_waitcnt lgkmcnt(15)
    v_mfma_f32_32x32x16_bf16 v[192:207], v[60:63], v[40:43], v[192:207]
    ds_read_b64_tr_b16 v[102:103], v34 offset:10496
    ds_read_b64_tr_b16 v[104:105], v35 offset:8448
    ds_read_b64_tr_b16 v[106:107], v35 offset:10496
    v_lshlrev_b32 v118, 16, v124
    v_and_b32 v119, 0xffff0000, v124
    v_accvgpr_read_b32 v124, a32
    v_mfma_f32_32x32x16_bf16 v[208:223], v[64:67], v[40:43], v[208:223]
    ds_read_b64_tr_b16 v[108:109], v36 offset:8448
    ds_read_b64_tr_b16 v[110:111], v36 offset:10496
    v_lshlrev_b32 v122, 16, v124
    v_and_b32 v123, 0xffff0000, v124
    v_mul_f32 v116, v116, v122
    s_waitcnt lgkmcnt(15)
    v_mfma_f32_32x32x16_bf16 v[224:239], v[68:71], v[40:43], v[224:239]
    buffer_load_dwordx4 v8, s[20:23], s33 offen offset:3072 lds
    v_mul_f32 v117, v117, v123
    v_cvt_pk_bf16_f32 v124, v116, v117
    v_accvgpr_write_b32 a32, v124
    v_mfma_f32_32x32x16_bf16 v[240:255], v[72:75], v[40:43], v[240:255]
    v_accvgpr_read_b32 v124, a52
    v_lshlrev_b32 v122, 16, v124
    v_and_b32 v123, 0xffff0000, v124
    s_waitcnt vmcnt(24) lgkmcnt(0)
    s_barrier
    v_mfma_f32_32x32x16_bf16 v[128:143], v[80:83], v[76:79], v[128:143]
    ds_read_b128 v[40:43], v21 offset:16384
    ds_read_b64_tr_b16 v[44:45], v29 offset:0
    ds_read_b64_tr_b16 v[46:47], v29 offset:2048
    v_mul_f32 v118, v118, v122
    v_mul_f32 v119, v119, v123
    v_cvt_pk_bf16_f32 v124, v118, v119
    v_mfma_f32_32x32x16_bf16 v[144:159], v[84:87], v[76:79], v[144:159]
    ds_read_b64_tr_b16 v[48:49], v30 offset:0
    ds_read_b64_tr_b16 v[50:51], v30 offset:2048
    ds_read_b64_tr_b16 v[52:53], v31 offset:0
    s_add_u32 m0, s32, 114688
    s_mov_b32 s33, 2883584
    buffer_load_dwordx4 v5, s[20:23], s33 offen lds
    v_accvgpr_write_b32 a52, v124
    v_accvgpr_read_b32 v125, a5
    v_accvgpr_read_b32 v126, a7
    v_mfma_f32_32x32x16_bf16 v[160:175], v[88:91], v[76:79], v[160:175]
    ds_read_b64_tr_b16 v[54:55], v31 offset:2048
    ds_read_b64_tr_b16 v[56:57], v32 offset:0
    ds_read_b64_tr_b16 v[58:59], v32 offset:2048
    v_and_b32 v125, 0xffff0000, v125
    v_and_b32 v126, 0xffff0000, v126
    v_accvgpr_read_b32 v124, a29
    v_mfma_f32_32x32x16_bf16 v[176:191], v[92:95], v[76:79], v[176:191]
    ds_read_b64_tr_b16 v[60:61], v29 offset:256
    ds_read_b64_tr_b16 v[62:63], v29 offset:2304
    ds_read_b64_tr_b16 v[64:65], v30 offset:256
    buffer_load_dwordx4 v6, s[20:23], s33 offen offset:1024 lds
    v_lshlrev_b32 v122, 16, v124
    v_and_b32 v123, 0xffff0000, v124
    v_mul_f32 v120, v122, v125
    v_mfma_f32_32x32x16_bf16 v[192:207], v[96:99], v[76:79], v[192:207]
    ds_read_b64_tr_b16 v[66:67], v30 offset:2304
    ds_read_b64_tr_b16 v[68:69], v31 offset:256
    ds_read_b64_tr_b16 v[70:71], v31 offset:2304
    v_mul_f32 v121, v123, v126
    v_cvt_pk_bf16_f32 v124, v120, v121
    v_lshlrev_b32 v116, 16, v124
    v_mfma_f32_32x32x16_bf16 v[208:223], v[100:103], v[76:79], v[208:223]
    ds_read_b64_tr_b16 v[72:73], v32 offset:256
    ds_read_b64_tr_b16 v[74:75], v32 offset:2304
    buffer_load_dwordx4 v7, s[20:23], s33 offen offset:2048 lds
    v_and_b32 v117, 0xffff0000, v124
    v_accvgpr_read_b32 v124, a49
    v_lshlrev_b32 v122, 16, v124
    v_mfma_f32_32x32x16_bf16 v[224:239], v[104:107], v[76:79], v[224:239]
    v_and_b32 v123, 0xffff0000, v124
    v_mul_f32 v120, v122, v125
    v_mul_f32 v121, v123, v126
    v_mfma_f32_32x32x16_bf16 v[240:255], v[108:111], v[76:79], v[240:255]
    buffer_load_dwordx4 v8, s[20:23], s33 offen offset:3072 lds
    v_cvt_pk_bf16_f32 v124, v120, v121
    v_lshlrev_b32 v118, 16, v124
    v_and_b32 v119, 0xffff0000, v124
    s_waitcnt lgkmcnt(12)
    v_mfma_f32_32x32x16_bf16 v[128:143], v[44:47], v[40:43], v[128:143]
    ds_read_b128 v[76:79], v22 offset:16384
    ds_read_b64_tr_b16 v[80:81], v29 offset:8192
    ds_read_b64_tr_b16 v[82:83], v29 offset:10240
    v_accvgpr_read_b32 v125, a5
    v_accvgpr_read_b32 v126, a7
    v_lshlrev_b32 v125, 16, v125
    v_mfma_f32_32x32x16_bf16 v[144:159], v[48:51], v[40:43], v[144:159]
    ds_read_b64_tr_b16 v[84:85], v30 offset:8192
    ds_read_b64_tr_b16 v[86:87], v30 offset:10240
    ds_read_b64_tr_b16 v[88:89], v31 offset:8192
    s_add_u32 m0, s32, 131072
    s_mov_b32 s33, 768
    buffer_load_dwordx4 v9, s[16:19], s33 offen lds
    v_lshlrev_b32 v126, 16, v126
    v_accvgpr_read_b32 v124, a25
    v_lshlrev_b32 v122, 16, v124
    s_waitcnt lgkmcnt(14)
    v_mfma_f32_32x32x16_bf16 v[160:175], v[52:55], v[40:43], v[160:175]
    ds_read_b64_tr_b16 v[90:91], v31 offset:10240
    ds_read_b64_tr_b16 v[92:93], v32 offset:8192
    ds_read_b64_tr_b16 v[94:95], v32 offset:10240
    v_and_b32 v123, 0xffff0000, v124
    v_mul_f32 v120, v122, v125
    v_mul_f32 v121, v123, v126
    v_mfma_f32_32x32x16_bf16 v[176:191], v[56:59], v[40:43], v[176:191]
    ds_read_b64_tr_b16 v[96:97], v29 offset:8448
    ds_read_b64_tr_b16 v[98:99], v29 offset:10496
    ds_read_b64_tr_b16 v[100:101], v30 offset:8448
    buffer_load_dwordx4 v10, s[16:19], s33 offen offset:1024 lds
    v_cvt_pk_bf16_f32 v124, v120, v121
    v_lshlrev_b32 v120, 16, v124
    v_and_b32 v121, 0xffff0000, v124
    s_waitcnt lgkmcnt(15)
    v_mfma_f32_32x32x16_bf16 v[192:207], v[60:63], v[40:43], v[192:207]
    ds_read_b64_tr_b16 v[102:103], v30 offset:10496
    ds_read_b64_tr_b16 v[104:105], v31 offset:8448
    ds_read_b64_tr_b16 v[106:107], v31 offset:10496
    v_add_f32 v116, v116, v120
    v_add_f32 v117, v117, v121
    v_cvt_pk_bf16_f32 v124, v116, v117
    v_mfma_f32_32x32x16_bf16 v[208:223], v[64:67], v[40:43], v[208:223]
    ds_read_b64_tr_b16 v[108:109], v32 offset:8448
    ds_read_b64_tr_b16 v[110:111], v32 offset:10496
    buffer_load_dwordx4 v11, s[16:19], s33 offen offset:2048 lds
    v_lshlrev_b32 v116, 16, v124
    v_and_b32 v117, 0xffff0000, v124
    v_accvgpr_read_b32 v124, a45
    s_waitcnt lgkmcnt(15)
    v_mfma_f32_32x32x16_bf16 v[224:239], v[68:71], v[40:43], v[224:239]
    v_lshlrev_b32 v122, 16, v124
    v_and_b32 v123, 0xffff0000, v124
    v_mul_f32 v120, v122, v125
    v_mfma_f32_32x32x16_bf16 v[240:255], v[72:75], v[40:43], v[240:255]
    buffer_load_dwordx4 v12, s[16:19], s33 offen offset:3072 lds
    v_mul_f32 v121, v123, v126
    v_cvt_pk_bf16_f32 v124, v120, v121
    v_lshlrev_b32 v120, 16, v124
    s_waitcnt vmcnt(28) lgkmcnt(0)
    s_barrier
    v_mfma_f32_32x32x16_bf16 v[128:143], v[80:83], v[76:79], v[128:143]
    ds_read_b128 v[40:43], v23 offset:16384
    ds_read_b64_tr_b16 v[44:45], v25 offset:0
    ds_read_b64_tr_b16 v[46:47], v25 offset:2048
    v_and_b32 v121, 0xffff0000, v124
    v_add_f32 v118, v118, v120
    v_add_f32 v119, v119, v121
    v_mfma_f32_32x32x16_bf16 v[144:159], v[84:87], v[76:79], v[144:159]
    ds_read_b64_tr_b16 v[48:49], v26 offset:0
    ds_read_b64_tr_b16 v[50:51], v26 offset:2048
    ds_read_b64_tr_b16 v[52:53], v27 offset:0
    v_cvt_pk_bf16_f32 v124, v118, v119
    v_lshlrev_b32 v118, 16, v124
    v_and_b32 v119, 0xffff0000, v124
    v_mfma_f32_32x32x16_bf16 v[160:175], v[88:91], v[76:79], v[160:175]
    ds_read_b64_tr_b16 v[54:55], v27 offset:2048
    ds_read_b64_tr_b16 v[56:57], v28 offset:0
    ds_read_b64_tr_b16 v[58:59], v28 offset:2048
    v_accvgpr_read_b32 v125, a4
    v_accvgpr_read_b32 v126, a6
    v_and_b32 v125, 0xffff0000, v125
    v_mfma_f32_32x32x16_bf16 v[176:191], v[92:95], v[76:79], v[176:191]
    ds_read_b64_tr_b16 v[60:61], v25 offset:256
    ds_read_b64_tr_b16 v[62:63], v25 offset:2304
    ds_read_b64_tr_b16 v[64:65], v26 offset:256
    v_and_b32 v126, 0xffff0000, v126
    v_accvgpr_read_b32 v124, a21
    v_lshlrev_b32 v122, 16, v124
    v_mfma_f32_32x32x16_bf16 v[192:207], v[96:99], v[76:79], v[192:207]
    ds_read_b64_tr_b16 v[66:67], v26 offset:2304
    ds_read_b64_tr_b16 v[68:69], v27 offset:256
    ds_read_b64_tr_b16 v[70:71], v27 offset:2304
    v_and_b32 v123, 0xffff0000, v124
    v_mul_f32 v120, v122, v125
    v_mul_f32 v121, v123, v126
    v_mfma_f32_32x32x16_bf16 v[208:223], v[100:103], v[76:79], v[208:223]
    ds_read_b64_tr_b16 v[72:73], v28 offset:256
    ds_read_b64_tr_b16 v[74:75], v28 offset:2304
    v_cvt_pk_bf16_f32 v124, v120, v121
    v_lshlrev_b32 v120, 16, v124
    v_and_b32 v121, 0xffff0000, v124
    v_mfma_f32_32x32x16_bf16 v[224:239], v[104:107], v[76:79], v[224:239]
    v_add_f32 v116, v116, v120
    v_add_f32 v117, v117, v121
    v_cvt_pk_bf16_f32 v124, v116, v117
    v_mfma_f32_32x32x16_bf16 v[240:255], v[108:111], v[76:79], v[240:255]
    v_lshlrev_b32 v116, 16, v124
    v_and_b32 v117, 0xffff0000, v124
    v_accvgpr_read_b32 v124, a41
    s_waitcnt lgkmcnt(12)
    v_mfma_f32_32x32x16_bf16 v[128:143], v[44:47], v[40:43], v[128:143]
    ds_read_b128 v[76:79], v24 offset:16384
    ds_read_b64_tr_b16 v[80:81], v25 offset:8192
    ds_read_b64_tr_b16 v[82:83], v25 offset:10240
    v_lshlrev_b32 v122, 16, v124
    v_and_b32 v123, 0xffff0000, v124
    v_mul_f32 v120, v122, v125
    v_mfma_f32_32x32x16_bf16 v[144:159], v[48:51], v[40:43], v[144:159]
    ds_read_b64_tr_b16 v[84:85], v26 offset:8192
    ds_read_b64_tr_b16 v[86:87], v26 offset:10240
    ds_read_b64_tr_b16 v[88:89], v27 offset:8192
    v_mul_f32 v121, v123, v126
    v_cvt_pk_bf16_f32 v124, v120, v121
    v_lshlrev_b32 v120, 16, v124
    s_waitcnt lgkmcnt(14)
    v_mfma_f32_32x32x16_bf16 v[160:175], v[52:55], v[40:43], v[160:175]
    ds_read_b64_tr_b16 v[90:91], v27 offset:10240
    ds_read_b64_tr_b16 v[92:93], v28 offset:8192
    ds_read_b64_tr_b16 v[94:95], v28 offset:10240
    v_and_b32 v121, 0xffff0000, v124
    v_add_f32 v118, v118, v120
    v_add_f32 v119, v119, v121
    v_mfma_f32_32x32x16_bf16 v[176:191], v[56:59], v[40:43], v[176:191]
    ds_read_b64_tr_b16 v[96:97], v25 offset:8448
    ds_read_b64_tr_b16 v[98:99], v25 offset:10496
    ds_read_b64_tr_b16 v[100:101], v26 offset:8448
    v_cvt_pk_bf16_f32 v124, v118, v119
    v_lshlrev_b32 v118, 16, v124
    v_and_b32 v119, 0xffff0000, v124
    s_waitcnt lgkmcnt(15)
    v_mfma_f32_32x32x16_bf16 v[192:207], v[60:63], v[40:43], v[192:207]
    ds_read_b64_tr_b16 v[102:103], v26 offset:10496
    ds_read_b64_tr_b16 v[104:105], v27 offset:8448
    ds_read_b64_tr_b16 v[106:107], v27 offset:10496
    v_accvgpr_read_b32 v125, a4
    v_accvgpr_read_b32 v126, a6
    v_lshlrev_b32 v125, 16, v125
    v_mfma_f32_32x32x16_bf16 v[208:223], v[64:67], v[40:43], v[208:223]
    ds_read_b64_tr_b16 v[108:109], v28 offset:8448
    ds_read_b64_tr_b16 v[110:111], v28 offset:10496
    v_lshlrev_b32 v126, 16, v126
    v_accvgpr_read_b32 v124, a17
    v_lshlrev_b32 v122, 16, v124
    s_waitcnt lgkmcnt(15)
    v_mfma_f32_32x32x16_bf16 v[224:239], v[68:71], v[40:43], v[224:239]
    v_and_b32 v123, 0xffff0000, v124
    v_mul_f32 v120, v122, v125
    v_mul_f32 v121, v123, v126
    v_mfma_f32_32x32x16_bf16 v[240:255], v[72:75], v[40:43], v[240:255]
    v_cvt_pk_bf16_f32 v124, v120, v121
    v_lshlrev_b32 v120, 16, v124
    v_and_b32 v121, 0xffff0000, v124
    s_waitcnt vmcnt(20) lgkmcnt(0)
    s_barrier
    v_mfma_f32_32x32x16_bf16 v[128:143], v[80:83], v[76:79], v[128:143]
    ds_read_b128 v[40:43], v17 offset:16384
    ds_read_b64_tr_b16 v[44:45], v25 offset:32768
    ds_read_b64_tr_b16 v[46:47], v25 offset:34816
    v_add_f32 v116, v116, v120
    v_add_f32 v117, v117, v121
    v_cvt_pk_bf16_f32 v124, v116, v117
    v_mfma_f32_32x32x16_bf16 v[144:159], v[84:87], v[76:79], v[144:159]
    ds_read_b64_tr_b16 v[48:49], v26 offset:32768
    ds_read_b64_tr_b16 v[50:51], v26 offset:34816
    ds_read_b64_tr_b16 v[52:53], v27 offset:32768
    v_lshlrev_b32 v116, 16, v124
    v_and_b32 v117, 0xffff0000, v124
    v_accvgpr_read_b32 v124, a37
    v_mfma_f32_32x32x16_bf16 v[160:175], v[88:91], v[76:79], v[160:175]
    ds_read_b64_tr_b16 v[54:55], v27 offset:34816
    ds_read_b64_tr_b16 v[56:57], v28 offset:32768
    ds_read_b64_tr_b16 v[58:59], v28 offset:34816
    s_add_u32 m0, s32, 147456
    s_mov_b32 s33, 3145728
    buffer_load_dwordx4 v5, s[20:23], s33 offen lds
    v_lshlrev_b32 v122, 16, v124
    v_and_b32 v123, 0xffff0000, v124
    v_mul_f32 v120, v122, v125
    v_mfma_f32_32x32x16_bf16 v[176:191], v[92:95], v[76:79], v[176:191]
    ds_read_b64_tr_b16 v[60:61], v25 offset:33024
    ds_read_b64_tr_b16 v[62:63], v25 offset:35072
    ds_read_b64_tr_b16 v[64:65], v26 offset:33024
    v_mul_f32 v121, v123, v126
    v_cvt_pk_bf16_f32 v124, v120, v121
    v_lshlrev_b32 v120, 16, v124
    v_mfma_f32_32x32x16_bf16 v[192:207], v[96:99], v[76:79], v[192:207]
    ds_read_b64_tr_b16 v[66:67], v26 offset:35072
    ds_read_b64_tr_b16 v[68:69], v27 offset:33024
    ds_read_b64_tr_b16 v[70:71], v27 offset:35072
    v_and_b32 v121, 0xffff0000, v124
    v_add_f32 v118, v118, v120
    v_add_f32 v119, v119, v121
    v_mfma_f32_32x32x16_bf16 v[208:223], v[100:103], v[76:79], v[208:223]
    ds_read_b64_tr_b16 v[72:73], v28 offset:33024
    ds_read_b64_tr_b16 v[74:75], v28 offset:35072
    v_cvt_pk_bf16_f32 v124, v118, v119
    v_lshlrev_b32 v118, 16, v124
    v_and_b32 v119, 0xffff0000, v124
    v_mfma_f32_32x32x16_bf16 v[224:239], v[104:107], v[76:79], v[224:239]
    buffer_load_dwordx4 v6, s[20:23], s33 offen offset:1024 lds
    v_accvgpr_read_b32 v124, a33
    v_lshlrev_b32 v122, 16, v124
    v_and_b32 v123, 0xffff0000, v124
    v_mfma_f32_32x32x16_bf16 v[240:255], v[108:111], v[76:79], v[240:255]
    v_mul_f32 v116, v116, v122
    v_mul_f32 v117, v117, v123
    v_cvt_pk_bf16_f32 v124, v116, v117
    s_waitcnt lgkmcnt(12)
    v_mfma_f32_32x32x16_bf16 v[128:143], v[44:47], v[40:43], v[128:143]
    ds_read_b128 v[76:79], v18 offset:16384
    ds_read_b64_tr_b16 v[80:81], v25 offset:40960
    ds_read_b64_tr_b16 v[82:83], v25 offset:43008
    v_accvgpr_write_b32 a33, v124
    v_accvgpr_read_b32 v124, a53
    v_lshlrev_b32 v122, 16, v124
    v_mfma_f32_32x32x16_bf16 v[144:159], v[48:51], v[40:43], v[144:159]
    ds_read_b64_tr_b16 v[84:85], v26 offset:40960
    ds_read_b64_tr_b16 v[86:87], v26 offset:43008
    ds_read_b64_tr_b16 v[88:89], v27 offset:40960
    v_and_b32 v123, 0xffff0000, v124
    v_mul_f32 v118, v118, v122
    v_mul_f32 v119, v119, v123
    s_waitcnt lgkmcnt(14)
    v_mfma_f32_32x32x16_bf16 v[160:175], v[52:55], v[40:43], v[160:175]
    ds_read_b64_tr_b16 v[90:91], v27 offset:43008
    ds_read_b64_tr_b16 v[92:93], v28 offset:40960
    ds_read_b64_tr_b16 v[94:95], v28 offset:43008
    buffer_load_dwordx4 v7, s[20:23], s33 offen offset:2048 lds
    v_cvt_pk_bf16_f32 v124, v118, v119
    v_accvgpr_write_b32 a53, v124
    v_accvgpr_read_b32 v125, a9
    v_mfma_f32_32x32x16_bf16 v[176:191], v[56:59], v[40:43], v[176:191]
    ds_read_b64_tr_b16 v[96:97], v25 offset:41216
    ds_read_b64_tr_b16 v[98:99], v25 offset:43264
    ds_read_b64_tr_b16 v[100:101], v26 offset:41216
    v_accvgpr_read_b32 v126, a11
    v_and_b32 v125, 0xffff0000, v125
    v_and_b32 v126, 0xffff0000, v126
    s_waitcnt lgkmcnt(15)
    v_mfma_f32_32x32x16_bf16 v[192:207], v[60:63], v[40:43], v[192:207]
    ds_read_b64_tr_b16 v[102:103], v26 offset:43264
    ds_read_b64_tr_b16 v[104:105], v27 offset:41216
    ds_read_b64_tr_b16 v[106:107], v27 offset:43264
    v_accvgpr_read_b32 v124, a30
    v_lshlrev_b32 v122, 16, v124
    v_and_b32 v123, 0xffff0000, v124
    v_mfma_f32_32x32x16_bf16 v[208:223], v[64:67], v[40:43], v[208:223]
    ds_read_b64_tr_b16 v[108:109], v28 offset:41216
    ds_read_b64_tr_b16 v[110:111], v28 offset:43264
    v_mul_f32 v120, v122, v125
    v_mul_f32 v121, v123, v126
    v_cvt_pk_bf16_f32 v124, v120, v121
    s_waitcnt lgkmcnt(15)
    v_mfma_f32_32x32x16_bf16 v[224:239], v[68:71], v[40:43], v[224:239]
    buffer_load_dwordx4 v8, s[20:23], s33 offen offset:3072 lds
    v_lshlrev_b32 v116, 16, v124
    v_and_b32 v117, 0xffff0000, v124
    v_accvgpr_read_b32 v124, a50
    v_mfma_f32_32x32x16_bf16 v[240:255], v[72:75], v[40:43], v[240:255]
    v_lshlrev_b32 v122, 16, v124
    v_and_b32 v123, 0xffff0000, v124
    v_mul_f32 v120, v122, v125
    s_waitcnt vmcnt(20) lgkmcnt(0)
    s_barrier
    v_mfma_f32_32x32x16_bf16 v[128:143], v[80:83], v[76:79], v[128:143]
    ds_read_b128 v[40:43], v19 offset:16384
    ds_read_b64_tr_b16 v[44:45], v25 offset:16384
    ds_read_b64_tr_b16 v[46:47], v25 offset:18432
    v_mul_f32 v121, v123, v126
    v_cvt_pk_bf16_f32 v124, v120, v121
    v_lshlrev_b32 v118, 16, v124
    v_mfma_f32_32x32x16_bf16 v[144:159], v[84:87], v[76:79], v[144:159]
    ds_read_b64_tr_b16 v[48:49], v26 offset:16384
    ds_read_b64_tr_b16 v[50:51], v26 offset:18432
    ds_read_b64_tr_b16 v[52:53], v27 offset:16384
    s_add_u32 m0, s32, 32768
    s_mov_b32 s33, 3407872
    buffer_load_dwordx4 v5, s[20:23], s33 offen lds
    v_and_b32 v119, 0xffff0000, v124
    v_accvgpr_read_b32 v125, a9
    v_accvgpr_read_b32 v126, a11
    v_mfma_f32_32x32x16_bf16 v[160:175], v[88:91], v[76:79], v[160:175]
    ds_read_b64_tr_b16 v[54:55], v27 offset:18432
    ds_read_b64_tr_b16 v[56:57], v28 offset:16384
    ds_read_b64_tr_b16 v[58:59], v28 offset:18432
    v_lshlrev_b32 v125, 16, v125
    v_lshlrev_b32 v126, 16, v126
    v_accvgpr_read_b32 v124, a26
    v_mfma_f32_32x32x16_bf16 v[176:191], v[92:95], v[76:79], v[176:191]
    ds_read_b64_tr_b16 v[60:61], v25 offset:16640
    ds_read_b64_tr_b16 v[62:63], v25 offset:18688
    ds_read_b64_tr_b16 v[64:65], v26 offset:16640
    buffer_load_dwordx4 v6, s[20:23], s33 offen offset:1024 lds
    v_lshlrev_b32 v122, 16, v124
    v_and_b32 v123, 0xffff0000, v124
    v_mul_f32 v120, v122, v125
    v_mfma_f32_32x32x16_bf16 v[192:207], v[96:99], v[76:79], v[192:207]
    ds_read_b64_tr_b16 v[66:67], v26 offset:18688
    ds_read_b64_tr_b16 v[68:69], v27 offset:16640
    ds_read_b64_tr_b16 v[70:71], v27 offset:18688
    v_mul_f32 v121, v123, v126
    v_cvt_pk_bf16_f32 v124, v120, v121
    v_lshlrev_b32 v120, 16, v124
    v_mfma_f32_32x32x16_bf16 v[208:223], v[100:103], v[76:79], v[208:223]
    ds_read_b64_tr_b16 v[72:73], v28 offset:16640
    ds_read_b64_tr_b16 v[74:75], v28 offset:18688
    buffer_load_dwordx4 v7, s[20:23], s33 offen offset:2048 lds
    v_and_b32 v121, 0xffff0000, v124
    v_add_f32 v116, v116, v120
    v_add_f32 v117, v117, v121
    v_mfma_f32_32x32x16_bf16 v[224:239], v[104:107], v[76:79], v[224:239]
    v_cvt_pk_bf16_f32 v124, v116, v117
    v_lshlrev_b32 v116, 16, v124
    v_and_b32 v117, 0xffff0000, v124
    v_mfma_f32_32x32x16_bf16 v[240:255], v[108:111], v[76:79], v[240:255]
    buffer_load_dwordx4 v8, s[20:23], s33 offen offset:3072 lds
    v_accvgpr_read_b32 v124, a46
    v_lshlrev_b32 v122, 16, v124
    v_and_b32 v123, 0xffff0000, v124
    s_waitcnt lgkmcnt(12)
    v_mfma_f32_32x32x16_bf16 v[128:143], v[44:47], v[40:43], v[128:143]
    ds_read_b128 v[76:79], v20 offset:16384
    ds_read_b64_tr_b16 v[80:81], v25 offset:24576
    ds_read_b64_tr_b16 v[82:83], v25 offset:26624
    v_mul_f32 v120, v122, v125
    v_mul_f32 v121, v123, v126
    v_cvt_pk_bf16_f32 v124, v120, v121
    v_mfma_f32_32x32x16_bf16 v[144:159], v[48:51], v[40:43], v[144:159]
    ds_read_b64_tr_b16 v[84:85], v26 offset:24576
    ds_read_b64_tr_b16 v[86:87], v26 offset:26624
    ds_read_b64_tr_b16 v[88:89], v27 offset:24576
    s_add_u32 m0, s32, 65536
    s_mov_b32 s33, 0
    buffer_load_dwordx4 v1, s[8:11], s33 offen lds
    v_lshlrev_b32 v120, 16, v124
    v_and_b32 v121, 0xffff0000, v124
    v_add_f32 v118, v118, v120
    s_waitcnt lgkmcnt(14)
    v_mfma_f32_32x32x16_bf16 v[160:175], v[52:55], v[40:43], v[160:175]
    ds_read_b64_tr_b16 v[90:91], v27 offset:26624
    ds_read_b64_tr_b16 v[92:93], v28 offset:24576
    ds_read_b64_tr_b16 v[94:95], v28 offset:26624
    v_add_f32 v119, v119, v121
    v_cvt_pk_bf16_f32 v124, v118, v119
    v_lshlrev_b32 v118, 16, v124
    v_mfma_f32_32x32x16_bf16 v[176:191], v[56:59], v[40:43], v[176:191]
    ds_read_b64_tr_b16 v[96:97], v25 offset:24832
    ds_read_b64_tr_b16 v[98:99], v25 offset:26880
    ds_read_b64_tr_b16 v[100:101], v26 offset:24832
    buffer_load_dwordx4 v2, s[8:11], s33 offen offset:1024 lds
    v_and_b32 v119, 0xffff0000, v124
    v_accvgpr_read_b32 v125, a8
    v_accvgpr_read_b32 v126, a10
    s_waitcnt lgkmcnt(15)
    v_mfma_f32_32x32x16_bf16 v[192:207], v[60:63], v[40:43], v[192:207]
    ds_read_b64_tr_b16 v[102:103], v26 offset:26880
    ds_read_b64_tr_b16 v[104:105], v27 offset:24832
    ds_read_b64_tr_b16 v[106:107], v27 offset:26880
    v_and_b32 v125, 0xffff0000, v125
    v_and_b32 v126, 0xffff0000, v126
    v_accvgpr_read_b32 v124, a22
    v_mfma_f32_32x32x16_bf16 v[208:223], v[64:67], v[40:43], v[208:223]
    ds_read_b64_tr_b16 v[108:109], v28 offset:24832
    ds_read_b64_tr_b16 v[110:111], v28 offset:26880
    buffer_load_dwordx4 v3, s[8:11], s33 offen offset:2048 lds
    v_lshlrev_b32 v122, 16, v124
    v_and_b32 v123, 0xffff0000, v124
    v_mul_f32 v120, v122, v125
    s_waitcnt lgkmcnt(15)
    v_mfma_f32_32x32x16_bf16 v[224:239], v[68:71], v[40:43], v[224:239]
    v_mul_f32 v121, v123, v126
    v_cvt_pk_bf16_f32 v124, v120, v121
    v_lshlrev_b32 v120, 16, v124
    v_mfma_f32_32x32x16_bf16 v[240:255], v[72:75], v[40:43], v[240:255]
    buffer_load_dwordx4 v4, s[8:11], s33 offen offset:3072 lds
    v_and_b32 v121, 0xffff0000, v124
    v_add_f32 v116, v116, v120
    v_add_f32 v117, v117, v121
    s_waitcnt vmcnt(20) lgkmcnt(0)
    s_barrier
    v_mfma_f32_32x32x16_bf16 v[128:143], v[80:83], v[76:79], v[128:143]
    ds_read_b128 v[40:43], v17 offset:32768
    ds_read_b64_tr_b16 v[44:45], v25 offset:49152
    ds_read_b64_tr_b16 v[46:47], v25 offset:51200
    s_add_u32 m0, s32, 81920
    s_mov_b32 s33, 262144
    buffer_load_dwordx4 v1, s[8:11], s33 offen lds
    v_cvt_pk_bf16_f32 v124, v116, v117
    v_lshlrev_b32 v116, 16, v124
    v_and_b32 v117, 0xffff0000, v124
    v_mfma_f32_32x32x16_bf16 v[144:159], v[84:87], v[76:79], v[144:159]
    ds_read_b64_tr_b16 v[48:49], v26 offset:49152
    ds_read_b64_tr_b16 v[50:51], v26 offset:51200
    ds_read_b64_tr_b16 v[52:53], v27 offset:49152
    buffer_load_dwordx4 v2, s[8:11], s33 offen offset:1024 lds
    v_accvgpr_read_b32 v124, a42
    v_lshlrev_b32 v122, 16, v124
    v_and_b32 v123, 0xffff0000, v124
    v_mfma_f32_32x32x16_bf16 v[160:175], v[88:91], v[76:79], v[160:175]
    ds_read_b64_tr_b16 v[54:55], v27 offset:51200
    ds_read_b64_tr_b16 v[56:57], v28 offset:49152
    ds_read_b64_tr_b16 v[58:59], v28 offset:51200
    buffer_load_dwordx4 v3, s[8:11], s33 offen offset:2048 lds
    v_mul_f32 v120, v122, v125
    v_mul_f32 v121, v123, v126
    v_cvt_pk_bf16_f32 v124, v120, v121
    v_mfma_f32_32x32x16_bf16 v[176:191], v[92:95], v[76:79], v[176:191]
    ds_read_b64_tr_b16 v[60:61], v25 offset:49408
    ds_read_b64_tr_b16 v[62:63], v25 offset:51456
    ds_read_b64_tr_b16 v[64:65], v26 offset:49408
    v_lshlrev_b32 v120, 16, v124
    v_and_b32 v121, 0xffff0000, v124
    v_add_f32 v118, v118, v120
    v_mfma_f32_32x32x16_bf16 v[192:207], v[96:99], v[76:79], v[192:207]
    ds_read_b64_tr_b16 v[66:67], v26 offset:51456
    ds_read_b64_tr_b16 v[68:69], v27 offset:49408
    ds_read_b64_tr_b16 v[70:71], v27 offset:51456
    buffer_load_dwordx4 v4, s[8:11], s33 offen offset:3072 lds
    v_add_f32 v119, v119, v121
    v_cvt_pk_bf16_f32 v124, v118, v119
    v_lshlrev_b32 v118, 16, v124
    v_mfma_f32_32x32x16_bf16 v[208:223], v[100:103], v[76:79], v[208:223]
    ds_read_b64_tr_b16 v[72:73], v28 offset:49408
    ds_read_b64_tr_b16 v[74:75], v28 offset:51456
    s_add_u32 m0, s32, 0
    s_mov_b32 s33, 0
    buffer_load_dwordx4 v5, s[12:15], s33 offen lds
    v_and_b32 v119, 0xffff0000, v124
    v_accvgpr_read_b32 v125, a8
    v_accvgpr_read_b32 v126, a10
    v_mfma_f32_32x32x16_bf16 v[224:239], v[104:107], v[76:79], v[224:239]
    buffer_load_dwordx4 v6, s[12:15], s33 offen offset:1024 lds
    v_lshlrev_b32 v125, 16, v125
    v_lshlrev_b32 v126, 16, v126
    v_accvgpr_read_b32 v124, a18
    v_mfma_f32_32x32x16_bf16 v[240:255], v[108:111], v[76:79], v[240:255]
    v_lshlrev_b32 v122, 16, v124
    v_and_b32 v123, 0xffff0000, v124
    v_mul_f32 v120, v122, v125
    s_waitcnt lgkmcnt(12)
    v_mfma_f32_32x32x16_bf16 v[128:143], v[44:47], v[40:43], v[128:143]
    ds_read_b128 v[76:79], v18 offset:32768
    ds_read_b64_tr_b16 v[80:81], v25 offset:57344
    ds_read_b64_tr_b16 v[82:83], v25 offset:59392
    buffer_load_dwordx4 v7, s[12:15], s33 offen offset:2048 lds
    v_mul_f32 v121, v123, v126
    v_cvt_pk_bf16_f32 v124, v120, v121
    v_lshlrev_b32 v120, 16, v124
    v_mfma_f32_32x32x16_bf16 v[144:159], v[48:51], v[40:43], v[144:159]
    ds_read_b64_tr_b16 v[84:85], v26 offset:57344
    ds_read_b64_tr_b16 v[86:87], v26 offset:59392
    ds_read_b64_tr_b16 v[88:89], v27 offset:57344
    buffer_load_dwordx4 v8, s[12:15], s33 offen offset:3072 lds
    v_and_b32 v121, 0xffff0000, v124
    v_add_f32 v116, v116, v120
    v_add_f32 v117, v117, v121
    s_waitcnt lgkmcnt(14)
    v_mfma_f32_32x32x16_bf16 v[160:175], v[52:55], v[40:43], v[160:175]
    ds_read_b64_tr_b16 v[90:91], v27 offset:59392
    ds_read_b64_tr_b16 v[92:93], v28 offset:57344
    ds_read_b64_tr_b16 v[94:95], v28 offset:59392
    s_add_u32 m0, s32, 16384
    s_mov_b32 s33, 262144
    buffer_load_dwordx4 v5, s[12:15], s33 offen lds
    v_cvt_pk_bf16_f32 v124, v116, v117
    v_lshlrev_b32 v116, 16, v124
    v_and_b32 v117, 0xffff0000, v124
    v_mfma_f32_32x32x16_bf16 v[176:191], v[56:59], v[40:43], v[176:191]
    ds_read_b64_tr_b16 v[96:97], v25 offset:57600
    ds_read_b64_tr_b16 v[98:99], v25 offset:59648
    ds_read_b64_tr_b16 v[100:101], v26 offset:57600
    v_accvgpr_read_b32 v124, a38
    v_lshlrev_b32 v122, 16, v124
    v_and_b32 v123, 0xffff0000, v124
    s_waitcnt lgkmcnt(15)
    v_mfma_f32_32x32x16_bf16 v[192:207], v[60:63], v[40:43], v[192:207]
    ds_read_b64_tr_b16 v[102:103], v26 offset:59648
    ds_read_b64_tr_b16 v[104:105], v27 offset:57600
    ds_read_b64_tr_b16 v[106:107], v27 offset:59648
    buffer_load_dwordx4 v6, s[12:15], s33 offen offset:1024 lds
    v_mul_f32 v120, v122, v125
    v_mul_f32 v121, v123, v126
    v_cvt_pk_bf16_f32 v124, v120, v121
    v_mfma_f32_32x32x16_bf16 v[208:223], v[64:67], v[40:43], v[208:223]
    ds_read_b64_tr_b16 v[108:109], v28 offset:57600
    ds_read_b64_tr_b16 v[110:111], v28 offset:59648
    buffer_load_dwordx4 v7, s[12:15], s33 offen offset:2048 lds
    v_lshlrev_b32 v120, 16, v124
    v_and_b32 v121, 0xffff0000, v124
    v_add_f32 v118, v118, v120
    s_waitcnt lgkmcnt(15)
    v_mfma_f32_32x32x16_bf16 v[224:239], v[68:71], v[40:43], v[224:239]
    buffer_load_dwordx4 v8, s[12:15], s33 offen offset:3072 lds
    v_add_f32 v119, v119, v121
    v_cvt_pk_bf16_f32 v124, v118, v119
    v_lshlrev_b32 v118, 16, v124
    v_mfma_f32_32x32x16_bf16 v[240:255], v[72:75], v[40:43], v[240:255]
    v_and_b32 v119, 0xffff0000, v124
    v_accvgpr_read_b32 v124, a34
    v_lshlrev_b32 v122, 16, v124
    s_waitcnt vmcnt(28) lgkmcnt(0)
    s_barrier
    v_mfma_f32_32x32x16_bf16 v[128:143], v[80:83], v[76:79], v[128:143]
    ds_read_b128 v[40:43], v19 offset:32768
    ds_read_b64_tr_b16 v[44:45], v29 offset:49152
    ds_read_b64_tr_b16 v[46:47], v29 offset:51200
    v_and_b32 v123, 0xffff0000, v124
    v_mul_f32 v116, v116, v122
    v_mul_f32 v117, v117, v123
    v_mfma_f32_32x32x16_bf16 v[144:159], v[84:87], v[76:79], v[144:159]
    ds_read_b64_tr_b16 v[48:49], v30 offset:49152
    ds_read_b64_tr_b16 v[50:51], v30 offset:51200
    ds_read_b64_tr_b16 v[52:53], v31 offset:49152
    v_cvt_pk_bf16_f32 v124, v116, v117
    v_accvgpr_write_b32 a34, v124
    v_accvgpr_read_b32 v124, a54
    v_mfma_f32_32x32x16_bf16 v[160:175], v[88:91], v[76:79], v[160:175]
    ds_read_b64_tr_b16 v[54:55], v31 offset:51200
    ds_read_b64_tr_b16 v[56:57], v32 offset:49152
    ds_read_b64_tr_b16 v[58:59], v32 offset:51200
    v_lshlrev_b32 v122, 16, v124
    v_and_b32 v123, 0xffff0000, v124
    v_mul_f32 v118, v118, v122
    v_mfma_f32_32x32x16_bf16 v[176:191], v[92:95], v[76:79], v[176:191]
    ds_read_b64_tr_b16 v[60:61], v29 offset:49408
    ds_read_b64_tr_b16 v[62:63], v29 offset:51456
    ds_read_b64_tr_b16 v[64:65], v30 offset:49408
    v_mul_f32 v119, v119, v123
    v_cvt_pk_bf16_f32 v124, v118, v119
    v_accvgpr_write_b32 a54, v124
    v_mfma_f32_32x32x16_bf16 v[192:207], v[96:99], v[76:79], v[192:207]
    ds_read_b64_tr_b16 v[66:67], v30 offset:51456
    ds_read_b64_tr_b16 v[68:69], v31 offset:49408
    ds_read_b64_tr_b16 v[70:71], v31 offset:51456
    v_accvgpr_read_b32 v125, a13
    v_accvgpr_read_b32 v126, a15
    v_and_b32 v125, 0xffff0000, v125
    v_mfma_f32_32x32x16_bf16 v[208:223], v[100:103], v[76:79], v[208:223]
    ds_read_b64_tr_b16 v[72:73], v32 offset:49408
    ds_read_b64_tr_b16 v[74:75], v32 offset:51456
    v_and_b32 v126, 0xffff0000, v126
    v_accvgpr_read_b32 v124, a31
    v_lshlrev_b32 v122, 16, v124
    v_mfma_f32_32x32x16_bf16 v[224:239], v[104:107], v[76:79], v[224:239]
    v_and_b32 v123, 0xffff0000, v124
    v_mul_f32 v120, v122, v125
    v_mul_f32 v121, v123, v126
    v_mfma_f32_32x32x16_bf16 v[240:255], v[108:111], v[76:79], v[240:255]
    v_cvt_pk_bf16_f32 v124, v120, v121
    v_lshlrev_b32 v116, 16, v124
    v_and_b32 v117, 0xffff0000, v124
    s_waitcnt lgkmcnt(12)
    v_mfma_f32_32x32x16_bf16 v[128:143], v[44:47], v[40:43], v[128:143]
    ds_read_b128 v[76:79], v20 offset:32768
    ds_read_b64_tr_b16 v[80:81], v29 offset:57344
    ds_read_b64_tr_b16 v[82:83], v29 offset:59392
    v_accvgpr_read_b32 v124, a51
    v_lshlrev_b32 v122, 16, v124
    v_and_b32 v123, 0xffff0000, v124
    v_mfma_f32_32x32x16_bf16 v[144:159], v[48:51], v[40:43], v[144:159]
    ds_read_b64_tr_b16 v[84:85], v30 offset:57344
    ds_read_b64_tr_b16 v[86:87], v30 offset:59392
    ds_read_b64_tr_b16 v[88:89], v31 offset:57344
    v_mul_f32 v120, v122, v125
    v_mul_f32 v121, v123, v126
    v_cvt_pk_bf16_f32 v124, v120, v121
    s_waitcnt lgkmcnt(14)
    v_mfma_f32_32x32x16_bf16 v[160:175], v[52:55], v[40:43], v[160:175]
    ds_read_b64_tr_b16 v[90:91], v31 offset:59392
    ds_read_b64_tr_b16 v[92:93], v32 offset:57344
    ds_read_b64_tr_b16 v[94:95], v32 offset:59392
    v_lshlrev_b32 v118, 16, v124
    v_and_b32 v119, 0xffff0000, v124
    v_accvgpr_read_b32 v125, a13
    v_mfma_f32_32x32x16_bf16 v[176:191], v[56:59], v[40:43], v[176:191]
    ds_read_b64_tr_b16 v[96:97], v29 offset:57600
    ds_read_b64_tr_b16 v[98:99], v29 offset:59648
    ds_read_b64_tr_b16 v[100:101], v30 offset:57600
    v_accvgpr_read_b32 v126, a15
    v_lshlrev_b32 v125, 16, v125
    v_lshlrev_b32 v126, 16, v126
    s_waitcnt lgkmcnt(15)
    v_mfma_f32_32x32x16_bf16 v[192:207], v[60:63], v[40:43], v[192:207]
    ds_read_b64_tr_b16 v[102:103], v30 offset:59648
    ds_read_b64_tr_b16 v[104:105], v31 offset:57600
    ds_read_b64_tr_b16 v[106:107], v31 offset:59648
    v_accvgpr_read_b32 v124, a27
    v_lshlrev_b32 v122, 16, v124
    v_and_b32 v123, 0xffff0000, v124
    v_mfma_f32_32x32x16_bf16 v[208:223], v[64:67], v[40:43], v[208:223]
    ds_read_b64_tr_b16 v[108:109], v32 offset:57600
    ds_read_b64_tr_b16 v[110:111], v32 offset:59648
    v_mul_f32 v120, v122, v125
    v_mul_f32 v121, v123, v126
    v_cvt_pk_bf16_f32 v124, v120, v121
    s_waitcnt lgkmcnt(15)
    v_mfma_f32_32x32x16_bf16 v[224:239], v[68:71], v[40:43], v[224:239]
    v_lshlrev_b32 v120, 16, v124
    v_and_b32 v121, 0xffff0000, v124
    v_add_f32 v116, v116, v120
    v_mfma_f32_32x32x16_bf16 v[240:255], v[72:75], v[40:43], v[240:255]
    v_add_f32 v117, v117, v121
    v_cvt_pk_bf16_f32 v124, v116, v117
    v_lshlrev_b32 v116, 16, v124
    s_waitcnt vmcnt(20) lgkmcnt(0)
    s_barrier
    v_mfma_f32_32x32x16_bf16 v[128:143], v[80:83], v[76:79], v[128:143]
    ds_read_b128 v[40:43], v21 offset:0
    ds_read_b64_tr_b16 v[44:45], v33 offset:16384
    ds_read_b64_tr_b16 v[46:47], v33 offset:18432
    v_and_b32 v117, 0xffff0000, v124
    v_accvgpr_read_b32 v124, a47
    v_lshlrev_b32 v122, 16, v124
    v_mfma_f32_32x32x16_bf16 v[144:159], v[84:87], v[76:79], v[144:159]
    ds_read_b64_tr_b16 v[48:49], v34 offset:16384
    ds_read_b64_tr_b16 v[50:51], v34 offset:18432
    ds_read_b64_tr_b16 v[52:53], v35 offset:16384
    s_add_u32 m0, s32, 98304
    s_mov_b32 s33, 128
    buffer_load_dwordx4 v1, s[8:11], s33 offen lds
    v_and_b32 v123, 0xffff0000, v124
    v_mul_f32 v120, v122, v125
    v_mul_f32 v121, v123, v126
    v_mfma_f32_32x32x16_bf16 v[160:175], v[88:91], v[76:79], v[160:175]
    ds_read_b64_tr_b16 v[54:55], v35 offset:18432
    ds_read_b64_tr_b16 v[56:57], v36 offset:16384
    ds_read_b64_tr_b16 v[58:59], v36 offset:18432
    v_cvt_pk_bf16_f32 v124, v120, v121
    v_lshlrev_b32 v120, 16, v124
    v_and_b32 v121, 0xffff0000, v124
    v_mfma_f32_32x32x16_bf16 v[176:191], v[92:95], v[76:79], v[176:191]
    ds_read_b64_tr_b16 v[60:61], v33 offset:16640
    ds_read_b64_tr_b16 v[62:63], v33 offset:18688
    ds_read_b64_tr_b16 v[64:65], v34 offset:16640
    buffer_load_dwordx4 v2, s[8:11], s33 offen offset:1024 lds
    v_add_f32 v118, v118, v120
    v_add_f32 v119, v119, v121
    v_cvt_pk_bf16_f32 v124, v118, v119
    v_mfma_f32_32x32x16_bf16 v[192:207], v[96:99], v[76:79], v[192:207]
    ds_read_b64_tr_b16 v[66:67], v34 offset:18688
    ds_read_b64_tr_b16 v[68:69], v35 offset:16640
    ds_read_b64_tr_b16 v[70:71], v35 offset:18688
    v_lshlrev_b32 v118, 16, v124
    v_and_b32 v119, 0xffff0000, v124
    v_accvgpr_read_b32 v125, a12
    v_mfma_f32_32x32x16_bf16 v[208:223], v[100:103], v[76:79], v[208:223]
    ds_read_b64_tr_b16 v[72:73], v36 offset:16640
    ds_read_b64_tr_b16 v[74:75], v36 offset:18688
    buffer_load_dwordx4 v3, s[8:11], s33 offen offset:2048 lds
    v_accvgpr_read_b32 v126, a14
    v_and_b32 v125, 0xffff0000, v125
    v_and_b32 v126, 0xffff0000, v126
    v_mfma_f32_32x32x16_bf16 v[224:239], v[104:107], v[76:79], v[224:239]
    v_accvgpr_read_b32 v124, a23
    v_lshlrev_b32 v122, 16, v124
    v_and_b32 v123, 0xffff0000, v124
    v_mfma_f32_32x32x16_bf16 v[240:255], v[108:111], v[76:79], v[240:255]
    buffer_load_dwordx4 v4, s[8:11], s33 offen offset:3072 lds
    v_mul_f32 v120, v122, v125
    v_mul_f32 v121, v123, v126
    v_cvt_pk_bf16_f32 v124, v120, v121
    s_waitcnt lgkmcnt(12)
    v_mfma_f32_32x32x16_bf16 v[128:143], v[44:47], v[40:43], v[128:143]
    ds_read_b128 v[76:79], v22 offset:0
    ds_read_b64_tr_b16 v[80:81], v33 offset:24576
    ds_read_b64_tr_b16 v[82:83], v33 offset:26624
    v_lshlrev_b32 v120, 16, v124
    v_and_b32 v121, 0xffff0000, v124
    v_add_f32 v116, v116, v120
    v_mfma_f32_32x32x16_bf16 v[144:159], v[48:51], v[40:43], v[144:159]
    ds_read_b64_tr_b16 v[84:85], v34 offset:24576
    ds_read_b64_tr_b16 v[86:87], v34 offset:26624
    ds_read_b64_tr_b16 v[88:89], v35 offset:24576
    s_add_u32 m0, s32, 114688
    s_mov_b32 s33, 262272
    buffer_load_dwordx4 v1, s[8:11], s33 offen lds
    v_add_f32 v117, v117, v121
    v_cvt_pk_bf16_f32 v124, v116, v117
    v_lshlrev_b32 v116, 16, v124
    s_waitcnt lgkmcnt(14)
    v_mfma_f32_32x32x16_bf16 v[160:175], v[52:55], v[40:43], v[160:175]
    ds_read_b64_tr_b16 v[90:91], v35 offset:26624
    ds_read_b64_tr_b16 v[92:93], v36 offset:24576
    ds_read_b64_tr_b16 v[94:95], v36 offset:26624
    v_and_b32 v117, 0xffff0000, v124
    v_accvgpr_read_b32 v124, a43
    v_lshlrev_b32 v122, 16, v124
    v_mfma_f32_32x32x16_bf16 v[176:191], v[56:59], v[40:43], v[176:191]
    ds_read_b64_tr_b16 v[96:97], v33 offset:24832
    ds_read_b64_tr_b16 v[98:99], v33 offset:26880
    ds_read_b64_tr_b16 v[100:101], v34 offset:24832
    buffer_load_dwordx4 v2, s[8:11], s33 offen offset:1024 lds
    v_and_b32 v123, 0xffff0000, v124
    v_mul_f32 v120, v122, v125
    v_mul_f32 v121, v123, v126
    s_waitcnt lgkmcnt(15)
    v_mfma_f32_32x32x16_bf16 v[192:207], v[60:63], v[40:43], v[192:207]
    ds_read_b64_tr_b16 v[102:103], v34 offset:26880
    ds_read_b64_tr_b16 v[104:105], v35 offset:24832
    ds_read_b64_tr_b16 v[106:107], v35 offset:26880
    v_cvt_pk_bf16_f32 v124, v120, v121
    v_lshlrev_b32 v120, 16, v124
    v_and_b32 v121, 0xffff0000, v124
    v_mfma_f32_32x32x16_bf16 v[208:223], v[64:67], v[40:43], v[208:223]
    ds_read_b64_tr_b16 v[108:109], v36 offset:24832
    ds_read_b64_tr_b16 v[110:111], v36 offset:26880
    buffer_load_dwordx4 v3, s[8:11], s33 offen offset:2048 lds
    v_add_f32 v118, v118, v120
    v_add_f32 v119, v119, v121
    v_cvt_pk_bf16_f32 v124, v118, v119
    s_waitcnt lgkmcnt(15)
    v_mfma_f32_32x32x16_bf16 v[224:239], v[68:71], v[40:43], v[224:239]
    v_lshlrev_b32 v118, 16, v124
    v_and_b32 v119, 0xffff0000, v124
    v_accvgpr_read_b32 v125, a12
    v_mfma_f32_32x32x16_bf16 v[240:255], v[72:75], v[40:43], v[240:255]
    buffer_load_dwordx4 v4, s[8:11], s33 offen offset:3072 lds
    v_accvgpr_read_b32 v126, a14
    v_lshlrev_b32 v125, 16, v125
    v_lshlrev_b32 v126, 16, v126
    s_waitcnt vmcnt(24) lgkmcnt(0)
    s_barrier
    v_mfma_f32_32x32x16_bf16 v[128:143], v[80:83], v[76:79], v[128:143]
    ds_read_b128 v[40:43], v23 offset:0
    ds_read_b64_tr_b16 v[44:45], v25 offset:32768
    ds_read_b64_tr_b16 v[46:47], v25 offset:34816
    v_accvgpr_read_b32 v124, a19
    v_lshlrev_b32 v122, 16, v124
    v_and_b32 v123, 0xffff0000, v124
    v_mfma_f32_32x32x16_bf16 v[144:159], v[84:87], v[76:79], v[144:159]
    ds_read_b64_tr_b16 v[48:49], v26 offset:32768
    ds_read_b64_tr_b16 v[50:51], v26 offset:34816
    ds_read_b64_tr_b16 v[52:53], v27 offset:32768
    v_mul_f32 v120, v122, v125
    v_mul_f32 v121, v123, v126
    v_cvt_pk_bf16_f32 v124, v120, v121
    v_mfma_f32_32x32x16_bf16 v[160:175], v[88:91], v[76:79], v[160:175]
    ds_read_b64_tr_b16 v[54:55], v27 offset:34816
    ds_read_b64_tr_b16 v[56:57], v28 offset:32768
    ds_read_b64_tr_b16 v[58:59], v28 offset:34816
    v_lshlrev_b32 v120, 16, v124
    v_and_b32 v121, 0xffff0000, v124
    v_add_f32 v116, v116, v120
    v_mfma_f32_32x32x16_bf16 v[176:191], v[92:95], v[76:79], v[176:191]
    ds_read_b64_tr_b16 v[60:61], v25 offset:33024
    ds_read_b64_tr_b16 v[62:63], v25 offset:35072
    ds_read_b64_tr_b16 v[64:65], v26 offset:33024
    v_add_f32 v117, v117, v121
    v_cvt_pk_bf16_f32 v124, v116, v117
    v_lshlrev_b32 v116, 16, v124
    v_mfma_f32_32x32x16_bf16 v[192:207], v[96:99], v[76:79], v[192:207]
    ds_read_b64_tr_b16 v[66:67], v26 offset:35072
    ds_read_b64_tr_b16 v[68:69], v27 offset:33024
    ds_read_b64_tr_b16 v[70:71], v27 offset:35072
    v_and_b32 v117, 0xffff0000, v124
    v_accvgpr_read_b32 v124, a39
    v_lshlrev_b32 v122, 16, v124
    v_mfma_f32_32x32x16_bf16 v[208:223], v[100:103], v[76:79], v[208:223]
    ds_read_b64_tr_b16 v[72:73], v28 offset:33024
    ds_read_b64_tr_b16 v[74:75], v28 offset:35072
    v_and_b32 v123, 0xffff0000, v124
    v_mul_f32 v120, v122, v125
    v_mul_f32 v121, v123, v126
    v_mfma_f32_32x32x16_bf16 v[224:239], v[104:107], v[76:79], v[224:239]
    v_cvt_pk_bf16_f32 v124, v120, v121
    v_lshlrev_b32 v120, 16, v124
    v_and_b32 v121, 0xffff0000, v124
    v_mfma_f32_32x32x16_bf16 v[240:255], v[108:111], v[76:79], v[240:255]
    v_add_f32 v118, v118, v120
    v_add_f32 v119, v119, v121
    v_cvt_pk_bf16_f32 v124, v118, v119
    s_waitcnt lgkmcnt(12)
    v_mfma_f32_32x32x16_bf16 v[128:143], v[44:47], v[40:43], v[128:143]
    ds_read_b128 v[76:79], v24 offset:0
    ds_read_b64_tr_b16 v[80:81], v25 offset:40960
    ds_read_b64_tr_b16 v[82:83], v25 offset:43008
    v_lshlrev_b32 v118, 16, v124
    v_and_b32 v119, 0xffff0000, v124
    v_accvgpr_read_b32 v124, a35
    v_mfma_f32_32x32x16_bf16 v[144:159], v[48:51], v[40:43], v[144:159]
    ds_read_b64_tr_b16 v[84:85], v26 offset:40960
    ds_read_b64_tr_b16 v[86:87], v26 offset:43008
    ds_read_b64_tr_b16 v[88:89], v27 offset:40960
    v_lshlrev_b32 v122, 16, v124
    v_and_b32 v123, 0xffff0000, v124
    v_mul_f32 v116, v116, v122
    s_waitcnt lgkmcnt(14)
    v_mfma_f32_32x32x16_bf16 v[160:175], v[52:55], v[40:43], v[160:175]
    ds_read_b64_tr_b16 v[90:91], v27 offset:43008
    ds_read_b64_tr_b16 v[92:93], v28 offset:40960
    ds_read_b64_tr_b16 v[94:95], v28 offset:43008
    v_mul_f32 v117, v117, v123
    v_cvt_pk_bf16_f32 v124, v116, v117
    v_accvgpr_write_b32 a35, v124
    v_mfma_f32_32x32x16_bf16 v[176:191], v[56:59], v[40:43], v[176:191]
    ds_read_b64_tr_b16 v[96:97], v25 offset:41216
    ds_read_b64_tr_b16 v[98:99], v25 offset:43264
    ds_read_b64_tr_b16 v[100:101], v26 offset:41216
    v_accvgpr_read_b32 v124, a55
    v_lshlrev_b32 v122, 16, v124
    v_and_b32 v123, 0xffff0000, v124
    s_waitcnt lgkmcnt(15)
    v_mfma_f32_32x32x16_bf16 v[192:207], v[60:63], v[40:43], v[192:207]
    ds_read_b64_tr_b16 v[102:103], v26 offset:43264
    ds_read_b64_tr_b16 v[104:105], v27 offset:41216
    ds_read_b64_tr_b16 v[106:107], v27 offset:43264
    v_mul_f32 v118, v118, v122
    v_mul_f32 v119, v119, v123
    v_cvt_pk_bf16_f32 v124, v118, v119
    v_mfma_f32_32x32x16_bf16 v[208:223], v[64:67], v[40:43], v[208:223]
    ds_read_b64_tr_b16 v[108:109], v28 offset:41216
    ds_read_b64_tr_b16 v[110:111], v28 offset:43264
    v_accvgpr_write_b32 a55, v124
    buffer_store_dwordx4 a[32:35], v127, s[72:75], 0 offen offset:0 sc1
    buffer_store_dwordx4 a[52:55], v127, s[72:75], 0 offen offset:512 sc1
    s_waitcnt lgkmcnt(15)
    v_mfma_f32_32x32x16_bf16 v[224:239], v[68:71], v[40:43], v[224:239]
    s_mov_b32 s60, s92
    s_mov_b32 s61, s93
    s_mov_b32 s62, 256
    s_mov_b32 s63, 0x20000
    s_add_u32 s64, s46, 96468992
    s_addc_u32 s65, s47, 0
    s_mov_b32 s66, 8192
    s_mov_b32 s67, 0x20000
    s_cmp_eq_u32 s2, 0
    s_cselect_b32 s66, 8192, 0
    s_movk_i32 s55, 0x1000
    v_mov_b32 v120, 0
    v_mov_b32 v121, 0
    v_mov_b32 v122, 0
    v_mov_b32 v123, 0
    v_lshlrev_b32 v124, 4, v0
    buffer_store_dwordx4 v[120:123], v124, s[64:67], 0 offen sc1
    buffer_store_dwordx4 v[120:123], v124, s[64:67], s55 offen sc1
    s_mov_b32 s66, 8192
    v_mfma_f32_32x32x16_bf16 v[240:255], v[72:75], v[40:43], v[240:255]
    s_waitcnt vmcnt(16) lgkmcnt(0)
    s_barrier
    s_and_b32 s55, s54, 1
    s_lshl_b32 s55, s55, 14
    s_sub_u32 s55, s55, s32
    s_lshr_b32 s56, s54, 1
    s_lshl_b32 s56, s56, 8
    v_add_u32 v13, s55, v13
    v_add_u32 v14, s55, v14
    v_add_u32 v15, s55, v15
    v_add_u32 v16, s55, v16
    v_add_u32 v17, s55, v17
    v_add_u32 v18, s55, v18
    v_add_u32 v19, s55, v19
    v_add_u32 v20, s55, v20
    v_add_u32 v21, s55, v21
    v_add_u32 v22, s55, v22
    v_add_u32 v23, s55, v23
    v_add_u32 v24, s55, v24
    v_add_u32 v25, s56, v25
    v_add_u32 v26, s56, v26
    v_add_u32 v27, s56, v27
    v_add_u32 v28, s56, v28
    v_add_u32 v29, s56, v29
    v_add_u32 v30, s56, v30
    v_add_u32 v31, s56, v31
    v_add_u32 v32, s56, v32
    v_add_u32 v33, s56, v33
    v_add_u32 v34, s56, v34
    v_add_u32 v35, s56, v35
    v_add_u32 v36, s56, v36
    v_mfma_f32_32x32x16_bf16 v[128:143], v[80:83], v[76:79], v[128:143]
    ds_read_b128 v[40:43], v17 offset:0
    ds_read_b64_tr_b16 v[56:57], v25 offset:0
    s_add_u32 m0, s32, 32768
    s_mov_b32 s33, 524288
    buffer_load_dwordx4 v5, s[12:15], s33 offen lds
    v_mfma_f32_32x32x16_bf16 v[144:159], v[84:87], v[76:79], v[144:159]
    ds_read_b64_tr_b16 v[58:59], v25 offset:2048
    ds_read_b128 v[44:47], v17 offset:4096
    buffer_load_dwordx4 v6, s[12:15], s33 offen offset:1024 lds
    v_mfma_f32_32x32x16_bf16 v[160:175], v[88:91], v[76:79], v[160:175]
    ds_read_b128 v[48:51], v17 offset:8192
    ds_read_b128 v[52:55], v17 offset:12288
    buffer_load_dwordx4 v7, s[12:15], s33 offen offset:2048 lds
    v_mfma_f32_32x32x16_bf16 v[176:191], v[92:95], v[76:79], v[176:191]
    ds_read_b64_tr_b16 v[60:61], v26 offset:0
    ds_read_b64_tr_b16 v[62:63], v26 offset:2048
    v_mfma_f32_32x32x16_bf16 v[192:207], v[96:99], v[76:79], v[192:207]
    ds_read_b64_tr_b16 v[64:65], v27 offset:0
    ds_read_b64_tr_b16 v[66:67], v27 offset:2048
    buffer_load_dwordx4 v8, s[12:15], s33 offen offset:3072 lds
    v_mfma_f32_32x32x16_bf16 v[208:223], v[100:103], v[76:79], v[208:223]
    ds_read_b64_tr_b16 v[68:69], v28 offset:0
    ds_read_b64_tr_b16 v[70:71], v28 offset:2048
    s_add_u32 m0, s32, 49152
    s_mov_b32 s33, 786432
    buffer_load_dwordx4 v5, s[12:15], s33 offen lds
    v_mfma_f32_32x32x16_bf16 v[224:239], v[104:107], v[76:79], v[224:239]
    buffer_load_dwordx4 v6, s[12:15], s33 offen offset:1024 lds
    v_mfma_f32_32x32x16_bf16 v[240:255], v[108:111], v[76:79], v[240:255]
    s_cmp_eq_u32 s52, 0
    s_cbranch_scc0 k1_vkind
    s_waitcnt lgkmcnt(9)
    v_mfma_f32_32x32x16_bf16 a[0:15], v[56:59], v[40:43], 0
    ds_read_b128 v[72:75], v18 offset:0
    s_waitcnt lgkmcnt(9)
    v_mfma_f32_32x32x16_bf16 a[16:31], v[56:59], v[44:47], 0
    ds_read_b64_tr_b16 v[88:89], v25 offset:8192
    buffer_load_dwordx4 v7, s[12:15], s33 offen offset:2048 lds
    s_waitcnt lgkmcnt(9)
    v_mfma_f32_32x32x16_bf16 a[32:47], v[56:59], v[48:51], 0
    ds_read_b64_tr_b16 v[90:91], v25 offset:10240
    s_waitcnt lgkmcnt(9)
    v_mfma_f32_32x32x16_bf16 a[48:63], v[56:59], v[52:55], 0
    ds_read_b128 v[76:79], v18 offset:4096
    buffer_load_dwordx4 v8, s[12:15], s33 offen offset:3072 lds
    s_waitcnt lgkmcnt(8)
    v_mfma_f32_32x32x16_bf16 a[64:79], v[60:63], v[40:43], 0
    ds_read_b128 v[80:83], v18 offset:8192
    v_mfma_f32_32x32x16_bf16 a[80:95], v[60:63], v[44:47], 0
    ds_read_b128 v[84:87], v18 offset:12288
    v_mfma_f32_32x32x16_bf16 a[96:111], v[60:63], v[48:51], 0
    ds_read_b64_tr_b16 v[92:93], v26 offset:8192
    s_add_u32 m0, s32, 131072
    s_mov_b32 s33, 256
    buffer_load_dwordx4 v1, s[8:11], s33 offen lds
    v_mfma_f32_32x32x16_bf16 a[112:127], v[60:63], v[52:55], 0
    ds_read_b64_tr_b16 v[94:95], v26 offset:10240
    s_waitcnt lgkmcnt(10)
    v_mfma_f32_32x32x16_bf16 a[128:143], v[64:67], v[40:43], 0
    ds_read_b64_tr_b16 v[96:97], v27 offset:8192
    v_mfma_f32_32x32x16_bf16 a[144:159], v[64:67], v[44:47], 0
    ds_read_b64_tr_b16 v[98:99], v27 offset:10240
    buffer_load_dwordx4 v2, s[8:11], s33 offen offset:1024 lds
    v_mfma_f32_32x32x16_bf16 a[160:175], v[64:67], v[48:51], 0
    ds_read_b64_tr_b16 v[100:101], v28 offset:8192
    v_mfma_f32_32x32x16_bf16 a[176:191], v[64:67], v[52:55], 0
    ds_read_b64_tr_b16 v[102:103], v28 offset:10240
    buffer_load_dwordx4 v3, s[8:11], s33 offen offset:2048 lds
    s_waitcnt lgkmcnt(12)
    v_mfma_f32_32x32x16_bf16 a[192:207], v[68:71], v[40:43], 0
    v_mfma_f32_32x32x16_bf16 a[208:223], v[68:71], v[44:47], 0
    v_mfma_f32_32x32x16_bf16 a[224:239], v[68:71], v[48:51], 0
    buffer_load_dwordx4 v4, s[8:11], s33 offen offset:3072 lds
    v_mfma_f32_32x32x16_bf16 a[240:255], v[68:71], v[52:55], 0
    s_waitcnt vmcnt(24) lgkmcnt(0)
    s_barrier
    v_mfma_f32_32x32x16_bf16 a[0:15], v[88:91], v[72:75], a[0:15]
    ds_read_b128 v[40:43], v19 offset:0
    v_mul_f32 v254, s35, v254
    v_mul_f32 v255, s35, v255
    v_mfma_f32_32x32x16_bf16 a[16:31], v[88:91], v[76:79], a[16:31]
    ds_read_b64_tr_b16 v[56:57], v25 offset:16384
    v_cvt_pk_bf16_f32 v255, v254, v255
    v_mul_f32 v252, s35, v252
    v_mfma_f32_32x32x16_bf16 a[32:47], v[88:91], v[80:83], a[32:47]
    ds_read_b64_tr_b16 v[58:59], v25 offset:18432
    s_add_u32 m0, s32, 147456
    s_mov_b32 s33, 262400
    buffer_load_dwordx4 v1, s[8:11], s33 offen lds
    v_mul_f32 v253, s35, v253
    v_cvt_pk_bf16_f32 v254, v252, v253
    v_mfma_f32_32x32x16_bf16 a[48:63], v[88:91], v[84:87], a[48:63]
    ds_read_b128 v[44:47], v19 offset:4096
    v_mul_f32 v250, s35, v250
    v_mul_f32 v251, s35, v251
    v_mfma_f32_32x32x16_bf16 a[64:79], v[92:95], v[72:75], a[64:79]
    ds_read_b128 v[48:51], v19 offset:8192
    v_cvt_pk_bf16_f32 v253, v250, v251
    v_mul_f32 v248, s35, v248
    v_mfma_f32_32x32x16_bf16 a[80:95], v[92:95], v[76:79], a[80:95]
    ds_read_b128 v[52:55], v19 offset:12288
    v_mul_f32 v249, s35, v249
    v_cvt_pk_bf16_f32 v252, v248, v249
    v_mfma_f32_32x32x16_bf16 a[96:111], v[92:95], v[80:83], a[96:111]
    ds_read_b64_tr_b16 v[60:61], v26 offset:16384
    buffer_load_dwordx4 v2, s[8:11], s33 offen offset:1024 lds
    v_mul_f32 v246, s35, v246
    v_mul_f32 v247, s35, v247
    v_mfma_f32_32x32x16_bf16 a[112:127], v[92:95], v[84:87], a[112:127]
    ds_read_b64_tr_b16 v[62:63], v26 offset:18432
    v_cvt_pk_bf16_f32 v251, v246, v247
    v_mul_f32 v244, s35, v244
    v_mfma_f32_32x32x16_bf16 a[128:143], v[96:99], v[72:75], a[128:143]
    ds_read_b64_tr_b16 v[64:65], v27 offset:16384
    v_mul_f32 v245, s35, v245
    v_cvt_pk_bf16_f32 v250, v244, v245
    v_mfma_f32_32x32x16_bf16 a[144:159], v[96:99], v[76:79], a[144:159]
    ds_read_b64_tr_b16 v[66:67], v27 offset:18432
    v_mul_f32 v242, s35, v242
    v_mul_f32 v243, s35, v243
    v_mfma_f32_32x32x16_bf16 a[160:175], v[96:99], v[80:83], a[160:175]
    ds_read_b64_tr_b16 v[68:69], v28 offset:16384
    buffer_load_dwordx4 v3, s[8:11], s33 offen offset:2048 lds
    v_cvt_pk_bf16_f32 v249, v242, v243
    v_mul_f32 v240, s35, v240
    v_mfma_f32_32x32x16_bf16 a[176:191], v[96:99], v[84:87], a[176:191]
    ds_read_b64_tr_b16 v[70:71], v28 offset:18432
    v_mul_f32 v241, s35, v241
    v_cvt_pk_bf16_f32 v248, v240, v241
    v_mfma_f32_32x32x16_bf16 a[192:207], v[100:103], v[72:75], a[192:207]
    v_mul_f32 v238, s35, v238
    v_mul_f32 v239, s35, v239
    v_mfma_f32_32x32x16_bf16 a[208:223], v[100:103], v[76:79], a[208:223]
    v_cvt_pk_bf16_f32 v247, v238, v239
    v_mul_f32 v236, s35, v236
    v_mfma_f32_32x32x16_bf16 a[224:239], v[100:103], v[80:83], a[224:239]
    buffer_load_dwordx4 v4, s[8:11], s33 offen offset:3072 lds
    v_mul_f32 v237, s35, v237
    v_cvt_pk_bf16_f32 v246, v236, v237
    v_mfma_f32_32x32x16_bf16 a[240:255], v[100:103], v[84:87], a[240:255]
    v_mul_f32 v234, s35, v234
    v_mul_f32 v235, s35, v235
    s_waitcnt lgkmcnt(9)
    v_mfma_f32_32x32x16_bf16 a[0:15], v[56:59], v[40:43], a[0:15]
    ds_read_b128 v[72:75], v20 offset:0
    v_cvt_pk_bf16_f32 v245, v234, v235
    v_mul_f32 v232, s35, v232
    s_waitcnt lgkmcnt(9)
    v_mfma_f32_32x32x16_bf16 a[16:31], v[56:59], v[44:47], a[16:31]
    ds_read_b64_tr_b16 v[88:89], v25 offset:24576
    v_mul_f32 v233, s35, v233
    v_cvt_pk_bf16_f32 v244, v232, v233
    s_waitcnt lgkmcnt(9)
    v_mfma_f32_32x32x16_bf16 a[32:47], v[56:59], v[48:51], a[32:47]
    ds_read_b64_tr_b16 v[90:91], v25 offset:26624
    s_add_u32 m0, s32, 0
    s_mov_b32 s33, 1048576
    buffer_load_dwordx4 v5, s[12:15], s33 offen lds
    v_mul_f32 v230, s35, v230
    v_mul_f32 v231, s35, v231
    s_waitcnt lgkmcnt(9)
    v_mfma_f32_32x32x16_bf16 a[48:63], v[56:59], v[52:55], a[48:63]
    ds_read_b128 v[76:79], v20 offset:4096
    v_cvt_pk_bf16_f32 v243, v230, v231
    v_mul_f32 v228, s35, v228
    s_waitcnt lgkmcnt(8)
    v_mfma_f32_32x32x16_bf16 a[64:79], v[60:63], v[40:43], a[64:79]
    ds_read_b128 v[80:83], v20 offset:8192
    v_mul_f32 v229, s35, v229
    v_cvt_pk_bf16_f32 v242, v228, v229
    v_mfma_f32_32x32x16_bf16 a[80:95], v[60:63], v[44:47], a[80:95]
    ds_read_b128 v[84:87], v20 offset:12288
    v_mul_f32 v226, s35, v226
    v_mul_f32 v227, s35, v227
    v_mfma_f32_32x32x16_bf16 a[96:111], v[60:63], v[48:51], a[96:111]
    ds_read_b64_tr_b16 v[92:93], v26 offset:24576
    buffer_load_dwordx4 v6, s[12:15], s33 offen offset:1024 lds
    v_cvt_pk_bf16_f32 v241, v226, v227
    v_mul_f32 v224, s35, v224
    v_mfma_f32_32x32x16_bf16 a[112:127], v[60:63], v[52:55], a[112:127]
    ds_read_b64_tr_b16 v[94:95], v26 offset:26624
    v_mul_f32 v225, s35, v225
    v_cvt_pk_bf16_f32 v240, v224, v225
    s_waitcnt lgkmcnt(10)
    v_mfma_f32_32x32x16_bf16 a[128:143], v[64:67], v[40:43], a[128:143]
    ds_read_b64_tr_b16 v[96:97], v27 offset:24576
    v_mul_f32 v222, s35, v222
    v_mul_f32 v223, s35, v223
    v_mfma_f32_32x32x16_bf16 a[144:159], v[64:67], v[44:47], a[144:159]
    ds_read_b64_tr_b16 v[98:99], v27 offset:26624
    v_cvt_pk_bf16_f32 v239, v222, v223
    v_mul_f32 v220, s35, v220
    v_mfma_f32_32x32x16_bf16 a[160:175], v[64:67], v[48:51], a[160:175]
    ds_read_b64_tr_b16 v[100:101], v28 offset:24576
    buffer_load_dwordx4 v7, s[12:15], s33 offen offset:2048 lds
    v_mul_f32 v221, s35, v221
    v_cvt_pk_bf16_f32 v238, v220, v221
    v_mfma_f32_32x32x16_bf16 a[176:191], v[64:67], v[52:55], a[176:191]
    ds_read_b64_tr_b16 v[102:103], v28 offset:26624
    v_mul_f32 v218, s35, v218
    v_mul_f32 v219, s35, v219
    s_waitcnt lgkmcnt(12)
    v_mfma_f32_32x32x16_bf16 a[192:207], v[68:71], v[40:43], a[192:207]
    v_cvt_pk_bf16_f32 v237, v218, v219
    v_mul_f32 v216, s35, v216
    v_mfma_f32_32x32x16_bf16 a[208:223], v[68:71], v[44:47], a[208:223]
    v_mul_f32 v217, s35, v217
    v_cvt_pk_bf16_f32 v236, v216, v217
    v_mfma_f32_32x32x16_bf16 a[224:239], v[68:71], v[48:51], a[224:239]
    buffer_load_dwordx4 v8, s[12:15], s33 offen offset:3072 lds
    v_mul_f32 v214, s35, v214
    v_mul_f32 v215, s35, v215
    v_mfma_f32_32x32x16_bf16 a[240:255], v[68:71], v[52:55], a[240:255]
    v_cvt_pk_bf16_f32 v235, v214, v215
    v_mul_f32 v212, s35, v212
    s_waitcnt vmcnt(16) lgkmcnt(0)
    s_barrier
    v_mfma_f32_32x32x16_bf16 a[0:15], v[88:91], v[72:75], a[0:15]
    ds_read_b128 v[40:43], v17 offset:32768
    v_mul_f32 v213, s35, v213
    v_cvt_pk_bf16_f32 v234, v212, v213
    v_mfma_f32_32x32x16_bf16 a[16:31], v[88:91], v[76:79], a[16:31]
    ds_read_b64_tr_b16 v[56:57], v25 offset:32768
    s_add_u32 m0, s32, 16384
    s_mov_b32 s33, 1310720
    buffer_load_dwordx4 v5, s[12:15], s33 offen lds
    v_mul_f32 v210, s35, v210
    v_mul_f32 v211, s35, v211
    v_mfma_f32_32x32x16_bf16 a[32:47], v[88:91], v[80:83], a[32:47]
    ds_read_b64_tr_b16 v[58:59], v25 offset:34816
    v_cvt_pk_bf16_f32 v233, v210, v211
    v_mul_f32 v208, s35, v208
    v_mfma_f32_32x32x16_bf16 a[48:63], v[88:91], v[84:87], a[48:63]
    ds_read_b128 v[44:47], v17 offset:36864
    buffer_load_dwordx4 v6, s[12:15], s33 offen offset:1024 lds
    v_mul_f32 v209, s35, v209
    v_cvt_pk_bf16_f32 v232, v208, v209
    v_mfma_f32_32x32x16_bf16 a[64:79], v[92:95], v[72:75], a[64:79]
    ds_read_b128 v[48:51], v17 offset:40960
    v_mul_f32 v206, s35, v206
    v_mul_f32 v207, s35, v207
    v_mfma_f32_32x32x16_bf16 a[80:95], v[92:95], v[76:79], a[80:95]
    ds_read_b128 v[52:55], v17 offset:45056
    v_cvt_pk_bf16_f32 v231, v206, v207
    v_mul_f32 v204, s35, v204
    v_mfma_f32_32x32x16_bf16 a[96:111], v[92:95], v[80:83], a[96:111]
    ds_read_b64_tr_b16 v[60:61], v26 offset:32768
    buffer_load_dwordx4 v7, s[12:15], s33 offen offset:2048 lds
    v_mul_f32 v205, s35, v205
    v_cvt_pk_bf16_f32 v230, v204, v205
    v_mfma_f32_32x32x16_bf16 a[112:127], v[92:95], v[84:87], a[112:127]
    ds_read_b64_tr_b16 v[62:63], v26 offset:34816
    v_mul_f32 v202, s35, v202
    v_mul_f32 v203, s35, v203
    v_mfma_f32_32x32x16_bf16 a[128:143], v[96:99], v[72:75], a[128:143]
    ds_read_b64_tr_b16 v[64:65], v27 offset:32768
    v_cvt_pk_bf16_f32 v229, v202, v203
    v_mul_f32 v200, s35, v200
    v_mfma_f32_32x32x16_bf16 a[144:159], v[96:99], v[76:79], a[144:159]
    ds_read_b64_tr_b16 v[66:67], v27 offset:34816
    buffer_load_dwordx4 v8, s[12:15], s33 offen offset:3072 lds
    v_mul_f32 v201, s35, v201
    v_cvt_pk_bf16_f32 v228, v200, v201
    v_mfma_f32_32x32x16_bf16 a[160:175], v[96:99], v[80:83], a[160:175]
    ds_read_b64_tr_b16 v[68:69], v28 offset:32768
    v_mul_f32 v198, s35, v198
    v_mul_f32 v199, s35, v199
    v_mfma_f32_32x32x16_bf16 a[176:191], v[96:99], v[84:87], a[176:191]
    ds_read_b64_tr_b16 v[70:71], v28 offset:34816
    s_add_u32 m0, s32, 65536
    s_mov_b32 s33, 384
    buffer_load_dwordx4 v1, s[8:11], s33 offen lds
    v_cvt_pk_bf16_f32 v227, v198, v199
    v_mul_f32 v196, s35, v196
    v_mfma_f32_32x32x16_bf16 a[192:207], v[100:103], v[72:75], a[192:207]
    v_mul_f32 v197, s35, v197
    v_cvt_pk_bf16_f32 v226, v196, v197
    v_mfma_f32_32x32x16_bf16 a[208:223], v[100:103], v[76:79], a[208:223]
    v_mul_f32 v194, s35, v194
    v_mul_f32 v195, s35, v195
    v_mfma_f32_32x32x16_bf16 a[224:239], v[100:103], v[80:83], a[224:239]
    buffer_load_dwordx4 v2, s[8:11], s33 offen offset:1024 lds
    v_cvt_pk_bf16_f32 v225, v194, v195
    v_mul_f32 v192, s35, v192
    v_mfma_f32_32x32x16_bf16 a[240:255], v[100:103], v[84:87], a[240:255]
    v_mul_f32 v193, s35, v193
    v_cvt_pk_bf16_f32 v224, v192, v193
    s_waitcnt lgkmcnt(9)
    v_mfma_f32_32x32x16_bf16 a[0:15], v[56:59], v[40:43], a[0:15]
    ds_read_b128 v[72:75], v18 offset:32768
    v_mul_f32 v190, s35, v190
    v_mul_f32 v191, s35, v191
    s_waitcnt lgkmcnt(9)
    v_mfma_f32_32x32x16_bf16 a[16:31], v[56:59], v[44:47], a[16:31]
    ds_read_b64_tr_b16 v[88:89], v25 offset:40960
    buffer_load_dwordx4 v3, s[8:11], s33 offen offset:2048 lds
    v_cvt_pk_bf16_f32 v223, v190, v191
    v_mul_f32 v188, s35, v188
    s_waitcnt lgkmcnt(9)
    v_mfma_f32_32x32x16_bf16 a[32:47], v[56:59], v[48:51], a[32:47]
    ds_read_b64_tr_b16 v[90:91], v25 offset:43008
    v_mul_f32 v189, s35, v189
    v_cvt_pk_bf16_f32 v222, v188, v189
    s_waitcnt lgkmcnt(9)
    v_mfma_f32_32x32x16_bf16 a[48:63], v[56:59], v[52:55], a[48:63]
    ds_read_b128 v[76:79], v18 offset:36864
    buffer_load_dwordx4 v4, s[8:11], s33 offen offset:3072 lds
    v_mul_f32 v186, s35, v186
    v_mul_f32 v187, s35, v187
    s_waitcnt lgkmcnt(8)
    v_mfma_f32_32x32x16_bf16 a[64:79], v[60:63], v[40:43], a[64:79]
    ds_read_b128 v[80:83], v18 offset:40960
    v_cvt_pk_bf16_f32 v221, v186, v187
    v_mul_f32 v184, s35, v184
    v_mfma_f32_32x32x16_bf16 a[80:95], v[60:63], v[44:47], a[80:95]
    ds_read_b128 v[84:87], v18 offset:45056
    v_mul_f32 v185, s35, v185
    v_cvt_pk_bf16_f32 v220, v184, v185
    v_mfma_f32_32x32x16_bf16 a[96:111], v[60:63], v[48:51], a[96:111]
    ds_read_b64_tr_b16 v[92:93], v26 offset:40960
    s_add_u32 m0, s32, 81920
    s_mov_b32 s33, 262528
    buffer_load_dwordx4 v1, s[8:11], s33 offen lds
    v_mul_f32 v182, s35, v182
    v_mul_f32 v183, s35, v183
    v_mfma_f32_32x32x16_bf16 a[112:127], v[60:63], v[52:55], a[112:127]
    ds_read_b64_tr_b16 v[94:95], v26 offset:43008
    v_cvt_pk_bf16_f32 v219, v182, v183
    v_mul_f32 v180, s35, v180
    s_waitcnt lgkmcnt(10)
    v_mfma_f32_32x32x16_bf16 a[128:143], v[64:67], v[40:43], a[128:143]
    ds_read_b64_tr_b16 v[96:97], v27 offset:40960
    v_mul_f32 v181, s35, v181
    v_cvt_pk_bf16_f32 v218, v180, v181
    v_mfma_f32_32x32x16_bf16 a[144:159], v[64:67], v[44:47], a[144:159]
    ds_read_b64_tr_b16 v[98:99], v27 offset:43008
    buffer_load_dwordx4 v2, s[8:11], s33 offen offset:1024 lds
    v_mul_f32 v178, s35, v178
    v_mul_f32 v179, s35, v179
    v_mfma_f32_32x32x16_bf16 a[160:175], v[64:67], v[48:51], a[160:175]
    ds_read_b64_tr_b16 v[100:101], v28 offset:40960
    v_cvt_pk_bf16_f32 v217, v178, v179
    v_mul_f32 v176, s35, v176
    v_mfma_f32_32x32x16_bf16 a[176:191], v[64:67], v[52:55], a[176:191]
    ds_read_b64_tr_b16 v[102:103], v28 offset:43008
    buffer_load_dwordx4 v3, s[8:11], s33 offen offset:2048 lds
    v_mul_f32 v177, s35, v177
    v_cvt_pk_bf16_f32 v216, v176, v177
    s_waitcnt lgkmcnt(12)
    v_mfma_f32_32x32x16_bf16 a[192:207], v[68:71], v[40:43], a[192:207]
    v_mul_f32 v174, s35, v174
    v_mul_f32 v175, s35, v175
    v_mfma_f32_32x32x16_bf16 a[208:223], v[68:71], v[44:47], a[208:223]
    v_cvt_pk_bf16_f32 v215, v174, v175
    v_mul_f32 v172, s35, v172
    v_mfma_f32_32x32x16_bf16 a[224:239], v[68:71], v[48:51], a[224:239]
    buffer_load_dwordx4 v4, s[8:11], s33 offen offset:3072 lds
    v_mul_f32 v173, s35, v173
    v_cvt_pk_bf16_f32 v214, v172, v173
    v_mfma_f32_32x32x16_bf16 a[240:255], v[68:71], v[52:55], a[240:255]
    v_mul_f32 v170, s35, v170
    v_mul_f32 v171, s35, v171
    s_waitcnt vmcnt(24) lgkmcnt(0)
    s_barrier
    v_mfma_f32_32x32x16_bf16 a[0:15], v[88:91], v[72:75], a[0:15]
    ds_read_b128 v[40:43], v19 offset:32768
    v_cvt_pk_bf16_f32 v213, v170, v171
    v_mul_f32 v168, s35, v168
    v_mfma_f32_32x32x16_bf16 a[16:31], v[88:91], v[76:79], a[16:31]
    ds_read_b64_tr_b16 v[56:57], v25 offset:49152
    v_mul_f32 v169, s35, v169
    v_cvt_pk_bf16_f32 v212, v168, v169
    v_mfma_f32_32x32x16_bf16 a[32:47], v[88:91], v[80:83], a[32:47]
    ds_read_b64_tr_b16 v[58:59], v25 offset:51200
    v_mul_f32 v166, s35, v166
    v_mul_f32 v167, s35, v167
    v_mfma_f32_32x32x16_bf16 a[48:63], v[88:91], v[84:87], a[48:63]
    ds_read_b128 v[44:47], v19 offset:36864
    v_cvt_pk_bf16_f32 v211, v166, v167
    v_mul_f32 v164, s35, v164
    v_mfma_f32_32x32x16_bf16 a[64:79], v[92:95], v[72:75], a[64:79]
    ds_read_b128 v[48:51], v19 offset:40960
    s_add_u32 m0, s32, 32768
    s_mov_b32 s33, 1572864
    buffer_load_dwordx4 v5, s[12:15], s33 offen lds
    v_mul_f32 v165, s35, v165
    v_cvt_pk_bf16_f32 v210, v164, v165
    v_mfma_f32_32x32x16_bf16 a[80:95], v[92:95], v[76:79], a[80:95]
    ds_read_b128 v[52:55], v19 offset:45056
    v_mul_f32 v162, s35, v162
    v_mul_f32 v163, s35, v163
    v_mfma_f32_32x32x16_bf16 a[96:111], v[92:95], v[80:83], a[96:111]
    ds_read_b64_tr_b16 v[60:61], v26 offset:49152
    v_cvt_pk_bf16_f32 v209, v162, v163
    v_mul_f32 v160, s35, v160
    v_mfma_f32_32x32x16_bf16 a[112:127], v[92:95], v[84:87], a[112:127]
    ds_read_b64_tr_b16 v[62:63], v26 offset:51200
    v_mul_f32 v161, s35, v161
    v_cvt_pk_bf16_f32 v208, v160, v161
    v_mfma_f32_32x32x16_bf16 a[128:143], v[96:99], v[72:75], a[128:143]
    ds_read_b64_tr_b16 v[64:65], v27 offset:49152
    v_mul_f32 v158, s35, v158
    v_mul_f32 v159, s35, v159
    v_mfma_f32_32x32x16_bf16 a[144:159], v[96:99], v[76:79], a[144:159]
    ds_read_b64_tr_b16 v[66:67], v27 offset:51200
    v_cvt_pk_bf16_f32 v207, v158, v159
    v_mul_f32 v156, s35, v156
    v_mfma_f32_32x32x16_bf16 a[160:175], v[96:99], v[80:83], a[160:175]
    ds_read_b64_tr_b16 v[68:69], v28 offset:49152
    v_mul_f32 v157, s35, v157
    v_cvt_pk_bf16_f32 v206, v156, v157
    v_mfma_f32_32x32x16_bf16 a[176:191], v[96:99], v[84:87], a[176:191]
    ds_read_b64_tr_b16 v[70:71], v28 offset:51200
    v_mul_f32 v154, s35, v154
    v_mul_f32 v155, s35, v155
    v_mfma_f32_32x32x16_bf16 a[192:207], v[100:103], v[72:75], a[192:207]
    buffer_load_dwordx4 v6, s[12:15], s33 offen offset:1024 lds
    v_cvt_pk_bf16_f32 v205, v154, v155
    v_mul_f32 v152, s35, v152
    v_mfma_f32_32x32x16_bf16 a[208:223], v[100:103], v[76:79], a[208:223]
    v_mul_f32 v153, s35, v153
    v_cvt_pk_bf16_f32 v204, v152, v153
    v_mfma_f32_32x32x16_bf16 a[224:239], v[100:103], v[80:83], a[224:239]
    v_mul_f32 v150, s35, v150
    v_mul_f32 v151, s35, v151
    v_mfma_f32_32x32x16_bf16 a[240:255], v[100:103], v[84:87], a[240:255]
    v_cvt_pk_bf16_f32 v203, v150, v151
    v_mul_f32 v148, s35, v148
    s_waitcnt lgkmcnt(9)
    v_mfma_f32_32x32x16_bf16 a[0:15], v[56:59], v[40:43], a[0:15]
    ds_read_b128 v[72:75], v20 offset:32768
    v_mul_f32 v149, s35, v149
    v_cvt_pk_bf16_f32 v202, v148, v149
    s_waitcnt lgkmcnt(9)
    v_mfma_f32_32x32x16_bf16 a[16:31], v[56:59], v[44:47], a[16:31]
    ds_read_b64_tr_b16 v[88:89], v25 offset:57344
    v_mul_f32 v146, s35, v146
    v_mul_f32 v147, s35, v147
    s_waitcnt lgkmcnt(9)
    v_mfma_f32_32x32x16_bf16 a[32:47], v[56:59], v[48:51], a[32:47]
    ds_read_b64_tr_b16 v[90:91], v25 offset:59392
    v_cvt_pk_bf16_f32 v201, v146, v147
    v_mul_f32 v144, s35, v144
    s_waitcnt lgkmcnt(9)
    v_mfma_f32_32x32x16_bf16 a[48:63], v[56:59], v[52:55], a[48:63]
    ds_read_b128 v[76:79], v20 offset:36864
    v_mul_f32 v145, s35, v145
    v_cvt_pk_bf16_f32 v200, v144, v145
    s_waitcnt lgkmcnt(8)
    v_mfma_f32_32x32x16_bf16 a[64:79], v[60:63], v[40:43], a[64:79]
    ds_read_b128 v[80:83], v20 offset:40960
    buffer_load_dwordx4 v7, s[12:15], s33 offen offset:2048 lds
    v_mul_f32 v142, s35, v142
    v_mul_f32 v143, s35, v143
    v_mfma_f32_32x32x16_bf16 a[80:95], v[60:63], v[44:47], a[80:95]
    ds_read_b128 v[84:87], v20 offset:45056
    v_cvt_pk_bf16_f32 v199, v142, v143
    v_mul_f32 v140, s35, v140
    v_mfma_f32_32x32x16_bf16 a[96:111], v[60:63], v[48:51], a[96:111]
    ds_read_b64_tr_b16 v[92:93], v26 offset:57344
    v_mul_f32 v141, s35, v141
    v_cvt_pk_bf16_f32 v198, v140, v141
    v_mfma_f32_32x32x16_bf16 a[112:127], v[60:63], v[52:55], a[112:127]
    ds_read_b64_tr_b16 v[94:95], v26 offset:59392
    v_mul_f32 v138, s35, v138
    v_mul_f32 v139, s35, v139
    s_waitcnt lgkmcnt(10)
    v_mfma_f32_32x32x16_bf16 a[128:143], v[64:67], v[40:43], a[128:143]
    ds_read_b64_tr_b16 v[96:97], v27 offset:57344
    v_cvt_pk_bf16_f32 v197, v138, v139
    v_mul_f32 v136, s35, v136
    v_mfma_f32_32x32x16_bf16 a[144:159], v[64:67], v[44:47], a[144:159]
    ds_read_b64_tr_b16 v[98:99], v27 offset:59392
    v_mul_f32 v137, s35, v137
    v_cvt_pk_bf16_f32 v196, v136, v137
    v_mfma_f32_32x32x16_bf16 a[160:175], v[64:67], v[48:51], a[160:175]
    ds_read_b64_tr_b16 v[100:101], v28 offset:57344
    v_mul_f32 v134, s35, v134
    v_mul_f32 v135, s35, v135
    v_mfma_f32_32x32x16_bf16 a[176:191], v[64:67], v[52:55], a[176:191]
    ds_read_b64_tr_b16 v[102:103], v28 offset:59392
    v_cvt_pk_bf16_f32 v195, v134, v135
    v_mul_f32 v132, s35, v132
    s_waitcnt lgkmcnt(12)
    v_mfma_f32_32x32x16_bf16 a[192:207], v[68:71], v[40:43], a[192:207]
    buffer_load_dwordx4 v8, s[12:15], s33 offen offset:3072 lds
    v_mul_f32 v133, s35, v133
    v_cvt_pk_bf16_f32 v194, v132, v133
    v_mfma_f32_32x32x16_bf16 a[208:223], v[68:71], v[44:47], a[208:223]
    v_mul_f32 v130, s35, v130
    v_mul_f32 v131, s35, v131
    v_mfma_f32_32x32x16_bf16 a[224:239], v[68:71], v[48:51], a[224:239]
    v_cvt_pk_bf16_f32 v193, v130, v131
    v_mul_f32 v128, s35, v128
    v_mfma_f32_32x32x16_bf16 a[240:255], v[68:71], v[52:55], a[240:255]
    v_mul_f32 v129, s35, v129
    v_cvt_pk_bf16_f32 v192, v128, v129
    s_waitcnt vmcnt(16) lgkmcnt(0)
    s_barrier
    v_mfma_f32_32x32x16_bf16 a[0:15], v[88:91], v[72:75], a[0:15]
    ds_read_b128 v[40:43], v21 offset:0
    v_mfma_f32_32x32x16_bf16 a[16:31], v[88:91], v[76:79], a[16:31]
    ds_read_b64_tr_b16 v[56:57], v25 offset:0
    s_add_u32 m0, s32, 49152
    s_mov_b32 s33, 1835008
    buffer_load_dwordx4 v5, s[12:15], s33 offen lds
    v_mfma_f32_32x32x16_bf16 a[32:47], v[88:91], v[80:83], a[32:47]
    ds_read_b64_tr_b16 v[58:59], v25 offset:2048
    v_mfma_f32_32x32x16_bf16 a[48:63], v[88:91], v[84:87], a[48:63]
    ds_read_b128 v[44:47], v21 offset:4096
    buffer_load_dwordx4 v6, s[12:15], s33 offen offset:1024 lds
    v_mfma_f32_32x32x16_bf16 a[64:79], v[92:95], v[72:75], a[64:79]
    ds_read_b128 v[48:51], v21 offset:8192
    v_mfma_f32_32x32x16_bf16 a[80:95], v[92:95], v[76:79], a[80:95]
    ds_read_b128 v[52:55], v21 offset:12288
    v_mfma_f32_32x32x16_bf16 a[96:111], v[92:95], v[80:83], a[96:111]
    ds_read_b64_tr_b16 v[60:61], v26 offset:0
    buffer_load_dwordx4 v7, s[12:15], s33 offen offset:2048 lds
    v_mfma_f32_32x32x16_bf16 a[112:127], v[92:95], v[84:87], a[112:127]
    ds_read_b64_tr_b16 v[62:63], v26 offset:2048
    v_mfma_f32_32x32x16_bf16 a[128:143], v[96:99], v[72:75], a[128:143]
    ds_read_b64_tr_b16 v[64:65], v27 offset:0
    v_mfma_f32_32x32x16_bf16 a[144:159], v[96:99], v[76:79], a[144:159]
    ds_read_b64_tr_b16 v[66:67], v27 offset:2048
    buffer_load_dwordx4 v8, s[12:15], s33 offen offset:3072 lds
    v_mfma_f32_32x32x16_bf16 a[160:175], v[96:99], v[80:83], a[160:175]
    ds_read_b64_tr_b16 v[68:69], v28 offset:0
    v_mfma_f32_32x32x16_bf16 a[176:191], v[96:99], v[84:87], a[176:191]
    ds_read_b64_tr_b16 v[70:71], v28 offset:2048
    s_add_u32 m0, s32, 98304
    s_mov_b32 s33, 512
    buffer_load_dwordx4 v1, s[8:11], s33 offen lds
    v_mfma_f32_32x32x16_bf16 a[192:207], v[100:103], v[72:75], a[192:207]
    v_mfma_f32_32x32x16_bf16 a[208:223], v[100:103], v[76:79], a[208:223]
    v_mfma_f32_32x32x16_bf16 a[224:239], v[100:103], v[80:83], a[224:239]
    buffer_load_dwordx4 v2, s[8:11], s33 offen offset:1024 lds
    v_mfma_f32_32x32x16_bf16 a[240:255], v[100:103], v[84:87], a[240:255]
    s_waitcnt lgkmcnt(9)
    v_mfma_f32_32x32x16_bf16 a[0:15], v[56:59], v[40:43], a[0:15]
    ds_read_b128 v[72:75], v22 offset:0
    s_waitcnt lgkmcnt(9)
    v_mfma_f32_32x32x16_bf16 a[16:31], v[56:59], v[44:47], a[16:31]
    ds_read_b64_tr_b16 v[88:89], v25 offset:8192
    buffer_load_dwordx4 v3, s[8:11], s33 offen offset:2048 lds
    s_waitcnt lgkmcnt(9)
    v_mfma_f32_32x32x16_bf16 a[32:47], v[56:59], v[48:51], a[32:47]
    ds_read_b64_tr_b16 v[90:91], v25 offset:10240
    s_waitcnt lgkmcnt(9)
    v_mfma_f32_32x32x16_bf16 a[48:63], v[56:59], v[52:55], a[48:63]
    ds_read_b128 v[76:79], v22 offset:4096
    buffer_load_dwordx4 v4, s[8:11], s33 offen offset:3072 lds
    s_waitcnt lgkmcnt(8)
    v_mfma_f32_32x32x16_bf16 a[64:79], v[60:63], v[40:43], a[64:79]
    ds_read_b128 v[80:83], v22 offset:8192
    v_mfma_f32_32x32x16_bf16 a[80:95], v[60:63], v[44:47], a[80:95]
    ds_read_b128 v[84:87], v22 offset:12288
    v_mfma_f32_32x32x16_bf16 a[96:111], v[60:63], v[48:51], a[96:111]
    ds_read_b64_tr_b16 v[92:93], v26 offset:8192
    s_add_u32 m0, s32, 114688
    s_mov_b32 s33, 262656
    buffer_load_dwordx4 v1, s[8:11], s33 offen lds
    v_mfma_f32_32x32x16_bf16 a[112:127], v[60:63], v[52:55], a[112:127]
    ds_read_b64_tr_b16 v[94:95], v26 offset:10240
    s_waitcnt lgkmcnt(10)
    v_mfma_f32_32x32x16_bf16 a[128:143], v[64:67], v[40:43], a[128:143]
    ds_read_b64_tr_b16 v[96:97], v27 offset:8192
    v_mfma_f32_32x32x16_bf16 a[144:159], v[64:67], v[44:47], a[144:159]
    ds_read_b64_tr_b16 v[98:99], v27 offset:10240
    buffer_load_dwordx4 v2, s[8:11], s33 offen offset:1024 lds
    v_mfma_f32_32x32x16_bf16 a[160:175], v[64:67], v[48:51], a[160:175]
    ds_read_b64_tr_b16 v[100:101], v28 offset:8192
    v_mfma_f32_32x32x16_bf16 a[176:191], v[64:67], v[52:55], a[176:191]
    ds_read_b64_tr_b16 v[102:103], v28 offset:10240
    buffer_load_dwordx4 v3, s[8:11], s33 offen offset:2048 lds
    s_waitcnt lgkmcnt(12)
    v_mfma_f32_32x32x16_bf16 a[192:207], v[68:71], v[40:43], a[192:207]
    v_mfma_f32_32x32x16_bf16 a[208:223], v[68:71], v[44:47], a[208:223]
    v_mfma_f32_32x32x16_bf16 a[224:239], v[68:71], v[48:51], a[224:239]
    buffer_load_dwordx4 v4, s[8:11], s33 offen offset:3072 lds
    s_mov_b32 s34, 0
    buffer_store_dwordx4 v[192:195], v38, s[28:31], s34 offen sc1
    v_mfma_f32_32x32x16_bf16 a[240:255], v[68:71], v[52:55], a[240:255]
    s_waitcnt vmcnt(25) lgkmcnt(0)
    s_barrier
    v_mfma_f32_32x32x16_bf16 a[0:15], v[88:91], v[72:75], a[0:15]
    ds_read_b128 v[40:43], v23 offset:0
    v_mfma_f32_32x32x16_bf16 a[16:31], v[88:91], v[76:79], a[16:31]
    ds_read_b64_tr_b16 v[56:57], v25 offset:16384
    v_mfma_f32_32x32x16_bf16 a[32:47], v[88:91], v[80:83], a[32:47]
    ds_read_b64_tr_b16 v[58:59], v25 offset:18432
    v_mfma_f32_32x32x16_bf16 a[48:63], v[88:91], v[84:87], a[48:63]
    ds_read_b128 v[44:47], v23 offset:4096
    v_mfma_f32_32x32x16_bf16 a[64:79], v[92:95], v[72:75], a[64:79]
    ds_read_b128 v[48:51], v23 offset:8192
    s_add_u32 m0, s32, 0
    s_mov_b32 s33, 2097152
    buffer_load_dwordx4 v5, s[12:15], s33 offen lds
    v_mfma_f32_32x32x16_bf16 a[80:95], v[92:95], v[76:79], a[80:95]
    ds_read_b128 v[52:55], v23 offset:12288
    v_mfma_f32_32x32x16_bf16 a[96:111], v[92:95], v[80:83], a[96:111]
    ds_read_b64_tr_b16 v[60:61], v26 offset:16384
    v_mfma_f32_32x32x16_bf16 a[112:127], v[92:95], v[84:87], a[112:127]
    ds_read_b64_tr_b16 v[62:63], v26 offset:18432
    v_mfma_f32_32x32x16_bf16 a[128:143], v[96:99], v[72:75], a[128:143]
    ds_read_b64_tr_b16 v[64:65], v27 offset:16384
    v_mfma_f32_32x32x16_bf16 a[144:159], v[96:99], v[76:79], a[144:159]
    ds_read_b64_tr_b16 v[66:67], v27 offset:18432
    v_mfma_f32_32x32x16_bf16 a[160:175], v[96:99], v[80:83], a[160:175]
    ds_read_b64_tr_b16 v[68:69], v28 offset:16384
    v_mfma_f32_32x32x16_bf16 a[176:191], v[96:99], v[84:87], a[176:191]
    ds_read_b64_tr_b16 v[70:71], v28 offset:18432
    v_mfma_f32_32x32x16_bf16 a[192:207], v[100:103], v[72:75], a[192:207]
    buffer_load_dwordx4 v6, s[12:15], s33 offen offset:1024 lds
    v_mfma_f32_32x32x16_bf16 a[208:223], v[100:103], v[76:79], a[208:223]
    v_mfma_f32_32x32x16_bf16 a[224:239], v[100:103], v[80:83], a[224:239]
    v_mfma_f32_32x32x16_bf16 a[240:255], v[100:103], v[84:87], a[240:255]
    s_waitcnt lgkmcnt(9)
    v_mfma_f32_32x32x16_bf16 a[0:15], v[56:59], v[40:43], a[0:15]
    ds_read_b128 v[72:75], v24 offset:0
    s_waitcnt lgkmcnt(9)
    v_mfma_f32_32x32x16_bf16 a[16:31], v[56:59], v[44:47], a[16:31]
    ds_read_b64_tr_b16 v[88:89], v25 offset:24576
    s_waitcnt lgkmcnt(9)
    v_mfma_f32_32x32x16_bf16 a[32:47], v[56:59], v[48:51], a[32:47]
    ds_read_b64_tr_b16 v[90:91], v25 offset:26624
    s_waitcnt lgkmcnt(9)
    v_mfma_f32_32x32x16_bf16 a[48:63], v[56:59], v[52:55], a[48:63]
    ds_read_b128 v[76:79], v24 offset:4096
    s_waitcnt lgkmcnt(8)
    v_mfma_f32_32x32x16_bf16 a[64:79], v[60:63], v[40:43], a[64:79]
    ds_read_b128 v[80:83], v24 offset:8192
    buffer_load_dwordx4 v7, s[12:15], s33 offen offset:2048 lds
    v_mfma_f32_32x32x16_bf16 a[80:95], v[60:63], v[44:47], a[80:95]
    ds_read_b128 v[84:87], v24 offset:12288
    v_mfma_f32_32x32x16_bf16 a[96:111], v[60:63], v[48:51], a[96:111]
    ds_read_b64_tr_b16 v[92:93], v26 offset:24576
    v_mfma_f32_32x32x16_bf16 a[112:127], v[60:63], v[52:55], a[112:127]
    ds_read_b64_tr_b16 v[94:95], v26 offset:26624
    s_waitcnt lgkmcnt(10)
    v_mfma_f32_32x32x16_bf16 a[128:143], v[64:67], v[40:43], a[128:143]
    ds_read_b64_tr_b16 v[96:97], v27 offset:24576
    v_mfma_f32_32x32x16_bf16 a[144:159], v[64:67], v[44:47], a[144:159]
    ds_read_b64_tr_b16 v[98:99], v27 offset:26624
    v_mfma_f32_32x32x16_bf16 a[160:175], v[64:67], v[48:51], a[160:175]
    ds_read_b64_tr_b16 v[100:101], v28 offset:24576
    v_mfma_f32_32x32x16_bf16 a[176:191], v[64:67], v[52:55], a[176:191]
    ds_read_b64_tr_b16 v[102:103], v28 offset:26624
    s_waitcnt lgkmcnt(12)
    v_mfma_f32_32x32x16_bf16 a[192:207], v[68:71], v[40:43], a[192:207]
    buffer_load_dwordx4 v8, s[12:15], s33 offen offset:3072 lds
    v_mfma_f32_32x32x16_bf16 a[208:223], v[68:71], v[44:47], a[208:223]
    v_mfma_f32_32x32x16_bf16 a[224:239], v[68:71], v[48:51], a[224:239]
    v_mfma_f32_32x32x16_bf16 a[240:255], v[68:71], v[52:55], a[240:255]
    s_waitcnt vmcnt(17) lgkmcnt(0)
    s_barrier
    s_cmp_eq_u32 s54, 0
    s_cbranch_scc0 k1_c0_0
    s_mov_b64 exec, 1
    v_mov_b32 v124, s2
    v_mov_b32 v125, 1
    buffer_store_byte v125, v124, s[60:63], 0 offen sc1
    s_mov_b64 exec, -1
k1_c0_0:
    v_mfma_f32_32x32x16_bf16 a[0:15], v[88:91], v[72:75], a[0:15]
    ds_read_b128 v[40:43], v17 offset:0
    v_mfma_f32_32x32x16_bf16 a[16:31], v[88:91], v[76:79], a[16:31]
    ds_read_b64_tr_b16 v[56:57], v25 offset:32768
    s_add_u32 m0, s32, 16384
    s_mov_b32 s33, 2359296
    buffer_load_dwordx4 v5, s[12:15], s33 offen lds
    v_mfma_f32_32x32x16_bf16 a[32:47], v[88:91], v[80:83], a[32:47]
    ds_read_b64_tr_b16 v[58:59], v25 offset:34816
    v_mfma_f32_32x32x16_bf16 a[48:63], v[88:91], v[84:87], a[48:63]
    ds_read_b128 v[44:47], v17 offset:4096
    buffer_load_dwordx4 v6, s[12:15], s33 offen offset:1024 lds
    v_mfma_f32_32x32x16_bf16 a[64:79], v[92:95], v[72:75], a[64:79]
    ds_read_b128 v[48:51], v17 offset:8192
    v_mfma_f32_32x32x16_bf16 a[80:95], v[92:95], v[76:79], a[80:95]
    ds_read_b128 v[52:55], v17 offset:12288
    v_mfma_f32_32x32x16_bf16 a[96:111], v[92:95], v[80:83], a[96:111]
    ds_read_b64_tr_b16 v[60:61], v26 offset:32768
    buffer_load_dwordx4 v7, s[12:15], s33 offen offset:2048 lds
    v_mfma_f32_32x32x16_bf16 a[112:127], v[92:95], v[84:87], a[112:127]
    ds_read_b64_tr_b16 v[62:63], v26 offset:34816
    v_mfma_f32_32x32x16_bf16 a[128:143], v[96:99], v[72:75], a[128:143]
    ds_read_b64_tr_b16 v[64:65], v27 offset:32768
    v_mfma_f32_32x32x16_bf16 a[144:159], v[96:99], v[76:79], a[144:159]
    ds_read_b64_tr_b16 v[66:67], v27 offset:34816
    buffer_load_dwordx4 v8, s[12:15], s33 offen offset:3072 lds
    v_mfma_f32_32x32x16_bf16 a[160:175], v[96:99], v[80:83], a[160:175]
    ds_read_b64_tr_b16 v[68:69], v28 offset:32768
    v_mfma_f32_32x32x16_bf16 a[176:191], v[96:99], v[84:87], a[176:191]
    ds_read_b64_tr_b16 v[70:71], v28 offset:34816
    s_add_u32 m0, s32, 131072
    s_mov_b32 s33, 640
    buffer_load_dwordx4 v1, s[8:11], s33 offen lds
    v_mfma_f32_32x32x16_bf16 a[192:207], v[100:103], v[72:75], a[192:207]
    v_mfma_f32_32x32x16_bf16 a[208:223], v[100:103], v[76:79], a[208:223]
    v_mfma_f32_32x32x16_bf16 a[224:239], v[100:103], v[80:83], a[224:239]
    buffer_load_dwordx4 v2, s[8:11], s33 offen offset:1024 lds
    s_mov_b32 s34, 1024
    buffer_store_dwordx4 v[196:199], v38, s[28:31], s34 offen sc1
    v_mfma_f32_32x32x16_bf16 a[240:255], v[100:103], v[84:87], a[240:255]
    s_waitcnt lgkmcnt(9)
    v_mfma_f32_32x32x16_bf16 a[0:15], v[56:59], v[40:43], a[0:15]
    ds_read_b128 v[72:75], v18 offset:0
    s_waitcnt lgkmcnt(9)
    v_mfma_f32_32x32x16_bf16 a[16:31], v[56:59], v[44:47], a[16:31]
    ds_read_b64_tr_b16 v[88:89], v25 offset:40960
    buffer_load_dwordx4 v3, s[8:11], s33 offen offset:2048 lds
    s_waitcnt lgkmcnt(9)
    v_mfma_f32_32x32x16_bf16 a[32:47], v[56:59], v[48:51], a[32:47]
    ds_read_b64_tr_b16 v[90:91], v25 offset:43008
    s_waitcnt lgkmcnt(9)
    v_mfma_f32_32x32x16_bf16 a[48:63], v[56:59], v[52:55], a[48:63]
    ds_read_b128 v[76:79], v18 offset:4096
    buffer_load_dwordx4 v4, s[8:11], s33 offen offset:3072 lds
    s_waitcnt lgkmcnt(8)
    v_mfma_f32_32x32x16_bf16 a[64:79], v[60:63], v[40:43], a[64:79]
    ds_read_b128 v[80:83], v18 offset:8192
    v_mfma_f32_32x32x16_bf16 a[80:95], v[60:63], v[44:47], a[80:95]
    ds_read_b128 v[84:87], v18 offset:12288
    v_mfma_f32_32x32x16_bf16 a[96:111], v[60:63], v[48:51], a[96:111]
    ds_read_b64_tr_b16 v[92:93], v26 offset:40960
    s_add_u32 m0, s32, 147456
    s_mov_b32 s33, 262784
    buffer_load_dwordx4 v1, s[8:11], s33 offen lds
    v_mfma_f32_32x32x16_bf16 a[112:127], v[60:63], v[52:55], a[112:127]
    ds_read_b64_tr_b16 v[94:95], v26 offset:43008
    s_waitcnt lgkmcnt(10)
    v_mfma_f32_32x32x16_bf16 a[128:143], v[64:67], v[40:43], a[128:143]
    ds_read_b64_tr_b16 v[96:97], v27 offset:40960
    v_mfma_f32_32x32x16_bf16 a[144:159], v[64:67], v[44:47], a[144:159]
    ds_read_b64_tr_b16 v[98:99], v27 offset:43008
    buffer_load_dwordx4 v2, s[8:11], s33 offen offset:1024 lds
    v_mfma_f32_32x32x16_bf16 a[160:175], v[64:67], v[48:51], a[160:175]
    ds_read_b64_tr_b16 v[100:101], v28 offset:40960
    v_mfma_f32_32x32x16_bf16 a[176:191], v[64:67], v[52:55], a[176:191]
    ds_read_b64_tr_b16 v[102:103], v28 offset:43008
    buffer_load_dwordx4 v3, s[8:11], s33 offen offset:2048 lds
    s_waitcnt lgkmcnt(12)
    v_mfma_f32_32x32x16_bf16 a[192:207], v[68:71], v[40:43], a[192:207]
    v_mfma_f32_32x32x16_bf16 a[208:223], v[68:71], v[44:47], a[208:223]
    v_mfma_f32_32x32x16_bf16 a[224:239], v[68:71], v[48:51], a[224:239]
    buffer_load_dwordx4 v4, s[8:11], s33 offen offset:3072 lds
    v_mfma_f32_32x32x16_bf16 a[240:255], v[68:71], v[52:55], a[240:255]
    s_waitcnt vmcnt(26) lgkmcnt(0)
    s_barrier
    v_mfma_f32_32x32x16_bf16 a[0:15], v[88:91], v[72:75], a[0:15]
    ds_read_b128 v[40:43], v19 offset:0
    v_mfma_f32_32x32x16_bf16 a[16:31], v[88:91], v[76:79], a[16:31]
    ds_read_b64_tr_b16 v[56:57], v25 offset:49152
    v_mfma_f32_32x32x16_bf16 a[32:47], v[88:91], v[80:83], a[32:47]
    ds_read_b64_tr_b16 v[58:59], v25 offset:51200
    v_mfma_f32_32x32x16_bf16 a[48:63], v[88:91], v[84:87], a[48:63]
    ds_read_b128 v[44:47], v19 offset:4096
    v_mfma_f32_32x32x16_bf16 a[64:79], v[92:95], v[72:75], a[64:79]
    ds_read_b128 v[48:51], v19 offset:8192
    s_add_u32 m0, s32, 32768
    s_mov_b32 s33, 2621440
    buffer_load_dwordx4 v5, s[12:15], s33 offen lds
    v_mfma_f32_32x32x16_bf16 a[80:95], v[92:95], v[76:79], a[80:95]
    ds_read_b128 v[52:55], v19 offset:12288
    v_mfma_f32_32x32x16_bf16 a[96:111], v[92:95], v[80:83], a[96:111]
    ds_read_b64_tr_b16 v[60:61], v26 offset:49152
    v_mfma_f32_32x32x16_bf16 a[112:127], v[92:95], v[84:87], a[112:127]
    ds_read_b64_tr_b16 v[62:63], v26 offset:51200
    v_mfma_f32_32x32x16_bf16 a[128:143], v[96:99], v[72:75], a[128:143]
    ds_read_b64_tr_b16 v[64:65], v27 offset:49152
    v_mfma_f32_32x32x16_bf16 a[144:159], v[96:99], v[76:79], a[144:159]
    ds_read_b64_tr_b16 v[66:67], v27 offset:51200
    v_mfma_f32_32x32x16_bf16 a[160:175], v[96:99], v[80:83], a[160:175]
    ds_read_b64_tr_b16 v[68:69], v28 offset:49152
    v_mfma_f32_32x32x16_bf16 a[176:191], v[96:99], v[84:87], a[176:191]
    ds_read_b64_tr_b16 v[70:71], v28 offset:51200
    v_mfma_f32_32x32x16_bf16 a[192:207], v[100:103], v[72:75], a[192:207]
    buffer_load_dwordx4 v6, s[12:15], s33 offen offset:1024 lds
    v_mfma_f32_32x32x16_bf16 a[208:223], v[100:103], v[76:79], a[208:223]
    v_mfma_f32_32x32x16_bf16 a[224:239], v[100:103], v[80:83], a[224:239]
    v_mfma_f32_32x32x16_bf16 a[240:255], v[100:103], v[84:87], a[240:255]
    s_waitcnt lgkmcnt(9)
    v_mfma_f32_32x32x16_bf16 a[0:15], v[56:59], v[40:43], a[0:15]
    ds_read_b128 v[72:75], v20 offset:0
    s_waitcnt lgkmcnt(9)
    v_mfma_f32_32x32x16_bf16 a[16:31], v[56:59], v[44:47], a[16:31]
    ds_read_b64_tr_b16 v[88:89], v25 offset:57344
    s_waitcnt lgkmcnt(9)
    v_mfma_f32_32x32x16_bf16 a[32:47], v[56:59], v[48:51], a[32:47]
    ds_read_b64_tr_b16 v[90:91], v25 offset:59392
    s_waitcnt lgkmcnt(9)
    v_mfma_f32_32x32x16_bf16 a[48:63], v[56:59], v[52:55], a[48:63]
    ds_read_b128 v[76:79], v20 offset:4096
    s_waitcnt lgkmcnt(8)
    v_mfma_f32_32x32x16_bf16 a[64:79], v[60:63], v[40:43], a[64:79]
    ds_read_b128 v[80:83], v20 offset:8192
    buffer_load_dwordx4 v7, s[12:15], s33 offen offset:2048 lds
    v_mfma_f32_32x32x16_bf16 a[80:95], v[60:63], v[44:47], a[80:95]
    ds_read_b128 v[84:87], v20 offset:12288
    v_mfma_f32_32x32x16_bf16 a[96:111], v[60:63], v[48:51], a[96:111]
    ds_read_b64_tr_b16 v[92:93], v26 offset:57344
    v_mfma_f32_32x32x16_bf16 a[112:127], v[60:63], v[52:55], a[112:127]
    ds_read_b64_tr_b16 v[94:95], v26 offset:59392
    s_waitcnt lgkmcnt(10)
    v_mfma_f32_32x32x16_bf16 a[128:143], v[64:67], v[40:43], a[128:143]
    ds_read_b64_tr_b16 v[96:97], v27 offset:57344
    v_mfma_f32_32x32x16_bf16 a[144:159], v[64:67], v[44:47], a[144:159]
    ds_read_b64_tr_b16 v[98:99], v27 offset:59392
    v_mfma_f32_32x32x16_bf16 a[160:175], v[64:67], v[48:51], a[160:175]
    ds_read_b64_tr_b16 v[100:101], v28 offset:57344
    v_mfma_f32_32x32x16_bf16 a[176:191], v[64:67], v[52:55], a[176:191]
    ds_read_b64_tr_b16 v[102:103], v28 offset:59392
    s_waitcnt lgkmcnt(12)
    v_mfma_f32_32x32x16_bf16 a[192:207], v[68:71], v[40:43], a[192:207]
    buffer_load_dwordx4 v8, s[12:15], s33 offen offset:3072 lds
    v_mfma_f32_32x32x16_bf16 a[208:223], v[68:71], v[44:47], a[208:223]
    v_mfma_f32_32x32x16_bf16 a[224:239], v[68:71], v[48:51], a[224:239]
    s_mov_b32 s34, 2048
    buffer_store_dwordx4 v[200:203], v38, s[28:31], s34 offen sc1
    v_mfma_f32_32x32x16_bf16 a[240:255], v[68:71], v[52:55], a[240:255]
    s_waitcnt vmcnt(18) lgkmcnt(0)
    s_barrier
    v_mfma_f32_32x32x16_bf16 a[0:15], v[88:91], v[72:75], a[0:15]
    ds_read_b128 v[40:43], v17 offset:32768
    v_mfma_f32_32x32x16_bf16 a[16:31], v[88:91], v[76:79], a[16:31]
    ds_read_b64_tr_b16 v[56:57], v25 offset:0
    s_add_u32 m0, s32, 49152
    s_mov_b32 s33, 2883584
    buffer_load_dwordx4 v5, s[12:15], s33 offen lds
    v_mfma_f32_32x32x16_bf16 a[32:47], v[88:91], v[80:83], a[32:47]
    ds_read_b64_tr_b16 v[58:59], v25 offset:2048
    v_mfma_f32_32x32x16_bf16 a[48:63], v[88:91], v[84:87], a[48:63]
    ds_read_b128 v[44:47], v17 offset:36864
    buffer_load_dwordx4 v6, s[12:15], s33 offen offset:1024 lds
    v_mfma_f32_32x32x16_bf16 a[64:79], v[92:95], v[72:75], a[64:79]
    ds_read_b128 v[48:51], v17 offset:40960
    v_mfma_f32_32x32x16_bf16 a[80:95], v[92:95], v[76:79], a[80:95]
    ds_read_b128 v[52:55], v17 offset:45056
    v_mfma_f32_32x32x16_bf16 a[96:111], v[92:95], v[80:83], a[96:111]
    ds_read_b64_tr_b16 v[60:61], v26 offset:0
    buffer_load_dwordx4 v7, s[12:15], s33 offen offset:2048 lds
    v_mfma_f32_32x32x16_bf16 a[112:127], v[92:95], v[84:87], a[112:127]
    ds_read_b64_tr_b16 v[62:63], v26 offset:2048
    v_mfma_f32_32x32x16_bf16 a[128:143], v[96:99], v[72:75], a[128:143]
    ds_read_b64_tr_b16 v[64:65], v27 offset:0
    v_mfma_f32_32x32x16_bf16 a[144:159], v[96:99], v[76:79], a[144:159]
    ds_read_b64_tr_b16 v[66:67], v27 offset:2048
    buffer_load_dwordx4 v8, s[12:15], s33 offen offset:3072 lds
    v_mfma_f32_32x32x16_bf16 a[160:175], v[96:99], v[80:83], a[160:175]
    ds_read_b64_tr_b16 v[68:69], v28 offset:0
    v_mfma_f32_32x32x16_bf16 a[176:191], v[96:99], v[84:87], a[176:191]
    ds_read_b64_tr_b16 v[70:71], v28 offset:2048
    s_add_u32 m0, s32, 65536
    s_mov_b32 s33, 768
    buffer_load_dwordx4 v1, s[8:11], s33 offen lds
    v_mfma_f32_32x32x16_bf16 a[192:207], v[100:103], v[72:75], a[192:207]
    v_mfma_f32_32x32x16_bf16 a[208:223], v[100:103], v[76:79], a[208:223]
    v_mfma_f32_32x32x16_bf16 a[224:239], v[100:103], v[80:83], a[224:239]
    buffer_load_dwordx4 v2, s[8:11], s33 offen offset:1024 lds
    v_mfma_f32_32x32x16_bf16 a[240:255], v[100:103], v[84:87], a[240:255]
    s_waitcnt lgkmcnt(9)
    v_mfma_f32_32x32x16_bf16 a[0:15], v[56:59], v[40:43], a[0:15]
    ds_read_b128 v[72:75], v18 offset:32768
    s_waitcnt lgkmcnt(9)
    v_mfma_f32_32x32x16_bf16 a[16:31], v[56:59], v[44:47], a[16:31]
    ds_read_b64_tr_b16 v[88:89], v25 offset:8192
    buffer_load_dwordx4 v3, s[8:11], s33 offen offset:2048 lds
    s_waitcnt lgkmcnt(9)
    v_mfma_f32_32x32x16_bf16 a[32:47], v[56:59], v[48:51], a[32:47]
    ds_read_b64_tr_b16 v[90:91], v25 offset:10240
    s_waitcnt lgkmcnt(9)
    v_mfma_f32_32x32x16_bf16 a[48:63], v[56:59], v[52:55], a[48:63]
    ds_read_b128 v[76:79], v18 offset:36864
    buffer_load_dwordx4 v4, s[8:11], s33 offen offset:3072 lds
    s_waitcnt lgkmcnt(8)
    v_mfma_f32_32x32x16_bf16 a[64:79], v[60:63], v[40:43], a[64:79]
    ds_read_b128 v[80:83], v18 offset:40960
    v_mfma_f32_32x32x16_bf16 a[80:95], v[60:63], v[44:47], a[80:95]
    ds_read_b128 v[84:87], v18 offset:45056
    v_mfma_f32_32x32x16_bf16 a[96:111], v[60:63], v[48:51], a[96:111]
    ds_read_b64_tr_b16 v[92:93], v26 offset:8192
    s_add_u32 m0, s32, 81920
    s_mov_b32 s33, 262912
    buffer_load_dwordx4 v1, s[8:11], s33 offen lds
    v_mfma_f32_32x32x16_bf16 a[112:127], v[60:63], v[52:55], a[112:127]
    ds_read_b64_tr_b16 v[94:95], v26 offset:10240
    s_waitcnt lgkmcnt(10)
    v_mfma_f32_32x32x16_bf16 a[128:143], v[64:67], v[40:43], a[128:143]
    ds_read_b64_tr_b16 v[96:97], v27 offset:8192
    v_mfma_f32_32x32x16_bf16 a[144:159], v[64:67], v[44:47], a[144:159]
    ds_read_b64_tr_b16 v[98:99], v27 offset:10240
    buffer_load_dwordx4 v2, s[8:11], s33 offen offset:1024 lds
    v_mfma_f32_32x32x16_bf16 a[160:175], v[64:67], v[48:51], a[160:175]
    ds_read_b64_tr_b16 v[100:101], v28 offset:8192
    v_mfma_f32_32x32x16_bf16 a[176:191], v[64:67], v[52:55], a[176:191]
    ds_read_b64_tr_b16 v[102:103], v28 offset:10240
    buffer_load_dwordx4 v3, s[8:11], s33 offen offset:2048 lds
    s_waitcnt lgkmcnt(12)
    v_mfma_f32_32x32x16_bf16 a[192:207], v[68:71], v[40:43], a[192:207]
    v_mfma_f32_32x32x16_bf16 a[208:223], v[68:71], v[44:47], a[208:223]
    v_mfma_f32_32x32x16_bf16 a[224:239], v[68:71], v[48:51], a[224:239]
    buffer_load_dwordx4 v4, s[8:11], s33 offen offset:3072 lds
    v_mfma_f32_32x32x16_bf16 a[240:255], v[68:71], v[52:55], a[240:255]
    s_waitcnt vmcnt(26) lgkmcnt(0)
    s_barrier
    v_mfma_f32_32x32x16_bf16 a[0:15], v[88:91], v[72:75], a[0:15]
    ds_read_b128 v[40:43], v19 offset:32768
    v_mfma_f32_32x32x16_bf16 a[16:31], v[88:91], v[76:79], a[16:31]
    ds_read_b64_tr_b16 v[56:57], v25 offset:16384
    v_mfma_f32_32x32x16_bf16 a[32:47], v[88:91], v[80:83], a[32:47]
    ds_read_b64_tr_b16 v[58:59], v25 offset:18432
    v_mfma_f32_32x32x16_bf16 a[48:63], v[88:91], v[84:87], a[48:63]
    ds_read_b128 v[44:47], v19 offset:36864
    v_mfma_f32_32x32x16_bf16 a[64:79], v[92:95], v[72:75], a[64:79]
    ds_read_b128 v[48:51], v19 offset:40960
    s_add_u32 m0, s32, 0
    s_mov_b32 s33, 3145728
    buffer_load_dwordx4 v5, s[12:15], s33 offen lds
    v_mfma_f32_32x32x16_bf16 a[80:95], v[92:95], v[76:79], a[80:95]
    ds_read_b128 v[52:55], v19 offset:45056
    v_mfma_f32_32x32x16_bf16 a[96:111], v[92:95], v[80:83], a[96:111]
    ds_read_b64_tr_b16 v[60:61], v26 offset:16384
    v_mfma_f32_32x32x16_bf16 a[112:127], v[92:95], v[84:87], a[112:127]
    ds_read_b64_tr_b16 v[62:63], v26 offset:18432
    v_mfma_f32_32x32x16_bf16 a[128:143], v[96:99], v[72:75], a[128:143]
    ds_read_b64_tr_b16 v[64:65], v27 offset:16384
    v_mfma_f32_32x32x16_bf16 a[144:159], v[96:99], v[76:79], a[144:159]
    ds_read_b64_tr_b16 v[66:67], v27 offset:18432
    v_mfma_f32_32x32x16_bf16 a[160:175], v[96:99], v[80:83], a[160:175]
    ds_read_b64_tr_b16 v[68:69], v28 offset:16384
    v_mfma_f32_32x32x16_bf16 a[176:191], v[96:99], v[84:87], a[176:191]
    ds_read_b64_tr_b16 v[70:71], v28 offset:18432
    v_mfma_f32_32x32x16_bf16 a[192:207], v[100:103], v[72:75], a[192:207]
    buffer_load_dwordx4 v6, s[12:15], s33 offen offset:1024 lds
    v_mfma_f32_32x32x16_bf16 a[208:223], v[100:103], v[76:79], a[208:223]
    v_mfma_f32_32x32x16_bf16 a[224:239], v[100:103], v[80:83], a[224:239]
    s_mov_b32 s34, 3072
    buffer_store_dwordx4 v[204:207], v38, s[28:31], s34 offen sc1
    v_mfma_f32_32x32x16_bf16 a[240:255], v[100:103], v[84:87], a[240:255]
    s_waitcnt lgkmcnt(9)
    v_mfma_f32_32x32x16_bf16 a[0:15], v[56:59], v[40:43], a[0:15]
    ds_read_b128 v[72:75], v20 offset:32768
    s_waitcnt lgkmcnt(9)
    v_mfma_f32_32x32x16_bf16 a[16:31], v[56:59], v[44:47], a[16:31]
    ds_read_b64_tr_b16 v[88:89], v25 offset:24576
    s_waitcnt lgkmcnt(9)
    v_mfma_f32_32x32x16_bf16 a[32:47], v[56:59], v[48:51], a[32:47]
    ds_read_b64_tr_b16 v[90:91], v25 offset:26624
    s_waitcnt lgkmcnt(9)
    v_mfma_f32_32x32x16_bf16 a[48:63], v[56:59], v[52:55], a[48:63]
    ds_read_b128 v[76:79], v20 offset:36864
    s_waitcnt lgkmcnt(8)
    v_mfma_f32_32x32x16_bf16 a[64:79], v[60:63], v[40:43], a[64:79]
    ds_read_b128 v[80:83], v20 offset:40960
    buffer_load_dwordx4 v7, s[12:15], s33 offen offset:2048 lds
    v_mfma_f32_32x32x16_bf16 a[80:95], v[60:63], v[44:47], a[80:95]
    ds_read_b128 v[84:87], v20 offset:45056
    v_mfma_f32_32x32x16_bf16 a[96:111], v[60:63], v[48:51], a[96:111]
    ds_read_b64_tr_b16 v[92:93], v26 offset:24576
    v_mfma_f32_32x32x16_bf16 a[112:127], v[60:63], v[52:55], a[112:127]
    ds_read_b64_tr_b16 v[94:95], v26 offset:26624
    s_waitcnt lgkmcnt(10)
    v_mfma_f32_32x32x16_bf16 a[128:143], v[64:67], v[40:43], a[128:143]
    ds_read_b64_tr_b16 v[96:97], v27 offset:24576
    v_mfma_f32_32x32x16_bf16 a[144:159], v[64:67], v[44:47], a[144:159]
    ds_read_b64_tr_b16 v[98:99], v27 offset:26624
    v_mfma_f32_32x32x16_bf16 a[160:175], v[64:67], v[48:51], a[160:175]
    ds_read_b64_tr_b16 v[100:101], v28 offset:24576
    v_mfma_f32_32x32x16_bf16 a[176:191], v[64:67], v[52:55], a[176:191]
    ds_read_b64_tr_b16 v[102:103], v28 offset:26624
    s_waitcnt lgkmcnt(12)
    v_mfma_f32_32x32x16_bf16 a[192:207], v[68:71], v[40:43], a[192:207]
    buffer_load_dwordx4 v8, s[12:15], s33 offen offset:3072 lds
    v_mfma_f32_32x32x16_bf16 a[208:223], v[68:71], v[44:47], a[208:223]
    v_mfma_f32_32x32x16_bf16 a[224:239], v[68:71], v[48:51], a[224:239]
    v_mfma_f32_32x32x16_bf16 a[240:255], v[68:71], v[52:55], a[240:255]
    s_waitcnt vmcnt(18) lgkmcnt(0)
    s_barrier
    v_mfma_f32_32x32x16_bf16 a[0:15], v[88:91], v[72:75], a[0:15]
    ds_read_b128 v[40:43], v21 offset:0
    v_mfma_f32_32x32x16_bf16 a[16:31], v[88:91], v[76:79], a[16:31]
    ds_read_b64_tr_b16 v[56:57], v25 offset:32768
    v_mfma_f32_32x32x16_bf16 a[32:47], v[88:91], v[80:83], a[32:47]
    ds_read_b64_tr_b16 v[58:59], v25 offset:34816
    s_add_u32 m0, s32, 16384
    s_mov_b32 s33, 3407872
    buffer_load_dwordx4 v5, s[12:15], s33 offen lds
    v_mfma_f32_32x32x16_bf16 a[48:63], v[88:91], v[84:87], a[48:63]
    ds_read_b128 v[44:47], v21 offset:4096
    v_mfma_f32_32x32x16_bf16 a[64:79], v[92:95], v[72:75], a[64:79]
    ds_read_b128 v[48:51], v21 offset:8192
    v_mfma_f32_32x32x16_bf16 a[80:95], v[92:95], v[76:79], a[80:95]
    ds_read_b128 v[52:55], v21 offset:12288
    v_mfma_f32_32x32x16_bf16 a[96:111], v[92:95], v[80:83], a[96:111]
    ds_read_b64_tr_b16 v[60:61], v26 offset:32768
    buffer_load_dwordx4 v6, s[12:15], s33 offen offset:1024 lds
    v_mfma_f32_32x32x16_bf16 a[112:127], v[92:95], v[84:87], a[112:127]
    ds_read_b64_tr_b16 v[62:63], v26 offset:34816
    v_mfma_f32_32x32x16_bf16 a[128:143], v[96:99], v[72:75], a[128:143]
    ds_read_b64_tr_b16 v[64:65], v27 offset:32768
    v_mfma_f32_32x32x16_bf16 a[144:159], v[96:99], v[76:79], a[144:159]
    ds_read_b64_tr_b16 v[66:67], v27 offset:34816
    v_mfma_f32_32x32x16_bf16 a[160:175], v[96:99], v[80:83], a[160:175]
    ds_read_b64_tr_b16 v[68:69], v28 offset:32768
    buffer_load_dwordx4 v7, s[12:15], s33 offen offset:2048 lds
    v_mfma_f32_32x32x16_bf16 a[176:191], v[96:99], v[84:87], a[176:191]
    ds_read_b64_tr_b16 v[70:71], v28 offset:34816
    v_mfma_f32_32x32x16_bf16 a[192:207], v[100:103], v[72:75], a[192:207]
    v_mfma_f32_32x32x16_bf16 a[208:223], v[100:103], v[76:79], a[208:223]
    v_mfma_f32_32x32x16_bf16 a[224:239], v[100:103], v[80:83], a[224:239]
    buffer_load_dwordx4 v8, s[12:15], s33 offen offset:3072 lds
    v_mfma_f32_32x32x16_bf16 a[240:255], v[100:103], v[84:87], a[240:255]
    s_waitcnt lgkmcnt(9)
    v_mfma_f32_32x32x16_bf16 a[0:15], v[56:59], v[40:43], a[0:15]
    ds_read_b128 v[72:75], v22 offset:0
    s_waitcnt lgkmcnt(9)
    v_mfma_f32_32x32x16_bf16 a[16:31], v[56:59], v[44:47], a[16:31]
    ds_read_b64_tr_b16 v[88:89], v25 offset:40960
    s_waitcnt lgkmcnt(9)
    v_mfma_f32_32x32x16_bf16 a[32:47], v[56:59], v[48:51], a[32:47]
    ds_read_b64_tr_b16 v[90:91], v25 offset:43008
    s_add_u32 m0, s32, 98304
    s_mov_b32 s33, 896
    buffer_load_dwordx4 v1, s[8:11], s33 offen lds
    s_waitcnt lgkmcnt(9)
    v_mfma_f32_32x32x16_bf16 a[48:63], v[56:59], v[52:55], a[48:63]
    ds_read_b128 v[76:79], v22 offset:4096
    s_waitcnt lgkmcnt(8)
    v_mfma_f32_32x32x16_bf16 a[64:79], v[60:63], v[40:43], a[64:79]
    ds_read_b128 v[80:83], v22 offset:8192
    v_mfma_f32_32x32x16_bf16 a[80:95], v[60:63], v[44:47], a[80:95]
    ds_read_b128 v[84:87], v22 offset:12288
    v_mfma_f32_32x32x16_bf16 a[96:111], v[60:63], v[48:51], a[96:111]
    ds_read_b64_tr_b16 v[92:93], v26 offset:40960
    buffer_load_dwordx4 v2, s[8:11], s33 offen offset:1024 lds
    v_mfma_f32_32x32x16_bf16 a[112:127], v[60:63], v[52:55], a[112:127]
    ds_read_b64_tr_b16 v[94:95], v26 offset:43008
    s_waitcnt lgkmcnt(10)
    v_mfma_f32_32x32x16_bf16 a[128:143], v[64:67], v[40:43], a[128:143]
    ds_read_b64_tr_b16 v[96:97], v27 offset:40960
    v_mfma_f32_32x32x16_bf16 a[144:159], v[64:67], v[44:47], a[144:159]
    ds_read_b64_tr_b16 v[98:99], v27 offset:43008
    v_mfma_f32_32x32x16_bf16 a[160:175], v[64:67], v[48:51], a[160:175]
    ds_read_b64_tr_b16 v[100:101], v28 offset:40960
    buffer_load_dwordx4 v3, s[8:11], s33 offen offset:2048 lds
    v_mfma_f32_32x32x16_bf16 a[176:191], v[64:67], v[52:55], a[176:191]
    ds_read_b64_tr_b16 v[102:103], v28 offset:43008
    s_waitcnt lgkmcnt(12)
    v_mfma_f32_32x32x16_bf16 a[192:207], v[68:71], v[40:43], a[192:207]
    v_mfma_f32_32x32x16_bf16 a[208:223], v[68:71], v[44:47], a[208:223]
    v_mfma_f32_32x32x16_bf16 a[224:239], v[68:71], v[48:51], a[224:239]
    buffer_load_dwordx4 v4, s[8:11], s33 offen offset:3072 lds
    s_mov_b32 s34, 4096
    buffer_store_dwordx4 v[208:211], v38, s[28:31], s34 offen sc1
    v_mfma_f32_32x32x16_bf16 a[240:255], v[68:71], v[52:55], a[240:255]
    s_waitcnt vmcnt(22) lgkmcnt(0)
    s_barrier
    v_mfma_f32_32x32x16_bf16 a[0:15], v[88:91], v[72:75], a[0:15]
    ds_read_b128 v[40:43], v23 offset:0
    v_mfma_f32_32x32x16_bf16 a[16:31], v[88:91], v[76:79], a[16:31]
    ds_read_b64_tr_b16 v[56:57], v25 offset:49152
    v_mfma_f32_32x32x16_bf16 a[32:47], v[88:91], v[80:83], a[32:47]
    ds_read_b64_tr_b16 v[58:59], v25 offset:51200
    s_add_u32 m0, s32, 114688
    s_mov_b32 s33, 263040
    buffer_load_dwordx4 v1, s[8:11], s33 offen lds
    v_mfma_f32_32x32x16_bf16 a[48:63], v[88:91], v[84:87], a[48:63]
    ds_read_b128 v[44:47], v23 offset:4096
    v_mfma_f32_32x32x16_bf16 a[64:79], v[92:95], v[72:75], a[64:79]
    ds_read_b128 v[48:51], v23 offset:8192
    v_mfma_f32_32x32x16_bf16 a[80:95], v[92:95], v[76:79], a[80:95]
    ds_read_b128 v[52:55], v23 offset:12288
    v_mfma_f32_32x32x16_bf16 a[96:111], v[92:95], v[80:83], a[96:111]
    ds_read_b64_tr_b16 v[60:61], v26 offset:49152
    buffer_load_dwordx4 v2, s[8:11], s33 offen offset:1024 lds
    v_mfma_f32_32x32x16_bf16 a[112:127], v[92:95], v[84:87], a[112:127]
    ds_read_b64_tr_b16 v[62:63], v26 offset:51200
    v_mfma_f32_32x32x16_bf16 a[128:143], v[96:99], v[72:75], a[128:143]
    ds_read_b64_tr_b16 v[64:65], v27 offset:49152
    v_mfma_f32_32x32x16_bf16 a[144:159], v[96:99], v[76:79], a[144:159]
    ds_read_b64_tr_b16 v[66:67], v27 offset:51200
    v_mfma_f32_32x32x16_bf16 a[160:175], v[96:99], v[80:83], a[160:175]
    ds_read_b64_tr_b16 v[68:69], v28 offset:49152
    buffer_load_dwordx4 v3, s[8:11], s33 offen offset:2048 lds
    v_mfma_f32_32x32x16_bf16 a[176:191], v[96:99], v[84:87], a[176:191]
    ds_read_b64_tr_b16 v[70:71], v28 offset:51200
    v_mfma_f32_32x32x16_bf16 a[192:207], v[100:103], v[72:75], a[192:207]
    v_mfma_f32_32x32x16_bf16 a[208:223], v[100:103], v[76:79], a[208:223]
    v_mfma_f32_32x32x16_bf16 a[224:239], v[100:103], v[80:83], a[224:239]
    buffer_load_dwordx4 v4, s[8:11], s33 offen offset:3072 lds
    v_mfma_f32_32x32x16_bf16 a[240:255], v[100:103], v[84:87], a[240:255]
    s_waitcnt lgkmcnt(9)
    v_mfma_f32_32x32x16_bf16 a[0:15], v[56:59], v[40:43], a[0:15]
    ds_read_b128 v[72:75], v24 offset:0
    s_waitcnt lgkmcnt(9)
    v_mfma_f32_32x32x16_bf16 a[16:31], v[56:59], v[44:47], a[16:31]
    ds_read_b64_tr_b16 v[88:89], v25 offset:57344
    s_waitcnt lgkmcnt(9)
    v_mfma_f32_32x32x16_bf16 a[32:47], v[56:59], v[48:51], a[32:47]
    ds_read_b64_tr_b16 v[90:91], v25 offset:59392
    s_add_u32 m0, s32, 32768
    s_mov_b32 s33, 3670016
    buffer_load_dwordx4 v5, s[12:15], s33 offen lds
    s_waitcnt lgkmcnt(9)
    v_mfma_f32_32x32x16_bf16 a[48:63], v[56:59], v[52:55], a[48:63]
    ds_read_b128 v[76:79], v24 offset:4096
    s_waitcnt lgkmcnt(8)
    v_mfma_f32_32x32x16_bf16 a[64:79], v[60:63], v[40:43], a[64:79]
    ds_read_b128 v[80:83], v24 offset:8192
    v_mfma_f32_32x32x16_bf16 a[80:95], v[60:63], v[44:47], a[80:95]
    ds_read_b128 v[84:87], v24 offset:12288
    v_mfma_f32_32x32x16_bf16 a[96:111], v[60:63], v[48:51], a[96:111]
    ds_read_b64_tr_b16 v[92:93], v26 offset:57344
    buffer_load_dwordx4 v6, s[12:15], s33 offen offset:1024 lds
    v_mfma_f32_32x32x16_bf16 a[112:127], v[60:63], v[52:55], a[112:127]
    ds_read_b64_tr_b16 v[94:95], v26 offset:59392
    s_waitcnt lgkmcnt(10)
    v_mfma_f32_32x32x16_bf16 a[128:143], v[64:67], v[40:43], a[128:143]
    ds_read_b64_tr_b16 v[96:97], v27 offset:57344
    v_mfma_f32_32x32x16_bf16 a[144:159], v[64:67], v[44:47], a[144:159]
    ds_read_b64_tr_b16 v[98:99], v27 offset:59392
    v_mfma_f32_32x32x16_bf16 a[160:175], v[64:67], v[48:51], a[160:175]
    ds_read_b64_tr_b16 v[100:101], v28 offset:57344
    buffer_load_dwordx4 v7, s[12:15], s33 offen offset:2048 lds
    v_mfma_f32_32x32x16_bf16 a[176:191], v[64:67], v[52:55], a[176:191]
    ds_read_b64_tr_b16 v[102:103], v28 offset:59392
    s_waitcnt lgkmcnt(12)
    v_mfma_f32_32x32x16_bf16 a[192:207], v[68:71], v[40:43], a[192:207]
    v_mfma_f32_32x32x16_bf16 a[208:223], v[68:71], v[44:47], a[208:223]
    v_mfma_f32_32x32x16_bf16 a[224:239], v[68:71], v[48:51], a[224:239]
    buffer_load_dwordx4 v8, s[12:15], s33 offen offset:3072 lds
    v_mfma_f32_32x32x16_bf16 a[240:255], v[68:71], v[52:55], a[240:255]
    s_waitcnt vmcnt(17) lgkmcnt(0)
    s_barrier
    v_mfma_f32_32x32x16_bf16 a[0:15], v[88:91], v[72:75], a[0:15]
    ds_read_b128 v[40:43], v17 offset:0
    v_mfma_f32_32x32x16_bf16 a[16:31], v[88:91], v[76:79], a[16:31]
    ds_read_b64_tr_b16 v[56:57], v25 offset:0
    v_mfma_f32_32x32x16_bf16 a[32:47], v[88:91], v[80:83], a[32:47]
    ds_read_b64_tr_b16 v[58:59], v25 offset:2048
    s_add_u32 m0, s32, 49152
    s_mov_b32 s33, 3932160
    buffer_load_dwordx4 v5, s[12:15], s33 offen lds
    v_mfma_f32_32x32x16_bf16 a[48:63], v[88:91], v[84:87], a[48:63]
    ds_read_b128 v[44:47], v17 offset:4096
    v_mfma_f32_32x32x16_bf16 a[64:79], v[92:95], v[72:75], a[64:79]
    ds_read_b128 v[48:51], v17 offset:8192
    v_mfma_f32_32x32x16_bf16 a[80:95], v[92:95], v[76:79], a[80:95]
    ds_read_b128 v[52:55], v17 offset:12288
    v_mfma_f32_32x32x16_bf16 a[96:111], v[92:95], v[80:83], a[96:111]
    ds_read_b64_tr_b16 v[60:61], v26 offset:0
    buffer_load_dwordx4 v6, s[12:15], s33 offen offset:1024 lds
    v_mfma_f32_32x32x16_bf16 a[112:127], v[92:95], v[84:87], a[112:127]
    ds_read_b64_tr_b16 v[62:63], v26 offset:2048
    v_mfma_f32_32x32x16_bf16 a[128:143], v[96:99], v[72:75], a[128:143]
    ds_read_b64_tr_b16 v[64:65], v27 offset:0
    v_mfma_f32_32x32x16_bf16 a[144:159], v[96:99], v[76:79], a[144:159]
    ds_read_b64_tr_b16 v[66:67], v27 offset:2048
    v_mfma_f32_32x32x16_bf16 a[160:175], v[96:99], v[80:83], a[160:175]
    ds_read_b64_tr_b16 v[68:69], v28 offset:0
    buffer_load_dwordx4 v7, s[12:15], s33 offen offset:2048 lds
    v_mfma_f32_32x32x16_bf16 a[176:191], v[96:99], v[84:87], a[176:191]
    ds_read_b64_tr_b16 v[70:71], v28 offset:2048
    v_mfma_f32_32x32x16_bf16 a[192:207], v[100:103], v[72:75], a[192:207]
    v_mfma_f32_32x32x16_bf16 a[208:223], v[100:103], v[76:79], a[208:223]
    v_mfma_f32_32x32x16_bf16 a[224:239], v[100:103], v[80:83], a[224:239]
    buffer_load_dwordx4 v8, s[12:15], s33 offen offset:3072 lds
    s_mov_b32 s34, 5120
    buffer_store_dwordx4 v[212:215], v38, s[28:31], s34 offen sc1
    v_mfma_f32_32x32x16_bf16 a[240:255], v[100:103], v[84:87], a[240:255]
    s_waitcnt lgkmcnt(9)
    v_mfma_f32_32x32x16_bf16 a[0:15], v[56:59], v[40:43], a[0:15]
    ds_read_b128 v[72:75], v18 offset:0
    s_waitcnt lgkmcnt(9)
    v_mfma_f32_32x32x16_bf16 a[16:31], v[56:59], v[44:47], a[16:31]
    ds_read_b64_tr_b16 v[88:89], v25 offset:8192
    s_waitcnt lgkmcnt(9)
    v_mfma_f32_32x32x16_bf16 a[32:47], v[56:59], v[48:51], a[32:47]
    ds_read_b64_tr_b16 v[90:91], v25 offset:10240
    s_add_u32 m0, s32, 131072
    s_mov_b32 s33, 1024
    buffer_load_dwordx4 v1, s[8:11], s33 offen lds
    s_waitcnt lgkmcnt(9)
    v_mfma_f32_32x32x16_bf16 a[48:63], v[56:59], v[52:55], a[48:63]
    ds_read_b128 v[76:79], v18 offset:4096
    s_waitcnt lgkmcnt(8)
    v_mfma_f32_32x32x16_bf16 a[64:79], v[60:63], v[40:43], a[64:79]
    ds_read_b128 v[80:83], v18 offset:8192
    v_mfma_f32_32x32x16_bf16 a[80:95], v[60:63], v[44:47], a[80:95]
    ds_read_b128 v[84:87], v18 offset:12288
    v_mfma_f32_32x32x16_bf16 a[96:111], v[60:63], v[48:51], a[96:111]
    ds_read_b64_tr_b16 v[92:93], v26 offset:8192
    buffer_load_dwordx4 v2, s[8:11], s33 offen offset:1024 lds
    v_mfma_f32_32x32x16_bf16 a[112:127], v[60:63], v[52:55], a[112:127]
    ds_read_b64_tr_b16 v[94:95], v26 offset:10240
    s_waitcnt lgkmcnt(10)
    v_mfma_f32_32x32x16_bf16 a[128:143], v[64:67], v[40:43], a[128:143]
    ds_read_b64_tr_b16 v[96:97], v27 offset:8192
    v_mfma_f32_32x32x16_bf16 a[144:159], v[64:67], v[44:47], a[144:159]
    ds_read_b64_tr_b16 v[98:99], v27 offset:10240
    v_mfma_f32_32x32x16_bf16 a[160:175], v[64:67], v[48:51], a[160:175]
    ds_read_b64_tr_b16 v[100:101], v28 offset:8192
    buffer_load_dwordx4 v3, s[8:11], s33 offen offset:2048 lds
    v_mfma_f32_32x32x16_bf16 a[176:191], v[64:67], v[52:55], a[176:191]
    ds_read_b64_tr_b16 v[102:103], v28 offset:10240
    s_waitcnt lgkmcnt(12)
    v_mfma_f32_32x32x16_bf16 a[192:207], v[68:71], v[40:43], a[192:207]
    v_mfma_f32_32x32x16_bf16 a[208:223], v[68:71], v[44:47], a[208:223]
    v_mfma_f32_32x32x16_bf16 a[224:239], v[68:71], v[48:51], a[224:239]
    buffer_load_dwordx4 v4, s[8:11], s33 offen offset:3072 lds
    v_mfma_f32_32x32x16_bf16 a[240:255], v[68:71], v[52:55], a[240:255]
    s_waitcnt vmcnt(22) lgkmcnt(0)
    s_barrier
    v_mfma_f32_32x32x16_bf16 a[0:15], v[88:91], v[72:75], a[0:15]
    ds_read_b128 v[40:43], v19 offset:0
    v_mfma_f32_32x32x16_bf16 a[16:31], v[88:91], v[76:79], a[16:31]
    ds_read_b64_tr_b16 v[56:57], v25 offset:16384
    v_mfma_f32_32x32x16_bf16 a[32:47], v[88:91], v[80:83], a[32:47]
    ds_read_b64_tr_b16 v[58:59], v25 offset:18432
    s_add_u32 m0, s32, 147456
    s_mov_b32 s33, 263168
    buffer_load_dwordx4 v1, s[8:11], s33 offen lds
    v_mfma_f32_32x32x16_bf16 a[48:63], v[88:91], v[84:87], a[48:63]
    ds_read_b128 v[44:47], v19 offset:4096
    v_mfma_f32_32x32x16_bf16 a[64:79], v[92:95], v[72:75], a[64:79]
    ds_read_b128 v[48:51], v19 offset:8192
    v_mfma_f32_32x32x16_bf16 a[80:95], v[92:95], v[76:79], a[80:95]
    ds_read_b128 v[52:55], v19 offset:12288
    v_mfma_f32_32x32x16_bf16 a[96:111], v[92:95], v[80:83], a[96:111]
    ds_read_b64_tr_b16 v[60:61], v26 offset:16384
    buffer_load_dwordx4 v2, s[8:11], s33 offen offset:1024 lds
    v_mfma_f32_32x32x16_bf16 a[112:127], v[92:95], v[84:87], a[112:127]
    ds_read_b64_tr_b16 v[62:63], v26 offset:18432
    v_mfma_f32_32x32x16_bf16 a[128:143], v[96:99], v[72:75], a[128:143]
    ds_read_b64_tr_b16 v[64:65], v27 offset:16384
    v_mfma_f32_32x32x16_bf16 a[144:159], v[96:99], v[76:79], a[144:159]
    ds_read_b64_tr_b16 v[66:67], v27 offset:18432
    v_mfma_f32_32x32x16_bf16 a[160:175], v[96:99], v[80:83], a[160:175]
    ds_read_b64_tr_b16 v[68:69], v28 offset:16384
    buffer_load_dwordx4 v3, s[8:11], s33 offen offset:2048 lds
    v_mfma_f32_32x32x16_bf16 a[176:191], v[96:99], v[84:87], a[176:191]
    ds_read_b64_tr_b16 v[70:71], v28 offset:18432
    v_mfma_f32_32x32x16_bf16 a[192:207], v[100:103], v[72:75], a[192:207]
    v_mfma_f32_32x32x16_bf16 a[208:223], v[100:103], v[76:79], a[208:223]
    v_mfma_f32_32x32x16_bf16 a[224:239], v[100:103], v[80:83], a[224:239]
    buffer_load_dwordx4 v4, s[8:11], s33 offen offset:3072 lds
    v_mfma_f32_32x32x16_bf16 a[240:255], v[100:103], v[84:87], a[240:255]
    s_waitcnt lgkmcnt(9)
    v_mfma_f32_32x32x16_bf16 a[0:15], v[56:59], v[40:43], a[0:15]
    ds_read_b128 v[72:75], v20 offset:0
    s_waitcnt lgkmcnt(9)
    v_mfma_f32_32x32x16_bf16 a[16:31], v[56:59], v[44:47], a[16:31]
    ds_read_b64_tr_b16 v[88:89], v25 offset:24576
    s_waitcnt lgkmcnt(9)
    v_mfma_f32_32x32x16_bf16 a[32:47], v[56:59], v[48:51], a[32:47]
    ds_read_b64_tr_b16 v[90:91], v25 offset:26624
    s_add_u32 m0, s32, 0
    s_mov_b32 s33, 4194304
    buffer_load_dwordx4 v5, s[12:15], s33 offen lds
    s_waitcnt lgkmcnt(9)
    v_mfma_f32_32x32x16_bf16 a[48:63], v[56:59], v[52:55], a[48:63]
    ds_read_b128 v[76:79], v20 offset:4096
    s_waitcnt lgkmcnt(8)
    v_mfma_f32_32x32x16_bf16 a[64:79], v[60:63], v[40:43], a[64:79]
    ds_read_b128 v[80:83], v20 offset:8192
    v_mfma_f32_32x32x16_bf16 a[80:95], v[60:63], v[44:47], a[80:95]
    ds_read_b128 v[84:87], v20 offset:12288
    v_mfma_f32_32x32x16_bf16 a[96:111], v[60:63], v[48:51], a[96:111]
    ds_read_b64_tr_b16 v[92:93], v26 offset:24576
    buffer_load_dwordx4 v6, s[12:15], s33 offen offset:1024 lds
    v_mfma_f32_32x32x16_bf16 a[112:127], v[60:63], v[52:55], a[112:127]
    ds_read_b64_tr_b16 v[94:95], v26 offset:26624
    s_waitcnt lgkmcnt(10)
    v_mfma_f32_32x32x16_bf16 a[128:143], v[64:67], v[40:43], a[128:143]
    ds_read_b64_tr_b16 v[96:97], v27 offset:24576
    v_mfma_f32_32x32x16_bf16 a[144:159], v[64:67], v[44:47], a[144:159]
    ds_read_b64_tr_b16 v[98:99], v27 offset:26624
    v_mfma_f32_32x32x16_bf16 a[160:175], v[64:67], v[48:51], a[160:175]
    ds_read_b64_tr_b16 v[100:101], v28 offset:24576
    buffer_load_dwordx4 v7, s[12:15], s33 offen offset:2048 lds
    v_mfma_f32_32x32x16_bf16 a[176:191], v[64:67], v[52:55], a[176:191]
    ds_read_b64_tr_b16 v[102:103], v28 offset:26624
    s_waitcnt lgkmcnt(12)
    v_mfma_f32_32x32x16_bf16 a[192:207], v[68:71], v[40:43], a[192:207]
    v_mfma_f32_32x32x16_bf16 a[208:223], v[68:71], v[44:47], a[208:223]
    v_mfma_f32_32x32x16_bf16 a[224:239], v[68:71], v[48:51], a[224:239]
    buffer_load_dwordx4 v8, s[12:15], s33 offen offset:3072 lds
    s_mov_b32 s34, 6144
    buffer_store_dwordx4 v[216:219], v38, s[28:31], s34 offen sc1
    v_mfma_f32_32x32x16_bf16 a[240:255], v[68:71], v[52:55], a[240:255]
    s_waitcnt vmcnt(18) lgkmcnt(0)
    s_barrier
    v_mfma_f32_32x32x16_bf16 a[0:15], v[88:91], v[72:75], a[0:15]
    ds_read_b128 v[40:43], v17 offset:32768
    v_mfma_f32_32x32x16_bf16 a[16:31], v[88:91], v[76:79], a[16:31]
    ds_read_b64_tr_b16 v[56:57], v25 offset:32768
    v_mfma_f32_32x32x16_bf16 a[32:47], v[88:91], v[80:83], a[32:47]
    ds_read_b64_tr_b16 v[58:59], v25 offset:34816
    s_add_u32 m0, s32, 16384
    s_mov_b32 s33, 4456448
    buffer_load_dwordx4 v5, s[12:15], s33 offen lds
    v_mfma_f32_32x32x16_bf16 a[48:63], v[88:91], v[84:87], a[48:63]
    ds_read_b128 v[44:47], v17 offset:36864
    v_mfma_f32_32x32x16_bf16 a[64:79], v[92:95], v[72:75], a[64:79]
    ds_read_b128 v[48:51], v17 offset:40960
    v_mfma_f32_32x32x16_bf16 a[80:95], v[92:95], v[76:79], a[80:95]
    ds_read_b128 v[52:55], v17 offset:45056
    v_mfma_f32_32x32x16_bf16 a[96:111], v[92:95], v[80:83], a[96:111]
    ds_read_b64_tr_b16 v[60:61], v26 offset:32768
    buffer_load_dwordx4 v6, s[12:15], s33 offen offset:1024 lds
    v_mfma_f32_32x32x16_bf16 a[112:127], v[92:95], v[84:87], a[112:127]
    ds_read_b64_tr_b16 v[62:63], v26 offset:34816
    v_mfma_f32_32x32x16_bf16 a[128:143], v[96:99], v[72:75], a[128:143]
    ds_read_b64_tr_b16 v[64:65], v27 offset:32768
    v_mfma_f32_32x32x16_bf16 a[144:159], v[96:99], v[76:79], a[144:159]
    ds_read_b64_tr_b16 v[66:67], v27 offset:34816
    v_mfma_f32_32x32x16_bf16 a[160:175], v[96:99], v[80:83], a[160:175]
    ds_read_b64_tr_b16 v[68:69], v28 offset:32768
    buffer_load_dwordx4 v7, s[12:15], s33 offen offset:2048 lds
    v_mfma_f32_32x32x16_bf16 a[176:191], v[96:99], v[84:87], a[176:191]
    ds_read_b64_tr_b16 v[70:71], v28 offset:34816
    v_mfma_f32_32x32x16_bf16 a[192:207], v[100:103], v[72:75], a[192:207]
    v_mfma_f32_32x32x16_bf16 a[208:223], v[100:103], v[76:79], a[208:223]
    v_mfma_f32_32x32x16_bf16 a[224:239], v[100:103], v[80:83], a[224:239]
    buffer_load_dwordx4 v8, s[12:15], s33 offen offset:3072 lds
    v_mfma_f32_32x32x16_bf16 a[240:255], v[100:103], v[84:87], a[240:255]
    s_waitcnt lgkmcnt(9)
    v_mfma_f32_32x32x16_bf16 a[0:15], v[56:59], v[40:43], a[0:15]
    ds_read_b128 v[72:75], v18 offset:32768
    s_waitcnt lgkmcnt(9)
    v_mfma_f32_32x32x16_bf16 a[16:31], v[56:59], v[44:47], a[16:31]
    ds_read_b64_tr_b16 v[88:89], v25 offset:40960
    s_waitcnt lgkmcnt(9)
    v_mfma_f32_32x32x16_bf16 a[32:47], v[56:59], v[48:51], a[32:47]
    ds_read_b64_tr_b16 v[90:91], v25 offset:43008
    s_add_u32 m0, s32, 65536
    s_mov_b32 s33, 1152
    buffer_load_dwordx4 v1, s[8:11], s33 offen lds
    s_waitcnt lgkmcnt(9)
    v_mfma_f32_32x32x16_bf16 a[48:63], v[56:59], v[52:55], a[48:63]
    ds_read_b128 v[76:79], v18 offset:36864
    s_waitcnt lgkmcnt(8)
    v_mfma_f32_32x32x16_bf16 a[64:79], v[60:63], v[40:43], a[64:79]
    ds_read_b128 v[80:83], v18 offset:40960
    v_mfma_f32_32x32x16_bf16 a[80:95], v[60:63], v[44:47], a[80:95]
    ds_read_b128 v[84:87], v18 offset:45056
    v_mfma_f32_32x32x16_bf16 a[96:111], v[60:63], v[48:51], a[96:111]
    ds_read_b64_tr_b16 v[92:93], v26 offset:40960
    buffer_load_dwordx4 v2, s[8:11], s33 offen offset:1024 lds
    v_mfma_f32_32x32x16_bf16 a[112:127], v[60:63], v[52:55], a[112:127]
    ds_read_b64_tr_b16 v[94:95], v26 offset:43008
    s_waitcnt lgkmcnt(10)
    v_mfma_f32_32x32x16_bf16 a[128:143], v[64:67], v[40:43], a[128:143]
    ds_read_b64_tr_b16 v[96:97], v27 offset:40960
    v_mfma_f32_32x32x16_bf16 a[144:159], v[64:67], v[44:47], a[144:159]
    ds_read_b64_tr_b16 v[98:99], v27 offset:43008
    v_mfma_f32_32x32x16_bf16 a[160:175], v[64:67], v[48:51], a[160:175]
    ds_read_b64_tr_b16 v[100:101], v28 offset:40960
    buffer_load_dwordx4 v3, s[8:11], s33 offen offset:2048 lds
    v_mfma_f32_32x32x16_bf16 a[176:191], v[64:67], v[52:55], a[176:191]
    ds_read_b64_tr_b16 v[102:103], v28 offset:43008
    s_waitcnt lgkmcnt(12)
    v_mfma_f32_32x32x16_bf16 a[192:207], v[68:71], v[40:43], a[192:207]
    v_mfma_f32_32x32x16_bf16 a[208:223], v[68:71], v[44:47], a[208:223]
    v_mfma_f32_32x32x16_bf16 a[224:239], v[68:71], v[48:51], a[224:239]
    buffer_load_dwordx4 v4, s[8:11], s33 offen offset:3072 lds
    v_mfma_f32_32x32x16_bf16 a[240:255], v[68:71], v[52:55], a[240:255]
    s_waitcnt vmcnt(22) lgkmcnt(0)
    s_barrier
    v_mfma_f32_32x32x16_bf16 a[0:15], v[88:91], v[72:75], a[0:15]
    ds_read_b128 v[40:43], v19 offset:32768
    v_mfma_f32_32x32x16_bf16 a[16:31], v[88:91], v[76:79], a[16:31]
    ds_read_b64_tr_b16 v[56:57], v25 offset:49152
    v_mfma_f32_32x32x16_bf16 a[32:47], v[88:91], v[80:83], a[32:47]
    ds_read_b64_tr_b16 v[58:59], v25 offset:51200
    s_add_u32 m0, s32, 81920
    s_mov_b32 s33, 263296
    buffer_load_dwordx4 v1, s[8:11], s33 offen lds
    v_mfma_f32_32x32x16_bf16 a[48:63], v[88:91], v[84:87], a[48:63]
    ds_read_b128 v[44:47], v19 offset:36864
    v_mfma_f32_32x32x16_bf16 a[64:79], v[92:95], v[72:75], a[64:79]
    ds_read_b128 v[48:51], v19 offset:40960
    v_mfma_f32_32x32x16_bf16 a[80:95], v[92:95], v[76:79], a[80:95]
    ds_read_b128 v[52:55], v19 offset:45056
    v_mfma_f32_32x32x16_bf16 a[96:111], v[92:95], v[80:83], a[96:111]
    ds_read_b64_tr_b16 v[60:61], v26 offset:49152
    buffer_load_dwordx4 v2, s[8:11], s33 offen offset:1024 lds
    v_mfma_f32_32x32x16_bf16 a[112:127], v[92:95], v[84:87], a[112:127]
    ds_read_b64_tr_b16 v[62:63], v26 offset:51200
    v_mfma_f32_32x32x16_bf16 a[128:143], v[96:99], v[72:75], a[128:143]
    ds_read_b64_tr_b16 v[64:65], v27 offset:49152
    v_mfma_f32_32x32x16_bf16 a[144:159], v[96:99], v[76:79], a[144:159]
    ds_read_b64_tr_b16 v[66:67], v27 offset:51200
    v_mfma_f32_32x32x16_bf16 a[160:175], v[96:99], v[80:83], a[160:175]
    ds_read_b64_tr_b16 v[68:69], v28 offset:49152
    buffer_load_dwordx4 v3, s[8:11], s33 offen offset:2048 lds
    v_mfma_f32_32x32x16_bf16 a[176:191], v[96:99], v[84:87], a[176:191]
    ds_read_b64_tr_b16 v[70:71], v28 offset:51200
    v_mfma_f32_32x32x16_bf16 a[192:207], v[100:103], v[72:75], a[192:207]
    v_mfma_f32_32x32x16_bf16 a[208:223], v[100:103], v[76:79], a[208:223]
    v_mfma_f32_32x32x16_bf16 a[224:239], v[100:103], v[80:83], a[224:239]
    buffer_load_dwordx4 v4, s[8:11], s33 offen offset:3072 lds
    s_mov_b32 s34, 7168
    buffer_store_dwordx4 v[220:223], v38, s[28:31], s34 offen sc1
    v_mfma_f32_32x32x16_bf16 a[240:255], v[100:103], v[84:87], a[240:255]
    s_waitcnt lgkmcnt(9)
    v_mfma_f32_32x32x16_bf16 a[0:15], v[56:59], v[40:43], a[0:15]
    ds_read_b128 v[72:75], v20 offset:32768
    s_waitcnt lgkmcnt(9)
    v_mfma_f32_32x32x16_bf16 a[16:31], v[56:59], v[44:47], a[16:31]
    ds_read_b64_tr_b16 v[88:89], v25 offset:57344
    s_waitcnt lgkmcnt(9)
    v_mfma_f32_32x32x16_bf16 a[32:47], v[56:59], v[48:51], a[32:47]
    ds_read_b64_tr_b16 v[90:91], v25 offset:59392
    s_add_u32 m0, s32, 32768
    s_mov_b32 s33, 4718592
    buffer_load_dwordx4 v5, s[12:15], s33 offen lds
    s_waitcnt lgkmcnt(9)
    v_mfma_f32_32x32x16_bf16 a[48:63], v[56:59], v[52:55], a[48:63]
    ds_read_b128 v[76:79], v20 offset:36864
    s_waitcnt lgkmcnt(8)
    v_mfma_f32_32x32x16_bf16 a[64:79], v[60:63], v[40:43], a[64:79]
    ds_read_b128 v[80:83], v20 offset:40960
    v_mfma_f32_32x32x16_bf16 a[80:95], v[60:63], v[44:47], a[80:95]
    ds_read_b128 v[84:87], v20 offset:45056
    v_mfma_f32_32x32x16_bf16 a[96:111], v[60:63], v[48:51], a[96:111]
    ds_read_b64_tr_b16 v[92:93], v26 offset:57344
    buffer_load_dwordx4 v6, s[12:15], s33 offen offset:1024 lds
    v_mfma_f32_32x32x16_bf16 a[112:127], v[60:63], v[52:55], a[112:127]
    ds_read_b64_tr_b16 v[94:95], v26 offset:59392
    s_waitcnt lgkmcnt(10)
    v_mfma_f32_32x32x16_bf16 a[128:143], v[64:67], v[40:43], a[128:143]
    ds_read_b64_tr_b16 v[96:97], v27 offset:57344
    v_mfma_f32_32x32x16_bf16 a[144:159], v[64:67], v[44:47], a[144:159]
    ds_read_b64_tr_b16 v[98:99], v27 offset:59392
    v_mfma_f32_32x32x16_bf16 a[160:175], v[64:67], v[48:51], a[160:175]
    ds_read_b64_tr_b16 v[100:101], v28 offset:57344
    buffer_load_dwordx4 v7, s[12:15], s33 offen offset:2048 lds
    v_mfma_f32_32x32x16_bf16 a[176:191], v[64:67], v[52:55], a[176:191]
    ds_read_b64_tr_b16 v[102:103], v28 offset:59392
    s_waitcnt lgkmcnt(12)
    v_mfma_f32_32x32x16_bf16 a[192:207], v[68:71], v[40:43], a[192:207]
    v_mfma_f32_32x32x16_bf16 a[208:223], v[68:71], v[44:47], a[208:223]
    v_mfma_f32_32x32x16_bf16 a[224:239], v[68:71], v[48:51], a[224:239]
    buffer_load_dwordx4 v8, s[12:15], s33 offen offset:3072 lds
    v_mfma_f32_32x32x16_bf16 a[240:255], v[68:71], v[52:55], a[240:255]
    s_waitcnt vmcnt(18) lgkmcnt(0)
    s_barrier
    v_mfma_f32_32x32x16_bf16 a[0:15], v[88:91], v[72:75], a[0:15]
    ds_read_b128 v[40:43], v21 offset:0
    v_mfma_f32_32x32x16_bf16 a[16:31], v[88:91], v[76:79], a[16:31]
    ds_read_b64_tr_b16 v[56:57], v25 offset:0
    v_mfma_f32_32x32x16_bf16 a[32:47], v[88:91], v[80:83], a[32:47]
    ds_read_b64_tr_b16 v[58:59], v25 offset:2048
    s_add_u32 m0, s32, 49152
    s_mov_b32 s33, 4980736
    buffer_load_dwordx4 v5, s[12:15], s33 offen lds
    v_mfma_f32_32x32x16_bf16 a[48:63], v[88:91], v[84:87], a[48:63]
    ds_read_b128 v[44:47], v21 offset:4096
    v_mfma_f32_32x32x16_bf16 a[64:79], v[92:95], v[72:75], a[64:79]
    ds_read_b128 v[48:51], v21 offset:8192
    v_mfma_f32_32x32x16_bf16 a[80:95], v[92:95], v[76:79], a[80:95]
    ds_read_b128 v[52:55], v21 offset:12288
    v_mfma_f32_32x32x16_bf16 a[96:111], v[92:95], v[80:83], a[96:111]
    ds_read_b64_tr_b16 v[60:61], v26 offset:0
    buffer_load_dwordx4 v6, s[12:15], s33 offen offset:1024 lds
    v_mfma_f32_32x32x16_bf16 a[112:127], v[92:95], v[84:87], a[112:127]
    ds_read_b64_tr_b16 v[62:63], v26 offset:2048
    v_mfma_f32_32x32x16_bf16 a[128:143], v[96:99], v[72:75], a[128:143]
    ds_read_b64_tr_b16 v[64:65], v27 offset:0
    v_mfma_f32_32x32x16_bf16 a[144:159], v[96:99], v[76:79], a[144:159]
    ds_read_b64_tr_b16 v[66:67], v27 offset:2048
    v_mfma_f32_32x32x16_bf16 a[160:175], v[96:99], v[80:83], a[160:175]
    ds_read_b64_tr_b16 v[68:69], v28 offset:0
    buffer_load_dwordx4 v7, s[12:15], s33 offen offset:2048 lds
    v_mfma_f32_32x32x16_bf16 a[176:191], v[96:99], v[84:87], a[176:191]
    ds_read_b64_tr_b16 v[70:71], v28 offset:2048
    v_mfma_f32_32x32x16_bf16 a[192:207], v[100:103], v[72:75], a[192:207]
    v_mfma_f32_32x32x16_bf16 a[208:223], v[100:103], v[76:79], a[208:223]
    v_mfma_f32_32x32x16_bf16 a[224:239], v[100:103], v[80:83], a[224:239]
    buffer_load_dwordx4 v8, s[12:15], s33 offen offset:3072 lds
    v_mfma_f32_32x32x16_bf16 a[240:255], v[100:103], v[84:87], a[240:255]
    s_waitcnt lgkmcnt(9)
    v_mfma_f32_32x32x16_bf16 a[0:15], v[56:59], v[40:43], a[0:15]
    ds_read_b128 v[72:75], v22 offset:0
    s_waitcnt lgkmcnt(9)
    v_mfma_f32_32x32x16_bf16 a[16:31], v[56:59], v[44:47], a[16:31]
    ds_read_b64_tr_b16 v[88:89], v25 offset:8192
    s_waitcnt lgkmcnt(9)
    v_mfma_f32_32x32x16_bf16 a[32:47], v[56:59], v[48:51], a[32:47]
    ds_read_b64_tr_b16 v[90:91], v25 offset:10240
    s_add_u32 m0, s32, 98304
    s_mov_b32 s33, 1280
    buffer_load_dwordx4 v1, s[8:11], s33 offen lds
    s_waitcnt lgkmcnt(9)
    v_mfma_f32_32x32x16_bf16 a[48:63], v[56:59], v[52:55], a[48:63]
    ds_read_b128 v[76:79], v22 offset:4096
    s_waitcnt lgkmcnt(8)
    v_mfma_f32_32x32x16_bf16 a[64:79], v[60:63], v[40:43], a[64:79]
    ds_read_b128 v[80:83], v22 offset:8192
    v_mfma_f32_32x32x16_bf16 a[80:95], v[60:63], v[44:47], a[80:95]
    ds_read_b128 v[84:87], v22 offset:12288
    v_mfma_f32_32x32x16_bf16 a[96:111], v[60:63], v[48:51], a[96:111]
    ds_read_b64_tr_b16 v[92:93], v26 offset:8192
    buffer_load_dwordx4 v2, s[8:11], s33 offen offset:1024 lds
    v_mfma_f32_32x32x16_bf16 a[112:127], v[60:63], v[52:55], a[112:127]
    ds_read_b64_tr_b16 v[94:95], v26 offset:10240
    s_waitcnt lgkmcnt(10)
    v_mfma_f32_32x32x16_bf16 a[128:143], v[64:67], v[40:43], a[128:143]
    ds_read_b64_tr_b16 v[96:97], v27 offset:8192
    v_mfma_f32_32x32x16_bf16 a[144:159], v[64:67], v[44:47], a[144:159]
    ds_read_b64_tr_b16 v[98:99], v27 offset:10240
    v_mfma_f32_32x32x16_bf16 a[160:175], v[64:67], v[48:51], a[160:175]
    ds_read_b64_tr_b16 v[100:101], v28 offset:8192
    buffer_load_dwordx4 v3, s[8:11], s33 offen offset:2048 lds
    v_mfma_f32_32x32x16_bf16 a[176:191], v[64:67], v[52:55], a[176:191]
    ds_read_b64_tr_b16 v[102:103], v28 offset:10240
    s_waitcnt lgkmcnt(12)
    v_mfma_f32_32x32x16_bf16 a[192:207], v[68:71], v[40:43], a[192:207]
    v_mfma_f32_32x32x16_bf16 a[208:223], v[68:71], v[44:47], a[208:223]
    v_mfma_f32_32x32x16_bf16 a[224:239], v[68:71], v[48:51], a[224:239]
    buffer_load_dwordx4 v4, s[8:11], s33 offen offset:3072 lds
    s_mov_b32 s34, 8192
    buffer_store_dwordx4 v[224:227], v38, s[28:31], s34 offen sc1
    v_mfma_f32_32x32x16_bf16 a[240:255], v[68:71], v[52:55], a[240:255]
    s_waitcnt vmcnt(22) lgkmcnt(0)
    s_barrier
    v_mfma_f32_32x32x16_bf16 a[0:15], v[88:91], v[72:75], a[0:15]
    ds_read_b128 v[40:43], v23 offset:0
    v_mfma_f32_32x32x16_bf16 a[16:31], v[88:91], v[76:79], a[16:31]
    ds_read_b64_tr_b16 v[56:57], v25 offset:16384
    v_mfma_f32_32x32x16_bf16 a[32:47], v[88:91], v[80:83], a[32:47]
    ds_read_b64_tr_b16 v[58:59], v25 offset:18432
    s_add_u32 m0, s32, 114688
    s_mov_b32 s33, 263424
    buffer_load_dwordx4 v1, s[8:11], s33 offen lds
    v_mfma_f32_32x32x16_bf16 a[48:63], v[88:91], v[84:87], a[48:63]
    ds_read_b128 v[44:47], v23 offset:4096
    v_mfma_f32_32x32x16_bf16 a[64:79], v[92:95], v[72:75], a[64:79]
    ds_read_b128 v[48:51], v23 offset:8192
    v_mfma_f32_32x32x16_bf16 a[80:95], v[92:95], v[76:79], a[80:95]
    ds_read_b128 v[52:55], v23 offset:12288
    v_mfma_f32_32x32x16_bf16 a[96:111], v[92:95], v[80:83], a[96:111]
    ds_read_b64_tr_b16 v[60:61], v26 offset:16384
    buffer_load_dwordx4 v2, s[8:11], s33 offen offset:1024 lds
    v_mfma_f32_32x32x16_bf16 a[112:127], v[92:95], v[84:87], a[112:127]
    ds_read_b64_tr_b16 v[62:63], v26 offset:18432
    v_mfma_f32_32x32x16_bf16 a[128:143], v[96:99], v[72:75], a[128:143]
    ds_read_b64_tr_b16 v[64:65], v27 offset:16384
    v_mfma_f32_32x32x16_bf16 a[144:159], v[96:99], v[76:79], a[144:159]
    ds_read_b64_tr_b16 v[66:67], v27 offset:18432
    v_mfma_f32_32x32x16_bf16 a[160:175], v[96:99], v[80:83], a[160:175]
    ds_read_b64_tr_b16 v[68:69], v28 offset:16384
    buffer_load_dwordx4 v3, s[8:11], s33 offen offset:2048 lds
    v_mfma_f32_32x32x16_bf16 a[176:191], v[96:99], v[84:87], a[176:191]
    ds_read_b64_tr_b16 v[70:71], v28 offset:18432
    v_mfma_f32_32x32x16_bf16 a[192:207], v[100:103], v[72:75], a[192:207]
    v_mfma_f32_32x32x16_bf16 a[208:223], v[100:103], v[76:79], a[208:223]
    v_mfma_f32_32x32x16_bf16 a[224:239], v[100:103], v[80:83], a[224:239]
    buffer_load_dwordx4 v4, s[8:11], s33 offen offset:3072 lds
    v_mfma_f32_32x32x16_bf16 a[240:255], v[100:103], v[84:87], a[240:255]
    s_waitcnt lgkmcnt(9)
    v_mfma_f32_32x32x16_bf16 a[0:15], v[56:59], v[40:43], a[0:15]
    ds_read_b128 v[72:75], v24 offset:0
    s_waitcnt lgkmcnt(9)
    v_mfma_f32_32x32x16_bf16 a[16:31], v[56:59], v[44:47], a[16:31]
    ds_read_b64_tr_b16 v[88:89], v25 offset:24576
    s_waitcnt lgkmcnt(9)
    v_mfma_f32_32x32x16_bf16 a[32:47], v[56:59], v[48:51], a[32:47]
    ds_read_b64_tr_b16 v[90:91], v25 offset:26624
    s_add_u32 m0, s32, 0
    s_mov_b32 s33, 5242880
    buffer_load_dwordx4 v5, s[12:15], s33 offen lds
    s_waitcnt lgkmcnt(9)
    v_mfma_f32_32x32x16_bf16 a[48:63], v[56:59], v[52:55], a[48:63]
    ds_read_b128 v[76:79], v24 offset:4096
    s_waitcnt lgkmcnt(8)
    v_mfma_f32_32x32x16_bf16 a[64:79], v[60:63], v[40:43], a[64:79]
    ds_read_b128 v[80:83], v24 offset:8192
    v_mfma_f32_32x32x16_bf16 a[80:95], v[60:63], v[44:47], a[80:95]
    ds_read_b128 v[84:87], v24 offset:12288
    v_mfma_f32_32x32x16_bf16 a[96:111], v[60:63], v[48:51], a[96:111]
    ds_read_b64_tr_b16 v[92:93], v26 offset:24576
    buffer_load_dwordx4 v6, s[12:15], s33 offen offset:1024 lds
    v_mfma_f32_32x32x16_bf16 a[112:127], v[60:63], v[52:55], a[112:127]
    ds_read_b64_tr_b16 v[94:95], v26 offset:26624
    s_waitcnt lgkmcnt(10)
    v_mfma_f32_32x32x16_bf16 a[128:143], v[64:67], v[40:43], a[128:143]
    ds_read_b64_tr_b16 v[96:97], v27 offset:24576
    v_mfma_f32_32x32x16_bf16 a[144:159], v[64:67], v[44:47], a[144:159]
    ds_read_b64_tr_b16 v[98:99], v27 offset:26624
    v_mfma_f32_32x32x16_bf16 a[160:175], v[64:67], v[48:51], a[160:175]
    ds_read_b64_tr_b16 v[100:101], v28 offset:24576
    buffer_load_dwordx4 v7, s[12:15], s33 offen offset:2048 lds
    v_mfma_f32_32x32x16_bf16 a[176:191], v[64:67], v[52:55], a[176:191]
    ds_read_b64_tr_b16 v[102:103], v28 offset:26624
    s_waitcnt lgkmcnt(12)
    v_mfma_f32_32x32x16_bf16 a[192:207], v[68:71], v[40:43], a[192:207]
    v_mfma_f32_32x32x16_bf16 a[208:223], v[68:71], v[44:47], a[208:223]
    v_mfma_f32_32x32x16_bf16 a[224:239], v[68:71], v[48:51], a[224:239]
    buffer_load_dwordx4 v8, s[12:15], s33 offen offset:3072 lds
    v_mfma_f32_32x32x16_bf16 a[240:255], v[68:71], v[52:55], a[240:255]
    s_waitcnt vmcnt(17) lgkmcnt(0)
    s_barrier
    v_mfma_f32_32x32x16_bf16 a[0:15], v[88:91], v[72:75], a[0:15]
    ds_read_b128 v[40:43], v17 offset:0
    v_mfma_f32_32x32x16_bf16 a[16:31], v[88:91], v[76:79], a[16:31]
    ds_read_b64_tr_b16 v[56:57], v25 offset:32768
    v_mfma_f32_32x32x16_bf16 a[32:47], v[88:91], v[80:83], a[32:47]
    ds_read_b64_tr_b16 v[58:59], v25 offset:34816
    s_add_u32 m0, s32, 16384
    s_mov_b32 s33, 5505024
    buffer_load_dwordx4 v5, s[12:15], s33 offen lds
    v_mfma_f32_32x32x16_bf16 a[48:63], v[88:91], v[84:87], a[48:63]
    ds_read_b128 v[44:47], v17 offset:4096
    v_mfma_f32_32x32x16_bf16 a[64:79], v[92:95], v[72:75], a[64:79]
    ds_read_b128 v[48:51], v17 offset:8192
    v_mfma_f32_32x32x16_bf16 a[80:95], v[92:95], v[76:79], a[80:95]
    ds_read_b128 v[52:55], v17 offset:12288
    v_mfma_f32_32x32x16_bf16 a[96:111], v[92:95], v[80:83], a[96:111]
    ds_read_b64_tr_b16 v[60:61], v26 offset:32768
    buffer_load_dwordx4 v6, s[12:15], s33 offen offset:1024 lds
    v_mfma_f32_32x32x16_bf16 a[112:127], v[92:95], v[84:87], a[112:127]
    ds_read_b64_tr_b16 v[62:63], v26 offset:34816
    v_mfma_f32_32x32x16_bf16 a[128:143], v[96:99], v[72:75], a[128:143]
    ds_read_b64_tr_b16 v[64:65], v27 offset:32768
    v_mfma_f32_32x32x16_bf16 a[144:159], v[96:99], v[76:79], a[144:159]
    ds_read_b64_tr_b16 v[66:67], v27 offset:34816
    v_mfma_f32_32x32x16_bf16 a[160:175], v[96:99], v[80:83], a[160:175]
    ds_read_b64_tr_b16 v[68:69], v28 offset:32768
    buffer_load_dwordx4 v7, s[12:15], s33 offen offset:2048 lds
    v_mfma_f32_32x32x16_bf16 a[176:191], v[96:99], v[84:87], a[176:191]
    ds_read_b64_tr_b16 v[70:71], v28 offset:34816
    v_mfma_f32_32x32x16_bf16 a[192:207], v[100:103], v[72:75], a[192:207]
    v_mfma_f32_32x32x16_bf16 a[208:223], v[100:103], v[76:79], a[208:223]
    v_mfma_f32_32x32x16_bf16 a[224:239], v[100:103], v[80:83], a[224:239]
    buffer_load_dwordx4 v8, s[12:15], s33 offen offset:3072 lds
    s_mov_b32 s34, 9216
    buffer_store_dwordx4 v[228:231], v38, s[28:31], s34 offen sc1
    v_mfma_f32_32x32x16_bf16 a[240:255], v[100:103], v[84:87], a[240:255]
    s_waitcnt lgkmcnt(9)
    v_mfma_f32_32x32x16_bf16 a[0:15], v[56:59], v[40:43], a[0:15]
    ds_read_b128 v[72:75], v18 offset:0
    s_waitcnt lgkmcnt(9)
    v_mfma_f32_32x32x16_bf16 a[16:31], v[56:59], v[44:47], a[16:31]
    ds_read_b64_tr_b16 v[88:89], v25 offset:40960
    s_waitcnt lgkmcnt(9)
    v_mfma_f32_32x32x16_bf16 a[32:47], v[56:59], v[48:51], a[32:47]
    ds_read_b64_tr_b16 v[90:91], v25 offset:43008
    s_add_u32 m0, s32, 131072
    s_mov_b32 s33, 1408
    buffer_load_dwordx4 v1, s[8:11], s33 offen lds
    s_waitcnt lgkmcnt(9)
    v_mfma_f32_32x32x16_bf16 a[48:63], v[56:59], v[52:55], a[48:63]
    ds_read_b128 v[76:79], v18 offset:4096
    s_waitcnt lgkmcnt(8)
    v_mfma_f32_32x32x16_bf16 a[64:79], v[60:63], v[40:43], a[64:79]
    ds_read_b128 v[80:83], v18 offset:8192
    v_mfma_f32_32x32x16_bf16 a[80:95], v[60:63], v[44:47], a[80:95]
    ds_read_b128 v[84:87], v18 offset:12288
    v_mfma_f32_32x32x16_bf16 a[96:111], v[60:63], v[48:51], a[96:111]
    ds_read_b64_tr_b16 v[92:93], v26 offset:40960
    buffer_load_dwordx4 v2, s[8:11], s33 offen offset:1024 lds
    v_mfma_f32_32x32x16_bf16 a[112:127], v[60:63], v[52:55], a[112:127]
    ds_read_b64_tr_b16 v[94:95], v26 offset:43008
    s_waitcnt lgkmcnt(10)
    v_mfma_f32_32x32x16_bf16 a[128:143], v[64:67], v[40:43], a[128:143]
    ds_read_b64_tr_b16 v[96:97], v27 offset:40960
    v_mfma_f32_32x32x16_bf16 a[144:159], v[64:67], v[44:47], a[144:159]
    ds_read_b64_tr_b16 v[98:99], v27 offset:43008
    v_mfma_f32_32x32x16_bf16 a[160:175], v[64:67], v[48:51], a[160:175]
    ds_read_b64_tr_b16 v[100:101], v28 offset:40960
    buffer_load_dwordx4 v3, s[8:11], s33 offen offset:2048 lds
    v_mfma_f32_32x32x16_bf16 a[176:191], v[64:67], v[52:55], a[176:191]
    ds_read_b64_tr_b16 v[102:103], v28 offset:43008
    s_waitcnt lgkmcnt(12)
    v_mfma_f32_32x32x16_bf16 a[192:207], v[68:71], v[40:43], a[192:207]
    v_mfma_f32_32x32x16_bf16 a[208:223], v[68:71], v[44:47], a[208:223]
    v_mfma_f32_32x32x16_bf16 a[224:239], v[68:71], v[48:51], a[224:239]
    buffer_load_dwordx4 v4, s[8:11], s33 offen offset:3072 lds
    v_mfma_f32_32x32x16_bf16 a[240:255], v[68:71], v[52:55], a[240:255]
    s_waitcnt vmcnt(22) lgkmcnt(0)
    s_barrier
    v_mfma_f32_32x32x16_bf16 a[0:15], v[88:91], v[72:75], a[0:15]
    ds_read_b128 v[40:43], v19 offset:0
    v_mfma_f32_32x32x16_bf16 a[16:31], v[88:91], v[76:79], a[16:31]
    ds_read_b64_tr_b16 v[56:57], v25 offset:49152
    v_mfma_f32_32x32x16_bf16 a[32:47], v[88:91], v[80:83], a[32:47]
    ds_read_b64_tr_b16 v[58:59], v25 offset:51200
    s_add_u32 m0, s32, 147456
    s_mov_b32 s33, 263552
    buffer_load_dwordx4 v1, s[8:11], s33 offen lds
    v_mfma_f32_32x32x16_bf16 a[48:63], v[88:91], v[84:87], a[48:63]
    ds_read_b128 v[44:47], v19 offset:4096
    v_mfma_f32_32x32x16_bf16 a[64:79], v[92:95], v[72:75], a[64:79]
    ds_read_b128 v[48:51], v19 offset:8192
    v_mfma_f32_32x32x16_bf16 a[80:95], v[92:95], v[76:79], a[80:95]
    ds_read_b128 v[52:55], v19 offset:12288
    v_mfma_f32_32x32x16_bf16 a[96:111], v[92:95], v[80:83], a[96:111]
    ds_read_b64_tr_b16 v[60:61], v26 offset:49152
    buffer_load_dwordx4 v2, s[8:11], s33 offen offset:1024 lds
    v_mfma_f32_32x32x16_bf16 a[112:127], v[92:95], v[84:87], a[112:127]
    ds_read_b64_tr_b16 v[62:63], v26 offset:51200
    v_mfma_f32_32x32x16_bf16 a[128:143], v[96:99], v[72:75], a[128:143]
    ds_read_b64_tr_b16 v[64:65], v27 offset:49152
    v_mfma_f32_32x32x16_bf16 a[144:159], v[96:99], v[76:79], a[144:159]
    ds_read_b64_tr_b16 v[66:67], v27 offset:51200
    v_mfma_f32_32x32x16_bf16 a[160:175], v[96:99], v[80:83], a[160:175]
    ds_read_b64_tr_b16 v[68:69], v28 offset:49152
    buffer_load_dwordx4 v3, s[8:11], s33 offen offset:2048 lds
    v_mfma_f32_32x32x16_bf16 a[176:191], v[96:99], v[84:87], a[176:191]
    ds_read_b64_tr_b16 v[70:71], v28 offset:51200
    v_mfma_f32_32x32x16_bf16 a[192:207], v[100:103], v[72:75], a[192:207]
    v_mfma_f32_32x32x16_bf16 a[208:223], v[100:103], v[76:79], a[208:223]
    v_mfma_f32_32x32x16_bf16 a[224:239], v[100:103], v[80:83], a[224:239]
    buffer_load_dwordx4 v4, s[8:11], s33 offen offset:3072 lds
    v_mfma_f32_32x32x16_bf16 a[240:255], v[100:103], v[84:87], a[240:255]
    s_waitcnt lgkmcnt(9)
    v_mfma_f32_32x32x16_bf16 a[0:15], v[56:59], v[40:43], a[0:15]
    ds_read_b128 v[72:75], v20 offset:0
    s_waitcnt lgkmcnt(9)
    v_mfma_f32_32x32x16_bf16 a[16:31], v[56:59], v[44:47], a[16:31]
    ds_read_b64_tr_b16 v[88:89], v25 offset:57344
    s_waitcnt lgkmcnt(9)
    v_mfma_f32_32x32x16_bf16 a[32:47], v[56:59], v[48:51], a[32:47]
    ds_read_b64_tr_b16 v[90:91], v25 offset:59392
    s_add_u32 m0, s32, 32768
    s_mov_b32 s33, 5767168
    buffer_load_dwordx4 v5, s[12:15], s33 offen lds
    s_waitcnt lgkmcnt(9)
    v_mfma_f32_32x32x16_bf16 a[48:63], v[56:59], v[52:55], a[48:63]
    ds_read_b128 v[76:79], v20 offset:4096
    s_waitcnt lgkmcnt(8)
    v_mfma_f32_32x32x16_bf16 a[64:79], v[60:63], v[40:43], a[64:79]
    ds_read_b128 v[80:83], v20 offset:8192
    v_mfma_f32_32x32x16_bf16 a[80:95], v[60:63], v[44:47], a[80:95]
    ds_read_b128 v[84:87], v20 offset:12288
    v_mfma_f32_32x32x16_bf16 a[96:111], v[60:63], v[48:51], a[96:111]
    ds_read_b64_tr_b16 v[92:93], v26 offset:57344
    buffer_load_dwordx4 v6, s[12:15], s33 offen offset:1024 lds
    v_mfma_f32_32x32x16_bf16 a[112:127], v[60:63], v[52:55], a[112:127]
    ds_read_b64_tr_b16 v[94:95], v26 offset:59392
    s_waitcnt lgkmcnt(10)
    v_mfma_f32_32x32x16_bf16 a[128:143], v[64:67], v[40:43], a[128:143]
    ds_read_b64_tr_b16 v[96:97], v27 offset:57344
    v_mfma_f32_32x32x16_bf16 a[144:159], v[64:67], v[44:47], a[144:159]
    ds_read_b64_tr_b16 v[98:99], v27 offset:59392
    v_mfma_f32_32x32x16_bf16 a[160:175], v[64:67], v[48:51], a[160:175]
    ds_read_b64_tr_b16 v[100:101], v28 offset:57344
    buffer_load_dwordx4 v7, s[12:15], s33 offen offset:2048 lds
    v_mfma_f32_32x32x16_bf16 a[176:191], v[64:67], v[52:55], a[176:191]
    ds_read_b64_tr_b16 v[102:103], v28 offset:59392
    s_waitcnt lgkmcnt(12)
    v_mfma_f32_32x32x16_bf16 a[192:207], v[68:71], v[40:43], a[192:207]
    v_mfma_f32_32x32x16_bf16 a[208:223], v[68:71], v[44:47], a[208:223]
    v_mfma_f32_32x32x16_bf16 a[224:239], v[68:71], v[48:51], a[224:239]
    buffer_load_dwordx4 v8, s[12:15], s33 offen offset:3072 lds
    s_mov_b32 s34, 10240
    buffer_store_dwordx4 v[232:235], v38, s[28:31], s34 offen sc1
    v_mfma_f32_32x32x16_bf16 a[240:255], v[68:71], v[52:55], a[240:255]
    s_waitcnt vmcnt(18) lgkmcnt(0)
    s_barrier
    v_mfma_f32_32x32x16_bf16 a[0:15], v[88:91], v[72:75], a[0:15]
    ds_read_b128 v[40:43], v17 offset:32768
    v_mfma_f32_32x32x16_bf16 a[16:31], v[88:91], v[76:79], a[16:31]
    ds_read_b64_tr_b16 v[56:57], v25 offset:0
    v_mfma_f32_32x32x16_bf16 a[32:47], v[88:91], v[80:83], a[32:47]
    ds_read_b64_tr_b16 v[58:59], v25 offset:2048
    s_add_u32 m0, s32, 49152
    s_mov_b32 s33, 6029312
    buffer_load_dwordx4 v5, s[12:15], s33 offen lds
    v_mfma_f32_32x32x16_bf16 a[48:63], v[88:91], v[84:87], a[48:63]
    ds_read_b128 v[44:47], v17 offset:36864
    v_mfma_f32_32x32x16_bf16 a[64:79], v[92:95], v[72:75], a[64:79]
    ds_read_b128 v[48:51], v17 offset:40960
    v_mfma_f32_32x32x16_bf16 a[80:95], v[92:95], v[76:79], a[80:95]
    ds_read_b128 v[52:55], v17 offset:45056
    v_mfma_f32_32x32x16_bf16 a[96:111], v[92:95], v[80:83], a[96:111]
    ds_read_b64_tr_b16 v[60:61], v26 offset:0
    buffer_load_dwordx4 v6, s[12:15], s33 offen offset:1024 lds
    v_mfma_f32_32x32x16_bf16 a[112:127], v[92:95], v[84:87], a[112:127]
    ds_read_b64_tr_b16 v[62:63], v26 offset:2048
    v_mfma_f32_32x32x16_bf16 a[128:143], v[96:99], v[72:75], a[128:143]
    ds_read_b64_tr_b16 v[64:65], v27 offset:0
    v_mfma_f32_32x32x16_bf16 a[144:159], v[96:99], v[76:79], a[144:159]
    ds_read_b64_tr_b16 v[66:67], v27 offset:2048
    v_mfma_f32_32x32x16_bf16 a[160:175], v[96:99], v[80:83], a[160:175]
    ds_read_b64_tr_b16 v[68:69], v28 offset:0
    buffer_load_dwordx4 v7, s[12:15], s33 offen offset:2048 lds
    v_mfma_f32_32x32x16_bf16 a[176:191], v[96:99], v[84:87], a[176:191]
    ds_read_b64_tr_b16 v[70:71], v28 offset:2048
    v_mfma_f32_32x32x16_bf16 a[192:207], v[100:103], v[72:75], a[192:207]
    v_mfma_f32_32x32x16_bf16 a[208:223], v[100:103], v[76:79], a[208:223]
    v_mfma_f32_32x32x16_bf16 a[224:239], v[100:103], v[80:83], a[224:239]
    buffer_load_dwordx4 v8, s[12:15], s33 offen offset:3072 lds
    v_mfma_f32_32x32x16_bf16 a[240:255], v[100:103], v[84:87], a[240:255]
    s_waitcnt lgkmcnt(9)
    v_mfma_f32_32x32x16_bf16 a[0:15], v[56:59], v[40:43], a[0:15]
    ds_read_b128 v[72:75], v18 offset:32768
    s_waitcnt lgkmcnt(9)
    v_mfma_f32_32x32x16_bf16 a[16:31], v[56:59], v[44:47], a[16:31]
    ds_read_b64_tr_b16 v[88:89], v25 offset:8192
    s_waitcnt lgkmcnt(9)
    v_mfma_f32_32x32x16_bf16 a[32:47], v[56:59], v[48:51], a[32:47]
    ds_read_b64_tr_b16 v[90:91], v25 offset:10240
    s_add_u32 m0, s32, 65536
    s_mov_b32 s33, 1536
    buffer_load_dwordx4 v1, s[8:11], s33 offen lds
    s_waitcnt lgkmcnt(9)
    v_mfma_f32_32x32x16_bf16 a[48:63], v[56:59], v[52:55], a[48:63]
    ds_read_b128 v[76:79], v18 offset:36864
    s_waitcnt lgkmcnt(8)
    v_mfma_f32_32x32x16_bf16 a[64:79], v[60:63], v[40:43], a[64:79]
    ds_read_b128 v[80:83], v18 offset:40960
    v_mfma_f32_32x32x16_bf16 a[80:95], v[60:63], v[44:47], a[80:95]
    ds_read_b128 v[84:87], v18 offset:45056
    v_mfma_f32_32x32x16_bf16 a[96:111], v[60:63], v[48:51], a[96:111]
    ds_read_b64_tr_b16 v[92:93], v26 offset:8192
    buffer_load_dwordx4 v2, s[8:11], s33 offen offset:1024 lds
    v_mfma_f32_32x32x16_bf16 a[112:127], v[60:63], v[52:55], a[112:127]
    ds_read_b64_tr_b16 v[94:95], v26 offset:10240
    s_waitcnt lgkmcnt(10)
    v_mfma_f32_32x32x16_bf16 a[128:143], v[64:67], v[40:43], a[128:143]
    ds_read_b64_tr_b16 v[96:97], v27 offset:8192
    v_mfma_f32_32x32x16_bf16 a[144:159], v[64:67], v[44:47], a[144:159]
    ds_read_b64_tr_b16 v[98:99], v27 offset:10240
    v_mfma_f32_32x32x16_bf16 a[160:175], v[64:67], v[48:51], a[160:175]
    ds_read_b64_tr_b16 v[100:101], v28 offset:8192
    buffer_load_dwordx4 v3, s[8:11], s33 offen offset:2048 lds
    v_mfma_f32_32x32x16_bf16 a[176:191], v[64:67], v[52:55], a[176:191]
    ds_read_b64_tr_b16 v[102:103], v28 offset:10240
    s_waitcnt lgkmcnt(12)
    v_mfma_f32_32x32x16_bf16 a[192:207], v[68:71], v[40:43], a[192:207]
    v_mfma_f32_32x32x16_bf16 a[208:223], v[68:71], v[44:47], a[208:223]
    v_mfma_f32_32x32x16_bf16 a[224:239], v[68:71], v[48:51], a[224:239]
    buffer_load_dwordx4 v4, s[8:11], s33 offen offset:3072 lds
    v_mfma_f32_32x32x16_bf16 a[240:255], v[68:71], v[52:55], a[240:255]
    s_waitcnt vmcnt(22) lgkmcnt(0)
    s_barrier
    v_mfma_f32_32x32x16_bf16 a[0:15], v[88:91], v[72:75], a[0:15]
    ds_read_b128 v[40:43], v19 offset:32768
    v_mfma_f32_32x32x16_bf16 a[16:31], v[88:91], v[76:79], a[16:31]
    ds_read_b64_tr_b16 v[56:57], v25 offset:16384
    v_mfma_f32_32x32x16_bf16 a[32:47], v[88:91], v[80:83], a[32:47]
    ds_read_b64_tr_b16 v[58:59], v25 offset:18432
    s_add_u32 m0, s32, 81920
    s_mov_b32 s33, 263680
    buffer_load_dwordx4 v1, s[8:11], s33 offen lds
    v_mfma_f32_32x32x16_bf16 a[48:63], v[88:91], v[84:87], a[48:63]
    ds_read_b128 v[44:47], v19 offset:36864
    v_mfma_f32_32x32x16_bf16 a[64:79], v[92:95], v[72:75], a[64:79]
    ds_read_b128 v[48:51], v19 offset:40960
    v_mfma_f32_32x32x16_bf16 a[80:95], v[92:95], v[76:79], a[80:95]
    ds_read_b128 v[52:55], v19 offset:45056
    v_mfma_f32_32x32x16_bf16 a[96:111], v[92:95], v[80:83], a[96:111]
    ds_read_b64_tr_b16 v[60:61], v26 offset:16384
    buffer_load_dwordx4 v2, s[8:11], s33 offen offset:1024 lds
    v_mfma_f32_32x32x16_bf16 a[112:127], v[92:95], v[84:87], a[112:127]
    ds_read_b64_tr_b16 v[62:63], v26 offset:18432
    v_mfma_f32_32x32x16_bf16 a[128:143], v[96:99], v[72:75], a[128:143]
    ds_read_b64_tr_b16 v[64:65], v27 offset:16384
    v_mfma_f32_32x32x16_bf16 a[144:159], v[96:99], v[76:79], a[144:159]
    ds_read_b64_tr_b16 v[66:67], v27 offset:18432
    v_mfma_f32_32x32x16_bf16 a[160:175], v[96:99], v[80:83], a[160:175]
    ds_read_b64_tr_b16 v[68:69], v28 offset:16384
    buffer_load_dwordx4 v3, s[8:11], s33 offen offset:2048 lds
    v_mfma_f32_32x32x16_bf16 a[176:191], v[96:99], v[84:87], a[176:191]
    ds_read_b64_tr_b16 v[70:71], v28 offset:18432
    v_mfma_f32_32x32x16_bf16 a[192:207], v[100:103], v[72:75], a[192:207]
    v_mfma_f32_32x32x16_bf16 a[208:223], v[100:103], v[76:79], a[208:223]
    v_mfma_f32_32x32x16_bf16 a[224:239], v[100:103], v[80:83], a[224:239]
    buffer_load_dwordx4 v4, s[8:11], s33 offen offset:3072 lds
    s_mov_b32 s34, 11264
    buffer_store_dwordx4 v[236:239], v38, s[28:31], s34 offen sc1
    v_mfma_f32_32x32x16_bf16 a[240:255], v[100:103], v[84:87], a[240:255]
    s_waitcnt lgkmcnt(9)
    v_mfma_f32_32x32x16_bf16 a[0:15], v[56:59], v[40:43], a[0:15]
    ds_read_b128 v[72:75], v20 offset:32768
    s_waitcnt lgkmcnt(9)
    v_mfma_f32_32x32x16_bf16 a[16:31], v[56:59], v[44:47], a[16:31]
    ds_read_b64_tr_b16 v[88:89], v25 offset:24576
    s_waitcnt lgkmcnt(9)
    v_mfma_f32_32x32x16_bf16 a[32:47], v[56:59], v[48:51], a[32:47]
    ds_read_b64_tr_b16 v[90:91], v25 offset:26624
    s_add_u32 m0, s32, 0
    s_mov_b32 s33, 6291456
    buffer_load_dwordx4 v5, s[12:15], s33 offen lds
    s_waitcnt lgkmcnt(9)
    v_mfma_f32_32x32x16_bf16 a[48:63], v[56:59], v[52:55], a[48:63]
    ds_read_b128 v[76:79], v20 offset:36864
    s_waitcnt lgkmcnt(8)
    v_mfma_f32_32x32x16_bf16 a[64:79], v[60:63], v[40:43], a[64:79]
    ds_read_b128 v[80:83], v20 offset:40960
    v_mfma_f32_32x32x16_bf16 a[80:95], v[60:63], v[44:47], a[80:95]
    ds_read_b128 v[84:87], v20 offset:45056
    v_mfma_f32_32x32x16_bf16 a[96:111], v[60:63], v[48:51], a[96:111]
    ds_read_b64_tr_b16 v[92:93], v26 offset:24576
    buffer_load_dwordx4 v6, s[12:15], s33 offen offset:1024 lds
    v_mfma_f32_32x32x16_bf16 a[112:127], v[60:63], v[52:55], a[112:127]
    ds_read_b64_tr_b16 v[94:95], v26 offset:26624
    s_waitcnt lgkmcnt(10)
    v_mfma_f32_32x32x16_bf16 a[128:143], v[64:67], v[40:43], a[128:143]
    ds_read_b64_tr_b16 v[96:97], v27 offset:24576
    v_mfma_f32_32x32x16_bf16 a[144:159], v[64:67], v[44:47], a[144:159]
    ds_read_b64_tr_b16 v[98:99], v27 offset:26624
    v_mfma_f32_32x32x16_bf16 a[160:175], v[64:67], v[48:51], a[160:175]
    ds_read_b64_tr_b16 v[100:101], v28 offset:24576
    buffer_load_dwordx4 v7, s[12:15], s33 offen offset:2048 lds
    v_mfma_f32_32x32x16_bf16 a[176:191], v[64:67], v[52:55], a[176:191]
    ds_read_b64_tr_b16 v[102:103], v28 offset:26624
    s_waitcnt lgkmcnt(12)
    v_mfma_f32_32x32x16_bf16 a[192:207], v[68:71], v[40:43], a[192:207]
    v_mfma_f32_32x32x16_bf16 a[208:223], v[68:71], v[44:47], a[208:223]
    v_mfma_f32_32x32x16_bf16 a[224:239], v[68:71], v[48:51], a[224:239]
    buffer_load_dwordx4 v8, s[12:15], s33 offen offset:3072 lds
    v_mfma_f32_32x32x16_bf16 a[240:255], v[68:71], v[52:55], a[240:255]
    s_waitcnt vmcnt(18) lgkmcnt(0)
    s_barrier
    v_mfma_f32_32x32x16_bf16 a[0:15], v[88:91], v[72:75], a[0:15]
    ds_read_b128 v[40:43], v21 offset:0
    v_mfma_f32_32x32x16_bf16 a[16:31], v[88:91], v[76:79], a[16:31]
    ds_read_b64_tr_b16 v[56:57], v25 offset:32768
    v_mfma_f32_32x32x16_bf16 a[32:47], v[88:91], v[80:83], a[32:47]
    ds_read_b64_tr_b16 v[58:59], v25 offset:34816
    s_add_u32 m0, s32, 16384
    s_mov_b32 s33, 6553600
    buffer_load_dwordx4 v5, s[12:15], s33 offen lds
    v_mfma_f32_32x32x16_bf16 a[48:63], v[88:91], v[84:87], a[48:63]
    ds_read_b128 v[44:47], v21 offset:4096
    v_mfma_f32_32x32x16_bf16 a[64:79], v[92:95], v[72:75], a[64:79]
    ds_read_b128 v[48:51], v21 offset:8192
    v_mfma_f32_32x32x16_bf16 a[80:95], v[92:95], v[76:79], a[80:95]
    ds_read_b128 v[52:55], v21 offset:12288
    v_mfma_f32_32x32x16_bf16 a[96:111], v[92:95], v[80:83], a[96:111]
    ds_read_b64_tr_b16 v[60:61], v26 offset:32768
    buffer_load_dwordx4 v6, s[12:15], s33 offen offset:1024 lds
    v_mfma_f32_32x32x16_bf16 a[112:127], v[92:95], v[84:87], a[112:127]
    ds_read_b64_tr_b16 v[62:63], v26 offset:34816
    v_mfma_f32_32x32x16_bf16 a[128:143], v[96:99], v[72:75], a[128:143]
    ds_read_b64_tr_b16 v[64:65], v27 offset:32768
    v_mfma_f32_32x32x16_bf16 a[144:159], v[96:99], v[76:79], a[144:159]
    ds_read_b64_tr_b16 v[66:67], v27 offset:34816
    v_mfma_f32_32x32x16_bf16 a[160:175], v[96:99], v[80:83], a[160:175]
    ds_read_b64_tr_b16 v[68:69], v28 offset:32768
    buffer_load_dwordx4 v7, s[12:15], s33 offen offset:2048 lds
    v_mfma_f32_32x32x16_bf16 a[176:191], v[96:99], v[84:87], a[176:191]
    ds_read_b64_tr_b16 v[70:71], v28 offset:34816
    v_mfma_f32_32x32x16_bf16 a[192:207], v[100:103], v[72:75], a[192:207]
    v_mfma_f32_32x32x16_bf16 a[208:223], v[100:103], v[76:79], a[208:223]
    v_mfma_f32_32x32x16_bf16 a[224:239], v[100:103], v[80:83], a[224:239]
    buffer_load_dwordx4 v8, s[12:15], s33 offen offset:3072 lds
    v_mfma_f32_32x32x16_bf16 a[240:255], v[100:103], v[84:87], a[240:255]
    s_waitcnt lgkmcnt(9)
    v_mfma_f32_32x32x16_bf16 a[0:15], v[56:59], v[40:43], a[0:15]
    ds_read_b128 v[72:75], v22 offset:0
    s_waitcnt lgkmcnt(9)
    v_mfma_f32_32x32x16_bf16 a[16:31], v[56:59], v[44:47], a[16:31]
    ds_read_b64_tr_b16 v[88:89], v25 offset:40960
    s_waitcnt lgkmcnt(9)
    v_mfma_f32_32x32x16_bf16 a[32:47], v[56:59], v[48:51], a[32:47]
    ds_read_b64_tr_b16 v[90:91], v25 offset:43008
    s_add_u32 m0, s32, 98304
    s_mov_b32 s33, 1664
    buffer_load_dwordx4 v1, s[8:11], s33 offen lds
    s_waitcnt lgkmcnt(9)
    v_mfma_f32_32x32x16_bf16 a[48:63], v[56:59], v[52:55], a[48:63]
    ds_read_b128 v[76:79], v22 offset:4096
    s_waitcnt lgkmcnt(8)
    v_mfma_f32_32x32x16_bf16 a[64:79], v[60:63], v[40:43], a[64:79]
    ds_read_b128 v[80:83], v22 offset:8192
    v_mfma_f32_32x32x16_bf16 a[80:95], v[60:63], v[44:47], a[80:95]
    ds_read_b128 v[84:87], v22 offset:12288
    v_mfma_f32_32x32x16_bf16 a[96:111], v[60:63], v[48:51], a[96:111]
    ds_read_b64_tr_b16 v[92:93], v26 offset:40960
    buffer_load_dwordx4 v2, s[8:11], s33 offen offset:1024 lds
    v_mfma_f32_32x32x16_bf16 a[112:127], v[60:63], v[52:55], a[112:127]
    ds_read_b64_tr_b16 v[94:95], v26 offset:43008
    s_waitcnt lgkmcnt(10)
    v_mfma_f32_32x32x16_bf16 a[128:143], v[64:67], v[40:43], a[128:143]
    ds_read_b64_tr_b16 v[96:97], v27 offset:40960
    v_mfma_f32_32x32x16_bf16 a[144:159], v[64:67], v[44:47], a[144:159]
    ds_read_b64_tr_b16 v[98:99], v27 offset:43008
    v_mfma_f32_32x32x16_bf16 a[160:175], v[64:67], v[48:51], a[160:175]
    ds_read_b64_tr_b16 v[100:101], v28 offset:40960
    buffer_load_dwordx4 v3, s[8:11], s33 offen offset:2048 lds
    v_mfma_f32_32x32x16_bf16 a[176:191], v[64:67], v[52:55], a[176:191]
    ds_read_b64_tr_b16 v[102:103], v28 offset:43008
    s_waitcnt lgkmcnt(12)
    v_mfma_f32_32x32x16_bf16 a[192:207], v[68:71], v[40:43], a[192:207]
    v_mfma_f32_32x32x16_bf16 a[208:223], v[68:71], v[44:47], a[208:223]
    v_mfma_f32_32x32x16_bf16 a[224:239], v[68:71], v[48:51], a[224:239]
    buffer_load_dwordx4 v4, s[8:11], s33 offen offset:3072 lds
    s_mov_b32 s34, 12288
    buffer_store_dwordx4 v[240:243], v38, s[28:31], s34 offen sc1
    v_mfma_f32_32x32x16_bf16 a[240:255], v[68:71], v[52:55], a[240:255]
    s_waitcnt vmcnt(22) lgkmcnt(0)
    s_barrier
    v_mfma_f32_32x32x16_bf16 a[0:15], v[88:91], v[72:75], a[0:15]
    ds_read_b128 v[40:43], v23 offset:0
    v_mfma_f32_32x32x16_bf16 a[16:31], v[88:91], v[76:79], a[16:31]
    ds_read_b64_tr_b16 v[56:57], v25 offset:49152
    v_mfma_f32_32x32x16_bf16 a[32:47], v[88:91], v[80:83], a[32:47]
    ds_read_b64_tr_b16 v[58:59], v25 offset:51200
    s_add_u32 m0, s32, 114688
    s_mov_b32 s33, 263808
    buffer_load_dwordx4 v1, s[8:11], s33 offen lds
    v_mfma_f32_32x32x16_bf16 a[48:63], v[88:91], v[84:87], a[48:63]
    ds_read_b128 v[44:47], v23 offset:4096
    v_mfma_f32_32x32x16_bf16 a[64:79], v[92:95], v[72:75], a[64:79]
    ds_read_b128 v[48:51], v23 offset:8192
    v_mfma_f32_32x32x16_bf16 a[80:95], v[92:95], v[76:79], a[80:95]
    ds_read_b128 v[52:55], v23 offset:12288
    v_mfma_f32_32x32x16_bf16 a[96:111], v[92:95], v[80:83], a[96:111]
    ds_read_b64_tr_b16 v[60:61], v26 offset:49152
    buffer_load_dwordx4 v2, s[8:11], s33 offen offset:1024 lds
    v_mfma_f32_32x32x16_bf16 a[112:127], v[92:95], v[84:87], a[112:127]
    ds_read_b64_tr_b16 v[62:63], v26 offset:51200
    v_mfma_f32_32x32x16_bf16 a[128:143], v[96:99], v[72:75], a[128:143]
    ds_read_b64_tr_b16 v[64:65], v27 offset:49152
    v_mfma_f32_32x32x16_bf16 a[144:159], v[96:99], v[76:79], a[144:159]
    ds_read_b64_tr_b16 v[66:67], v27 offset:51200
    v_mfma_f32_32x32x16_bf16 a[160:175], v[96:99], v[80:83], a[160:175]
    ds_read_b64_tr_b16 v[68:69], v28 offset:49152
    buffer_load_dwordx4 v3, s[8:11], s33 offen offset:2048 lds
    v_mfma_f32_32x32x16_bf16 a[176:191], v[96:99], v[84:87], a[176:191]
    ds_read_b64_tr_b16 v[70:71], v28 offset:51200
    v_mfma_f32_32x32x16_bf16 a[192:207], v[100:103], v[72:75], a[192:207]
    v_mfma_f32_32x32x16_bf16 a[208:223], v[100:103], v[76:79], a[208:223]
    v_lshlrev_b32 v126, 2, v39
    buffer_load_dword v125, v126, s[60:63], 0 offen sc1
    v_mfma_f32_32x32x16_bf16 a[224:239], v[100:103], v[80:83], a[224:239]
    buffer_load_dwordx4 v4, s[8:11], s33 offen offset:3072 lds
    v_mfma_f32_32x32x16_bf16 a[240:255], v[100:103], v[84:87], a[240:255]
    s_waitcnt lgkmcnt(9)
    v_mfma_f32_32x32x16_bf16 a[0:15], v[56:59], v[40:43], a[0:15]
    ds_read_b128 v[72:75], v24 offset:0
    s_waitcnt lgkmcnt(9)
    v_mfma_f32_32x32x16_bf16 a[16:31], v[56:59], v[44:47], a[16:31]
    ds_read_b64_tr_b16 v[88:89], v25 offset:57344
    s_waitcnt lgkmcnt(9)
    v_mfma_f32_32x32x16_bf16 a[32:47], v[56:59], v[48:51], a[32:47]
    ds_read_b64_tr_b16 v[90:91], v25 offset:59392
    s_add_u32 m0, s32, 32768
    s_mov_b32 s33, 6815744
    buffer_load_dwordx4 v5, s[12:15], s33 offen lds
    s_waitcnt lgkmcnt(9)
    v_mfma_f32_32x32x16_bf16 a[48:63], v[56:59], v[52:55], a[48:63]
    ds_read_b128 v[76:79], v24 offset:4096
    s_waitcnt lgkmcnt(8)
    v_mfma_f32_32x32x16_bf16 a[64:79], v[60:63], v[40:43], a[64:79]
    ds_read_b128 v[80:83], v24 offset:8192
    v_mfma_f32_32x32x16_bf16 a[80:95], v[60:63], v[44:47], a[80:95]
    ds_read_b128 v[84:87], v24 offset:12288
    v_mfma_f32_32x32x16_bf16 a[96:111], v[60:63], v[48:51], a[96:111]
    ds_read_b64_tr_b16 v[92:93], v26 offset:57344
    buffer_load_dwordx4 v6, s[12:15], s33 offen offset:1024 lds
    v_mfma_f32_32x32x16_bf16 a[112:127], v[60:63], v[52:55], a[112:127]
    ds_read_b64_tr_b16 v[94:95], v26 offset:59392
    s_waitcnt lgkmcnt(10)
    v_mfma_f32_32x32x16_bf16 a[128:143], v[64:67], v[40:43], a[128:143]
    ds_read_b64_tr_b16 v[96:97], v27 offset:57344
    v_mfma_f32_32x32x16_bf16 a[144:159], v[64:67], v[44:47], a[144:159]
    ds_read_b64_tr_b16 v[98:99], v27 offset:59392
    v_mfma_f32_32x32x16_bf16 a[160:175], v[64:67], v[48:51], a[160:175]
    ds_read_b64_tr_b16 v[100:101], v28 offset:57344
    buffer_load_dwordx4 v7, s[12:15], s33 offen offset:2048 lds
    v_mfma_f32_32x32x16_bf16 a[176:191], v[64:67], v[52:55], a[176:191]
    ds_read_b64_tr_b16 v[102:103], v28 offset:59392
    s_waitcnt lgkmcnt(12)
    v_mfma_f32_32x32x16_bf16 a[192:207], v[68:71], v[40:43], a[192:207]
    v_mfma_f32_32x32x16_bf16 a[208:223], v[68:71], v[44:47], a[208:223]
    v_mfma_f32_32x32x16_bf16 a[224:239], v[68:71], v[48:51], a[224:239]
    buffer_load_dwordx4 v8, s[12:15], s33 offen offset:3072 lds
    v_mfma_f32_32x32x16_bf16 a[240:255], v[68:71], v[52:55], a[240:255]
    s_waitcnt vmcnt(18) lgkmcnt(0)
    s_barrier
    v_mfma_f32_32x32x16_bf16 a[0:15], v[88:91], v[72:75], a[0:15]
    ds_read_b128 v[40:43], v17 offset:0
    v_mfma_f32_32x32x16_bf16 a[16:31], v[88:91], v[76:79], a[16:31]
    ds_read_b64_tr_b16 v[56:57], v25 offset:0
    v_mfma_f32_32x32x16_bf16 a[32:47], v[88:91], v[80:83], a[32:47]
    ds_read_b64_tr_b16 v[58:59], v25 offset:2048
    s_add_u32 m0, s32, 49152
    s_mov_b32 s33, 7077888
    buffer_load_dwordx4 v5, s[12:15], s33 offen lds
    v_mfma_f32_32x32x16_bf16 a[48:63], v[88:91], v[84:87], a[48:63]
    ds_read_b128 v[44:47], v17 offset:4096
    v_mfma_f32_32x32x16_bf16 a[64:79], v[92:95], v[72:75], a[64:79]
    ds_read_b128 v[48:51], v17 offset:8192
    v_mfma_f32_32x32x16_bf16 a[80:95], v[92:95], v[76:79], a[80:95]
    ds_read_b128 v[52:55], v17 offset:12288
    v_mfma_f32_32x32x16_bf16 a[96:111], v[92:95], v[80:83], a[96:111]
    ds_read_b64_tr_b16 v[60:61], v26 offset:0
    buffer_load_dwordx4 v6, s[12:15], s33 offen offset:1024 lds
    v_mfma_f32_32x32x16_bf16 a[112:127], v[92:95], v[84:87], a[112:127]
    ds_read_b64_tr_b16 v[62:63], v26 offset:2048
    v_mfma_f32_32x32x16_bf16 a[128:143], v[96:99], v[72:75], a[128:143]
    ds_read_b64_tr_b16 v[64:65], v27 offset:0
    v_mfma_f32_32x32x16_bf16 a[144:159], v[96:99], v[76:79], a[144:159]
    ds_read_b64_tr_b16 v[66:67], v27 offset:2048
    v_mfma_f32_32x32x16_bf16 a[160:175], v[96:99], v[80:83], a[160:175]
    ds_read_b64_tr_b16 v[68:69], v28 offset:0
    buffer_load_dwordx4 v7, s[12:15], s33 offen offset:2048 lds
    v_mfma_f32_32x32x16_bf16 a[176:191], v[96:99], v[84:87], a[176:191]
    ds_read_b64_tr_b16 v[70:71], v28 offset:2048
    v_mfma_f32_32x32x16_bf16 a[192:207], v[100:103], v[72:75], a[192:207]
    v_mfma_f32_32x32x16_bf16 a[208:223], v[100:103], v[76:79], a[208:223]
    v_mfma_f32_32x32x16_bf16 a[224:239], v[100:103], v[80:83], a[224:239]
    buffer_load_dwordx4 v8, s[12:15], s33 offen offset:3072 lds
    s_mov_b32 s34, 13312
    buffer_store_dwordx4 v[244:247], v38, s[28:31], s34 offen sc1
    v_mfma_f32_32x32x16_bf16 a[240:255], v[100:103], v[84:87], a[240:255]
    s_waitcnt lgkmcnt(9)
    v_mfma_f32_32x32x16_bf16 a[0:15], v[56:59], v[40:43], a[0:15]
    ds_read_b128 v[72:75], v18 offset:0
    s_waitcnt lgkmcnt(9)
    v_mfma_f32_32x32x16_bf16 a[16:31], v[56:59], v[44:47], a[16:31]
    ds_read_b64_tr_b16 v[88:89], v25 offset:8192
    s_waitcnt lgkmcnt(9)
    v_mfma_f32_32x32x16_bf16 a[32:47], v[56:59], v[48:51], a[32:47]
    ds_read_b64_tr_b16 v[90:91], v25 offset:10240
    s_add_u32 m0, s32, 131072
    s_mov_b32 s33, 1792
    buffer_load_dwordx4 v1, s[8:11], s33 offen lds
    s_waitcnt lgkmcnt(9)
    v_mfma_f32_32x32x16_bf16 a[48:63], v[56:59], v[52:55], a[48:63]
    ds_read_b128 v[76:79], v18 offset:4096
    s_waitcnt lgkmcnt(8)
    v_mfma_f32_32x32x16_bf16 a[64:79], v[60:63], v[40:43], a[64:79]
    ds_read_b128 v[80:83], v18 offset:8192
    v_mfma_f32_32x32x16_bf16 a[80:95], v[60:63], v[44:47], a[80:95]
    ds_read_b128 v[84:87], v18 offset:12288
    v_mfma_f32_32x32x16_bf16 a[96:111], v[60:63], v[48:51], a[96:111]
    ds_read_b64_tr_b16 v[92:93], v26 offset:8192
    buffer_load_dwordx4 v2, s[8:11], s33 offen offset:1024 lds
    v_mfma_f32_32x32x16_bf16 a[112:127], v[60:63], v[52:55], a[112:127]
    ds_read_b64_tr_b16 v[94:95], v26 offset:10240
    s_waitcnt lgkmcnt(10)
    v_mfma_f32_32x32x16_bf16 a[128:143], v[64:67], v[40:43], a[128:143]
    ds_read_b64_tr_b16 v[96:97], v27 offset:8192
    v_mfma_f32_32x32x16_bf16 a[144:159], v[64:67], v[44:47], a[144:159]
    ds_read_b64_tr_b16 v[98:99], v27 offset:10240
    v_mfma_f32_32x32x16_bf16 a[160:175], v[64:67], v[48:51], a[160:175]
    ds_read_b64_tr_b16 v[100:101], v28 offset:8192
    buffer_load_dwordx4 v3, s[8:11], s33 offen offset:2048 lds
    v_mfma_f32_32x32x16_bf16 a[176:191], v[64:67], v[52:55], a[176:191]
    ds_read_b64_tr_b16 v[102:103], v28 offset:10240
    s_waitcnt lgkmcnt(12)
    v_mfma_f32_32x32x16_bf16 a[192:207], v[68:71], v[40:43], a[192:207]
    v_mfma_f32_32x32x16_bf16 a[208:223], v[68:71], v[44:47], a[208:223]
    v_mfma_f32_32x32x16_bf16 a[224:239], v[68:71], v[48:51], a[224:239]
    buffer_load_dwordx4 v4, s[8:11], s33 offen offset:3072 lds
    v_mfma_f32_32x32x16_bf16 a[240:255], v[68:71], v[52:55], a[240:255]
    s_waitcnt vmcnt(14) lgkmcnt(0)
    s_barrier
    s_mov_b32 s55, 0x01010101
    v_cmp_ne_u32 s[58:59], s55, v125
    s_cmp_eq_u64 s[58:59], 0
    s_cbranch_scc0 k1_c0slow_0
k1_c0ret_0:
    v_mfma_f32_32x32x16_bf16 a[0:15], v[88:91], v[72:75], a[0:15]
    ds_read_b128 v[40:43], v19 offset:0
    v_mfma_f32_32x32x16_bf16 a[16:31], v[88:91], v[76:79], a[16:31]
    ds_read_b64_tr_b16 v[56:57], v25 offset:16384
    v_mfma_f32_32x32x16_bf16 a[32:47], v[88:91], v[80:83], a[32:47]
    ds_read_b64_tr_b16 v[58:59], v25 offset:18432
    s_add_u32 m0, s32, 147456
    s_mov_b32 s33, 263936
    buffer_load_dwordx4 v1, s[8:11], s33 offen lds
    v_mfma_f32_32x32x16_bf16 a[48:63], v[88:91], v[84:87], a[48:63]
    ds_read_b128 v[44:47], v19 offset:4096
    v_mfma_f32_32x32x16_bf16 a[64:79], v[92:95], v[72:75], a[64:79]
    ds_read_b128 v[48:51], v19 offset:8192
    v_mfma_f32_32x32x16_bf16 a[80:95], v[92:95], v[76:79], a[80:95]
    ds_read_b128 v[52:55], v19 offset:12288
    v_mfma_f32_32x32x16_bf16 a[96:111], v[92:95], v[80:83], a[96:111]
    ds_read_b64_tr_b16 v[60:61], v26 offset:16384
    buffer_load_dwordx4 v2, s[8:11], s33 offen offset:1024 lds
    v_mfma_f32_32x32x16_bf16 a[112:127], v[92:95], v[84:87], a[112:127]
    ds_read_b64_tr_b16 v[62:63], v26 offset:18432
    v_mfma_f32_32x32x16_bf16 a[128:143], v[96:99], v[72:75], a[128:143]
    ds_read_b64_tr_b16 v[64:65], v27 offset:16384
    v_mfma_f32_32x32x16_bf16 a[144:159], v[96:99], v[76:79], a[144:159]
    ds_read_b64_tr_b16 v[66:67], v27 offset:18432
    v_mfma_f32_32x32x16_bf16 a[160:175], v[96:99], v[80:83], a[160:175]
    ds_read_b64_tr_b16 v[68:69], v28 offset:16384
    buffer_load_dwordx4 v3, s[8:11], s33 offen offset:2048 lds
    v_mfma_f32_32x32x16_bf16 a[176:191], v[96:99], v[84:87], a[176:191]
    ds_read_b64_tr_b16 v[70:71], v28 offset:18432
    v_mfma_f32_32x32x16_bf16 a[192:207], v[100:103], v[72:75], a[192:207]
    v_mfma_f32_32x32x16_bf16 a[208:223], v[100:103], v[76:79], a[208:223]
    v_mfma_f32_32x32x16_bf16 a[224:239], v[100:103], v[80:83], a[224:239]
    buffer_load_dwordx4 v4, s[8:11], s33 offen offset:3072 lds
    v_mfma_f32_32x32x16_bf16 a[240:255], v[100:103], v[84:87], a[240:255]
    s_waitcnt lgkmcnt(9)
    v_mfma_f32_32x32x16_bf16 a[0:15], v[56:59], v[40:43], a[0:15]
    ds_read_b128 v[72:75], v20 offset:0
    s_waitcnt lgkmcnt(9)
    v_mfma_f32_32x32x16_bf16 a[16:31], v[56:59], v[44:47], a[16:31]
    ds_read_b64_tr_b16 v[88:89], v25 offset:24576
    s_waitcnt lgkmcnt(9)
    v_mfma_f32_32x32x16_bf16 a[32:47], v[56:59], v[48:51], a[32:47]
    ds_read_b64_tr_b16 v[90:91], v25 offset:26624
    s_add_u32 m0, s32, 0
    s_mov_b32 s33, 7340032
    buffer_load_dwordx4 v5, s[12:15], s33 offen lds
    s_waitcnt lgkmcnt(9)
    v_mfma_f32_32x32x16_bf16 a[48:63], v[56:59], v[52:55], a[48:63]
    ds_read_b128 v[76:79], v20 offset:4096
    s_waitcnt lgkmcnt(8)
    v_mfma_f32_32x32x16_bf16 a[64:79], v[60:63], v[40:43], a[64:79]
    ds_read_b128 v[80:83], v20 offset:8192
    v_mfma_f32_32x32x16_bf16 a[80:95], v[60:63], v[44:47], a[80:95]
    ds_read_b128 v[84:87], v20 offset:12288
    v_mfma_f32_32x32x16_bf16 a[96:111], v[60:63], v[48:51], a[96:111]
    ds_read_b64_tr_b16 v[92:93], v26 offset:24576
    buffer_load_dwordx4 v6, s[12:15], s33 offen offset:1024 lds
    v_mfma_f32_32x32x16_bf16 a[112:127], v[60:63], v[52:55], a[112:127]
    ds_read_b64_tr_b16 v[94:95], v26 offset:26624
    s_waitcnt lgkmcnt(10)
    v_mfma_f32_32x32x16_bf16 a[128:143], v[64:67], v[40:43], a[128:143]
    ds_read_b64_tr_b16 v[96:97], v27 offset:24576
    v_mfma_f32_32x32x16_bf16 a[144:159], v[64:67], v[44:47], a[144:159]
    ds_read_b64_tr_b16 v[98:99], v27 offset:26624
    v_mfma_f32_32x32x16_bf16 a[160:175], v[64:67], v[48:51], a[160:175]
    ds_read_b64_tr_b16 v[100:101], v28 offset:24576
    buffer_load_dwordx4 v7, s[12:15], s33 offen offset:2048 lds
    v_mfma_f32_32x32x16_bf16 a[176:191], v[64:67], v[52:55], a[176:191]
    ds_read_b64_tr_b16 v[102:103], v28 offset:26624
    s_waitcnt lgkmcnt(12)
    v_mfma_f32_32x32x16_bf16 a[192:207], v[68:71], v[40:43], a[192:207]
    s_mov_b64 s[80:81], s[94:95]
    s_mov_b64 s[82:83], s[46:47]
    s_lshl_b32 s84, s2, 13
    s_mov_b32 s88, s54
    s_add_u32 s68, s80, s84
    s_addc_u32 s69, s81, 0
    s_mov_b32 s70, 8192
    s_mov_b32 s71, 0x20000
    s_lshr_b32 s85, s2, 2
    s_lshl_b32 s85, s85, 15
    s_and_b32 s86, s2, 3
    s_lshl_b32 s86, s86, 2
    s_add_u32 s85, s85, s86
    s_add_u32 s85, s85, 88080384
    s_add_u32 s72, s82, s85
    s_addc_u32 s73, s83, 0
    s_mov_b32 s74, 32756
    s_mov_b32 s75, 0x20000
    s_add_u32 s85, s84, 92274688
    s_add_u32 s76, s82, s85
    s_addc_u32 s77, s83, 0
    s_mov_b32 s78, 8192
    s_mov_b32 s79, 0x20000
    s_cmp_lt_u32 s2, 224
    s_cselect_b32 s70, s70, 0
    s_cselect_b32 s74, s74, 0
    s_cselect_b32 s78, s78, 0
    v_lshlrev_b32 v127, 4, v0
    s_movk_i32 s85, 0x1000
    v_mfma_f32_32x32x16_bf16 a[208:223], v[68:71], v[44:47], a[208:223]
    v_mfma_f32_32x32x16_bf16 a[224:239], v[68:71], v[48:51], a[224:239]
    buffer_load_dwordx4 v8, s[12:15], s33 offen offset:3072 lds
    s_mov_b32 s34, 14336
    buffer_store_dwordx4 v[248:251], v38, s[28:31], s34 offen sc1
    v_mfma_f32_32x32x16_bf16 a[240:255], v[68:71], v[52:55], a[240:255]
    s_waitcnt vmcnt(18) lgkmcnt(0)
    s_barrier
    v_mfma_f32_32x32x16_bf16 a[0:15], v[88:91], v[72:75], a[0:15]
    ds_read_b128 v[40:43], v17 offset:32768
    v_mfma_f32_32x32x16_bf16 a[16:31], v[88:91], v[76:79], a[16:31]
    ds_read_b64_tr_b16 v[56:57], v25 offset:32768
    v_mfma_f32_32x32x16_bf16 a[32:47], v[88:91], v[80:83], a[32:47]
    ds_read_b64_tr_b16 v[58:59], v25 offset:34816
    s_add_u32 m0, s32, 16384
    s_mov_b32 s33, 7602176
    buffer_load_dwordx4 v5, s[12:15], s33 offen lds
    v_mfma_f32_32x32x16_bf16 a[48:63], v[88:91], v[84:87], a[48:63]
    ds_read_b128 v[44:47], v17 offset:36864
    v_mfma_f32_32x32x16_bf16 a[64:79], v[92:95], v[72:75], a[64:79]
    ds_read_b128 v[48:51], v17 offset:40960
    v_mfma_f32_32x32x16_bf16 a[80:95], v[92:95], v[76:79], a[80:95]
    ds_read_b128 v[52:55], v17 offset:45056
    v_mfma_f32_32x32x16_bf16 a[96:111], v[92:95], v[80:83], a[96:111]
    ds_read_b64_tr_b16 v[60:61], v26 offset:32768
    buffer_load_dwordx4 v6, s[12:15], s33 offen offset:1024 lds
    v_mfma_f32_32x32x16_bf16 a[112:127], v[92:95], v[84:87], a[112:127]
    ds_read_b64_tr_b16 v[62:63], v26 offset:34816
    buffer_load_dwordx4 v[140:143], v127, s[68:71], 0 offen offset:16
    v_mfma_f32_32x32x16_bf16 a[128:143], v[96:99], v[72:75], a[128:143]
    ds_read_b64_tr_b16 v[64:65], v27 offset:32768
    v_mfma_f32_32x32x16_bf16 a[144:159], v[96:99], v[76:79], a[144:159]
    ds_read_b64_tr_b16 v[66:67], v27 offset:34816
    v_mfma_f32_32x32x16_bf16 a[160:175], v[96:99], v[80:83], a[160:175]
    ds_read_b64_tr_b16 v[68:69], v28 offset:32768
    buffer_load_dwordx4 v7, s[12:15], s33 offen offset:2048 lds
    v_mfma_f32_32x32x16_bf16 a[176:191], v[96:99], v[84:87], a[176:191]
    ds_read_b64_tr_b16 v[70:71], v28 offset:34816
    v_mfma_f32_32x32x16_bf16 a[192:207], v[100:103], v[72:75], a[192:207]
    v_mfma_f32_32x32x16_bf16 a[208:223], v[100:103], v[76:79], a[208:223]
    buffer_load_dwordx4 v[136:139], v127, s[68:71], 0 offen
    v_mfma_f32_32x32x16_bf16 a[224:239], v[100:103], v[80:83], a[224:239]
    buffer_load_dwordx4 v8, s[12:15], s33 offen offset:3072 lds
    v_mfma_f32_32x32x16_bf16 a[240:255], v[100:103], v[84:87], a[240:255]
    s_waitcnt lgkmcnt(9)
    v_mfma_f32_32x32x16_bf16 a[0:15], v[56:59], v[40:43], a[0:15]
    ds_read_b128 v[72:75], v18 offset:32768
    s_waitcnt lgkmcnt(9)
    v_mfma_f32_32x32x16_bf16 a[16:31], v[56:59], v[44:47], a[16:31]
    ds_read_b64_tr_b16 v[88:89], v25 offset:40960
    s_waitcnt lgkmcnt(9)
    v_mfma_f32_32x32x16_bf16 a[32:47], v[56:59], v[48:51], a[32:47]
    ds_read_b64_tr_b16 v[90:91], v25 offset:43008
    s_add_u32 m0, s32, 65536
    s_mov_b32 s33, 1920
    buffer_load_dwordx4 v1, s[8:11], s33 offen lds
    s_waitcnt lgkmcnt(9)
    v_mfma_f32_32x32x16_bf16 a[48:63], v[56:59], v[52:55], a[48:63]
    ds_read_b128 v[76:79], v18 offset:36864
    s_waitcnt lgkmcnt(8)
    v_mfma_f32_32x32x16_bf16 a[64:79], v[60:63], v[40:43], a[64:79]
    ds_read_b128 v[80:83], v18 offset:40960
    v_mfma_f32_32x32x16_bf16 a[80:95], v[60:63], v[44:47], a[80:95]
    ds_read_b128 v[84:87], v18 offset:45056
    v_mfma_f32_32x32x16_bf16 a[96:111], v[60:63], v[48:51], a[96:111]
    ds_read_b64_tr_b16 v[92:93], v26 offset:40960
    buffer_load_dwordx4 v2, s[8:11], s33 offen offset:1024 lds
    v_mfma_f32_32x32x16_bf16 a[112:127], v[60:63], v[52:55], a[112:127]
    ds_read_b64_tr_b16 v[94:95], v26 offset:43008
    buffer_load_dwordx4 v[148:151], v127, s[68:71], s85 offen offset:16
    s_waitcnt lgkmcnt(10)
    v_mfma_f32_32x32x16_bf16 a[128:143], v[64:67], v[40:43], a[128:143]
    ds_read_b64_tr_b16 v[96:97], v27 offset:40960
    v_mfma_f32_32x32x16_bf16 a[144:159], v[64:67], v[44:47], a[144:159]
    ds_read_b64_tr_b16 v[98:99], v27 offset:43008
    v_mfma_f32_32x32x16_bf16 a[160:175], v[64:67], v[48:51], a[160:175]
    ds_read_b64_tr_b16 v[100:101], v28 offset:40960
    buffer_load_dwordx4 v3, s[8:11], s33 offen offset:2048 lds
    v_mfma_f32_32x32x16_bf16 a[176:191], v[64:67], v[52:55], a[176:191]
    ds_read_b64_tr_b16 v[102:103], v28 offset:43008
    s_waitcnt lgkmcnt(12)
    v_mfma_f32_32x32x16_bf16 a[192:207], v[68:71], v[40:43], a[192:207]
    v_mfma_f32_32x32x16_bf16 a[208:223], v[68:71], v[44:47], a[208:223]
    buffer_load_dwordx4 v[144:147], v127, s[68:71], s85 offen
    v_mfma_f32_32x32x16_bf16 a[224:239], v[68:71], v[48:51], a[224:239]
    buffer_load_dwordx4 v4, s[8:11], s33 offen offset:3072 lds
    v_mfma_f32_32x32x16_bf16 a[240:255], v[68:71], v[52:55], a[240:255]
    s_waitcnt vmcnt(26) lgkmcnt(0)
    s_barrier
    v_mfma_f32_32x32x16_bf16 a[0:15], v[88:91], v[72:75], a[0:15]
    ds_read_b128 v[40:43], v19 offset:32768
    v_mfma_f32_32x32x16_bf16 a[16:31], v[88:91], v[76:79], a[16:31]
    ds_read_b64_tr_b16 v[56:57], v25 offset:49152
    v_mfma_f32_32x32x16_bf16 a[32:47], v[88:91], v[80:83], a[32:47]
    ds_read_b64_tr_b16 v[58:59], v25 offset:51200
    s_add_u32 m0, s32, 81920
    s_mov_b32 s33, 264064
    buffer_load_dwordx4 v1, s[8:11], s33 offen lds
    v_mfma_f32_32x32x16_bf16 a[48:63], v[88:91], v[84:87], a[48:63]
    ds_read_b128 v[44:47], v19 offset:36864
    v_mfma_f32_32x32x16_bf16 a[64:79], v[92:95], v[72:75], a[64:79]
    ds_read_b128 v[48:51], v19 offset:40960
    v_mfma_f32_32x32x16_bf16 a[80:95], v[92:95], v[76:79], a[80:95]
    ds_read_b128 v[52:55], v19 offset:45056
    v_mfma_f32_32x32x16_bf16 a[96:111], v[92:95], v[80:83], a[96:111]
    ds_read_b64_tr_b16 v[60:61], v26 offset:49152
    buffer_load_dwordx4 v2, s[8:11], s33 offen offset:1024 lds
    v_mfma_f32_32x32x16_bf16 a[112:127], v[92:95], v[84:87], a[112:127]
    ds_read_b64_tr_b16 v[62:63], v26 offset:51200
    s_movk_i32 s86, 4096
    buffer_load_dword v153, v127, s[72:75], s86 offen
    v_mfma_f32_32x32x16_bf16 a[128:143], v[96:99], v[72:75], a[128:143]
    ds_read_b64_tr_b16 v[64:65], v27 offset:49152
    v_mfma_f32_32x32x16_bf16 a[144:159], v[96:99], v[76:79], a[144:159]
    ds_read_b64_tr_b16 v[66:67], v27 offset:51200
    v_mfma_f32_32x32x16_bf16 a[160:175], v[96:99], v[80:83], a[160:175]
    ds_read_b64_tr_b16 v[68:69], v28 offset:49152
    buffer_load_dwordx4 v3, s[8:11], s33 offen offset:2048 lds
    v_mfma_f32_32x32x16_bf16 a[176:191], v[96:99], v[84:87], a[176:191]
    ds_read_b64_tr_b16 v[70:71], v28 offset:51200
    v_mfma_f32_32x32x16_bf16 a[192:207], v[100:103], v[72:75], a[192:207]
    v_mfma_f32_32x32x16_bf16 a[208:223], v[100:103], v[76:79], a[208:223]
    s_movk_i32 s86, 0
    buffer_load_dword v152, v127, s[72:75], s86 offen
    v_mfma_f32_32x32x16_bf16 a[224:239], v[100:103], v[80:83], a[224:239]
    buffer_load_dwordx4 v4, s[8:11], s33 offen offset:3072 lds
    s_mov_b32 s34, 15360
    buffer_store_dwordx4 v[252:255], v38, s[28:31], s34 offen sc1
    v_mfma_f32_32x32x16_bf16 a[240:255], v[100:103], v[84:87], a[240:255]
    s_waitcnt lgkmcnt(9)
    v_mfma_f32_32x32x16_bf16 a[0:15], v[56:59], v[40:43], a[0:15]
    ds_read_b128 v[72:75], v20 offset:32768
    s_waitcnt lgkmcnt(9)
    v_mfma_f32_32x32x16_bf16 a[16:31], v[56:59], v[44:47], a[16:31]
    ds_read_b64_tr_b16 v[88:89], v25 offset:57344
    s_waitcnt lgkmcnt(9)
    v_mfma_f32_32x32x16_bf16 a[32:47], v[56:59], v[48:51], a[32:47]
    ds_read_b64_tr_b16 v[90:91], v25 offset:59392
    s_add_u32 m0, s32, 32768
    s_mov_b32 s33, 7864320
    buffer_load_dwordx4 v5, s[12:15], s33 offen lds
    s_waitcnt lgkmcnt(9)
    v_mfma_f32_32x32x16_bf16 a[48:63], v[56:59], v[52:55], a[48:63]
    ds_read_b128 v[76:79], v20 offset:36864
    s_waitcnt lgkmcnt(8)
    v_mfma_f32_32x32x16_bf16 a[64:79], v[60:63], v[40:43], a[64:79]
    ds_read_b128 v[80:83], v20 offset:40960
    v_mfma_f32_32x32x16_bf16 a[80:95], v[60:63], v[44:47], a[80:95]
    ds_read_b128 v[84:87], v20 offset:45056
    v_mfma_f32_32x32x16_bf16 a[96:111], v[60:63], v[48:51], a[96:111]
    ds_read_b64_tr_b16 v[92:93], v26 offset:57344
    buffer_load_dwordx4 v6, s[12:15], s33 offen offset:1024 lds
    v_mfma_f32_32x32x16_bf16 a[112:127], v[60:63], v[52:55], a[112:127]
    ds_read_b64_tr_b16 v[94:95], v26 offset:59392
    s_movk_i32 s86, 12288
    buffer_load_dword v155, v127, s[72:75], s86 offen
    s_waitcnt lgkmcnt(10)
    v_mfma_f32_32x32x16_bf16 a[128:143], v[64:67], v[40:43], a[128:143]
    ds_read_b64_tr_b16 v[96:97], v27 offset:57344
    v_mfma_f32_32x32x16_bf16 a[144:159], v[64:67], v[44:47], a[144:159]
    ds_read_b64_tr_b16 v[98:99], v27 offset:59392
    v_mfma_f32_32x32x16_bf16 a[160:175], v[64:67], v[48:51], a[160:175]
    ds_read_b64_tr_b16 v[100:101], v28 offset:57344
    buffer_load_dwordx4 v7, s[12:15], s33 offen offset:2048 lds
    v_mfma_f32_32x32x16_bf16 a[176:191], v[64:67], v[52:55], a[176:191]
    ds_read_b64_tr_b16 v[102:103], v28 offset:59392
    s_waitcnt lgkmcnt(12)
    v_mfma_f32_32x32x16_bf16 a[192:207], v[68:71], v[40:43], a[192:207]
    v_mfma_f32_32x32x16_bf16 a[208:223], v[68:71], v[44:47], a[208:223]
    s_movk_i32 s86, 8192
    buffer_load_dword v154, v127, s[72:75], s86 offen
    v_mfma_f32_32x32x16_bf16 a[224:239], v[68:71], v[48:51], a[224:239]
    buffer_load_dwordx4 v8, s[12:15], s33 offen offset:3072 lds
    v_mfma_f32_32x32x16_bf16 a[240:255], v[68:71], v[52:55], a[240:255]
    s_waitcnt vmcnt(26) lgkmcnt(0)
    s_barrier
    v_mfma_f32_32x32x16_bf16 a[0:15], v[88:91], v[72:75], a[0:15]
    ds_read_b128 v[40:43], v21 offset:0
    v_mfma_f32_32x32x16_bf16 a[16:31], v[88:91], v[76:79], a[16:31]
    ds_read_b64_tr_b16 v[56:57], v25 offset:0
    v_mfma_f32_32x32x16_bf16 a[32:47], v[88:91], v[80:83], a[32:47]
    ds_read_b64_tr_b16 v[58:59], v25 offset:2048
    v_mfma_f32_32x32x16_bf16 a[48:63], v[88:91], v[84:87], a[48:63]
    ds_read_b128 v[44:47], v21 offset:4096
    v_mfma_f32_32x32x16_bf16 a[64:79], v[92:95], v[72:75], a[64:79]
    ds_read_b128 v[48:51], v21 offset:8192
    s_add_u32 m0, s32, 49152
    s_mov_b32 s33, 8126464
    buffer_load_dwordx4 v5, s[12:15], s33 offen lds
    v_mfma_f32_32x32x16_bf16 a[80:95], v[92:95], v[76:79], a[80:95]
    ds_read_b128 v[52:55], v21 offset:12288
    v_mfma_f32_32x32x16_bf16 a[96:111], v[92:95], v[80:83], a[96:111]
    ds_read_b64_tr_b16 v[60:61], v26 offset:0
    v_mfma_f32_32x32x16_bf16 a[112:127], v[92:95], v[84:87], a[112:127]
    ds_read_b64_tr_b16 v[62:63], v26 offset:2048
    s_movk_i32 s86, 20480
    buffer_load_dword v157, v127, s[72:75], s86 offen
    v_mfma_f32_32x32x16_bf16 a[128:143], v[96:99], v[72:75], a[128:143]
    v_mfma_f32_32x32x16_bf16 a[144:159], v[96:99], v[76:79], a[144:159]
    v_mfma_f32_32x32x16_bf16 a[160:175], v[96:99], v[80:83], a[160:175]
    v_mfma_f32_32x32x16_bf16 a[176:191], v[96:99], v[84:87], a[176:191]
    v_mfma_f32_32x32x16_bf16 a[192:207], v[100:103], v[72:75], a[192:207]
    buffer_load_dwordx4 v6, s[12:15], s33 offen offset:1024 lds
    v_mfma_f32_32x32x16_bf16 a[208:223], v[100:103], v[76:79], a[208:223]
    s_movk_i32 s86, 16384
    buffer_load_dword v156, v127, s[72:75], s86 offen
    v_mfma_f32_32x32x16_bf16 a[224:239], v[100:103], v[80:83], a[224:239]
    v_mfma_f32_32x32x16_bf16 a[240:255], v[100:103], v[84:87], a[240:255]
    s_waitcnt lgkmcnt(5)
    v_mfma_f32_32x32x16_bf16 a[0:15], v[56:59], v[40:43], a[0:15]
    ds_read_b128 v[72:75], v22 offset:0
    ds_read_b64_tr_b16 v[88:89], v25 offset:8192
    s_waitcnt lgkmcnt(6)
    v_mfma_f32_32x32x16_bf16 a[16:31], v[56:59], v[44:47], a[16:31]
    ds_read_b64_tr_b16 v[90:91], v25 offset:10240
    ds_read_b128 v[76:79], v22 offset:4096
    s_waitcnt lgkmcnt(7)
    v_mfma_f32_32x32x16_bf16 a[32:47], v[56:59], v[48:51], a[32:47]
    ds_read_b128 v[80:83], v22 offset:8192
    ds_read_b128 v[84:87], v22 offset:12288
    buffer_load_dwordx4 v7, s[12:15], s33 offen offset:2048 lds
    s_waitcnt lgkmcnt(8)
    v_mfma_f32_32x32x16_bf16 a[48:63], v[56:59], v[52:55], a[48:63]
    ds_read_b64_tr_b16 v[92:93], v26 offset:8192
    ds_read_b64_tr_b16 v[94:95], v26 offset:10240
    s_waitcnt lgkmcnt(8)
    v_mfma_f32_32x32x16_bf16 a[64:79], v[60:63], v[40:43], a[64:79]
    v_mfma_f32_32x32x16_bf16 a[80:95], v[60:63], v[44:47], a[80:95]
    v_mfma_f32_32x32x16_bf16 a[96:111], v[60:63], v[48:51], a[96:111]
    buffer_load_dwordx4 v8, s[12:15], s33 offen offset:3072 lds
    v_mfma_f32_32x32x16_bf16 a[112:127], v[60:63], v[52:55], a[112:127]
    s_movk_i32 s86, 24576
    buffer_load_dword v158, v127, s[72:75], s86 offen
    s_movk_i32 s86, 28672
    buffer_load_dword v159, v127, s[72:75], s86 offen
    s_waitcnt vmcnt(27) lgkmcnt(0)
    s_barrier
    v_mfma_f32_32x32x16_bf16 a[0:15], v[88:91], v[72:75], a[0:15]
    ds_read_b128 v[40:43], v23 offset:0
    ds_read_b64_tr_b16 v[56:57], v25 offset:16384
    v_mfma_f32_32x32x16_bf16 a[16:31], v[88:91], v[76:79], a[16:31]
    ds_read_b64_tr_b16 v[58:59], v25 offset:18432
    ds_read_b128 v[44:47], v23 offset:4096
    v_mfma_f32_32x32x16_bf16 a[32:47], v[88:91], v[80:83], a[32:47]
    ds_read_b128 v[48:51], v23 offset:8192
    ds_read_b128 v[52:55], v23 offset:12288
    v_mfma_f32_32x32x16_bf16 a[48:63], v[88:91], v[84:87], a[48:63]
    ds_read_b64_tr_b16 v[60:61], v26 offset:16384
    ds_read_b64_tr_b16 v[62:63], v26 offset:18432
    v_mfma_f32_32x32x16_bf16 a[64:79], v[92:95], v[72:75], a[64:79]
    v_mfma_f32_32x32x16_bf16 a[80:95], v[92:95], v[76:79], a[80:95]
    v_mfma_f32_32x32x16_bf16 a[96:111], v[92:95], v[80:83], a[96:111]
    v_mfma_f32_32x32x16_bf16 a[112:127], v[92:95], v[84:87], a[112:127]
    s_waitcnt lgkmcnt(5)
    v_mfma_f32_32x32x16_bf16 a[0:15], v[56:59], v[40:43], a[0:15]
    ds_read_b128 v[72:75], v24 offset:0
    ds_read_b64_tr_b16 v[88:89], v25 offset:24576
    s_waitcnt lgkmcnt(6)
    v_mfma_f32_32x32x16_bf16 a[16:31], v[56:59], v[44:47], a[16:31]
    ds_read_b64_tr_b16 v[90:91], v25 offset:26624
    ds_read_b128 v[76:79], v24 offset:4096
    s_waitcnt lgkmcnt(7)
    v_mfma_f32_32x32x16_bf16 a[32:47], v[56:59], v[48:51], a[32:47]
    ds_read_b128 v[80:83], v24 offset:8192
    ds_read_b128 v[84:87], v24 offset:12288
    s_waitcnt lgkmcnt(8)
    v_mfma_f32_32x32x16_bf16 a[48:63], v[56:59], v[52:55], a[48:63]
    ds_read_b64_tr_b16 v[92:93], v26 offset:24576
    ds_read_b64_tr_b16 v[94:95], v26 offset:26624
    s_waitcnt lgkmcnt(8)
    v_mfma_f32_32x32x16_bf16 a[64:79], v[60:63], v[40:43], a[64:79]
    v_mfma_f32_32x32x16_bf16 a[80:95], v[60:63], v[44:47], a[80:95]
    v_mfma_f32_32x32x16_bf16 a[96:111], v[60:63], v[48:51], a[96:111]
    v_mfma_f32_32x32x16_bf16 a[112:127], v[60:63], v[52:55], a[112:127]
    s_waitcnt vmcnt(8) lgkmcnt(0)
    s_barrier
    v_mfma_f32_32x32x16_bf16 a[0:15], v[88:91], v[72:75], a[0:15]
    ds_read_b128 v[40:43], v17 offset:0
    ds_read_b64_tr_b16 v[56:57], v25 offset:32768
    v_mfma_f32_32x32x16_bf16 a[16:31], v[88:91], v[76:79], a[16:31]
    ds_read_b64_tr_b16 v[58:59], v25 offset:34816
    ds_read_b128 v[44:47], v17 offset:4096
    v_mfma_f32_32x32x16_bf16 a[32:47], v[88:91], v[80:83], a[32:47]
    ds_read_b128 v[48:51], v17 offset:8192
    ds_read_b128 v[52:55], v17 offset:12288
    v_mfma_f32_32x32x16_bf16 a[48:63], v[88:91], v[84:87], a[48:63]
    ds_read_b64_tr_b16 v[60:61], v26 offset:32768
    ds_read_b64_tr_b16 v[62:63], v26 offset:34816
    v_mfma_f32_32x32x16_bf16 a[64:79], v[92:95], v[72:75], a[64:79]
    v_mfma_f32_32x32x16_bf16 a[80:95], v[92:95], v[76:79], a[80:95]
    v_mfma_f32_32x32x16_bf16 a[96:111], v[92:95], v[80:83], a[96:111]
    v_mfma_f32_32x32x16_bf16 a[112:127], v[92:95], v[84:87], a[112:127]
    s_waitcnt lgkmcnt(5)
    v_mfma_f32_32x32x16_bf16 a[0:15], v[56:59], v[40:43], a[0:15]
    ds_read_b128 v[72:75], v18 offset:0
    ds_read_b64_tr_b16 v[88:89], v25 offset:40960
    s_waitcnt lgkmcnt(6)
    v_mfma_f32_32x32x16_bf16 a[16:31], v[56:59], v[44:47], a[16:31]
    ds_read_b64_tr_b16 v[90:91], v25 offset:43008
    ds_read_b128 v[76:79], v18 offset:4096
    s_waitcnt lgkmcnt(7)
    v_mfma_f32_32x32x16_bf16 a[32:47], v[56:59], v[48:51], a[32:47]
    ds_read_b128 v[80:83], v18 offset:8192
    ds_read_b128 v[84:87], v18 offset:12288
    s_waitcnt lgkmcnt(8)
    v_mfma_f32_32x32x16_bf16 a[48:63], v[56:59], v[52:55], a[48:63]
    ds_read_b64_tr_b16 v[92:93], v26 offset:40960
    ds_read_b64_tr_b16 v[94:95], v26 offset:43008
    s_waitcnt lgkmcnt(8)
    v_mfma_f32_32x32x16_bf16 a[64:79], v[60:63], v[40:43], a[64:79]
    v_mfma_f32_32x32x16_bf16 a[80:95], v[60:63], v[44:47], a[80:95]
    v_mfma_f32_32x32x16_bf16 a[96:111], v[60:63], v[48:51], a[96:111]
    v_mfma_f32_32x32x16_bf16 a[112:127], v[60:63], v[52:55], a[112:127]
    s_waitcnt vmcnt(2) lgkmcnt(0)
    s_barrier
    v_mfma_f32_32x32x16_bf16 a[0:15], v[88:91], v[72:75], a[0:15]
    ds_read_b128 v[40:43], v19 offset:0
    ds_read_b64_tr_b16 v[56:57], v25 offset:49152
    v_mfma_f32_32x32x16_bf16 a[16:31], v[88:91], v[76:79], a[16:31]
    ds_read_b64_tr_b16 v[58:59], v25 offset:51200
    ds_read_b128 v[44:47], v19 offset:4096
    v_mfma_f32_32x32x16_bf16 a[32:47], v[88:91], v[80:83], a[32:47]
    ds_read_b128 v[48:51], v19 offset:8192
    ds_read_b128 v[52:55], v19 offset:12288
    v_mfma_f32_32x32x16_bf16 a[48:63], v[88:91], v[84:87], a[48:63]
    ds_read_b64_tr_b16 v[60:61], v26 offset:49152
    ds_read_b64_tr_b16 v[62:63], v26 offset:51200
    v_mfma_f32_32x32x16_bf16 a[64:79], v[92:95], v[72:75], a[64:79]
    v_mfma_f32_32x32x16_bf16 a[80:95], v[92:95], v[76:79], a[80:95]
    v_mfma_f32_32x32x16_bf16 a[96:111], v[92:95], v[80:83], a[96:111]
    v_mfma_f32_32x32x16_bf16 a[112:127], v[92:95], v[84:87], a[112:127]
    s_waitcnt lgkmcnt(5)
    v_mfma_f32_32x32x16_bf16 a[0:15], v[56:59], v[40:43], a[0:15]
    ds_read_b128 v[72:75], v20 offset:0
    ds_read_b64_tr_b16 v[88:89], v25 offset:57344
    s_waitcnt lgkmcnt(6)
    v_mfma_f32_32x32x16_bf16 a[16:31], v[56:59], v[44:47], a[16:31]
    ds_read_b64_tr_b16 v[90:91], v25 offset:59392
    ds_read_b128 v[76:79], v20 offset:4096
    s_waitcnt lgkmcnt(7)
    v_mfma_f32_32x32x16_bf16 a[32:47], v[56:59], v[48:51], a[32:47]
    ds_read_b128 v[80:83], v20 offset:8192
    ds_read_b128 v[84:87], v20 offset:12288
    s_waitcnt lgkmcnt(8)
    v_mfma_f32_32x32x16_bf16 a[48:63], v[56:59], v[52:55], a[48:63]
    ds_read_b64_tr_b16 v[92:93], v26 offset:57344
    ds_read_b64_tr_b16 v[94:95], v26 offset:59392
    s_waitcnt lgkmcnt(8)
    v_mfma_f32_32x32x16_bf16 a[64:79], v[60:63], v[40:43], a[64:79]
    v_mfma_f32_32x32x16_bf16 a[80:95], v[60:63], v[44:47], a[80:95]
    v_mfma_f32_32x32x16_bf16 a[96:111], v[60:63], v[48:51], a[96:111]
    v_mfma_f32_32x32x16_bf16 a[112:127], v[60:63], v[52:55], a[112:127]
    s_waitcnt lgkmcnt(0)
    s_barrier
    v_mfma_f32_32x32x16_bf16 a[0:15], v[88:91], v[72:75], a[0:15]
    ds_read_b128 v[40:43], v21 offset:0
    ds_read_b64_tr_b16 v[64:65], v27 offset:0
    v_mfma_f32_32x32x16_bf16 a[16:31], v[88:91], v[76:79], a[16:31]
    ds_read_b64_tr_b16 v[66:67], v27 offset:2048
    ds_read_b128 v[44:47], v21 offset:4096
    v_mfma_f32_32x32x16_bf16 a[32:47], v[88:91], v[80:83], a[32:47]
    ds_read_b128 v[48:51], v21 offset:8192
    ds_read_b128 v[52:55], v21 offset:12288
    v_mfma_f32_32x32x16_bf16 a[48:63], v[88:91], v[84:87], a[48:63]
    ds_read_b64_tr_b16 v[68:69], v28 offset:0
    ds_read_b64_tr_b16 v[70:71], v28 offset:2048
    v_mfma_f32_32x32x16_bf16 a[64:79], v[92:95], v[72:75], a[64:79]
    v_mfma_f32_32x32x16_bf16 a[80:95], v[92:95], v[76:79], a[80:95]
    v_mfma_f32_32x32x16_bf16 a[96:111], v[92:95], v[80:83], a[96:111]
    v_mfma_f32_32x32x16_bf16 a[112:127], v[92:95], v[84:87], a[112:127]
    s_waitcnt lgkmcnt(5)
    v_mfma_f32_32x32x16_bf16 a[128:143], v[64:67], v[40:43], a[128:143]
    ds_read_b128 v[72:75], v22 offset:0
    ds_read_b64_tr_b16 v[96:97], v27 offset:8192
    s_waitcnt lgkmcnt(6)
    v_mfma_f32_32x32x16_bf16 a[144:159], v[64:67], v[44:47], a[144:159]
    ds_read_b64_tr_b16 v[98:99], v27 offset:10240
    ds_read_b128 v[76:79], v22 offset:4096
    s_waitcnt lgkmcnt(7)
    v_mfma_f32_32x32x16_bf16 a[160:175], v[64:67], v[48:51], a[160:175]
    ds_read_b128 v[80:83], v22 offset:8192
    ds_read_b128 v[84:87], v22 offset:12288
    s_waitcnt lgkmcnt(8)
    v_mfma_f32_32x32x16_bf16 a[176:191], v[64:67], v[52:55], a[176:191]
    ds_read_b64_tr_b16 v[100:101], v28 offset:8192
    ds_read_b64_tr_b16 v[102:103], v28 offset:10240
    s_waitcnt lgkmcnt(8)
    v_mfma_f32_32x32x16_bf16 a[192:207], v[68:71], v[40:43], a[192:207]
    v_mfma_f32_32x32x16_bf16 a[208:223], v[68:71], v[44:47], a[208:223]
    v_mfma_f32_32x32x16_bf16 a[224:239], v[68:71], v[48:51], a[224:239]
    v_mfma_f32_32x32x16_bf16 a[240:255], v[68:71], v[52:55], a[240:255]
    s_waitcnt lgkmcnt(5)
    v_mfma_f32_32x32x16_bf16 a[128:143], v[96:99], v[72:75], a[128:143]
    ds_read_b128 v[40:43], v23 offset:0
    ds_read_b64_tr_b16 v[64:65], v27 offset:16384
    v_accvgpr_read_b32 v160, a0
    v_accvgpr_read_b32 v161, a1
    v_accvgpr_read_b32 v162, a2
    v_accvgpr_read_b32 v163, a3
    s_waitcnt lgkmcnt(6)
    v_mfma_f32_32x32x16_bf16 a[144:159], v[96:99], v[76:79], a[144:159]
    ds_read_b64_tr_b16 v[66:67], v27 offset:18432
    ds_read_b128 v[44:47], v23 offset:4096
    v_accvgpr_read_b32 v164, a4
    v_accvgpr_read_b32 v165, a5
    v_accvgpr_read_b32 v166, a6
    v_accvgpr_read_b32 v167, a7
    s_waitcnt lgkmcnt(7)
    v_mfma_f32_32x32x16_bf16 a[160:175], v[96:99], v[80:83], a[160:175]
    ds_read_b128 v[48:51], v23 offset:8192
    ds_read_b128 v[52:55], v23 offset:12288
    v_cvt_pk_bf16_f32 v176, v160, v161
    v_cvt_pk_bf16_f32 v177, v162, v163
    v_cvt_pk_bf16_f32 v178, v164, v165
    v_cvt_pk_bf16_f32 v179, v166, v167
    s_waitcnt lgkmcnt(8)
    v_mfma_f32_32x32x16_bf16 a[176:191], v[96:99], v[84:87], a[176:191]
    ds_read_b64_tr_b16 v[68:69], v28 offset:16384
    ds_read_b64_tr_b16 v[70:71], v28 offset:18432
    s_mov_b32 s34, 0
    buffer_store_dwordx4 v[176:179], v37, s[24:27], s34 offen sc1
    v_accvgpr_read_b32 v168, a8
    v_accvgpr_read_b32 v169, a9
    s_waitcnt lgkmcnt(8)
    v_mfma_f32_32x32x16_bf16 a[192:207], v[100:103], v[72:75], a[192:207]
    v_accvgpr_read_b32 v170, a10
    v_accvgpr_read_b32 v171, a11
    v_accvgpr_read_b32 v172, a12
    v_accvgpr_read_b32 v173, a13
    v_mfma_f32_32x32x16_bf16 a[208:223], v[100:103], v[76:79], a[208:223]
    v_accvgpr_read_b32 v174, a14
    v_accvgpr_read_b32 v175, a15
    v_cvt_pk_bf16_f32 v180, v168, v169
    v_cvt_pk_bf16_f32 v181, v170, v171
    v_mfma_f32_32x32x16_bf16 a[224:239], v[100:103], v[80:83], a[224:239]
    v_cvt_pk_bf16_f32 v182, v172, v173
    v_cvt_pk_bf16_f32 v183, v174, v175
    s_mov_b32 s34, 1024
    buffer_store_dwordx4 v[180:183], v37, s[24:27], s34 offen sc1
    v_mfma_f32_32x32x16_bf16 a[240:255], v[100:103], v[84:87], a[240:255]
    v_accvgpr_read_b32 v160, a16
    v_accvgpr_read_b32 v161, a17
    v_accvgpr_read_b32 v162, a18
    v_accvgpr_read_b32 v163, a19
    s_waitcnt lgkmcnt(5)
    v_mfma_f32_32x32x16_bf16 a[128:143], v[64:67], v[40:43], a[128:143]
    ds_read_b128 v[72:75], v24 offset:0
    ds_read_b64_tr_b16 v[96:97], v27 offset:24576
    v_accvgpr_read_b32 v164, a20
    v_accvgpr_read_b32 v165, a21
    v_accvgpr_read_b32 v166, a22
    v_accvgpr_read_b32 v167, a23
    s_waitcnt lgkmcnt(6)
    v_mfma_f32_32x32x16_bf16 a[144:159], v[64:67], v[44:47], a[144:159]
    ds_read_b64_tr_b16 v[98:99], v27 offset:26624
    ds_read_b128 v[76:79], v24 offset:4096
    v_cvt_pk_bf16_f32 v184, v160, v161
    v_cvt_pk_bf16_f32 v185, v162, v163
    v_cvt_pk_bf16_f32 v186, v164, v165
    v_cvt_pk_bf16_f32 v187, v166, v167
    s_waitcnt lgkmcnt(7)
    v_mfma_f32_32x32x16_bf16 a[160:175], v[64:67], v[48:51], a[160:175]
    ds_read_b128 v[80:83], v24 offset:8192
    ds_read_b128 v[84:87], v24 offset:12288
    s_mov_b32 s34, 16384
    buffer_store_dwordx4 v[184:187], v37, s[24:27], s34 offen sc1
    v_accvgpr_read_b32 v168, a24
    v_accvgpr_read_b32 v169, a25
    s_waitcnt lgkmcnt(8)
    v_mfma_f32_32x32x16_bf16 a[176:191], v[64:67], v[52:55], a[176:191]
    ds_read_b64_tr_b16 v[100:101], v28 offset:24576
    ds_read_b64_tr_b16 v[102:103], v28 offset:26624
    v_accvgpr_read_b32 v170, a26
    v_accvgpr_read_b32 v171, a27
    v_accvgpr_read_b32 v172, a28
    v_accvgpr_read_b32 v173, a29
    s_waitcnt lgkmcnt(8)
    v_mfma_f32_32x32x16_bf16 a[192:207], v[68:71], v[40:43], a[192:207]
    v_accvgpr_read_b32 v174, a30
    v_accvgpr_read_b32 v175, a31
    v_cvt_pk_bf16_f32 v188, v168, v169
    v_cvt_pk_bf16_f32 v189, v170, v171
    v_mfma_f32_32x32x16_bf16 a[208:223], v[68:71], v[44:47], a[208:223]
    v_cvt_pk_bf16_f32 v190, v172, v173
    v_cvt_pk_bf16_f32 v191, v174, v175
    s_mov_b32 s34, 17408
    buffer_store_dwordx4 v[188:191], v37, s[24:27], s34 offen sc1
    v_mfma_f32_32x32x16_bf16 a[224:239], v[68:71], v[48:51], a[224:239]
    v_accvgpr_read_b32 v160, a32
    v_accvgpr_read_b32 v161, a33
    v_accvgpr_read_b32 v162, a34
    v_accvgpr_read_b32 v163, a35
    v_mfma_f32_32x32x16_bf16 a[240:255], v[68:71], v[52:55], a[240:255]
    v_accvgpr_read_b32 v164, a36
    v_accvgpr_read_b32 v165, a37
    v_accvgpr_read_b32 v166, a38
    v_accvgpr_read_b32 v167, a39
    s_waitcnt lgkmcnt(5)
    v_mfma_f32_32x32x16_bf16 a[128:143], v[96:99], v[72:75], a[128:143]
    ds_read_b128 v[40:43], v17 offset:0
    ds_read_b64_tr_b16 v[64:65], v27 offset:32768
    v_cvt_pk_bf16_f32 v176, v160, v161
    v_cvt_pk_bf16_f32 v177, v162, v163
    v_cvt_pk_bf16_f32 v178, v164, v165
    v_cvt_pk_bf16_f32 v179, v166, v167
    s_waitcnt lgkmcnt(6)
    v_mfma_f32_32x32x16_bf16 a[144:159], v[96:99], v[76:79], a[144:159]
    ds_read_b64_tr_b16 v[66:67], v27 offset:34816
    ds_read_b128 v[44:47], v17 offset:4096
    s_mov_b32 s34, 32768
    buffer_store_dwordx4 v[176:179], v37, s[24:27], s34 offen sc1
    v_accvgpr_read_b32 v168, a40
    v_accvgpr_read_b32 v169, a41
    s_waitcnt lgkmcnt(7)
    v_mfma_f32_32x32x16_bf16 a[160:175], v[96:99], v[80:83], a[160:175]
    ds_read_b128 v[48:51], v17 offset:8192
    ds_read_b128 v[52:55], v17 offset:12288
    v_accvgpr_read_b32 v170, a42
    v_accvgpr_read_b32 v171, a43
    v_accvgpr_read_b32 v172, a44
    v_accvgpr_read_b32 v173, a45
    s_waitcnt lgkmcnt(8)
    v_mfma_f32_32x32x16_bf16 a[176:191], v[96:99], v[84:87], a[176:191]
    ds_read_b64_tr_b16 v[68:69], v28 offset:32768
    ds_read_b64_tr_b16 v[70:71], v28 offset:34816
    v_accvgpr_read_b32 v174, a46
    v_accvgpr_read_b32 v175, a47
    v_cvt_pk_bf16_f32 v180, v168, v169
    v_cvt_pk_bf16_f32 v181, v170, v171
    s_waitcnt lgkmcnt(8)
    v_mfma_f32_32x32x16_bf16 a[192:207], v[100:103], v[72:75], a[192:207]
    v_cvt_pk_bf16_f32 v182, v172, v173
    v_cvt_pk_bf16_f32 v183, v174, v175
    s_mov_b32 s34, 33792
    buffer_store_dwordx4 v[180:183], v37, s[24:27], s34 offen sc1
    v_mfma_f32_32x32x16_bf16 a[208:223], v[100:103], v[76:79], a[208:223]
    v_accvgpr_read_b32 v160, a48
    v_accvgpr_read_b32 v161, a49
    v_accvgpr_read_b32 v162, a50
    v_accvgpr_read_b32 v163, a51
    v_mfma_f32_32x32x16_bf16 a[224:239], v[100:103], v[80:83], a[224:239]
    v_accvgpr_read_b32 v164, a52
    v_accvgpr_read_b32 v165, a53
    v_accvgpr_read_b32 v166, a54
    v_accvgpr_read_b32 v167, a55
    v_mfma_f32_32x32x16_bf16 a[240:255], v[100:103], v[84:87], a[240:255]
    v_cvt_pk_bf16_f32 v184, v160, v161
    v_cvt_pk_bf16_f32 v185, v162, v163
    v_cvt_pk_bf16_f32 v186, v164, v165
    v_cvt_pk_bf16_f32 v187, v166, v167
    s_waitcnt lgkmcnt(5)
    v_mfma_f32_32x32x16_bf16 a[128:143], v[64:67], v[40:43], a[128:143]
    ds_read_b128 v[72:75], v18 offset:0
    ds_read_b64_tr_b16 v[96:97], v27 offset:40960
    s_mov_b32 s34, 49152
    buffer_store_dwordx4 v[184:187], v37, s[24:27], s34 offen sc1
    v_accvgpr_read_b32 v168, a56
    v_accvgpr_read_b32 v169, a57
    s_waitcnt lgkmcnt(6)
    v_mfma_f32_32x32x16_bf16 a[144:159], v[64:67], v[44:47], a[144:159]
    ds_read_b64_tr_b16 v[98:99], v27 offset:43008
    ds_read_b128 v[76:79], v18 offset:4096
    v_accvgpr_read_b32 v170, a58
    v_accvgpr_read_b32 v171, a59
    v_accvgpr_read_b32 v172, a60
    v_accvgpr_read_b32 v173, a61
    s_waitcnt lgkmcnt(7)
    v_mfma_f32_32x32x16_bf16 a[160:175], v[64:67], v[48:51], a[160:175]
    ds_read_b128 v[80:83], v18 offset:8192
    ds_read_b128 v[84:87], v18 offset:12288
    v_accvgpr_read_b32 v174, a62
    v_accvgpr_read_b32 v175, a63
    v_cvt_pk_bf16_f32 v188, v168, v169
    v_cvt_pk_bf16_f32 v189, v170, v171
    s_waitcnt lgkmcnt(8)
    v_mfma_f32_32x32x16_bf16 a[176:191], v[64:67], v[52:55], a[176:191]
    ds_read_b64_tr_b16 v[100:101], v28 offset:40960
    ds_read_b64_tr_b16 v[102:103], v28 offset:43008
    v_cvt_pk_bf16_f32 v190, v172, v173
    v_cvt_pk_bf16_f32 v191, v174, v175
    s_mov_b32 s34, 50176
    buffer_store_dwordx4 v[188:191], v37, s[24:27], s34 offen sc1
    s_waitcnt lgkmcnt(8)
    v_mfma_f32_32x32x16_bf16 a[192:207], v[68:71], v[40:43], a[192:207]
    v_accvgpr_read_b32 v160, a64
    v_accvgpr_read_b32 v161, a65
    v_accvgpr_read_b32 v162, a66
    v_accvgpr_read_b32 v163, a67
    v_mfma_f32_32x32x16_bf16 a[208:223], v[68:71], v[44:47], a[208:223]
    v_accvgpr_read_b32 v164, a68
    v_accvgpr_read_b32 v165, a69
    v_accvgpr_read_b32 v166, a70
    v_accvgpr_read_b32 v167, a71
    v_mfma_f32_32x32x16_bf16 a[224:239], v[68:71], v[48:51], a[224:239]
    v_cvt_pk_bf16_f32 v176, v160, v161
    v_cvt_pk_bf16_f32 v177, v162, v163
    v_cvt_pk_bf16_f32 v178, v164, v165
    v_cvt_pk_bf16_f32 v179, v166, v167
    v_mfma_f32_32x32x16_bf16 a[240:255], v[68:71], v[52:55], a[240:255]
    s_mov_b32 s34, 2048
    buffer_store_dwordx4 v[176:179], v37, s[24:27], s34 offen sc1
    v_accvgpr_read_b32 v168, a72
    v_accvgpr_read_b32 v169, a73
    s_waitcnt lgkmcnt(5)
    v_mfma_f32_32x32x16_bf16 a[128:143], v[96:99], v[72:75], a[128:143]
    ds_read_b128 v[40:43], v19 offset:0
    ds_read_b64_tr_b16 v[64:65], v27 offset:49152
    v_accvgpr_read_b32 v170, a74
    v_accvgpr_read_b32 v171, a75
    v_accvgpr_read_b32 v172, a76
    v_accvgpr_read_b32 v173, a77
    s_waitcnt lgkmcnt(6)
    v_mfma_f32_32x32x16_bf16 a[144:159], v[96:99], v[76:79], a[144:159]
    ds_read_b64_tr_b16 v[66:67], v27 offset:51200
    ds_read_b128 v[44:47], v19 offset:4096
    v_accvgpr_read_b32 v174, a78
    v_accvgpr_read_b32 v175, a79
    v_cvt_pk_bf16_f32 v180, v168, v169
    v_cvt_pk_bf16_f32 v181, v170, v171
    s_waitcnt lgkmcnt(7)
    v_mfma_f32_32x32x16_bf16 a[160:175], v[96:99], v[80:83], a[160:175]
    ds_read_b128 v[48:51], v19 offset:8192
    ds_read_b128 v[52:55], v19 offset:12288
    v_cvt_pk_bf16_f32 v182, v172, v173
    v_cvt_pk_bf16_f32 v183, v174, v175
    s_mov_b32 s34, 3072
    buffer_store_dwordx4 v[180:183], v37, s[24:27], s34 offen sc1
    s_waitcnt lgkmcnt(8)
    v_mfma_f32_32x32x16_bf16 a[176:191], v[96:99], v[84:87], a[176:191]
    ds_read_b64_tr_b16 v[68:69], v28 offset:49152
    ds_read_b64_tr_b16 v[70:71], v28 offset:51200
    v_accvgpr_read_b32 v160, a80
    v_accvgpr_read_b32 v161, a81
    v_accvgpr_read_b32 v162, a82
    v_accvgpr_read_b32 v163, a83
    s_waitcnt lgkmcnt(8)
    v_mfma_f32_32x32x16_bf16 a[192:207], v[100:103], v[72:75], a[192:207]
    v_accvgpr_read_b32 v164, a84
    v_accvgpr_read_b32 v165, a85
    v_accvgpr_read_b32 v166, a86
    v_accvgpr_read_b32 v167, a87
    v_mfma_f32_32x32x16_bf16 a[208:223], v[100:103], v[76:79], a[208:223]
    v_cvt_pk_bf16_f32 v184, v160, v161
    v_cvt_pk_bf16_f32 v185, v162, v163
    v_cvt_pk_bf16_f32 v186, v164, v165
    v_cvt_pk_bf16_f32 v187, v166, v167
    v_mfma_f32_32x32x16_bf16 a[224:239], v[100:103], v[80:83], a[224:239]
    s_mov_b32 s34, 18432
    buffer_store_dwordx4 v[184:187], v37, s[24:27], s34 offen sc1
    v_accvgpr_read_b32 v168, a88
    v_accvgpr_read_b32 v169, a89
    v_mfma_f32_32x32x16_bf16 a[240:255], v[100:103], v[84:87], a[240:255]
    v_accvgpr_read_b32 v170, a90
    v_accvgpr_read_b32 v171, a91
    v_accvgpr_read_b32 v172, a92
    v_accvgpr_read_b32 v173, a93
    s_waitcnt lgkmcnt(5)
    v_mfma_f32_32x32x16_bf16 a[128:143], v[64:67], v[40:43], a[128:143]
    ds_read_b128 v[72:75], v20 offset:0
    ds_read_b64_tr_b16 v[96:97], v27 offset:57344
    v_accvgpr_read_b32 v174, a94
    v_accvgpr_read_b32 v175, a95
    v_cvt_pk_bf16_f32 v188, v168, v169
    v_cvt_pk_bf16_f32 v189, v170, v171
    s_waitcnt lgkmcnt(6)
    v_mfma_f32_32x32x16_bf16 a[144:159], v[64:67], v[44:47], a[144:159]
    ds_read_b64_tr_b16 v[98:99], v27 offset:59392
    ds_read_b128 v[76:79], v20 offset:4096
    v_cvt_pk_bf16_f32 v190, v172, v173
    v_cvt_pk_bf16_f32 v191, v174, v175
    s_mov_b32 s34, 19456
    buffer_store_dwordx4 v[188:191], v37, s[24:27], s34 offen sc1
    s_waitcnt lgkmcnt(7)
    v_mfma_f32_32x32x16_bf16 a[160:175], v[64:67], v[48:51], a[160:175]
    ds_read_b128 v[80:83], v20 offset:8192
    ds_read_b128 v[84:87], v20 offset:12288
    v_accvgpr_read_b32 v160, a96
    v_accvgpr_read_b32 v161, a97
    v_accvgpr_read_b32 v162, a98
    v_accvgpr_read_b32 v163, a99
    s_waitcnt lgkmcnt(8)
    v_mfma_f32_32x32x16_bf16 a[176:191], v[64:67], v[52:55], a[176:191]
    ds_read_b64_tr_b16 v[100:101], v28 offset:57344
    ds_read_b64_tr_b16 v[102:103], v28 offset:59392
    v_accvgpr_read_b32 v164, a100
    v_accvgpr_read_b32 v165, a101
    v_accvgpr_read_b32 v166, a102
    v_accvgpr_read_b32 v167, a103
    s_waitcnt lgkmcnt(8)
    v_mfma_f32_32x32x16_bf16 a[192:207], v[68:71], v[40:43], a[192:207]
    v_cvt_pk_bf16_f32 v176, v160, v161
    v_cvt_pk_bf16_f32 v177, v162, v163
    v_cvt_pk_bf16_f32 v178, v164, v165
    v_cvt_pk_bf16_f32 v179, v166, v167
    v_mfma_f32_32x32x16_bf16 a[208:223], v[68:71], v[44:47], a[208:223]
    s_mov_b32 s34, 34816
    buffer_store_dwordx4 v[176:179], v37, s[24:27], s34 offen sc1
    v_accvgpr_read_b32 v168, a104
    v_accvgpr_read_b32 v169, a105
    v_mfma_f32_32x32x16_bf16 a[224:239], v[68:71], v[48:51], a[224:239]
    v_accvgpr_read_b32 v170, a106
    v_accvgpr_read_b32 v171, a107
    v_accvgpr_read_b32 v172, a108
    v_accvgpr_read_b32 v173, a109
    v_mfma_f32_32x32x16_bf16 a[240:255], v[68:71], v[52:55], a[240:255]
    v_accvgpr_read_b32 v174, a110
    v_accvgpr_read_b32 v175, a111
    v_cvt_pk_bf16_f32 v180, v168, v169
    v_cvt_pk_bf16_f32 v181, v170, v171
    s_waitcnt lgkmcnt(5)
    v_mfma_f32_32x32x16_bf16 a[128:143], v[96:99], v[72:75], a[128:143]
    v_cvt_pk_bf16_f32 v182, v172, v173
    v_cvt_pk_bf16_f32 v183, v174, v175
    s_mov_b32 s34, 35840
    buffer_store_dwordx4 v[180:183], v37, s[24:27], s34 offen sc1
    s_waitcnt lgkmcnt(4)
    v_mfma_f32_32x32x16_bf16 a[144:159], v[96:99], v[76:79], a[144:159]
    v_accvgpr_read_b32 v160, a112
    v_accvgpr_read_b32 v161, a113
    v_accvgpr_read_b32 v162, a114
    v_accvgpr_read_b32 v163, a115
    s_waitcnt lgkmcnt(3)
    v_mfma_f32_32x32x16_bf16 a[160:175], v[96:99], v[80:83], a[160:175]
    v_accvgpr_read_b32 v164, a116
    v_accvgpr_read_b32 v165, a117
    v_accvgpr_read_b32 v166, a118
    v_accvgpr_read_b32 v167, a119
    s_waitcnt lgkmcnt(2)
    v_mfma_f32_32x32x16_bf16 a[176:191], v[96:99], v[84:87], a[176:191]
    v_cvt_pk_bf16_f32 v184, v160, v161
    v_cvt_pk_bf16_f32 v185, v162, v163
    v_cvt_pk_bf16_f32 v186, v164, v165
    v_cvt_pk_bf16_f32 v187, v166, v167
    s_waitcnt lgkmcnt(0)
    v_mfma_f32_32x32x16_bf16 a[192:207], v[100:103], v[72:75], a[192:207]
    s_mov_b32 s34, 51200
    buffer_store_dwordx4 v[184:187], v37, s[24:27], s34 offen sc1
    v_accvgpr_read_b32 v168, a120
    v_accvgpr_read_b32 v169, a121
    v_mfma_f32_32x32x16_bf16 a[208:223], v[100:103], v[76:79], a[208:223]
    v_accvgpr_read_b32 v170, a122
    v_accvgpr_read_b32 v171, a123
    v_accvgpr_read_b32 v172, a124
    v_accvgpr_read_b32 v173, a125
    v_mfma_f32_32x32x16_bf16 a[224:239], v[100:103], v[80:83], a[224:239]
    v_accvgpr_read_b32 v174, a126
    v_accvgpr_read_b32 v175, a127
    v_cvt_pk_bf16_f32 v188, v168, v169
    v_cvt_pk_bf16_f32 v189, v170, v171
    v_mfma_f32_32x32x16_bf16 a[240:255], v[100:103], v[84:87], a[240:255]
    v_cvt_pk_bf16_f32 v190, v172, v173
    v_cvt_pk_bf16_f32 v191, v174, v175
    s_mov_b32 s34, 52224
    buffer_store_dwordx4 v[188:191], v37, s[24:27], s34 offen sc1
    s_nop 7
    s_nop 7
    v_accvgpr_read_b32 v160, a128
    v_accvgpr_read_b32 v161, a129
    v_accvgpr_read_b32 v162, a130
    v_accvgpr_read_b32 v163, a131
    v_accvgpr_read_b32 v164, a132
    v_accvgpr_read_b32 v165, a133
    v_accvgpr_read_b32 v166, a134
    v_accvgpr_read_b32 v167, a135
    v_cvt_pk_bf16_f32 v176, v160, v161
    v_cvt_pk_bf16_f32 v177, v162, v163
    v_cvt_pk_bf16_f32 v178, v164, v165
    v_cvt_pk_bf16_f32 v179, v166, v167
    s_mov_b32 s34, 4096
    buffer_store_dwordx4 v[176:179], v37, s[24:27], s34 offen sc1
    v_accvgpr_read_b32 v168, a136
    v_accvgpr_read_b32 v169, a137
    v_accvgpr_read_b32 v170, a138
    v_accvgpr_read_b32 v171, a139
    v_accvgpr_read_b32 v172, a140
    v_accvgpr_read_b32 v173, a141
    v_accvgpr_read_b32 v174, a142
    v_accvgpr_read_b32 v175, a143
    v_cvt_pk_bf16_f32 v180, v168, v169
    v_cvt_pk_bf16_f32 v181, v170, v171
    v_cvt_pk_bf16_f32 v182, v172, v173
    v_cvt_pk_bf16_f32 v183, v174, v175
    s_mov_b32 s34, 5120
    buffer_store_dwordx4 v[180:183], v37, s[24:27], s34 offen sc1
    v_accvgpr_read_b32 v160, a144
    v_accvgpr_read_b32 v161, a145
    v_accvgpr_read_b32 v162, a146
    v_accvgpr_read_b32 v163, a147
    v_accvgpr_read_b32 v164, a148
    v_accvgpr_read_b32 v165, a149
    v_accvgpr_read_b32 v166, a150
    v_accvgpr_read_b32 v167, a151
    v_cvt_pk_bf16_f32 v184, v160, v161
    v_cvt_pk_bf16_f32 v185, v162, v163
    v_cvt_pk_bf16_f32 v186, v164, v165
    v_cvt_pk_bf16_f32 v187, v166, v167
    s_mov_b32 s34, 20480
    buffer_store_dwordx4 v[184:187], v37, s[24:27], s34 offen sc1
    v_accvgpr_read_b32 v168, a152
    v_accvgpr_read_b32 v169, a153
    v_accvgpr_read_b32 v170, a154
    v_accvgpr_read_b32 v171, a155
    v_accvgpr_read_b32 v172, a156
    v_accvgpr_read_b32 v173, a157
    v_accvgpr_read_b32 v174, a158
    v_accvgpr_read_b32 v175, a159
    v_cvt_pk_bf16_f32 v188, v168, v169
    v_cvt_pk_bf16_f32 v189, v170, v171
    v_cvt_pk_bf16_f32 v190, v172, v173
    v_cvt_pk_bf16_f32 v191, v174, v175
    s_mov_b32 s34, 21504
    buffer_store_dwordx4 v[188:191], v37, s[24:27], s34 offen sc1
    v_accvgpr_read_b32 v160, a160
    v_accvgpr_read_b32 v161, a161
    v_accvgpr_read_b32 v162, a162
    v_accvgpr_read_b32 v163, a163
    v_accvgpr_read_b32 v164, a164
    v_accvgpr_read_b32 v165, a165
    v_accvgpr_read_b32 v166, a166
    v_accvgpr_read_b32 v167, a167
    v_cvt_pk_bf16_f32 v176, v160, v161
    v_cvt_pk_bf16_f32 v177, v162, v163
    v_cvt_pk_bf16_f32 v178, v164, v165
    v_cvt_pk_bf16_f32 v179, v166, v167
    s_mov_b32 s34, 36864
    buffer_store_dwordx4 v[176:179], v37, s[24:27], s34 offen sc1
    v_accvgpr_read_b32 v168, a168
    v_accvgpr_read_b32 v169, a169
    v_accvgpr_read_b32 v170, a170
    v_accvgpr_read_b32 v171, a171
    v_accvgpr_read_b32 v172, a172
    v_accvgpr_read_b32 v173, a173
    v_accvgpr_read_b32 v174, a174
    v_accvgpr_read_b32 v175, a175
    v_cvt_pk_bf16_f32 v180, v168, v169
    v_cvt_pk_bf16_f32 v181, v170, v171
    v_cvt_pk_bf16_f32 v182, v172, v173
    v_cvt_pk_bf16_f32 v183, v174, v175
    s_mov_b32 s34, 37888
    buffer_store_dwordx4 v[180:183], v37, s[24:27], s34 offen sc1
    v_accvgpr_read_b32 v160, a176
    v_accvgpr_read_b32 v161, a177
    v_accvgpr_read_b32 v162, a178
    v_accvgpr_read_b32 v163, a179
    v_accvgpr_read_b32 v164, a180
    v_accvgpr_read_b32 v165, a181
    v_accvgpr_read_b32 v166, a182
    v_accvgpr_read_b32 v167, a183
    v_cvt_pk_bf16_f32 v184, v160, v161
    v_cvt_pk_bf16_f32 v185, v162, v163
    v_cvt_pk_bf16_f32 v186, v164, v165
    v_cvt_pk_bf16_f32 v187, v166, v167
    s_mov_b32 s34, 53248
    buffer_store_dwordx4 v[184:187], v37, s[24:27], s34 offen sc1
    v_accvgpr_read_b32 v168, a184
    v_accvgpr_read_b32 v169, a185
    v_accvgpr_read_b32 v170, a186
    v_accvgpr_read_b32 v171, a187
    v_accvgpr_read_b32 v172, a188
    v_accvgpr_read_b32 v173, a189
    v_accvgpr_read_b32 v174, a190
    v_accvgpr_read_b32 v175, a191
    v_cvt_pk_bf16_f32 v188, v168, v169
    v_cvt_pk_bf16_f32 v189, v170, v171
    v_cvt_pk_bf16_f32 v190, v172, v173
    v_cvt_pk_bf16_f32 v191, v174, v175
    s_mov_b32 s34, 54272
    buffer_store_dwordx4 v[188:191], v37, s[24:27], s34 offen sc1
    v_accvgpr_read_b32 v160, a192
    v_accvgpr_read_b32 v161, a193
    v_accvgpr_read_b32 v162, a194
    v_accvgpr_read_b32 v163, a195
    v_accvgpr_read_b32 v164, a196
    v_accvgpr_read_b32 v165, a197
    v_accvgpr_read_b32 v166, a198
    v_accvgpr_read_b32 v167, a199
    v_cvt_pk_bf16_f32 v176, v160, v161
    v_cvt_pk_bf16_f32 v177, v162, v163
    v_cvt_pk_bf16_f32 v178, v164, v165
    v_cvt_pk_bf16_f32 v179, v166, v167
    s_mov_b32 s34, 6144
    buffer_store_dwordx4 v[176:179], v37, s[24:27], s34 offen sc1
    v_accvgpr_read_b32 v168, a200
    v_accvgpr_read_b32 v169, a201
    v_accvgpr_read_b32 v170, a202
    v_accvgpr_read_b32 v171, a203
    v_accvgpr_read_b32 v172, a204
    v_accvgpr_read_b32 v173, a205
    v_accvgpr_read_b32 v174, a206
    v_accvgpr_read_b32 v175, a207
    v_cvt_pk_bf16_f32 v180, v168, v169
    v_cvt_pk_bf16_f32 v181, v170, v171
    v_cvt_pk_bf16_f32 v182, v172, v173
    v_cvt_pk_bf16_f32 v183, v174, v175
    s_mov_b32 s34, 7168
    buffer_store_dwordx4 v[180:183], v37, s[24:27], s34 offen sc1
    v_accvgpr_read_b32 v160, a208
    v_accvgpr_read_b32 v161, a209
    v_accvgpr_read_b32 v162, a210
    v_accvgpr_read_b32 v163, a211
    v_accvgpr_read_b32 v164, a212
    v_accvgpr_read_b32 v165, a213
    v_accvgpr_read_b32 v166, a214
    v_accvgpr_read_b32 v167, a215
    v_cvt_pk_bf16_f32 v184, v160, v161
    v_cvt_pk_bf16_f32 v185, v162, v163
    v_cvt_pk_bf16_f32 v186, v164, v165
    v_cvt_pk_bf16_f32 v187, v166, v167
    s_mov_b32 s34, 22528
    buffer_store_dwordx4 v[184:187], v37, s[24:27], s34 offen sc1
    v_accvgpr_read_b32 v168, a216
    v_accvgpr_read_b32 v169, a217
    v_accvgpr_read_b32 v170, a218
    v_accvgpr_read_b32 v171, a219
    v_accvgpr_read_b32 v172, a220
    v_accvgpr_read_b32 v173, a221
    v_accvgpr_read_b32 v174, a222
    v_accvgpr_read_b32 v175, a223
    v_cvt_pk_bf16_f32 v188, v168, v169
    v_cvt_pk_bf16_f32 v189, v170, v171
    v_cvt_pk_bf16_f32 v190, v172, v173
    v_cvt_pk_bf16_f32 v191, v174, v175
    s_mov_b32 s34, 23552
    buffer_store_dwordx4 v[188:191], v37, s[24:27], s34 offen sc1
    v_accvgpr_read_b32 v160, a224
    v_accvgpr_read_b32 v161, a225
    v_accvgpr_read_b32 v162, a226
    v_accvgpr_read_b32 v163, a227
    v_accvgpr_read_b32 v164, a228
    v_accvgpr_read_b32 v165, a229
    v_accvgpr_read_b32 v166, a230
    v_accvgpr_read_b32 v167, a231
    v_cvt_pk_bf16_f32 v176, v160, v161
    v_cvt_pk_bf16_f32 v177, v162, v163
    v_cvt_pk_bf16_f32 v178, v164, v165
    v_cvt_pk_bf16_f32 v179, v166, v167
    s_mov_b32 s34, 38912
    buffer_store_dwordx4 v[176:179], v37, s[24:27], s34 offen sc1
    v_accvgpr_read_b32 v168, a232
    v_accvgpr_read_b32 v169, a233
    v_accvgpr_read_b32 v170, a234
    v_accvgpr_read_b32 v171, a235
    v_accvgpr_read_b32 v172, a236
    v_accvgpr_read_b32 v173, a237
    v_accvgpr_read_b32 v174, a238
    v_accvgpr_read_b32 v175, a239
    v_cvt_pk_bf16_f32 v180, v168, v169
    v_cvt_pk_bf16_f32 v181, v170, v171
    v_cvt_pk_bf16_f32 v182, v172, v173
    v_cvt_pk_bf16_f32 v183, v174, v175
    s_mov_b32 s34, 39936
    buffer_store_dwordx4 v[180:183], v37, s[24:27], s34 offen sc1
    v_accvgpr_read_b32 v160, a240
    v_accvgpr_read_b32 v161, a241
    v_accvgpr_read_b32 v162, a242
    v_accvgpr_read_b32 v163, a243
    v_accvgpr_read_b32 v164, a244
    v_accvgpr_read_b32 v165, a245
    v_accvgpr_read_b32 v166, a246
    v_accvgpr_read_b32 v167, a247
    v_cvt_pk_bf16_f32 v184, v160, v161
    v_cvt_pk_bf16_f32 v185, v162, v163
    v_cvt_pk_bf16_f32 v186, v164, v165
    v_cvt_pk_bf16_f32 v187, v166, v167
    s_mov_b32 s34, 55296
    buffer_store_dwordx4 v[184:187], v37, s[24:27], s34 offen sc1
    v_accvgpr_read_b32 v168, a248
    v_accvgpr_read_b32 v169, a249
    v_accvgpr_read_b32 v170, a250
    v_accvgpr_read_b32 v171, a251
    v_accvgpr_read_b32 v172, a252
    v_accvgpr_read_b32 v173, a253
    v_accvgpr_read_b32 v174, a254
    v_accvgpr_read_b32 v175, a255
    v_cvt_pk_bf16_f32 v188, v168, v169
    v_cvt_pk_bf16_f32 v189, v170, v171
    v_cvt_pk_bf16_f32 v190, v172, v173
    v_cvt_pk_bf16_f32 v191, v174, v175
    s_mov_b32 s34, 56320
    buffer_store_dwordx4 v[188:191], v37, s[24:27], s34 offen sc1
    s_barrier
    s_mul_i32 s55, s2, 14336
    s_add_u32 s8, s98, s55
    s_addc_u32 s9, s99, 0
    s_mov_b32 s10, 14336
    s_mov_b32 s11, 0x20000
    v_lshlrev_b32 v1, 4, v39
    s_mov_b32 m0, s32
    s_nop 0
    buffer_load_dwordx4 v1, s[8:11], s32 offen offset:0 lds
    buffer_load_dwordx4 v1, s[8:11], s32 offen offset:1024 lds
    buffer_load_dwordx4 v1, s[8:11], s32 offen offset:2048 lds
    buffer_load_dwordx4 v1, s[8:11], s32 offen offset:3072 lds
    v_lshlrev_b32 v41, 4, v0
    v_mov_b32 v72, 0
    v_mov_b32 v73, 0
    v_mov_b32 v74, 0
    v_mov_b32 v75, 0
    v_add_u32 v44, 140800, v41
    ds_write_b128 v44, v[72:75]
    v_add_u32 v45, 150016, v41
    ds_write_b128 v45, v[72:75]
    v_cmp_gt_u32 vcc, 32, v0
    s_and_saveexec_b64 s[86:87], vcc
    s_cbranch_execz b2_skipz_0
    ds_write_b128 v44, v[72:75] offset:4096
    ds_write_b128 v45, v[72:75] offset:4096
b2_skipz_0:
    s_mov_b64 exec, s[86:87]
    s_movk_i32 s85, 0x70
    v_lshrrev_b32 v46, 3, v0
    v_mul_u32_u24 v46, 4416, v46
    v_and_b32 v47, 7, v0
    v_lshlrev_b32 v47, 4, v47
    v_add3_u32 v46, v46, v47, 0
    v_add_u32 v46, 65536, v46
    v_cmp_gt_u32 vcc, 128, v0
    v_cmp_gt_u32 s[86:87], s85, v47
    s_and_b64 vcc, vcc, s[86:87]
    s_and_saveexec_b64 s[86:87], vcc
    s_cbranch_execz b2_skipz2_0
    ds_write_b128 v46, v[72:75]
b2_skipz2_0:
    s_mov_b64 exec, s[86:87]
    v_lshrrev_b32 v46, 3, v0
    v_mul_u32_u24 v46, 144, v46
    v_add_u32 v46, v46, v47
    v_add_u32 v44, 136192, v46
    v_sub_u32 v92, 255, v0
    v_lshrrev_b32 v93, 6, v92
    v_mul_u32_u24 v93, 144, v93
    v_and_b32 v92, 63, v92
    v_lshlrev_b32 v92, 1, v92
    v_add_u32 v92, v92, v93
    v_add_u32 v92, 136192, v92
    s_waitcnt vmcnt(36)
    ds_write_b16 v92, v152 offset:4032
    ds_write_b16 v92, v153 offset:3456
    ds_write_b16 v92, v154 offset:2880
    ds_write_b16 v92, v155 offset:2304
    ds_write_b16 v92, v156 offset:1728
    ds_write_b16 v92, v157 offset:1152
    ds_write_b16 v92, v158 offset:576
    ds_write_b16 v92, v159 offset:0
    v_add_u32 v45, 145408, v46
    ds_write_b16_d16_hi v92, v152 offset:13248
    ds_write_b16_d16_hi v92, v153 offset:12672
    ds_write_b16_d16_hi v92, v154 offset:12096
    ds_write_b16_d16_hi v92, v155 offset:11520
    ds_write_b16_d16_hi v92, v156 offset:10944
    ds_write_b16_d16_hi v92, v157 offset:10368
    ds_write_b16_d16_hi v92, v158 offset:9792
    ds_write_b16_d16_hi v92, v159 offset:9216
    v_cmp_eq_u32 vcc, 255, v0
    s_nop 1
    v_cndmask_b32 v140, v140, 0, vcc
    v_cndmask_b32 v141, v141, 0, vcc
    v_cndmask_b32 v142, v142, 0, vcc
    v_cndmask_b32 v143, v143, 0, vcc
    v_add_u32 v44, 65664, v41
    v_alignbit_b32 v76, v137, v136, 16
    v_alignbit_b32 v77, v138, v137, 16
    v_alignbit_b32 v78, v139, v138, 16
    v_alignbit_b32 v79, v140, v139, 16
    ds_write_b128 v44, v[76:79] offset:0
    v_mov_b32 v80, v137
    v_mov_b32 v81, v138
    v_mov_b32 v82, v139
    v_mov_b32 v83, v140
    ds_write_b128 v44, v[80:83] offset:4416
    v_alignbit_b32 v76, v138, v137, 16
    v_alignbit_b32 v77, v139, v138, 16
    v_alignbit_b32 v78, v140, v139, 16
    v_alignbit_b32 v79, v141, v140, 16
    ds_write_b128 v44, v[76:79] offset:8832
    ds_write_b128 v44, v[138:141] offset:13248
    v_alignbit_b32 v76, v139, v138, 16
    v_alignbit_b32 v77, v140, v139, 16
    v_alignbit_b32 v78, v141, v140, 16
    v_alignbit_b32 v79, v142, v141, 16
    ds_write_b128 v44, v[76:79] offset:17664
    v_mov_b32 v80, v139
    v_mov_b32 v81, v140
    v_mov_b32 v82, v141
    v_mov_b32 v83, v142
    ds_write_b128 v44, v[80:83] offset:22080
    v_alignbit_b32 v76, v140, v139, 16
    v_alignbit_b32 v77, v141, v140, 16
    v_alignbit_b32 v78, v142, v141, 16
    v_alignbit_b32 v79, v143, v142, 16
    ds_write_b128 v44, v[76:79] offset:26496
    ds_write_b128 v44, v[140:143] offset:30912
    v_add_u32 v44, 100992, v41
    v_alignbit_b32 v76, v145, v144, 16
    v_alignbit_b32 v77, v146, v145, 16
    v_alignbit_b32 v78, v147, v146, 16
    v_alignbit_b32 v79, v148, v147, 16
    ds_write_b128 v44, v[76:79] offset:0
    v_mov_b32 v80, v145
    v_mov_b32 v81, v146
    v_mov_b32 v82, v147
    v_mov_b32 v83, v148
    ds_write_b128 v44, v[80:83] offset:4416
    v_alignbit_b32 v76, v146, v145, 16
    v_alignbit_b32 v77, v147, v146, 16
    v_alignbit_b32 v78, v148, v147, 16
    v_alignbit_b32 v79, v149, v148, 16
    ds_write_b128 v44, v[76:79] offset:8832
    ds_write_b128 v44, v[146:149] offset:13248
    v_alignbit_b32 v76, v147, v146, 16
    v_alignbit_b32 v77, v148, v147, 16
    v_alignbit_b32 v78, v149, v148, 16
    v_alignbit_b32 v79, v150, v149, 16
    ds_write_b128 v44, v[76:79] offset:17664
    v_mov_b32 v80, v147
    v_mov_b32 v81, v148
    v_mov_b32 v82, v149
    v_mov_b32 v83, v150
    ds_write_b128 v44, v[80:83] offset:22080
    v_alignbit_b32 v76, v148, v147, 16
    v_alignbit_b32 v77, v149, v148, 16
    v_alignbit_b32 v78, v150, v149, 16
    v_alignbit_b32 v79, v151, v150, 16
    ds_write_b128 v44, v[76:79] offset:26496
    ds_write_b128 v44, v[148:151] offset:30912
    s_mov_b64 exec, 1
    s_cmp_eq_u32 s88, 0
    s_cbranch_scc0 b2_skip7_0
    v_mov_b32 v84, 0
    v_mov_b32 v85, 0
    v_mov_b32 v86, 0
    v_mov_b32 v87, 0
    v_mov_b32 v88, v136
    v_mov_b32 v89, v137
    v_mov_b32 v90, v138
    v_mov_b32 v91, v139
    v_mov_b32 v44, 65648
    v_alignbit_b32 v76, v85, v84, 16
    v_alignbit_b32 v77, v86, v85, 16
    v_alignbit_b32 v78, v87, v86, 16
    v_alignbit_b32 v79, v88, v87, 16
    ds_write_b128 v44, v[76:79] offset:0
    v_mov_b32 v80, v85
    v_mov_b32 v81, v86
    v_mov_b32 v82, v87
    v_mov_b32 v83, v88
    ds_write_b128 v44, v[80:83] offset:4416
    v_alignbit_b32 v76, v86, v85, 16
    v_alignbit_b32 v77, v87, v86, 16
    v_alignbit_b32 v78, v88, v87, 16
    v_alignbit_b32 v79, v89, v88, 16
    ds_write_b128 v44, v[76:79] offset:8832
    v_mov_b32 v80, v86
    v_mov_b32 v81, v87
    v_mov_b32 v82, v88
    v_mov_b32 v83, v89
    ds_write_b128 v44, v[80:83] offset:13248
    v_alignbit_b32 v76, v87, v86, 16
    v_alignbit_b32 v77, v88, v87, 16
    v_alignbit_b32 v78, v89, v88, 16
    v_alignbit_b32 v79, v90, v89, 16
    ds_write_b128 v44, v[76:79] offset:17664
    v_mov_b32 v80, v87
    v_mov_b32 v81, v88
    v_mov_b32 v82, v89
    v_mov_b32 v83, v90
    ds_write_b128 v44, v[80:83] offset:22080
    v_alignbit_b32 v76, v88, v87, 16
    v_alignbit_b32 v77, v89, v88, 16
    v_alignbit_b32 v78, v90, v89, 16
    v_alignbit_b32 v79, v91, v90, 16
    ds_write_b128 v44, v[76:79] offset:26496
    v_mov_b32 v80, v88
    v_mov_b32 v81, v89
    v_mov_b32 v82, v90
    v_mov_b32 v83, v91
    ds_write_b128 v44, v[80:83] offset:30912
    v_mov_b32 v84, 0
    v_mov_b32 v85, 0
    v_mov_b32 v86, 0
    v_mov_b32 v87, 0
    v_mov_b32 v88, v144
    v_mov_b32 v89, v145
    v_mov_b32 v90, v146
    v_mov_b32 v91, v147
    v_mov_b32 v44, 100976
    v_alignbit_b32 v76, v85, v84, 16
    v_alignbit_b32 v77, v86, v85, 16
    v_alignbit_b32 v78, v87, v86, 16
    v_alignbit_b32 v79, v88, v87, 16
    ds_write_b128 v44, v[76:79] offset:0
    v_mov_b32 v80, v85
    v_mov_b32 v81, v86
    v_mov_b32 v82, v87
    v_mov_b32 v83, v88
    ds_write_b128 v44, v[80:83] offset:4416
    v_alignbit_b32 v76, v86, v85, 16
    v_alignbit_b32 v77, v87, v86, 16
    v_alignbit_b32 v78, v88, v87, 16
    v_alignbit_b32 v79, v89, v88, 16
    ds_write_b128 v44, v[76:79] offset:8832
    v_mov_b32 v80, v86
    v_mov_b32 v81, v87
    v_mov_b32 v82, v88
    v_mov_b32 v83, v89
    ds_write_b128 v44, v[80:83] offset:13248
    v_alignbit_b32 v76, v87, v86, 16
    v_alignbit_b32 v77, v88, v87, 16
    v_alignbit_b32 v78, v89, v88, 16
    v_alignbit_b32 v79, v90, v89, 16
    ds_write_b128 v44, v[76:79] offset:17664
    v_mov_b32 v80, v87
    v_mov_b32 v81, v88
    v_mov_b32 v82, v89
    v_mov_b32 v83, v90
    ds_write_b128 v44, v[80:83] offset:22080
    v_alignbit_b32 v76, v88, v87, 16
    v_alignbit_b32 v77, v89, v88, 16
    v_alignbit_b32 v78, v90, v89, 16
    v_alignbit_b32 v79, v91, v90, 16
    ds_write_b128 v44, v[76:79] offset:26496
    v_mov_b32 v80, v88
    v_mov_b32 v81, v89
    v_mov_b32 v82, v90
    v_mov_b32 v83, v91
    ds_write_b128 v44, v[80:83] offset:30912
b2_skip7_0:
    s_mov_b64 exec, -1
    v_and_b32 v40, 63, v0
    v_and_b32 v41, 7, v0
    v_mul_u32_u24 v41, 4416, v41
    v_bfe_u32 v42, v0, 3, 2
    v_bfe_u32 v43, v0, 5, 1
    v_add_u32 v42, v42, v43
    v_lshlrev_b32 v42, 4, v42
    s_lshr_b32 s84, s88, 1
    s_and_b32 s85, s88, 1
    s_mul_i32 s86, s84, 35328
    s_lshl_b32 s87, s85, 11
    s_add_u32 s86, s86, s87
    s_add_u32 s86, s86, 65536
    v_add3_u32 v44, v41, v42, s86
    v_and_b32 v41, 31, v0
    v_sub_u32 v41, 31, v41
    v_mul_u32_u24 v41, 144, v41
    v_lshlrev_b32 v43, 4, v43
    s_mul_i32 s86, s84, 9216
    s_mul_i32 s87, s85, 2304
    s_add_u32 s86, s86, s87
    s_add_u32 s86, s86, 136192
    v_add3_u32 v45, v41, v43, s86
    s_branch k2_entry
k1_c0slow_0:
    s_mov_b32 s56, 0
k1_c0p_0_loop:
    buffer_load_dword v125, v126, s[60:63], 0 offen sc1
    s_waitcnt vmcnt(0)
    v_cmp_ne_u32 s[58:59], s55, v125
    s_add_u32 s56, s56, 1
    s_cmp_eq_u64 s[58:59], 0
    s_cbranch_scc1 k1_c0p_0_done
    s_sleep 6
    s_cmp_lt_u32 s56, 400000
    s_cbranch_scc1 k1_c0p_0_loop
k1_c0p_0_done:
    s_branch k1_c0ret_0
k1_vkind:
    s_waitcnt lgkmcnt(9)
    v_mfma_f32_32x32x16_bf16 a[0:15], v[40:43], v[56:59], 0
    ds_read_b128 v[72:75], v18 offset:0
    s_waitcnt lgkmcnt(9)
    v_mfma_f32_32x32x16_bf16 a[16:31], v[44:47], v[56:59], 0
    ds_read_b64_tr_b16 v[88:89], v25 offset:8192
    buffer_load_dwordx4 v7, s[12:15], s33 offen offset:2048 lds
    s_waitcnt lgkmcnt(9)
    v_mfma_f32_32x32x16_bf16 a[32:47], v[48:51], v[56:59], 0
    ds_read_b64_tr_b16 v[90:91], v25 offset:10240
    s_waitcnt lgkmcnt(9)
    v_mfma_f32_32x32x16_bf16 a[48:63], v[52:55], v[56:59], 0
    ds_read_b128 v[76:79], v18 offset:4096
    buffer_load_dwordx4 v8, s[12:15], s33 offen offset:3072 lds
    s_waitcnt lgkmcnt(8)
    v_mfma_f32_32x32x16_bf16 a[64:79], v[40:43], v[60:63], 0
    ds_read_b128 v[80:83], v18 offset:8192
    v_mfma_f32_32x32x16_bf16 a[80:95], v[44:47], v[60:63], 0
    ds_read_b128 v[84:87], v18 offset:12288
    v_mfma_f32_32x32x16_bf16 a[96:111], v[48:51], v[60:63], 0
    ds_read_b64_tr_b16 v[92:93], v26 offset:8192
    s_add_u32 m0, s32, 131072
    s_mov_b32 s33, 256
    buffer_load_dwordx4 v1, s[8:11], s33 offen lds
    v_mfma_f32_32x32x16_bf16 a[112:127], v[52:55], v[60:63], 0
    ds_read_b64_tr_b16 v[94:95], v26 offset:10240
    s_waitcnt lgkmcnt(10)
    v_mfma_f32_32x32x16_bf16 a[128:143], v[40:43], v[64:67], 0
    ds_read_b64_tr_b16 v[96:97], v27 offset:8192
    v_mfma_f32_32x32x16_bf16 a[144:159], v[44:47], v[64:67], 0
    ds_read_b64_tr_b16 v[98:99], v27 offset:10240
    buffer_load_dwordx4 v2, s[8:11], s33 offen offset:1024 lds
    v_mfma_f32_32x32x16_bf16 a[160:175], v[48:51], v[64:67], 0
    ds_read_b64_tr_b16 v[100:101], v28 offset:8192
    v_mfma_f32_32x32x16_bf16 a[176:191], v[52:55], v[64:67], 0
    ds_read_b64_tr_b16 v[102:103], v28 offset:10240
    buffer_load_dwordx4 v3, s[8:11], s33 offen offset:2048 lds
    s_waitcnt lgkmcnt(12)
    v_mfma_f32_32x32x16_bf16 a[192:207], v[40:43], v[68:71], 0
    v_mfma_f32_32x32x16_bf16 a[208:223], v[44:47], v[68:71], 0
    v_mfma_f32_32x32x16_bf16 a[224:239], v[48:51], v[68:71], 0
    buffer_load_dwordx4 v4, s[8:11], s33 offen offset:3072 lds
    v_mfma_f32_32x32x16_bf16 a[240:255], v[52:55], v[68:71], 0
    s_waitcnt vmcnt(24) lgkmcnt(0)
    s_barrier
    v_mfma_f32_32x32x16_bf16 a[0:15], v[72:75], v[88:91], a[0:15]
    ds_read_b128 v[40:43], v19 offset:0
    v_mul_f32 v254, s35, v254
    v_mul_f32 v255, s35, v255
    v_mfma_f32_32x32x16_bf16 a[16:31], v[76:79], v[88:91], a[16:31]
    ds_read_b64_tr_b16 v[56:57], v25 offset:16384
    v_cvt_pk_bf16_f32 v255, v254, v255
    v_mul_f32 v252, s35, v252
    v_mfma_f32_32x32x16_bf16 a[32:47], v[80:83], v[88:91], a[32:47]
    ds_read_b64_tr_b16 v[58:59], v25 offset:18432
    s_add_u32 m0, s32, 147456
    s_mov_b32 s33, 262400
    buffer_load_dwordx4 v1, s[8:11], s33 offen lds
    v_mul_f32 v253, s35, v253
    v_cvt_pk_bf16_f32 v254, v252, v253
    v_mfma_f32_32x32x16_bf16 a[48:63], v[84:87], v[88:91], a[48:63]
    ds_read_b128 v[44:47], v19 offset:4096
    v_mul_f32 v250, s35, v250
    v_mul_f32 v251, s35, v251
    v_mfma_f32_32x32x16_bf16 a[64:79], v[72:75], v[92:95], a[64:79]
    ds_read_b128 v[48:51], v19 offset:8192
    v_cvt_pk_bf16_f32 v253, v250, v251
    v_mul_f32 v248, s35, v248
    v_mfma_f32_32x32x16_bf16 a[80:95], v[76:79], v[92:95], a[80:95]
    ds_read_b128 v[52:55], v19 offset:12288
    v_mul_f32 v249, s35, v249
    v_cvt_pk_bf16_f32 v252, v248, v249
    v_mfma_f32_32x32x16_bf16 a[96:111], v[80:83], v[92:95], a[96:111]
    ds_read_b64_tr_b16 v[60:61], v26 offset:16384
    buffer_load_dwordx4 v2, s[8:11], s33 offen offset:1024 lds
    v_mul_f32 v246, s35, v246
    v_mul_f32 v247, s35, v247
    v_mfma_f32_32x32x16_bf16 a[112:127], v[84:87], v[92:95], a[112:127]
    ds_read_b64_tr_b16 v[62:63], v26 offset:18432
    v_cvt_pk_bf16_f32 v251, v246, v247
    v_mul_f32 v244, s35, v244
    v_mfma_f32_32x32x16_bf16 a[128:143], v[72:75], v[96:99], a[128:143]
    ds_read_b64_tr_b16 v[64:65], v27 offset:16384
    v_mul_f32 v245, s35, v245
    v_cvt_pk_bf16_f32 v250, v244, v245
    v_mfma_f32_32x32x16_bf16 a[144:159], v[76:79], v[96:99], a[144:159]
    ds_read_b64_tr_b16 v[66:67], v27 offset:18432
    v_mul_f32 v242, s35, v242
    v_mul_f32 v243, s35, v243
    v_mfma_f32_32x32x16_bf16 a[160:175], v[80:83], v[96:99], a[160:175]
    ds_read_b64_tr_b16 v[68:69], v28 offset:16384
    buffer_load_dwordx4 v3, s[8:11], s33 offen offset:2048 lds
    v_cvt_pk_bf16_f32 v249, v242, v243
    v_mul_f32 v240, s35, v240
    v_mfma_f32_32x32x16_bf16 a[176:191], v[84:87], v[96:99], a[176:191]
    ds_read_b64_tr_b16 v[70:71], v28 offset:18432
    v_mul_f32 v241, s35, v241
    v_cvt_pk_bf16_f32 v248, v240, v241
    v_mfma_f32_32x32x16_bf16 a[192:207], v[72:75], v[100:103], a[192:207]
    v_mul_f32 v238, s35, v238
    v_mul_f32 v239, s35, v239
    v_mfma_f32_32x32x16_bf16 a[208:223], v[76:79], v[100:103], a[208:223]
    v_cvt_pk_bf16_f32 v247, v238, v239
    v_mul_f32 v236, s35, v236
    v_mfma_f32_32x32x16_bf16 a[224:239], v[80:83], v[100:103], a[224:239]
    buffer_load_dwordx4 v4, s[8:11], s33 offen offset:3072 lds
    v_mul_f32 v237, s35, v237
    v_cvt_pk_bf16_f32 v246, v236, v237
    v_mfma_f32_32x32x16_bf16 a[240:255], v[84:87], v[100:103], a[240:255]
    v_mul_f32 v234, s35, v234
    v_mul_f32 v235, s35, v235
    s_waitcnt lgkmcnt(9)
    v_mfma_f32_32x32x16_bf16 a[0:15], v[40:43], v[56:59], a[0:15]
    ds_read_b128 v[72:75], v20 offset:0
    v_cvt_pk_bf16_f32 v245, v234, v235
    v_mul_f32 v232, s35, v232
    s_waitcnt lgkmcnt(9)
    v_mfma_f32_32x32x16_bf16 a[16:31], v[44:47], v[56:59], a[16:31]
    ds_read_b64_tr_b16 v[88:89], v25 offset:24576
    v_mul_f32 v233, s35, v233
    v_cvt_pk_bf16_f32 v244, v232, v233
    s_waitcnt lgkmcnt(9)
    v_mfma_f32_32x32x16_bf16 a[32:47], v[48:51], v[56:59], a[32:47]
    ds_read_b64_tr_b16 v[90:91], v25 offset:26624
    s_add_u32 m0, s32, 0
    s_mov_b32 s33, 1048576
    buffer_load_dwordx4 v5, s[12:15], s33 offen lds
    v_mul_f32 v230, s35, v230
    v_mul_f32 v231, s35, v231
    s_waitcnt lgkmcnt(9)
    v_mfma_f32_32x32x16_bf16 a[48:63], v[52:55], v[56:59], a[48:63]
    ds_read_b128 v[76:79], v20 offset:4096
    v_cvt_pk_bf16_f32 v243, v230, v231
    v_mul_f32 v228, s35, v228
    s_waitcnt lgkmcnt(8)
    v_mfma_f32_32x32x16_bf16 a[64:79], v[40:43], v[60:63], a[64:79]
    ds_read_b128 v[80:83], v20 offset:8192
    v_mul_f32 v229, s35, v229
    v_cvt_pk_bf16_f32 v242, v228, v229
    v_mfma_f32_32x32x16_bf16 a[80:95], v[44:47], v[60:63], a[80:95]
    ds_read_b128 v[84:87], v20 offset:12288
    v_mul_f32 v226, s35, v226
    v_mul_f32 v227, s35, v227
    v_mfma_f32_32x32x16_bf16 a[96:111], v[48:51], v[60:63], a[96:111]
    ds_read_b64_tr_b16 v[92:93], v26 offset:24576
    buffer_load_dwordx4 v6, s[12:15], s33 offen offset:1024 lds
    v_cvt_pk_bf16_f32 v241, v226, v227
    v_mul_f32 v224, s35, v224
    v_mfma_f32_32x32x16_bf16 a[112:127], v[52:55], v[60:63], a[112:127]
    ds_read_b64_tr_b16 v[94:95], v26 offset:26624
    v_mul_f32 v225, s35, v225
    v_cvt_pk_bf16_f32 v240, v224, v225
    s_waitcnt lgkmcnt(10)
    v_mfma_f32_32x32x16_bf16 a[128:143], v[40:43], v[64:67], a[128:143]
    ds_read_b64_tr_b16 v[96:97], v27 offset:24576
    v_mul_f32 v222, s35, v222
    v_mul_f32 v223, s35, v223
    v_mfma_f32_32x32x16_bf16 a[144:159], v[44:47], v[64:67], a[144:159]
    ds_read_b64_tr_b16 v[98:99], v27 offset:26624
    v_cvt_pk_bf16_f32 v239, v222, v223
    v_mul_f32 v220, s35, v220
    v_mfma_f32_32x32x16_bf16 a[160:175], v[48:51], v[64:67], a[160:175]
    ds_read_b64_tr_b16 v[100:101], v28 offset:24576
    buffer_load_dwordx4 v7, s[12:15], s33 offen offset:2048 lds
    v_mul_f32 v221, s35, v221
    v_cvt_pk_bf16_f32 v238, v220, v221
    v_mfma_f32_32x32x16_bf16 a[176:191], v[52:55], v[64:67], a[176:191]
    ds_read_b64_tr_b16 v[102:103], v28 offset:26624
    v_mul_f32 v218, s35, v218
    v_mul_f32 v219, s35, v219
    s_waitcnt lgkmcnt(12)
    v_mfma_f32_32x32x16_bf16 a[192:207], v[40:43], v[68:71], a[192:207]
    v_cvt_pk_bf16_f32 v237, v218, v219
    v_mul_f32 v216, s35, v216
    v_mfma_f32_32x32x16_bf16 a[208:223], v[44:47], v[68:71], a[208:223]
    v_mul_f32 v217, s35, v217
    v_cvt_pk_bf16_f32 v236, v216, v217
    v_mfma_f32_32x32x16_bf16 a[224:239], v[48:51], v[68:71], a[224:239]
    buffer_load_dwordx4 v8, s[12:15], s33 offen offset:3072 lds
    v_mul_f32 v214, s35, v214
    v_mul_f32 v215, s35, v215
    v_mfma_f32_32x32x16_bf16 a[240:255], v[52:55], v[68:71], a[240:255]
    v_cvt_pk_bf16_f32 v235, v214, v215
    v_mul_f32 v212, s35, v212
    s_waitcnt vmcnt(16) lgkmcnt(0)
    s_barrier
    v_mfma_f32_32x32x16_bf16 a[0:15], v[72:75], v[88:91], a[0:15]
    ds_read_b128 v[40:43], v17 offset:32768
    v_mul_f32 v213, s35, v213
    v_cvt_pk_bf16_f32 v234, v212, v213
    v_mfma_f32_32x32x16_bf16 a[16:31], v[76:79], v[88:91], a[16:31]
    ds_read_b64_tr_b16 v[56:57], v25 offset:32768
    s_add_u32 m0, s32, 16384
    s_mov_b32 s33, 1310720
    buffer_load_dwordx4 v5, s[12:15], s33 offen lds
    v_mul_f32 v210, s35, v210
    v_mul_f32 v211, s35, v211
    v_mfma_f32_32x32x16_bf16 a[32:47], v[80:83], v[88:91], a[32:47]
    ds_read_b64_tr_b16 v[58:59], v25 offset:34816
    v_cvt_pk_bf16_f32 v233, v210, v211
    v_mul_f32 v208, s35, v208
    v_mfma_f32_32x32x16_bf16 a[48:63], v[84:87], v[88:91], a[48:63]
    ds_read_b128 v[44:47], v17 offset:36864
    buffer_load_dwordx4 v6, s[12:15], s33 offen offset:1024 lds
    v_mul_f32 v209, s35, v209
    v_cvt_pk_bf16_f32 v232, v208, v209
    v_mfma_f32_32x32x16_bf16 a[64:79], v[72:75], v[92:95], a[64:79]
    ds_read_b128 v[48:51], v17 offset:40960
    v_mul_f32 v206, s35, v206
    v_mul_f32 v207, s35, v207
    v_mfma_f32_32x32x16_bf16 a[80:95], v[76:79], v[92:95], a[80:95]
    ds_read_b128 v[52:55], v17 offset:45056
    v_cvt_pk_bf16_f32 v231, v206, v207
    v_mul_f32 v204, s35, v204
    v_mfma_f32_32x32x16_bf16 a[96:111], v[80:83], v[92:95], a[96:111]
    ds_read_b64_tr_b16 v[60:61], v26 offset:32768
    buffer_load_dwordx4 v7, s[12:15], s33 offen offset:2048 lds
    v_mul_f32 v205, s35, v205
    v_cvt_pk_bf16_f32 v230, v204, v205
    v_mfma_f32_32x32x16_bf16 a[112:127], v[84:87], v[92:95], a[112:127]
    ds_read_b64_tr_b16 v[62:63], v26 offset:34816
    v_mul_f32 v202, s35, v202
    v_mul_f32 v203, s35, v203
    v_mfma_f32_32x32x16_bf16 a[128:143], v[72:75], v[96:99], a[128:143]
    ds_read_b64_tr_b16 v[64:65], v27 offset:32768
    v_cvt_pk_bf16_f32 v229, v202, v203
    v_mul_f32 v200, s35, v200
    v_mfma_f32_32x32x16_bf16 a[144:159], v[76:79], v[96:99], a[144:159]
    ds_read_b64_tr_b16 v[66:67], v27 offset:34816
    buffer_load_dwordx4 v8, s[12:15], s33 offen offset:3072 lds
    v_mul_f32 v201, s35, v201
    v_cvt_pk_bf16_f32 v228, v200, v201
    v_mfma_f32_32x32x16_bf16 a[160:175], v[80:83], v[96:99], a[160:175]
    ds_read_b64_tr_b16 v[68:69], v28 offset:32768
    v_mul_f32 v198, s35, v198
    v_mul_f32 v199, s35, v199
    v_mfma_f32_32x32x16_bf16 a[176:191], v[84:87], v[96:99], a[176:191]
    ds_read_b64_tr_b16 v[70:71], v28 offset:34816
    s_add_u32 m0, s32, 65536
    s_mov_b32 s33, 384
    buffer_load_dwordx4 v1, s[8:11], s33 offen lds
    v_cvt_pk_bf16_f32 v227, v198, v199
    v_mul_f32 v196, s35, v196
    v_mfma_f32_32x32x16_bf16 a[192:207], v[72:75], v[100:103], a[192:207]
    v_mul_f32 v197, s35, v197
    v_cvt_pk_bf16_f32 v226, v196, v197
    v_mfma_f32_32x32x16_bf16 a[208:223], v[76:79], v[100:103], a[208:223]
    v_mul_f32 v194, s35, v194
    v_mul_f32 v195, s35, v195
    v_mfma_f32_32x32x16_bf16 a[224:239], v[80:83], v[100:103], a[224:239]
    buffer_load_dwordx4 v2, s[8:11], s33 offen offset:1024 lds
    v_cvt_pk_bf16_f32 v225, v194, v195
    v_mul_f32 v192, s35, v192
    v_mfma_f32_32x32x16_bf16 a[240:255], v[84:87], v[100:103], a[240:255]
    v_mul_f32 v193, s35, v193
    v_cvt_pk_bf16_f32 v224, v192, v193
    s_waitcnt lgkmcnt(9)
    v_mfma_f32_32x32x16_bf16 a[0:15], v[40:43], v[56:59], a[0:15]
    ds_read_b128 v[72:75], v18 offset:32768
    v_mul_f32 v190, s35, v190
    v_mul_f32 v191, s35, v191
    s_waitcnt lgkmcnt(9)
    v_mfma_f32_32x32x16_bf16 a[16:31], v[44:47], v[56:59], a[16:31]
    ds_read_b64_tr_b16 v[88:89], v25 offset:40960
    buffer_load_dwordx4 v3, s[8:11], s33 offen offset:2048 lds
    v_cvt_pk_bf16_f32 v223, v190, v191
    v_mul_f32 v188, s35, v188
    s_waitcnt lgkmcnt(9)
    v_mfma_f32_32x32x16_bf16 a[32:47], v[48:51], v[56:59], a[32:47]
    ds_read_b64_tr_b16 v[90:91], v25 offset:43008
    v_mul_f32 v189, s35, v189
    v_cvt_pk_bf16_f32 v222, v188, v189
    s_waitcnt lgkmcnt(9)
    v_mfma_f32_32x32x16_bf16 a[48:63], v[52:55], v[56:59], a[48:63]
    ds_read_b128 v[76:79], v18 offset:36864
    buffer_load_dwordx4 v4, s[8:11], s33 offen offset:3072 lds
    v_mul_f32 v186, s35, v186
    v_mul_f32 v187, s35, v187
    s_waitcnt lgkmcnt(8)
    v_mfma_f32_32x32x16_bf16 a[64:79], v[40:43], v[60:63], a[64:79]
    ds_read_b128 v[80:83], v18 offset:40960
    v_cvt_pk_bf16_f32 v221, v186, v187
    v_mul_f32 v184, s35, v184
    v_mfma_f32_32x32x16_bf16 a[80:95], v[44:47], v[60:63], a[80:95]
    ds_read_b128 v[84:87], v18 offset:45056
    v_mul_f32 v185, s35, v185
    v_cvt_pk_bf16_f32 v220, v184, v185
    v_mfma_f32_32x32x16_bf16 a[96:111], v[48:51], v[60:63], a[96:111]
    ds_read_b64_tr_b16 v[92:93], v26 offset:40960
    s_add_u32 m0, s32, 81920
    s_mov_b32 s33, 262528
    buffer_load_dwordx4 v1, s[8:11], s33 offen lds
    v_mul_f32 v182, s35, v182
    v_mul_f32 v183, s35, v183
    v_mfma_f32_32x32x16_bf16 a[112:127], v[52:55], v[60:63], a[112:127]
    ds_read_b64_tr_b16 v[94:95], v26 offset:43008
    v_cvt_pk_bf16_f32 v219, v182, v183
    v_mul_f32 v180, s35, v180
    s_waitcnt lgkmcnt(10)
    v_mfma_f32_32x32x16_bf16 a[128:143], v[40:43], v[64:67], a[128:143]
    ds_read_b64_tr_b16 v[96:97], v27 offset:40960
    v_mul_f32 v181, s35, v181
    v_cvt_pk_bf16_f32 v218, v180, v181
    v_mfma_f32_32x32x16_bf16 a[144:159], v[44:47], v[64:67], a[144:159]
    ds_read_b64_tr_b16 v[98:99], v27 offset:43008
    buffer_load_dwordx4 v2, s[8:11], s33 offen offset:1024 lds
    v_mul_f32 v178, s35, v178
    v_mul_f32 v179, s35, v179
    v_mfma_f32_32x32x16_bf16 a[160:175], v[48:51], v[64:67], a[160:175]
    ds_read_b64_tr_b16 v[100:101], v28 offset:40960
    v_cvt_pk_bf16_f32 v217, v178, v179
    v_mul_f32 v176, s35, v176
    v_mfma_f32_32x32x16_bf16 a[176:191], v[52:55], v[64:67], a[176:191]
    ds_read_b64_tr_b16 v[102:103], v28 offset:43008
    buffer_load_dwordx4 v3, s[8:11], s33 offen offset:2048 lds
    v_mul_f32 v177, s35, v177
    v_cvt_pk_bf16_f32 v216, v176, v177
    s_waitcnt lgkmcnt(12)
    v_mfma_f32_32x32x16_bf16 a[192:207], v[40:43], v[68:71], a[192:207]
    v_mul_f32 v174, s35, v174
    v_mul_f32 v175, s35, v175
    v_mfma_f32_32x32x16_bf16 a[208:223], v[44:47], v[68:71], a[208:223]
    v_cvt_pk_bf16_f32 v215, v174, v175
    v_mul_f32 v172, s35, v172
    v_mfma_f32_32x32x16_bf16 a[224:239], v[48:51], v[68:71], a[224:239]
    buffer_load_dwordx4 v4, s[8:11], s33 offen offset:3072 lds
    v_mul_f32 v173, s35, v173
    v_cvt_pk_bf16_f32 v214, v172, v173
    v_mfma_f32_32x32x16_bf16 a[240:255], v[52:55], v[68:71], a[240:255]
    v_mul_f32 v170, s35, v170
    v_mul_f32 v171, s35, v171
    s_waitcnt vmcnt(24) lgkmcnt(0)
    s_barrier
    v_mfma_f32_32x32x16_bf16 a[0:15], v[72:75], v[88:91], a[0:15]
    ds_read_b128 v[40:43], v19 offset:32768
    v_cvt_pk_bf16_f32 v213, v170, v171
    v_mul_f32 v168, s35, v168
    v_mfma_f32_32x32x16_bf16 a[16:31], v[76:79], v[88:91], a[16:31]
    ds_read_b64_tr_b16 v[56:57], v25 offset:49152
    v_mul_f32 v169, s35, v169
    v_cvt_pk_bf16_f32 v212, v168, v169
    v_mfma_f32_32x32x16_bf16 a[32:47], v[80:83], v[88:91], a[32:47]
    ds_read_b64_tr_b16 v[58:59], v25 offset:51200
    v_mul_f32 v166, s35, v166
    v_mul_f32 v167, s35, v167
    v_mfma_f32_32x32x16_bf16 a[48:63], v[84:87], v[88:91], a[48:63]
    ds_read_b128 v[44:47], v19 offset:36864
    v_cvt_pk_bf16_f32 v211, v166, v167
    v_mul_f32 v164, s35, v164
    v_mfma_f32_32x32x16_bf16 a[64:79], v[72:75], v[92:95], a[64:79]
    ds_read_b128 v[48:51], v19 offset:40960
    s_add_u32 m0, s32, 32768
    s_mov_b32 s33, 1572864
    buffer_load_dwordx4 v5, s[12:15], s33 offen lds
    v_mul_f32 v165, s35, v165
    v_cvt_pk_bf16_f32 v210, v164, v165
    v_mfma_f32_32x32x16_bf16 a[80:95], v[76:79], v[92:95], a[80:95]
    ds_read_b128 v[52:55], v19 offset:45056
    v_mul_f32 v162, s35, v162
    v_mul_f32 v163, s35, v163
    v_mfma_f32_32x32x16_bf16 a[96:111], v[80:83], v[92:95], a[96:111]
    ds_read_b64_tr_b16 v[60:61], v26 offset:49152
    v_cvt_pk_bf16_f32 v209, v162, v163
    v_mul_f32 v160, s35, v160
    v_mfma_f32_32x32x16_bf16 a[112:127], v[84:87], v[92:95], a[112:127]
    ds_read_b64_tr_b16 v[62:63], v26 offset:51200
    v_mul_f32 v161, s35, v161
    v_cvt_pk_bf16_f32 v208, v160, v161
    v_mfma_f32_32x32x16_bf16 a[128:143], v[72:75], v[96:99], a[128:143]
    ds_read_b64_tr_b16 v[64:65], v27 offset:49152
    v_mul_f32 v158, s35, v158
    v_mul_f32 v159, s35, v159
    v_mfma_f32_32x32x16_bf16 a[144:159], v[76:79], v[96:99], a[144:159]
    ds_read_b64_tr_b16 v[66:67], v27 offset:51200
    v_cvt_pk_bf16_f32 v207, v158, v159
    v_mul_f32 v156, s35, v156
    v_mfma_f32_32x32x16_bf16 a[160:175], v[80:83], v[96:99], a[160:175]
    ds_read_b64_tr_b16 v[68:69], v28 offset:49152
    v_mul_f32 v157, s35, v157
    v_cvt_pk_bf16_f32 v206, v156, v157
    v_mfma_f32_32x32x16_bf16 a[176:191], v[84:87], v[96:99], a[176:191]
    ds_read_b64_tr_b16 v[70:71], v28 offset:51200
    v_mul_f32 v154, s35, v154
    v_mul_f32 v155, s35, v155
    v_mfma_f32_32x32x16_bf16 a[192:207], v[72:75], v[100:103], a[192:207]
    buffer_load_dwordx4 v6, s[12:15], s33 offen offset:1024 lds
    v_cvt_pk_bf16_f32 v205, v154, v155
    v_mul_f32 v152, s35, v152
    v_mfma_f32_32x32x16_bf16 a[208:223], v[76:79], v[100:103], a[208:223]
    v_mul_f32 v153, s35, v153
    v_cvt_pk_bf16_f32 v204, v152, v153
    v_mfma_f32_32x32x16_bf16 a[224:239], v[80:83], v[100:103], a[224:239]
    v_mul_f32 v150, s35, v150
    v_mul_f32 v151, s35, v151
    v_mfma_f32_32x32x16_bf16 a[240:255], v[84:87], v[100:103], a[240:255]
    v_cvt_pk_bf16_f32 v203, v150, v151
    v_mul_f32 v148, s35, v148
    s_waitcnt lgkmcnt(9)
    v_mfma_f32_32x32x16_bf16 a[0:15], v[40:43], v[56:59], a[0:15]
    ds_read_b128 v[72:75], v20 offset:32768
    v_mul_f32 v149, s35, v149
    v_cvt_pk_bf16_f32 v202, v148, v149
    s_waitcnt lgkmcnt(9)
    v_mfma_f32_32x32x16_bf16 a[16:31], v[44:47], v[56:59], a[16:31]
    ds_read_b64_tr_b16 v[88:89], v25 offset:57344
    v_mul_f32 v146, s35, v146
    v_mul_f32 v147, s35, v147
    s_waitcnt lgkmcnt(9)
    v_mfma_f32_32x32x16_bf16 a[32:47], v[48:51], v[56:59], a[32:47]
    ds_read_b64_tr_b16 v[90:91], v25 offset:59392
    v_cvt_pk_bf16_f32 v201, v146, v147
    v_mul_f32 v144, s35, v144
    s_waitcnt lgkmcnt(9)
    v_mfma_f32_32x32x16_bf16 a[48:63], v[52:55], v[56:59], a[48:63]
    ds_read_b128 v[76:79], v20 offset:36864
    v_mul_f32 v145, s35, v145
    v_cvt_pk_bf16_f32 v200, v144, v145
    s_waitcnt lgkmcnt(8)
    v_mfma_f32_32x32x16_bf16 a[64:79], v[40:43], v[60:63], a[64:79]
    ds_read_b128 v[80:83], v20 offset:40960
    buffer_load_dwordx4 v7, s[12:15], s33 offen offset:2048 lds
    v_mul_f32 v142, s35, v142
    v_mul_f32 v143, s35, v143
    v_mfma_f32_32x32x16_bf16 a[80:95], v[44:47], v[60:63], a[80:95]
    ds_read_b128 v[84:87], v20 offset:45056
    v_cvt_pk_bf16_f32 v199, v142, v143
    v_mul_f32 v140, s35, v140
    v_mfma_f32_32x32x16_bf16 a[96:111], v[48:51], v[60:63], a[96:111]
    ds_read_b64_tr_b16 v[92:93], v26 offset:57344
    v_mul_f32 v141, s35, v141
    v_cvt_pk_bf16_f32 v198, v140, v141
    v_mfma_f32_32x32x16_bf16 a[112:127], v[52:55], v[60:63], a[112:127]
    ds_read_b64_tr_b16 v[94:95], v26 offset:59392
    v_mul_f32 v138, s35, v138
    v_mul_f32 v139, s35, v139
    s_waitcnt lgkmcnt(10)
    v_mfma_f32_32x32x16_bf16 a[128:143], v[40:43], v[64:67], a[128:143]
    ds_read_b64_tr_b16 v[96:97], v27 offset:57344
    v_cvt_pk_bf16_f32 v197, v138, v139
    v_mul_f32 v136, s35, v136
    v_mfma_f32_32x32x16_bf16 a[144:159], v[44:47], v[64:67], a[144:159]
    ds_read_b64_tr_b16 v[98:99], v27 offset:59392
    v_mul_f32 v137, s35, v137
    v_cvt_pk_bf16_f32 v196, v136, v137
    v_mfma_f32_32x32x16_bf16 a[160:175], v[48:51], v[64:67], a[160:175]
    ds_read_b64_tr_b16 v[100:101], v28 offset:57344
    v_mul_f32 v134, s35, v134
    v_mul_f32 v135, s35, v135
    v_mfma_f32_32x32x16_bf16 a[176:191], v[52:55], v[64:67], a[176:191]
    ds_read_b64_tr_b16 v[102:103], v28 offset:59392
    v_cvt_pk_bf16_f32 v195, v134, v135
    v_mul_f32 v132, s35, v132
    s_waitcnt lgkmcnt(12)
    v_mfma_f32_32x32x16_bf16 a[192:207], v[40:43], v[68:71], a[192:207]
    buffer_load_dwordx4 v8, s[12:15], s33 offen offset:3072 lds
    v_mul_f32 v133, s35, v133
    v_cvt_pk_bf16_f32 v194, v132, v133
    v_mfma_f32_32x32x16_bf16 a[208:223], v[44:47], v[68:71], a[208:223]
    v_mul_f32 v130, s35, v130
    v_mul_f32 v131, s35, v131
    v_mfma_f32_32x32x16_bf16 a[224:239], v[48:51], v[68:71], a[224:239]
    v_cvt_pk_bf16_f32 v193, v130, v131
    v_mul_f32 v128, s35, v128
    v_mfma_f32_32x32x16_bf16 a[240:255], v[52:55], v[68:71], a[240:255]
    v_mul_f32 v129, s35, v129
    v_cvt_pk_bf16_f32 v192, v128, v129
    s_waitcnt vmcnt(16) lgkmcnt(0)
    s_barrier
    v_mfma_f32_32x32x16_bf16 a[0:15], v[72:75], v[88:91], a[0:15]
    ds_read_b128 v[40:43], v21 offset:0
    v_mfma_f32_32x32x16_bf16 a[16:31], v[76:79], v[88:91], a[16:31]
    ds_read_b64_tr_b16 v[56:57], v25 offset:0
    s_add_u32 m0, s32, 49152
    s_mov_b32 s33, 1835008
    buffer_load_dwordx4 v5, s[12:15], s33 offen lds
    v_mfma_f32_32x32x16_bf16 a[32:47], v[80:83], v[88:91], a[32:47]
    ds_read_b64_tr_b16 v[58:59], v25 offset:2048
    v_mfma_f32_32x32x16_bf16 a[48:63], v[84:87], v[88:91], a[48:63]
    ds_read_b128 v[44:47], v21 offset:4096
    buffer_load_dwordx4 v6, s[12:15], s33 offen offset:1024 lds
    v_mfma_f32_32x32x16_bf16 a[64:79], v[72:75], v[92:95], a[64:79]
    ds_read_b128 v[48:51], v21 offset:8192
    v_mfma_f32_32x32x16_bf16 a[80:95], v[76:79], v[92:95], a[80:95]
    ds_read_b128 v[52:55], v21 offset:12288
    v_mfma_f32_32x32x16_bf16 a[96:111], v[80:83], v[92:95], a[96:111]
    ds_read_b64_tr_b16 v[60:61], v26 offset:0
    buffer_load_dwordx4 v7, s[12:15], s33 offen offset:2048 lds
    v_mfma_f32_32x32x16_bf16 a[112:127], v[84:87], v[92:95], a[112:127]
    ds_read_b64_tr_b16 v[62:63], v26 offset:2048
    v_mfma_f32_32x32x16_bf16 a[128:143], v[72:75], v[96:99], a[128:143]
    ds_read_b64_tr_b16 v[64:65], v27 offset:0
    v_mfma_f32_32x32x16_bf16 a[144:159], v[76:79], v[96:99], a[144:159]
    ds_read_b64_tr_b16 v[66:67], v27 offset:2048
    buffer_load_dwordx4 v8, s[12:15], s33 offen offset:3072 lds
    v_mfma_f32_32x32x16_bf16 a[160:175], v[80:83], v[96:99], a[160:175]
    ds_read_b64_tr_b16 v[68:69], v28 offset:0
    v_mfma_f32_32x32x16_bf16 a[176:191], v[84:87], v[96:99], a[176:191]
    ds_read_b64_tr_b16 v[70:71], v28 offset:2048
    s_add_u32 m0, s32, 98304
    s_mov_b32 s33, 512
    buffer_load_dwordx4 v1, s[8:11], s33 offen lds
    v_mfma_f32_32x32x16_bf16 a[192:207], v[72:75], v[100:103], a[192:207]
    v_mfma_f32_32x32x16_bf16 a[208:223], v[76:79], v[100:103], a[208:223]
    v_mfma_f32_32x32x16_bf16 a[224:239], v[80:83], v[100:103], a[224:239]
    buffer_load_dwordx4 v2, s[8:11], s33 offen offset:1024 lds
    v_mfma_f32_32x32x16_bf16 a[240:255], v[84:87], v[100:103], a[240:255]
    s_waitcnt lgkmcnt(9)
    v_mfma_f32_32x32x16_bf16 a[0:15], v[40:43], v[56:59], a[0:15]
    ds_read_b128 v[72:75], v22 offset:0
    s_waitcnt lgkmcnt(9)
    v_mfma_f32_32x32x16_bf16 a[16:31], v[44:47], v[56:59], a[16:31]
    ds_read_b64_tr_b16 v[88:89], v25 offset:8192
    buffer_load_dwordx4 v3, s[8:11], s33 offen offset:2048 lds
    s_waitcnt lgkmcnt(9)
    v_mfma_f32_32x32x16_bf16 a[32:47], v[48:51], v[56:59], a[32:47]
    ds_read_b64_tr_b16 v[90:91], v25 offset:10240
    s_waitcnt lgkmcnt(9)
    v_mfma_f32_32x32x16_bf16 a[48:63], v[52:55], v[56:59], a[48:63]
    ds_read_b128 v[76:79], v22 offset:4096
    buffer_load_dwordx4 v4, s[8:11], s33 offen offset:3072 lds
    s_waitcnt lgkmcnt(8)
    v_mfma_f32_32x32x16_bf16 a[64:79], v[40:43], v[60:63], a[64:79]
    ds_read_b128 v[80:83], v22 offset:8192
    v_mfma_f32_32x32x16_bf16 a[80:95], v[44:47], v[60:63], a[80:95]
    ds_read_b128 v[84:87], v22 offset:12288
    v_mfma_f32_32x32x16_bf16 a[96:111], v[48:51], v[60:63], a[96:111]
    ds_read_b64_tr_b16 v[92:93], v26 offset:8192
    s_add_u32 m0, s32, 114688
    s_mov_b32 s33, 262656
    buffer_load_dwordx4 v1, s[8:11], s33 offen lds
    v_mfma_f32_32x32x16_bf16 a[112:127], v[52:55], v[60:63], a[112:127]
    ds_read_b64_tr_b16 v[94:95], v26 offset:10240
    s_waitcnt lgkmcnt(10)
    v_mfma_f32_32x32x16_bf16 a[128:143], v[40:43], v[64:67], a[128:143]
    ds_read_b64_tr_b16 v[96:97], v27 offset:8192
    v_mfma_f32_32x32x16_bf16 a[144:159], v[44:47], v[64:67], a[144:159]
    ds_read_b64_tr_b16 v[98:99], v27 offset:10240
    buffer_load_dwordx4 v2, s[8:11], s33 offen offset:1024 lds
    v_mfma_f32_32x32x16_bf16 a[160:175], v[48:51], v[64:67], a[160:175]
    ds_read_b64_tr_b16 v[100:101], v28 offset:8192
    v_mfma_f32_32x32x16_bf16 a[176:191], v[52:55], v[64:67], a[176:191]
    ds_read_b64_tr_b16 v[102:103], v28 offset:10240
    buffer_load_dwordx4 v3, s[8:11], s33 offen offset:2048 lds
    s_waitcnt lgkmcnt(12)
    v_mfma_f32_32x32x16_bf16 a[192:207], v[40:43], v[68:71], a[192:207]
    v_mfma_f32_32x32x16_bf16 a[208:223], v[44:47], v[68:71], a[208:223]
    v_mfma_f32_32x32x16_bf16 a[224:239], v[48:51], v[68:71], a[224:239]
    buffer_load_dwordx4 v4, s[8:11], s33 offen offset:3072 lds
    s_mov_b32 s34, 0
    buffer_store_dwordx4 v[192:195], v38, s[28:31], s34 offen sc1
    v_mfma_f32_32x32x16_bf16 a[240:255], v[52:55], v[68:71], a[240:255]
    s_waitcnt vmcnt(25) lgkmcnt(0)
    s_barrier
    v_mfma_f32_32x32x16_bf16 a[0:15], v[72:75], v[88:91], a[0:15]
    ds_read_b128 v[40:43], v23 offset:0
    v_mfma_f32_32x32x16_bf16 a[16:31], v[76:79], v[88:91], a[16:31]
    ds_read_b64_tr_b16 v[56:57], v25 offset:16384
    v_mfma_f32_32x32x16_bf16 a[32:47], v[80:83], v[88:91], a[32:47]
    ds_read_b64_tr_b16 v[58:59], v25 offset:18432
    v_mfma_f32_32x32x16_bf16 a[48:63], v[84:87], v[88:91], a[48:63]
    ds_read_b128 v[44:47], v23 offset:4096
    v_mfma_f32_32x32x16_bf16 a[64:79], v[72:75], v[92:95], a[64:79]
    ds_read_b128 v[48:51], v23 offset:8192
    s_add_u32 m0, s32, 0
    s_mov_b32 s33, 2097152
    buffer_load_dwordx4 v5, s[12:15], s33 offen lds
    v_mfma_f32_32x32x16_bf16 a[80:95], v[76:79], v[92:95], a[80:95]
    ds_read_b128 v[52:55], v23 offset:12288
    v_mfma_f32_32x32x16_bf16 a[96:111], v[80:83], v[92:95], a[96:111]
    ds_read_b64_tr_b16 v[60:61], v26 offset:16384
    v_mfma_f32_32x32x16_bf16 a[112:127], v[84:87], v[92:95], a[112:127]
    ds_read_b64_tr_b16 v[62:63], v26 offset:18432
    v_mfma_f32_32x32x16_bf16 a[128:143], v[72:75], v[96:99], a[128:143]
    ds_read_b64_tr_b16 v[64:65], v27 offset:16384
    v_mfma_f32_32x32x16_bf16 a[144:159], v[76:79], v[96:99], a[144:159]
    ds_read_b64_tr_b16 v[66:67], v27 offset:18432
    v_mfma_f32_32x32x16_bf16 a[160:175], v[80:83], v[96:99], a[160:175]
    ds_read_b64_tr_b16 v[68:69], v28 offset:16384
    v_mfma_f32_32x32x16_bf16 a[176:191], v[84:87], v[96:99], a[176:191]
    ds_read_b64_tr_b16 v[70:71], v28 offset:18432
    v_mfma_f32_32x32x16_bf16 a[192:207], v[72:75], v[100:103], a[192:207]
    buffer_load_dwordx4 v6, s[12:15], s33 offen offset:1024 lds
    v_mfma_f32_32x32x16_bf16 a[208:223], v[76:79], v[100:103], a[208:223]
    v_mfma_f32_32x32x16_bf16 a[224:239], v[80:83], v[100:103], a[224:239]
    v_mfma_f32_32x32x16_bf16 a[240:255], v[84:87], v[100:103], a[240:255]
    s_waitcnt lgkmcnt(9)
    v_mfma_f32_32x32x16_bf16 a[0:15], v[40:43], v[56:59], a[0:15]
    ds_read_b128 v[72:75], v24 offset:0
    s_waitcnt lgkmcnt(9)
    v_mfma_f32_32x32x16_bf16 a[16:31], v[44:47], v[56:59], a[16:31]
    ds_read_b64_tr_b16 v[88:89], v25 offset:24576
    s_waitcnt lgkmcnt(9)
    v_mfma_f32_32x32x16_bf16 a[32:47], v[48:51], v[56:59], a[32:47]
    ds_read_b64_tr_b16 v[90:91], v25 offset:26624
    s_waitcnt lgkmcnt(9)
    v_mfma_f32_32x32x16_bf16 a[48:63], v[52:55], v[56:59], a[48:63]
    ds_read_b128 v[76:79], v24 offset:4096
    s_waitcnt lgkmcnt(8)
    v_mfma_f32_32x32x16_bf16 a[64:79], v[40:43], v[60:63], a[64:79]
    ds_read_b128 v[80:83], v24 offset:8192
    buffer_load_dwordx4 v7, s[12:15], s33 offen offset:2048 lds
    v_mfma_f32_32x32x16_bf16 a[80:95], v[44:47], v[60:63], a[80:95]
    ds_read_b128 v[84:87], v24 offset:12288
    v_mfma_f32_32x32x16_bf16 a[96:111], v[48:51], v[60:63], a[96:111]
    ds_read_b64_tr_b16 v[92:93], v26 offset:24576
    v_mfma_f32_32x32x16_bf16 a[112:127], v[52:55], v[60:63], a[112:127]
    ds_read_b64_tr_b16 v[94:95], v26 offset:26624
    s_waitcnt lgkmcnt(10)
    v_mfma_f32_32x32x16_bf16 a[128:143], v[40:43], v[64:67], a[128:143]
    ds_read_b64_tr_b16 v[96:97], v27 offset:24576
    v_mfma_f32_32x32x16_bf16 a[144:159], v[44:47], v[64:67], a[144:159]
    ds_read_b64_tr_b16 v[98:99], v27 offset:26624
    v_mfma_f32_32x32x16_bf16 a[160:175], v[48:51], v[64:67], a[160:175]
    ds_read_b64_tr_b16 v[100:101], v28 offset:24576
    v_mfma_f32_32x32x16_bf16 a[176:191], v[52:55], v[64:67], a[176:191]
    ds_read_b64_tr_b16 v[102:103], v28 offset:26624
    s_waitcnt lgkmcnt(12)
    v_mfma_f32_32x32x16_bf16 a[192:207], v[40:43], v[68:71], a[192:207]
    buffer_load_dwordx4 v8, s[12:15], s33 offen offset:3072 lds
    v_mfma_f32_32x32x16_bf16 a[208:223], v[44:47], v[68:71], a[208:223]
    v_mfma_f32_32x32x16_bf16 a[224:239], v[48:51], v[68:71], a[224:239]
    v_mfma_f32_32x32x16_bf16 a[240:255], v[52:55], v[68:71], a[240:255]
    s_waitcnt vmcnt(17) lgkmcnt(0)
    s_barrier
    s_cmp_eq_u32 s54, 0
    s_cbranch_scc0 k1_c0_1
    s_mov_b64 exec, 1
    v_mov_b32 v124, s2
    v_mov_b32 v125, 1
    buffer_store_byte v125, v124, s[60:63], 0 offen sc1
    s_mov_b64 exec, -1
k1_c0_1:
    v_mfma_f32_32x32x16_bf16 a[0:15], v[72:75], v[88:91], a[0:15]
    ds_read_b128 v[40:43], v17 offset:0
    v_mfma_f32_32x32x16_bf16 a[16:31], v[76:79], v[88:91], a[16:31]
    ds_read_b64_tr_b16 v[56:57], v25 offset:32768
    s_add_u32 m0, s32, 16384
    s_mov_b32 s33, 2359296
    buffer_load_dwordx4 v5, s[12:15], s33 offen lds
    v_mfma_f32_32x32x16_bf16 a[32:47], v[80:83], v[88:91], a[32:47]
    ds_read_b64_tr_b16 v[58:59], v25 offset:34816
    v_mfma_f32_32x32x16_bf16 a[48:63], v[84:87], v[88:91], a[48:63]
    ds_read_b128 v[44:47], v17 offset:4096
    buffer_load_dwordx4 v6, s[12:15], s33 offen offset:1024 lds
    v_mfma_f32_32x32x16_bf16 a[64:79], v[72:75], v[92:95], a[64:79]
    ds_read_b128 v[48:51], v17 offset:8192
    v_mfma_f32_32x32x16_bf16 a[80:95], v[76:79], v[92:95], a[80:95]
    ds_read_b128 v[52:55], v17 offset:12288
    v_mfma_f32_32x32x16_bf16 a[96:111], v[80:83], v[92:95], a[96:111]
    ds_read_b64_tr_b16 v[60:61], v26 offset:32768
    buffer_load_dwordx4 v7, s[12:15], s33 offen offset:2048 lds
    v_mfma_f32_32x32x16_bf16 a[112:127], v[84:87], v[92:95], a[112:127]
    ds_read_b64_tr_b16 v[62:63], v26 offset:34816
    v_mfma_f32_32x32x16_bf16 a[128:143], v[72:75], v[96:99], a[128:143]
    ds_read_b64_tr_b16 v[64:65], v27 offset:32768
    v_mfma_f32_32x32x16_bf16 a[144:159], v[76:79], v[96:99], a[144:159]
    ds_read_b64_tr_b16 v[66:67], v27 offset:34816
    buffer_load_dwordx4 v8, s[12:15], s33 offen offset:3072 lds
    v_mfma_f32_32x32x16_bf16 a[160:175], v[80:83], v[96:99], a[160:175]
    ds_read_b64_tr_b16 v[68:69], v28 offset:32768
    v_mfma_f32_32x32x16_bf16 a[176:191], v[84:87], v[96:99], a[176:191]
    ds_read_b64_tr_b16 v[70:71], v28 offset:34816
    s_add_u32 m0, s32, 131072
    s_mov_b32 s33, 640
    buffer_load_dwordx4 v1, s[8:11], s33 offen lds
    v_mfma_f32_32x32x16_bf16 a[192:207], v[72:75], v[100:103], a[192:207]
    v_mfma_f32_32x32x16_bf16 a[208:223], v[76:79], v[100:103], a[208:223]
    v_mfma_f32_32x32x16_bf16 a[224:239], v[80:83], v[100:103], a[224:239]
    buffer_load_dwordx4 v2, s[8:11], s33 offen offset:1024 lds
    s_mov_b32 s34, 1024
    buffer_store_dwordx4 v[196:199], v38, s[28:31], s34 offen sc1
    v_mfma_f32_32x32x16_bf16 a[240:255], v[84:87], v[100:103], a[240:255]
    s_waitcnt lgkmcnt(9)
    v_mfma_f32_32x32x16_bf16 a[0:15], v[40:43], v[56:59], a[0:15]
    ds_read_b128 v[72:75], v18 offset:0
    s_waitcnt lgkmcnt(9)
    v_mfma_f32_32x32x16_bf16 a[16:31], v[44:47], v[56:59], a[16:31]
    ds_read_b64_tr_b16 v[88:89], v25 offset:40960
    buffer_load_dwordx4 v3, s[8:11], s33 offen offset:2048 lds
    s_waitcnt lgkmcnt(9)
    v_mfma_f32_32x32x16_bf16 a[32:47], v[48:51], v[56:59], a[32:47]
    ds_read_b64_tr_b16 v[90:91], v25 offset:43008
    s_waitcnt lgkmcnt(9)
    v_mfma_f32_32x32x16_bf16 a[48:63], v[52:55], v[56:59], a[48:63]
    ds_read_b128 v[76:79], v18 offset:4096
    buffer_load_dwordx4 v4, s[8:11], s33 offen offset:3072 lds
    s_waitcnt lgkmcnt(8)
    v_mfma_f32_32x32x16_bf16 a[64:79], v[40:43], v[60:63], a[64:79]
    ds_read_b128 v[80:83], v18 offset:8192
    v_mfma_f32_32x32x16_bf16 a[80:95], v[44:47], v[60:63], a[80:95]
    ds_read_b128 v[84:87], v18 offset:12288
    v_mfma_f32_32x32x16_bf16 a[96:111], v[48:51], v[60:63], a[96:111]
    ds_read_b64_tr_b16 v[92:93], v26 offset:40960
    s_add_u32 m0, s32, 147456
    s_mov_b32 s33, 262784
    buffer_load_dwordx4 v1, s[8:11], s33 offen lds
    v_mfma_f32_32x32x16_bf16 a[112:127], v[52:55], v[60:63], a[112:127]
    ds_read_b64_tr_b16 v[94:95], v26 offset:43008
    s_waitcnt lgkmcnt(10)
    v_mfma_f32_32x32x16_bf16 a[128:143], v[40:43], v[64:67], a[128:143]
    ds_read_b64_tr_b16 v[96:97], v27 offset:40960
    v_mfma_f32_32x32x16_bf16 a[144:159], v[44:47], v[64:67], a[144:159]
    ds_read_b64_tr_b16 v[98:99], v27 offset:43008
    buffer_load_dwordx4 v2, s[8:11], s33 offen offset:1024 lds
    v_mfma_f32_32x32x16_bf16 a[160:175], v[48:51], v[64:67], a[160:175]
    ds_read_b64_tr_b16 v[100:101], v28 offset:40960
    v_mfma_f32_32x32x16_bf16 a[176:191], v[52:55], v[64:67], a[176:191]
    ds_read_b64_tr_b16 v[102:103], v28 offset:43008
    buffer_load_dwordx4 v3, s[8:11], s33 offen offset:2048 lds
    s_waitcnt lgkmcnt(12)
    v_mfma_f32_32x32x16_bf16 a[192:207], v[40:43], v[68:71], a[192:207]
    v_mfma_f32_32x32x16_bf16 a[208:223], v[44:47], v[68:71], a[208:223]
    v_mfma_f32_32x32x16_bf16 a[224:239], v[48:51], v[68:71], a[224:239]
    buffer_load_dwordx4 v4, s[8:11], s33 offen offset:3072 lds
    v_mfma_f32_32x32x16_bf16 a[240:255], v[52:55], v[68:71], a[240:255]
    s_waitcnt vmcnt(26) lgkmcnt(0)
    s_barrier
    v_mfma_f32_32x32x16_bf16 a[0:15], v[72:75], v[88:91], a[0:15]
    ds_read_b128 v[40:43], v19 offset:0
    v_mfma_f32_32x32x16_bf16 a[16:31], v[76:79], v[88:91], a[16:31]
    ds_read_b64_tr_b16 v[56:57], v25 offset:49152
    v_mfma_f32_32x32x16_bf16 a[32:47], v[80:83], v[88:91], a[32:47]
    ds_read_b64_tr_b16 v[58:59], v25 offset:51200
    v_mfma_f32_32x32x16_bf16 a[48:63], v[84:87], v[88:91], a[48:63]
    ds_read_b128 v[44:47], v19 offset:4096
    v_mfma_f32_32x32x16_bf16 a[64:79], v[72:75], v[92:95], a[64:79]
    ds_read_b128 v[48:51], v19 offset:8192
    s_add_u32 m0, s32, 32768
    s_mov_b32 s33, 2621440
    buffer_load_dwordx4 v5, s[12:15], s33 offen lds
    v_mfma_f32_32x32x16_bf16 a[80:95], v[76:79], v[92:95], a[80:95]
    ds_read_b128 v[52:55], v19 offset:12288
    v_mfma_f32_32x32x16_bf16 a[96:111], v[80:83], v[92:95], a[96:111]
    ds_read_b64_tr_b16 v[60:61], v26 offset:49152
    v_mfma_f32_32x32x16_bf16 a[112:127], v[84:87], v[92:95], a[112:127]
    ds_read_b64_tr_b16 v[62:63], v26 offset:51200
    v_mfma_f32_32x32x16_bf16 a[128:143], v[72:75], v[96:99], a[128:143]
    ds_read_b64_tr_b16 v[64:65], v27 offset:49152
    v_mfma_f32_32x32x16_bf16 a[144:159], v[76:79], v[96:99], a[144:159]
    ds_read_b64_tr_b16 v[66:67], v27 offset:51200
    v_mfma_f32_32x32x16_bf16 a[160:175], v[80:83], v[96:99], a[160:175]
    ds_read_b64_tr_b16 v[68:69], v28 offset:49152
    v_mfma_f32_32x32x16_bf16 a[176:191], v[84:87], v[96:99], a[176:191]
    ds_read_b64_tr_b16 v[70:71], v28 offset:51200
    v_mfma_f32_32x32x16_bf16 a[192:207], v[72:75], v[100:103], a[192:207]
    buffer_load_dwordx4 v6, s[12:15], s33 offen offset:1024 lds
    v_mfma_f32_32x32x16_bf16 a[208:223], v[76:79], v[100:103], a[208:223]
    v_mfma_f32_32x32x16_bf16 a[224:239], v[80:83], v[100:103], a[224:239]
    v_mfma_f32_32x32x16_bf16 a[240:255], v[84:87], v[100:103], a[240:255]
    s_waitcnt lgkmcnt(9)
    v_mfma_f32_32x32x16_bf16 a[0:15], v[40:43], v[56:59], a[0:15]
    ds_read_b128 v[72:75], v20 offset:0
    s_waitcnt lgkmcnt(9)
    v_mfma_f32_32x32x16_bf16 a[16:31], v[44:47], v[56:59], a[16:31]
    ds_read_b64_tr_b16 v[88:89], v25 offset:57344
    s_waitcnt lgkmcnt(9)
    v_mfma_f32_32x32x16_bf16 a[32:47], v[48:51], v[56:59], a[32:47]
    ds_read_b64_tr_b16 v[90:91], v25 offset:59392
    s_waitcnt lgkmcnt(9)
    v_mfma_f32_32x32x16_bf16 a[48:63], v[52:55], v[56:59], a[48:63]
    ds_read_b128 v[76:79], v20 offset:4096
    s_waitcnt lgkmcnt(8)
    v_mfma_f32_32x32x16_bf16 a[64:79], v[40:43], v[60:63], a[64:79]
    ds_read_b128 v[80:83], v20 offset:8192
    buffer_load_dwordx4 v7, s[12:15], s33 offen offset:2048 lds
    v_mfma_f32_32x32x16_bf16 a[80:95], v[44:47], v[60:63], a[80:95]
    ds_read_b128 v[84:87], v20 offset:12288
    v_mfma_f32_32x32x16_bf16 a[96:111], v[48:51], v[60:63], a[96:111]
    ds_read_b64_tr_b16 v[92:93], v26 offset:57344
    v_mfma_f32_32x32x16_bf16 a[112:127], v[52:55], v[60:63], a[112:127]
    ds_read_b64_tr_b16 v[94:95], v26 offset:59392
    s_waitcnt lgkmcnt(10)
    v_mfma_f32_32x32x16_bf16 a[128:143], v[40:43], v[64:67], a[128:143]
    ds_read_b64_tr_b16 v[96:97], v27 offset:57344
    v_mfma_f32_32x32x16_bf16 a[144:159], v[44:47], v[64:67], a[144:159]
    ds_read_b64_tr_b16 v[98:99], v27 offset:59392
    v_mfma_f32_32x32x16_bf16 a[160:175], v[48:51], v[64:67], a[160:175]
    ds_read_b64_tr_b16 v[100:101], v28 offset:57344
    v_mfma_f32_32x32x16_bf16 a[176:191], v[52:55], v[64:67], a[176:191]
    ds_read_b64_tr_b16 v[102:103], v28 offset:59392
    s_waitcnt lgkmcnt(12)
    v_mfma_f32_32x32x16_bf16 a[192:207], v[40:43], v[68:71], a[192:207]
    buffer_load_dwordx4 v8, s[12:15], s33 offen offset:3072 lds
    v_mfma_f32_32x32x16_bf16 a[208:223], v[44:47], v[68:71], a[208:223]
    v_mfma_f32_32x32x16_bf16 a[224:239], v[48:51], v[68:71], a[224:239]
    s_mov_b32 s34, 2048
    buffer_store_dwordx4 v[200:203], v38, s[28:31], s34 offen sc1
    v_mfma_f32_32x32x16_bf16 a[240:255], v[52:55], v[68:71], a[240:255]
    s_waitcnt vmcnt(18) lgkmcnt(0)
    s_barrier
    v_mfma_f32_32x32x16_bf16 a[0:15], v[72:75], v[88:91], a[0:15]
    ds_read_b128 v[40:43], v17 offset:32768
    v_mfma_f32_32x32x16_bf16 a[16:31], v[76:79], v[88:91], a[16:31]
    ds_read_b64_tr_b16 v[56:57], v25 offset:0
    s_add_u32 m0, s32, 49152
    s_mov_b32 s33, 2883584
    buffer_load_dwordx4 v5, s[12:15], s33 offen lds
    v_mfma_f32_32x32x16_bf16 a[32:47], v[80:83], v[88:91], a[32:47]
    ds_read_b64_tr_b16 v[58:59], v25 offset:2048
    v_mfma_f32_32x32x16_bf16 a[48:63], v[84:87], v[88:91], a[48:63]
    ds_read_b128 v[44:47], v17 offset:36864
    buffer_load_dwordx4 v6, s[12:15], s33 offen offset:1024 lds
    v_mfma_f32_32x32x16_bf16 a[64:79], v[72:75], v[92:95], a[64:79]
    ds_read_b128 v[48:51], v17 offset:40960
    v_mfma_f32_32x32x16_bf16 a[80:95], v[76:79], v[92:95], a[80:95]
    ds_read_b128 v[52:55], v17 offset:45056
    v_mfma_f32_32x32x16_bf16 a[96:111], v[80:83], v[92:95], a[96:111]
    ds_read_b64_tr_b16 v[60:61], v26 offset:0
    buffer_load_dwordx4 v7, s[12:15], s33 offen offset:2048 lds
    v_mfma_f32_32x32x16_bf16 a[112:127], v[84:87], v[92:95], a[112:127]
    ds_read_b64_tr_b16 v[62:63], v26 offset:2048
    v_mfma_f32_32x32x16_bf16 a[128:143], v[72:75], v[96:99], a[128:143]
    ds_read_b64_tr_b16 v[64:65], v27 offset:0
    v_mfma_f32_32x32x16_bf16 a[144:159], v[76:79], v[96:99], a[144:159]
    ds_read_b64_tr_b16 v[66:67], v27 offset:2048
    buffer_load_dwordx4 v8, s[12:15], s33 offen offset:3072 lds
    v_mfma_f32_32x32x16_bf16 a[160:175], v[80:83], v[96:99], a[160:175]
    ds_read_b64_tr_b16 v[68:69], v28 offset:0
    v_mfma_f32_32x32x16_bf16 a[176:191], v[84:87], v[96:99], a[176:191]
    ds_read_b64_tr_b16 v[70:71], v28 offset:2048
    s_add_u32 m0, s32, 65536
    s_mov_b32 s33, 768
    buffer_load_dwordx4 v1, s[8:11], s33 offen lds
    v_mfma_f32_32x32x16_bf16 a[192:207], v[72:75], v[100:103], a[192:207]
    v_mfma_f32_32x32x16_bf16 a[208:223], v[76:79], v[100:103], a[208:223]
    v_mfma_f32_32x32x16_bf16 a[224:239], v[80:83], v[100:103], a[224:239]
    buffer_load_dwordx4 v2, s[8:11], s33 offen offset:1024 lds
    v_mfma_f32_32x32x16_bf16 a[240:255], v[84:87], v[100:103], a[240:255]
    s_waitcnt lgkmcnt(9)
    v_mfma_f32_32x32x16_bf16 a[0:15], v[40:43], v[56:59], a[0:15]
    ds_read_b128 v[72:75], v18 offset:32768
    s_waitcnt lgkmcnt(9)
    v_mfma_f32_32x32x16_bf16 a[16:31], v[44:47], v[56:59], a[16:31]
    ds_read_b64_tr_b16 v[88:89], v25 offset:8192
    buffer_load_dwordx4 v3, s[8:11], s33 offen offset:2048 lds
    s_waitcnt lgkmcnt(9)
    v_mfma_f32_32x32x16_bf16 a[32:47], v[48:51], v[56:59], a[32:47]
    ds_read_b64_tr_b16 v[90:91], v25 offset:10240
    s_waitcnt lgkmcnt(9)
    v_mfma_f32_32x32x16_bf16 a[48:63], v[52:55], v[56:59], a[48:63]
    ds_read_b128 v[76:79], v18 offset:36864
    buffer_load_dwordx4 v4, s[8:11], s33 offen offset:3072 lds
    s_waitcnt lgkmcnt(8)
    v_mfma_f32_32x32x16_bf16 a[64:79], v[40:43], v[60:63], a[64:79]
    ds_read_b128 v[80:83], v18 offset:40960
    v_mfma_f32_32x32x16_bf16 a[80:95], v[44:47], v[60:63], a[80:95]
    ds_read_b128 v[84:87], v18 offset:45056
    v_mfma_f32_32x32x16_bf16 a[96:111], v[48:51], v[60:63], a[96:111]
    ds_read_b64_tr_b16 v[92:93], v26 offset:8192
    s_add_u32 m0, s32, 81920
    s_mov_b32 s33, 262912
    buffer_load_dwordx4 v1, s[8:11], s33 offen lds
    v_mfma_f32_32x32x16_bf16 a[112:127], v[52:55], v[60:63], a[112:127]
    ds_read_b64_tr_b16 v[94:95], v26 offset:10240
    s_waitcnt lgkmcnt(10)
    v_mfma_f32_32x32x16_bf16 a[128:143], v[40:43], v[64:67], a[128:143]
    ds_read_b64_tr_b16 v[96:97], v27 offset:8192
    v_mfma_f32_32x32x16_bf16 a[144:159], v[44:47], v[64:67], a[144:159]
    ds_read_b64_tr_b16 v[98:99], v27 offset:10240
    buffer_load_dwordx4 v2, s[8:11], s33 offen offset:1024 lds
    v_mfma_f32_32x32x16_bf16 a[160:175], v[48:51], v[64:67], a[160:175]
    ds_read_b64_tr_b16 v[100:101], v28 offset:8192
    v_mfma_f32_32x32x16_bf16 a[176:191], v[52:55], v[64:67], a[176:191]
    ds_read_b64_tr_b16 v[102:103], v28 offset:10240
    buffer_load_dwordx4 v3, s[8:11], s33 offen offset:2048 lds
    s_waitcnt lgkmcnt(12)
    v_mfma_f32_32x32x16_bf16 a[192:207], v[40:43], v[68:71], a[192:207]
    v_mfma_f32_32x32x16_bf16 a[208:223], v[44:47], v[68:71], a[208:223]
    v_mfma_f32_32x32x16_bf16 a[224:239], v[48:51], v[68:71], a[224:239]
    buffer_load_dwordx4 v4, s[8:11], s33 offen offset:3072 lds
    v_mfma_f32_32x32x16_bf16 a[240:255], v[52:55], v[68:71], a[240:255]
    s_waitcnt vmcnt(26) lgkmcnt(0)
    s_barrier
    v_mfma_f32_32x32x16_bf16 a[0:15], v[72:75], v[88:91], a[0:15]
    ds_read_b128 v[40:43], v19 offset:32768
    v_mfma_f32_32x32x16_bf16 a[16:31], v[76:79], v[88:91], a[16:31]
    ds_read_b64_tr_b16 v[56:57], v25 offset:16384
    v_mfma_f32_32x32x16_bf16 a[32:47], v[80:83], v[88:91], a[32:47]
    ds_read_b64_tr_b16 v[58:59], v25 offset:18432
    v_mfma_f32_32x32x16_bf16 a[48:63], v[84:87], v[88:91], a[48:63]
    ds_read_b128 v[44:47], v19 offset:36864
    v_mfma_f32_32x32x16_bf16 a[64:79], v[72:75], v[92:95], a[64:79]
    ds_read_b128 v[48:51], v19 offset:40960
    s_add_u32 m0, s32, 0
    s_mov_b32 s33, 3145728
    buffer_load_dwordx4 v5, s[12:15], s33 offen lds
    v_mfma_f32_32x32x16_bf16 a[80:95], v[76:79], v[92:95], a[80:95]
    ds_read_b128 v[52:55], v19 offset:45056
    v_mfma_f32_32x32x16_bf16 a[96:111], v[80:83], v[92:95], a[96:111]
    ds_read_b64_tr_b16 v[60:61], v26 offset:16384
    v_mfma_f32_32x32x16_bf16 a[112:127], v[84:87], v[92:95], a[112:127]
    ds_read_b64_tr_b16 v[62:63], v26 offset:18432
    v_mfma_f32_32x32x16_bf16 a[128:143], v[72:75], v[96:99], a[128:143]
    ds_read_b64_tr_b16 v[64:65], v27 offset:16384
    v_mfma_f32_32x32x16_bf16 a[144:159], v[76:79], v[96:99], a[144:159]
    ds_read_b64_tr_b16 v[66:67], v27 offset:18432
    v_mfma_f32_32x32x16_bf16 a[160:175], v[80:83], v[96:99], a[160:175]
    ds_read_b64_tr_b16 v[68:69], v28 offset:16384
    v_mfma_f32_32x32x16_bf16 a[176:191], v[84:87], v[96:99], a[176:191]
    ds_read_b64_tr_b16 v[70:71], v28 offset:18432
    v_mfma_f32_32x32x16_bf16 a[192:207], v[72:75], v[100:103], a[192:207]
    buffer_load_dwordx4 v6, s[12:15], s33 offen offset:1024 lds
    v_mfma_f32_32x32x16_bf16 a[208:223], v[76:79], v[100:103], a[208:223]
    v_mfma_f32_32x32x16_bf16 a[224:239], v[80:83], v[100:103], a[224:239]
    s_mov_b32 s34, 3072
    buffer_store_dwordx4 v[204:207], v38, s[28:31], s34 offen sc1
    v_mfma_f32_32x32x16_bf16 a[240:255], v[84:87], v[100:103], a[240:255]
    s_waitcnt lgkmcnt(9)
    v_mfma_f32_32x32x16_bf16 a[0:15], v[40:43], v[56:59], a[0:15]
    ds_read_b128 v[72:75], v20 offset:32768
    s_waitcnt lgkmcnt(9)
    v_mfma_f32_32x32x16_bf16 a[16:31], v[44:47], v[56:59], a[16:31]
    ds_read_b64_tr_b16 v[88:89], v25 offset:24576
    s_waitcnt lgkmcnt(9)
    v_mfma_f32_32x32x16_bf16 a[32:47], v[48:51], v[56:59], a[32:47]
    ds_read_b64_tr_b16 v[90:91], v25 offset:26624
    s_waitcnt lgkmcnt(9)
    v_mfma_f32_32x32x16_bf16 a[48:63], v[52:55], v[56:59], a[48:63]
    ds_read_b128 v[76:79], v20 offset:36864
    s_waitcnt lgkmcnt(8)
    v_mfma_f32_32x32x16_bf16 a[64:79], v[40:43], v[60:63], a[64:79]
    ds_read_b128 v[80:83], v20 offset:40960
    buffer_load_dwordx4 v7, s[12:15], s33 offen offset:2048 lds
    v_mfma_f32_32x32x16_bf16 a[80:95], v[44:47], v[60:63], a[80:95]
    ds_read_b128 v[84:87], v20 offset:45056
    v_mfma_f32_32x32x16_bf16 a[96:111], v[48:51], v[60:63], a[96:111]
    ds_read_b64_tr_b16 v[92:93], v26 offset:24576
    v_mfma_f32_32x32x16_bf16 a[112:127], v[52:55], v[60:63], a[112:127]
    ds_read_b64_tr_b16 v[94:95], v26 offset:26624
    s_waitcnt lgkmcnt(10)
    v_mfma_f32_32x32x16_bf16 a[128:143], v[40:43], v[64:67], a[128:143]
    ds_read_b64_tr_b16 v[96:97], v27 offset:24576
    v_mfma_f32_32x32x16_bf16 a[144:159], v[44:47], v[64:67], a[144:159]
    ds_read_b64_tr_b16 v[98:99], v27 offset:26624
    v_mfma_f32_32x32x16_bf16 a[160:175], v[48:51], v[64:67], a[160:175]
    ds_read_b64_tr_b16 v[100:101], v28 offset:24576
    v_mfma_f32_32x32x16_bf16 a[176:191], v[52:55], v[64:67], a[176:191]
    ds_read_b64_tr_b16 v[102:103], v28 offset:26624
    s_waitcnt lgkmcnt(12)
    v_mfma_f32_32x32x16_bf16 a[192:207], v[40:43], v[68:71], a[192:207]
    buffer_load_dwordx4 v8, s[12:15], s33 offen offset:3072 lds
    v_mfma_f32_32x32x16_bf16 a[208:223], v[44:47], v[68:71], a[208:223]
    v_mfma_f32_32x32x16_bf16 a[224:239], v[48:51], v[68:71], a[224:239]
    v_mfma_f32_32x32x16_bf16 a[240:255], v[52:55], v[68:71], a[240:255]
    s_waitcnt vmcnt(18) lgkmcnt(0)
    s_barrier
    v_mfma_f32_32x32x16_bf16 a[0:15], v[72:75], v[88:91], a[0:15]
    ds_read_b128 v[40:43], v21 offset:0
    v_mfma_f32_32x32x16_bf16 a[16:31], v[76:79], v[88:91], a[16:31]
    ds_read_b64_tr_b16 v[56:57], v25 offset:32768
    v_mfma_f32_32x32x16_bf16 a[32:47], v[80:83], v[88:91], a[32:47]
    ds_read_b64_tr_b16 v[58:59], v25 offset:34816
    s_add_u32 m0, s32, 16384
    s_mov_b32 s33, 3407872
    buffer_load_dwordx4 v5, s[12:15], s33 offen lds
    v_mfma_f32_32x32x16_bf16 a[48:63], v[84:87], v[88:91], a[48:63]
    ds_read_b128 v[44:47], v21 offset:4096
    v_mfma_f32_32x32x16_bf16 a[64:79], v[72:75], v[92:95], a[64:79]
    ds_read_b128 v[48:51], v21 offset:8192
    v_mfma_f32_32x32x16_bf16 a[80:95], v[76:79], v[92:95], a[80:95]
    ds_read_b128 v[52:55], v21 offset:12288
    v_mfma_f32_32x32x16_bf16 a[96:111], v[80:83], v[92:95], a[96:111]
    ds_read_b64_tr_b16 v[60:61], v26 offset:32768
    buffer_load_dwordx4 v6, s[12:15], s33 offen offset:1024 lds
    v_mfma_f32_32x32x16_bf16 a[112:127], v[84:87], v[92:95], a[112:127]
    ds_read_b64_tr_b16 v[62:63], v26 offset:34816
    v_mfma_f32_32x32x16_bf16 a[128:143], v[72:75], v[96:99], a[128:143]
    ds_read_b64_tr_b16 v[64:65], v27 offset:32768
    v_mfma_f32_32x32x16_bf16 a[144:159], v[76:79], v[96:99], a[144:159]
    ds_read_b64_tr_b16 v[66:67], v27 offset:34816
    v_mfma_f32_32x32x16_bf16 a[160:175], v[80:83], v[96:99], a[160:175]
    ds_read_b64_tr_b16 v[68:69], v28 offset:32768
    buffer_load_dwordx4 v7, s[12:15], s33 offen offset:2048 lds
    v_mfma_f32_32x32x16_bf16 a[176:191], v[84:87], v[96:99], a[176:191]
    ds_read_b64_tr_b16 v[70:71], v28 offset:34816
    v_mfma_f32_32x32x16_bf16 a[192:207], v[72:75], v[100:103], a[192:207]
    v_mfma_f32_32x32x16_bf16 a[208:223], v[76:79], v[100:103], a[208:223]
    v_mfma_f32_32x32x16_bf16 a[224:239], v[80:83], v[100:103], a[224:239]
    buffer_load_dwordx4 v8, s[12:15], s33 offen offset:3072 lds
    v_mfma_f32_32x32x16_bf16 a[240:255], v[84:87], v[100:103], a[240:255]
    s_waitcnt lgkmcnt(9)
    v_mfma_f32_32x32x16_bf16 a[0:15], v[40:43], v[56:59], a[0:15]
    ds_read_b128 v[72:75], v22 offset:0
    s_waitcnt lgkmcnt(9)
    v_mfma_f32_32x32x16_bf16 a[16:31], v[44:47], v[56:59], a[16:31]
    ds_read_b64_tr_b16 v[88:89], v25 offset:40960
    s_waitcnt lgkmcnt(9)
    v_mfma_f32_32x32x16_bf16 a[32:47], v[48:51], v[56:59], a[32:47]
    ds_read_b64_tr_b16 v[90:91], v25 offset:43008
    s_add_u32 m0, s32, 98304
    s_mov_b32 s33, 896
    buffer_load_dwordx4 v1, s[8:11], s33 offen lds
    s_waitcnt lgkmcnt(9)
    v_mfma_f32_32x32x16_bf16 a[48:63], v[52:55], v[56:59], a[48:63]
    ds_read_b128 v[76:79], v22 offset:4096
    s_waitcnt lgkmcnt(8)
    v_mfma_f32_32x32x16_bf16 a[64:79], v[40:43], v[60:63], a[64:79]
    ds_read_b128 v[80:83], v22 offset:8192
    v_mfma_f32_32x32x16_bf16 a[80:95], v[44:47], v[60:63], a[80:95]
    ds_read_b128 v[84:87], v22 offset:12288
    v_mfma_f32_32x32x16_bf16 a[96:111], v[48:51], v[60:63], a[96:111]
    ds_read_b64_tr_b16 v[92:93], v26 offset:40960
    buffer_load_dwordx4 v2, s[8:11], s33 offen offset:1024 lds
    v_mfma_f32_32x32x16_bf16 a[112:127], v[52:55], v[60:63], a[112:127]
    ds_read_b64_tr_b16 v[94:95], v26 offset:43008
    s_waitcnt lgkmcnt(10)
    v_mfma_f32_32x32x16_bf16 a[128:143], v[40:43], v[64:67], a[128:143]
    ds_read_b64_tr_b16 v[96:97], v27 offset:40960
    v_mfma_f32_32x32x16_bf16 a[144:159], v[44:47], v[64:67], a[144:159]
    ds_read_b64_tr_b16 v[98:99], v27 offset:43008
    v_mfma_f32_32x32x16_bf16 a[160:175], v[48:51], v[64:67], a[160:175]
    ds_read_b64_tr_b16 v[100:101], v28 offset:40960
    buffer_load_dwordx4 v3, s[8:11], s33 offen offset:2048 lds
    v_mfma_f32_32x32x16_bf16 a[176:191], v[52:55], v[64:67], a[176:191]
    ds_read_b64_tr_b16 v[102:103], v28 offset:43008
    s_waitcnt lgkmcnt(12)
    v_mfma_f32_32x32x16_bf16 a[192:207], v[40:43], v[68:71], a[192:207]
    v_mfma_f32_32x32x16_bf16 a[208:223], v[44:47], v[68:71], a[208:223]
    v_mfma_f32_32x32x16_bf16 a[224:239], v[48:51], v[68:71], a[224:239]
    buffer_load_dwordx4 v4, s[8:11], s33 offen offset:3072 lds
    s_mov_b32 s34, 4096
    buffer_store_dwordx4 v[208:211], v38, s[28:31], s34 offen sc1
    v_mfma_f32_32x32x16_bf16 a[240:255], v[52:55], v[68:71], a[240:255]
    s_waitcnt vmcnt(22) lgkmcnt(0)
    s_barrier
    v_mfma_f32_32x32x16_bf16 a[0:15], v[72:75], v[88:91], a[0:15]
    ds_read_b128 v[40:43], v23 offset:0
    v_mfma_f32_32x32x16_bf16 a[16:31], v[76:79], v[88:91], a[16:31]
    ds_read_b64_tr_b16 v[56:57], v25 offset:49152
    v_mfma_f32_32x32x16_bf16 a[32:47], v[80:83], v[88:91], a[32:47]
    ds_read_b64_tr_b16 v[58:59], v25 offset:51200
    s_add_u32 m0, s32, 114688
    s_mov_b32 s33, 263040
    buffer_load_dwordx4 v1, s[8:11], s33 offen lds
    v_mfma_f32_32x32x16_bf16 a[48:63], v[84:87], v[88:91], a[48:63]
    ds_read_b128 v[44:47], v23 offset:4096
    v_mfma_f32_32x32x16_bf16 a[64:79], v[72:75], v[92:95], a[64:79]
    ds_read_b128 v[48:51], v23 offset:8192
    v_mfma_f32_32x32x16_bf16 a[80:95], v[76:79], v[92:95], a[80:95]
    ds_read_b128 v[52:55], v23 offset:12288
    v_mfma_f32_32x32x16_bf16 a[96:111], v[80:83], v[92:95], a[96:111]
    ds_read_b64_tr_b16 v[60:61], v26 offset:49152
    buffer_load_dwordx4 v2, s[8:11], s33 offen offset:1024 lds
    v_mfma_f32_32x32x16_bf16 a[112:127], v[84:87], v[92:95], a[112:127]
    ds_read_b64_tr_b16 v[62:63], v26 offset:51200
    v_mfma_f32_32x32x16_bf16 a[128:143], v[72:75], v[96:99], a[128:143]
    ds_read_b64_tr_b16 v[64:65], v27 offset:49152
    v_mfma_f32_32x32x16_bf16 a[144:159], v[76:79], v[96:99], a[144:159]
    ds_read_b64_tr_b16 v[66:67], v27 offset:51200
    v_mfma_f32_32x32x16_bf16 a[160:175], v[80:83], v[96:99], a[160:175]
    ds_read_b64_tr_b16 v[68:69], v28 offset:49152
    buffer_load_dwordx4 v3, s[8:11], s33 offen offset:2048 lds
    v_mfma_f32_32x32x16_bf16 a[176:191], v[84:87], v[96:99], a[176:191]
    ds_read_b64_tr_b16 v[70:71], v28 offset:51200
    v_mfma_f32_32x32x16_bf16 a[192:207], v[72:75], v[100:103], a[192:207]
    v_mfma_f32_32x32x16_bf16 a[208:223], v[76:79], v[100:103], a[208:223]
    v_mfma_f32_32x32x16_bf16 a[224:239], v[80:83], v[100:103], a[224:239]
    buffer_load_dwordx4 v4, s[8:11], s33 offen offset:3072 lds
    v_mfma_f32_32x32x16_bf16 a[240:255], v[84:87], v[100:103], a[240:255]
    s_waitcnt lgkmcnt(9)
    v_mfma_f32_32x32x16_bf16 a[0:15], v[40:43], v[56:59], a[0:15]
    ds_read_b128 v[72:75], v24 offset:0
    s_waitcnt lgkmcnt(9)
    v_mfma_f32_32x32x16_bf16 a[16:31], v[44:47], v[56:59], a[16:31]
    ds_read_b64_tr_b16 v[88:89], v25 offset:57344
    s_waitcnt lgkmcnt(9)
    v_mfma_f32_32x32x16_bf16 a[32:47], v[48:51], v[56:59], a[32:47]
    ds_read_b64_tr_b16 v[90:91], v25 offset:59392
    s_add_u32 m0, s32, 32768
    s_mov_b32 s33, 3670016
    buffer_load_dwordx4 v5, s[12:15], s33 offen lds
    s_waitcnt lgkmcnt(9)
    v_mfma_f32_32x32x16_bf16 a[48:63], v[52:55], v[56:59], a[48:63]
    ds_read_b128 v[76:79], v24 offset:4096
    s_waitcnt lgkmcnt(8)
    v_mfma_f32_32x32x16_bf16 a[64:79], v[40:43], v[60:63], a[64:79]
    ds_read_b128 v[80:83], v24 offset:8192
    v_mfma_f32_32x32x16_bf16 a[80:95], v[44:47], v[60:63], a[80:95]
    ds_read_b128 v[84:87], v24 offset:12288
    v_mfma_f32_32x32x16_bf16 a[96:111], v[48:51], v[60:63], a[96:111]
    ds_read_b64_tr_b16 v[92:93], v26 offset:57344
    buffer_load_dwordx4 v6, s[12:15], s33 offen offset:1024 lds
    v_mfma_f32_32x32x16_bf16 a[112:127], v[52:55], v[60:63], a[112:127]
    ds_read_b64_tr_b16 v[94:95], v26 offset:59392
    s_waitcnt lgkmcnt(10)
    v_mfma_f32_32x32x16_bf16 a[128:143], v[40:43], v[64:67], a[128:143]
    ds_read_b64_tr_b16 v[96:97], v27 offset:57344
    v_mfma_f32_32x32x16_bf16 a[144:159], v[44:47], v[64:67], a[144:159]
    ds_read_b64_tr_b16 v[98:99], v27 offset:59392
    v_mfma_f32_32x32x16_bf16 a[160:175], v[48:51], v[64:67], a[160:175]
    ds_read_b64_tr_b16 v[100:101], v28 offset:57344
    buffer_load_dwordx4 v7, s[12:15], s33 offen offset:2048 lds
    v_mfma_f32_32x32x16_bf16 a[176:191], v[52:55], v[64:67], a[176:191]
    ds_read_b64_tr_b16 v[102:103], v28 offset:59392
    s_waitcnt lgkmcnt(12)
    v_mfma_f32_32x32x16_bf16 a[192:207], v[40:43], v[68:71], a[192:207]
    v_mfma_f32_32x32x16_bf16 a[208:223], v[44:47], v[68:71], a[208:223]
    v_mfma_f32_32x32x16_bf16 a[224:239], v[48:51], v[68:71], a[224:239]
    buffer_load_dwordx4 v8, s[12:15], s33 offen offset:3072 lds
    v_mfma_f32_32x32x16_bf16 a[240:255], v[52:55], v[68:71], a[240:255]
    s_waitcnt vmcnt(17) lgkmcnt(0)
    s_barrier
    v_mfma_f32_32x32x16_bf16 a[0:15], v[72:75], v[88:91], a[0:15]
    ds_read_b128 v[40:43], v17 offset:0
    v_mfma_f32_32x32x16_bf16 a[16:31], v[76:79], v[88:91], a[16:31]
    ds_read_b64_tr_b16 v[56:57], v25 offset:0
    v_mfma_f32_32x32x16_bf16 a[32:47], v[80:83], v[88:91], a[32:47]
    ds_read_b64_tr_b16 v[58:59], v25 offset:2048
    s_add_u32 m0, s32, 49152
    s_mov_b32 s33, 3932160
    buffer_load_dwordx4 v5, s[12:15], s33 offen lds
    v_mfma_f32_32x32x16_bf16 a[48:63], v[84:87], v[88:91], a[48:63]
    ds_read_b128 v[44:47], v17 offset:4096
    v_mfma_f32_32x32x16_bf16 a[64:79], v[72:75], v[92:95], a[64:79]
    ds_read_b128 v[48:51], v17 offset:8192
    v_mfma_f32_32x32x16_bf16 a[80:95], v[76:79], v[92:95], a[80:95]
    ds_read_b128 v[52:55], v17 offset:12288
    v_mfma_f32_32x32x16_bf16 a[96:111], v[80:83], v[92:95], a[96:111]
    ds_read_b64_tr_b16 v[60:61], v26 offset:0
    buffer_load_dwordx4 v6, s[12:15], s33 offen offset:1024 lds
    v_mfma_f32_32x32x16_bf16 a[112:127], v[84:87], v[92:95], a[112:127]
    ds_read_b64_tr_b16 v[62:63], v26 offset:2048
    v_mfma_f32_32x32x16_bf16 a[128:143], v[72:75], v[96:99], a[128:143]
    ds_read_b64_tr_b16 v[64:65], v27 offset:0
    v_mfma_f32_32x32x16_bf16 a[144:159], v[76:79], v[96:99], a[144:159]
    ds_read_b64_tr_b16 v[66:67], v27 offset:2048
    v_mfma_f32_32x32x16_bf16 a[160:175], v[80:83], v[96:99], a[160:175]
    ds_read_b64_tr_b16 v[68:69], v28 offset:0
    buffer_load_dwordx4 v7, s[12:15], s33 offen offset:2048 lds
    v_mfma_f32_32x32x16_bf16 a[176:191], v[84:87], v[96:99], a[176:191]
    ds_read_b64_tr_b16 v[70:71], v28 offset:2048
    v_mfma_f32_32x32x16_bf16 a[192:207], v[72:75], v[100:103], a[192:207]
    v_mfma_f32_32x32x16_bf16 a[208:223], v[76:79], v[100:103], a[208:223]
    v_mfma_f32_32x32x16_bf16 a[224:239], v[80:83], v[100:103], a[224:239]
    buffer_load_dwordx4 v8, s[12:15], s33 offen offset:3072 lds
    s_mov_b32 s34, 5120
    buffer_store_dwordx4 v[212:215], v38, s[28:31], s34 offen sc1
    v_mfma_f32_32x32x16_bf16 a[240:255], v[84:87], v[100:103], a[240:255]
    s_waitcnt lgkmcnt(9)
    v_mfma_f32_32x32x16_bf16 a[0:15], v[40:43], v[56:59], a[0:15]
    ds_read_b128 v[72:75], v18 offset:0
    s_waitcnt lgkmcnt(9)
    v_mfma_f32_32x32x16_bf16 a[16:31], v[44:47], v[56:59], a[16:31]
    ds_read_b64_tr_b16 v[88:89], v25 offset:8192
    s_waitcnt lgkmcnt(9)
    v_mfma_f32_32x32x16_bf16 a[32:47], v[48:51], v[56:59], a[32:47]
    ds_read_b64_tr_b16 v[90:91], v25 offset:10240
    s_add_u32 m0, s32, 131072
    s_mov_b32 s33, 1024
    buffer_load_dwordx4 v1, s[8:11], s33 offen lds
    s_waitcnt lgkmcnt(9)
    v_mfma_f32_32x32x16_bf16 a[48:63], v[52:55], v[56:59], a[48:63]
    ds_read_b128 v[76:79], v18 offset:4096
    s_waitcnt lgkmcnt(8)
    v_mfma_f32_32x32x16_bf16 a[64:79], v[40:43], v[60:63], a[64:79]
    ds_read_b128 v[80:83], v18 offset:8192
    v_mfma_f32_32x32x16_bf16 a[80:95], v[44:47], v[60:63], a[80:95]
    ds_read_b128 v[84:87], v18 offset:12288
    v_mfma_f32_32x32x16_bf16 a[96:111], v[48:51], v[60:63], a[96:111]
    ds_read_b64_tr_b16 v[92:93], v26 offset:8192
    buffer_load_dwordx4 v2, s[8:11], s33 offen offset:1024 lds
    v_mfma_f32_32x32x16_bf16 a[112:127], v[52:55], v[60:63], a[112:127]
    ds_read_b64_tr_b16 v[94:95], v26 offset:10240
    s_waitcnt lgkmcnt(10)
    v_mfma_f32_32x32x16_bf16 a[128:143], v[40:43], v[64:67], a[128:143]
    ds_read_b64_tr_b16 v[96:97], v27 offset:8192
    v_mfma_f32_32x32x16_bf16 a[144:159], v[44:47], v[64:67], a[144:159]
    ds_read_b64_tr_b16 v[98:99], v27 offset:10240
    v_mfma_f32_32x32x16_bf16 a[160:175], v[48:51], v[64:67], a[160:175]
    ds_read_b64_tr_b16 v[100:101], v28 offset:8192
    buffer_load_dwordx4 v3, s[8:11], s33 offen offset:2048 lds
    v_mfma_f32_32x32x16_bf16 a[176:191], v[52:55], v[64:67], a[176:191]
    ds_read_b64_tr_b16 v[102:103], v28 offset:10240
    s_waitcnt lgkmcnt(12)
    v_mfma_f32_32x32x16_bf16 a[192:207], v[40:43], v[68:71], a[192:207]
    v_mfma_f32_32x32x16_bf16 a[208:223], v[44:47], v[68:71], a[208:223]
    v_mfma_f32_32x32x16_bf16 a[224:239], v[48:51], v[68:71], a[224:239]
    buffer_load_dwordx4 v4, s[8:11], s33 offen offset:3072 lds
    v_mfma_f32_32x32x16_bf16 a[240:255], v[52:55], v[68:71], a[240:255]
    s_waitcnt vmcnt(22) lgkmcnt(0)
    s_barrier
    v_mfma_f32_32x32x16_bf16 a[0:15], v[72:75], v[88:91], a[0:15]
    ds_read_b128 v[40:43], v19 offset:0
    v_mfma_f32_32x32x16_bf16 a[16:31], v[76:79], v[88:91], a[16:31]
    ds_read_b64_tr_b16 v[56:57], v25 offset:16384
    v_mfma_f32_32x32x16_bf16 a[32:47], v[80:83], v[88:91], a[32:47]
    ds_read_b64_tr_b16 v[58:59], v25 offset:18432
    s_add_u32 m0, s32, 147456
    s_mov_b32 s33, 263168
    buffer_load_dwordx4 v1, s[8:11], s33 offen lds
    v_mfma_f32_32x32x16_bf16 a[48:63], v[84:87], v[88:91], a[48:63]
    ds_read_b128 v[44:47], v19 offset:4096
    v_mfma_f32_32x32x16_bf16 a[64:79], v[72:75], v[92:95], a[64:79]
    ds_read_b128 v[48:51], v19 offset:8192
    v_mfma_f32_32x32x16_bf16 a[80:95], v[76:79], v[92:95], a[80:95]
    ds_read_b128 v[52:55], v19 offset:12288
    v_mfma_f32_32x32x16_bf16 a[96:111], v[80:83], v[92:95], a[96:111]
    ds_read_b64_tr_b16 v[60:61], v26 offset:16384
    buffer_load_dwordx4 v2, s[8:11], s33 offen offset:1024 lds
    v_mfma_f32_32x32x16_bf16 a[112:127], v[84:87], v[92:95], a[112:127]
    ds_read_b64_tr_b16 v[62:63], v26 offset:18432
    v_mfma_f32_32x32x16_bf16 a[128:143], v[72:75], v[96:99], a[128:143]
    ds_read_b64_tr_b16 v[64:65], v27 offset:16384
    v_mfma_f32_32x32x16_bf16 a[144:159], v[76:79], v[96:99], a[144:159]
    ds_read_b64_tr_b16 v[66:67], v27 offset:18432
    v_mfma_f32_32x32x16_bf16 a[160:175], v[80:83], v[96:99], a[160:175]
    ds_read_b64_tr_b16 v[68:69], v28 offset:16384
    buffer_load_dwordx4 v3, s[8:11], s33 offen offset:2048 lds
    v_mfma_f32_32x32x16_bf16 a[176:191], v[84:87], v[96:99], a[176:191]
    ds_read_b64_tr_b16 v[70:71], v28 offset:18432
    v_mfma_f32_32x32x16_bf16 a[192:207], v[72:75], v[100:103], a[192:207]
    v_mfma_f32_32x32x16_bf16 a[208:223], v[76:79], v[100:103], a[208:223]
    v_mfma_f32_32x32x16_bf16 a[224:239], v[80:83], v[100:103], a[224:239]
    buffer_load_dwordx4 v4, s[8:11], s33 offen offset:3072 lds
    v_mfma_f32_32x32x16_bf16 a[240:255], v[84:87], v[100:103], a[240:255]
    s_waitcnt lgkmcnt(9)
    v_mfma_f32_32x32x16_bf16 a[0:15], v[40:43], v[56:59], a[0:15]
    ds_read_b128 v[72:75], v20 offset:0
    s_waitcnt lgkmcnt(9)
    v_mfma_f32_32x32x16_bf16 a[16:31], v[44:47], v[56:59], a[16:31]
    ds_read_b64_tr_b16 v[88:89], v25 offset:24576
    s_waitcnt lgkmcnt(9)
    v_mfma_f32_32x32x16_bf16 a[32:47], v[48:51], v[56:59], a[32:47]
    ds_read_b64_tr_b16 v[90:91], v25 offset:26624
    s_add_u32 m0, s32, 0
    s_mov_b32 s33, 4194304
    buffer_load_dwordx4 v5, s[12:15], s33 offen lds
    s_waitcnt lgkmcnt(9)
    v_mfma_f32_32x32x16_bf16 a[48:63], v[52:55], v[56:59], a[48:63]
    ds_read_b128 v[76:79], v20 offset:4096
    s_waitcnt lgkmcnt(8)
    v_mfma_f32_32x32x16_bf16 a[64:79], v[40:43], v[60:63], a[64:79]
    ds_read_b128 v[80:83], v20 offset:8192
    v_mfma_f32_32x32x16_bf16 a[80:95], v[44:47], v[60:63], a[80:95]
    ds_read_b128 v[84:87], v20 offset:12288
    v_mfma_f32_32x32x16_bf16 a[96:111], v[48:51], v[60:63], a[96:111]
    ds_read_b64_tr_b16 v[92:93], v26 offset:24576
    buffer_load_dwordx4 v6, s[12:15], s33 offen offset:1024 lds
    v_mfma_f32_32x32x16_bf16 a[112:127], v[52:55], v[60:63], a[112:127]
    ds_read_b64_tr_b16 v[94:95], v26 offset:26624
    s_waitcnt lgkmcnt(10)
    v_mfma_f32_32x32x16_bf16 a[128:143], v[40:43], v[64:67], a[128:143]
    ds_read_b64_tr_b16 v[96:97], v27 offset:24576
    v_mfma_f32_32x32x16_bf16 a[144:159], v[44:47], v[64:67], a[144:159]
    ds_read_b64_tr_b16 v[98:99], v27 offset:26624
    v_mfma_f32_32x32x16_bf16 a[160:175], v[48:51], v[64:67], a[160:175]
    ds_read_b64_tr_b16 v[100:101], v28 offset:24576
    buffer_load_dwordx4 v7, s[12:15], s33 offen offset:2048 lds
    v_mfma_f32_32x32x16_bf16 a[176:191], v[52:55], v[64:67], a[176:191]
    ds_read_b64_tr_b16 v[102:103], v28 offset:26624
    s_waitcnt lgkmcnt(12)
    v_mfma_f32_32x32x16_bf16 a[192:207], v[40:43], v[68:71], a[192:207]
    v_mfma_f32_32x32x16_bf16 a[208:223], v[44:47], v[68:71], a[208:223]
    v_mfma_f32_32x32x16_bf16 a[224:239], v[48:51], v[68:71], a[224:239]
    buffer_load_dwordx4 v8, s[12:15], s33 offen offset:3072 lds
    s_mov_b32 s34, 6144
    buffer_store_dwordx4 v[216:219], v38, s[28:31], s34 offen sc1
    v_mfma_f32_32x32x16_bf16 a[240:255], v[52:55], v[68:71], a[240:255]
    s_waitcnt vmcnt(18) lgkmcnt(0)
    s_barrier
    v_mfma_f32_32x32x16_bf16 a[0:15], v[72:75], v[88:91], a[0:15]
    ds_read_b128 v[40:43], v17 offset:32768
    v_mfma_f32_32x32x16_bf16 a[16:31], v[76:79], v[88:91], a[16:31]
    ds_read_b64_tr_b16 v[56:57], v25 offset:32768
    v_mfma_f32_32x32x16_bf16 a[32:47], v[80:83], v[88:91], a[32:47]
    ds_read_b64_tr_b16 v[58:59], v25 offset:34816
    s_add_u32 m0, s32, 16384
    s_mov_b32 s33, 4456448
    buffer_load_dwordx4 v5, s[12:15], s33 offen lds
    v_mfma_f32_32x32x16_bf16 a[48:63], v[84:87], v[88:91], a[48:63]
    ds_read_b128 v[44:47], v17 offset:36864
    v_mfma_f32_32x32x16_bf16 a[64:79], v[72:75], v[92:95], a[64:79]
    ds_read_b128 v[48:51], v17 offset:40960
    v_mfma_f32_32x32x16_bf16 a[80:95], v[76:79], v[92:95], a[80:95]
    ds_read_b128 v[52:55], v17 offset:45056
    v_mfma_f32_32x32x16_bf16 a[96:111], v[80:83], v[92:95], a[96:111]
    ds_read_b64_tr_b16 v[60:61], v26 offset:32768
    buffer_load_dwordx4 v6, s[12:15], s33 offen offset:1024 lds
    v_mfma_f32_32x32x16_bf16 a[112:127], v[84:87], v[92:95], a[112:127]
    ds_read_b64_tr_b16 v[62:63], v26 offset:34816
    v_mfma_f32_32x32x16_bf16 a[128:143], v[72:75], v[96:99], a[128:143]
    ds_read_b64_tr_b16 v[64:65], v27 offset:32768
    v_mfma_f32_32x32x16_bf16 a[144:159], v[76:79], v[96:99], a[144:159]
    ds_read_b64_tr_b16 v[66:67], v27 offset:34816
    v_mfma_f32_32x32x16_bf16 a[160:175], v[80:83], v[96:99], a[160:175]
    ds_read_b64_tr_b16 v[68:69], v28 offset:32768
    buffer_load_dwordx4 v7, s[12:15], s33 offen offset:2048 lds
    v_mfma_f32_32x32x16_bf16 a[176:191], v[84:87], v[96:99], a[176:191]
    ds_read_b64_tr_b16 v[70:71], v28 offset:34816
    v_mfma_f32_32x32x16_bf16 a[192:207], v[72:75], v[100:103], a[192:207]
    v_mfma_f32_32x32x16_bf16 a[208:223], v[76:79], v[100:103], a[208:223]
    v_mfma_f32_32x32x16_bf16 a[224:239], v[80:83], v[100:103], a[224:239]
    buffer_load_dwordx4 v8, s[12:15], s33 offen offset:3072 lds
    v_mfma_f32_32x32x16_bf16 a[240:255], v[84:87], v[100:103], a[240:255]
    s_waitcnt lgkmcnt(9)
    v_mfma_f32_32x32x16_bf16 a[0:15], v[40:43], v[56:59], a[0:15]
    ds_read_b128 v[72:75], v18 offset:32768
    s_waitcnt lgkmcnt(9)
    v_mfma_f32_32x32x16_bf16 a[16:31], v[44:47], v[56:59], a[16:31]
    ds_read_b64_tr_b16 v[88:89], v25 offset:40960
    s_waitcnt lgkmcnt(9)
    v_mfma_f32_32x32x16_bf16 a[32:47], v[48:51], v[56:59], a[32:47]
    ds_read_b64_tr_b16 v[90:91], v25 offset:43008
    s_add_u32 m0, s32, 65536
    s_mov_b32 s33, 1152
    buffer_load_dwordx4 v1, s[8:11], s33 offen lds
    s_waitcnt lgkmcnt(9)
    v_mfma_f32_32x32x16_bf16 a[48:63], v[52:55], v[56:59], a[48:63]
    ds_read_b128 v[76:79], v18 offset:36864
    s_waitcnt lgkmcnt(8)
    v_mfma_f32_32x32x16_bf16 a[64:79], v[40:43], v[60:63], a[64:79]
    ds_read_b128 v[80:83], v18 offset:40960
    v_mfma_f32_32x32x16_bf16 a[80:95], v[44:47], v[60:63], a[80:95]
    ds_read_b128 v[84:87], v18 offset:45056
    v_mfma_f32_32x32x16_bf16 a[96:111], v[48:51], v[60:63], a[96:111]
    ds_read_b64_tr_b16 v[92:93], v26 offset:40960
    buffer_load_dwordx4 v2, s[8:11], s33 offen offset:1024 lds
    v_mfma_f32_32x32x16_bf16 a[112:127], v[52:55], v[60:63], a[112:127]
    ds_read_b64_tr_b16 v[94:95], v26 offset:43008
    s_waitcnt lgkmcnt(10)
    v_mfma_f32_32x32x16_bf16 a[128:143], v[40:43], v[64:67], a[128:143]
    ds_read_b64_tr_b16 v[96:97], v27 offset:40960
    v_mfma_f32_32x32x16_bf16 a[144:159], v[44:47], v[64:67], a[144:159]
    ds_read_b64_tr_b16 v[98:99], v27 offset:43008
    v_mfma_f32_32x32x16_bf16 a[160:175], v[48:51], v[64:67], a[160:175]
    ds_read_b64_tr_b16 v[100:101], v28 offset:40960
    buffer_load_dwordx4 v3, s[8:11], s33 offen offset:2048 lds
    v_mfma_f32_32x32x16_bf16 a[176:191], v[52:55], v[64:67], a[176:191]
    ds_read_b64_tr_b16 v[102:103], v28 offset:43008
    s_waitcnt lgkmcnt(12)
    v_mfma_f32_32x32x16_bf16 a[192:207], v[40:43], v[68:71], a[192:207]
    v_mfma_f32_32x32x16_bf16 a[208:223], v[44:47], v[68:71], a[208:223]
    v_mfma_f32_32x32x16_bf16 a[224:239], v[48:51], v[68:71], a[224:239]
    buffer_load_dwordx4 v4, s[8:11], s33 offen offset:3072 lds
    v_mfma_f32_32x32x16_bf16 a[240:255], v[52:55], v[68:71], a[240:255]
    s_waitcnt vmcnt(22) lgkmcnt(0)
    s_barrier
    v_mfma_f32_32x32x16_bf16 a[0:15], v[72:75], v[88:91], a[0:15]
    ds_read_b128 v[40:43], v19 offset:32768
    v_mfma_f32_32x32x16_bf16 a[16:31], v[76:79], v[88:91], a[16:31]
    ds_read_b64_tr_b16 v[56:57], v25 offset:49152
    v_mfma_f32_32x32x16_bf16 a[32:47], v[80:83], v[88:91], a[32:47]
    ds_read_b64_tr_b16 v[58:59], v25 offset:51200
    s_add_u32 m0, s32, 81920
    s_mov_b32 s33, 263296
    buffer_load_dwordx4 v1, s[8:11], s33 offen lds
    v_mfma_f32_32x32x16_bf16 a[48:63], v[84:87], v[88:91], a[48:63]
    ds_read_b128 v[44:47], v19 offset:36864
    v_mfma_f32_32x32x16_bf16 a[64:79], v[72:75], v[92:95], a[64:79]
    ds_read_b128 v[48:51], v19 offset:40960
    v_mfma_f32_32x32x16_bf16 a[80:95], v[76:79], v[92:95], a[80:95]
    ds_read_b128 v[52:55], v19 offset:45056
    v_mfma_f32_32x32x16_bf16 a[96:111], v[80:83], v[92:95], a[96:111]
    ds_read_b64_tr_b16 v[60:61], v26 offset:49152
    buffer_load_dwordx4 v2, s[8:11], s33 offen offset:1024 lds
    v_mfma_f32_32x32x16_bf16 a[112:127], v[84:87], v[92:95], a[112:127]
    ds_read_b64_tr_b16 v[62:63], v26 offset:51200
    v_mfma_f32_32x32x16_bf16 a[128:143], v[72:75], v[96:99], a[128:143]
    ds_read_b64_tr_b16 v[64:65], v27 offset:49152
    v_mfma_f32_32x32x16_bf16 a[144:159], v[76:79], v[96:99], a[144:159]
    ds_read_b64_tr_b16 v[66:67], v27 offset:51200
    v_mfma_f32_32x32x16_bf16 a[160:175], v[80:83], v[96:99], a[160:175]
    ds_read_b64_tr_b16 v[68:69], v28 offset:49152
    buffer_load_dwordx4 v3, s[8:11], s33 offen offset:2048 lds
    v_mfma_f32_32x32x16_bf16 a[176:191], v[84:87], v[96:99], a[176:191]
    ds_read_b64_tr_b16 v[70:71], v28 offset:51200
    v_mfma_f32_32x32x16_bf16 a[192:207], v[72:75], v[100:103], a[192:207]
    v_mfma_f32_32x32x16_bf16 a[208:223], v[76:79], v[100:103], a[208:223]
    v_mfma_f32_32x32x16_bf16 a[224:239], v[80:83], v[100:103], a[224:239]
    buffer_load_dwordx4 v4, s[8:11], s33 offen offset:3072 lds
    s_mov_b32 s34, 7168
    buffer_store_dwordx4 v[220:223], v38, s[28:31], s34 offen sc1
    v_mfma_f32_32x32x16_bf16 a[240:255], v[84:87], v[100:103], a[240:255]
    s_waitcnt lgkmcnt(9)
    v_mfma_f32_32x32x16_bf16 a[0:15], v[40:43], v[56:59], a[0:15]
    ds_read_b128 v[72:75], v20 offset:32768
    s_waitcnt lgkmcnt(9)
    v_mfma_f32_32x32x16_bf16 a[16:31], v[44:47], v[56:59], a[16:31]
    ds_read_b64_tr_b16 v[88:89], v25 offset:57344
    s_waitcnt lgkmcnt(9)
    v_mfma_f32_32x32x16_bf16 a[32:47], v[48:51], v[56:59], a[32:47]
    ds_read_b64_tr_b16 v[90:91], v25 offset:59392
    s_add_u32 m0, s32, 32768
    s_mov_b32 s33, 4718592
    buffer_load_dwordx4 v5, s[12:15], s33 offen lds
    s_waitcnt lgkmcnt(9)
    v_mfma_f32_32x32x16_bf16 a[48:63], v[52:55], v[56:59], a[48:63]
    ds_read_b128 v[76:79], v20 offset:36864
    s_waitcnt lgkmcnt(8)
    v_mfma_f32_32x32x16_bf16 a[64:79], v[40:43], v[60:63], a[64:79]
    ds_read_b128 v[80:83], v20 offset:40960
    v_mfma_f32_32x32x16_bf16 a[80:95], v[44:47], v[60:63], a[80:95]
    ds_read_b128 v[84:87], v20 offset:45056
    v_mfma_f32_32x32x16_bf16 a[96:111], v[48:51], v[60:63], a[96:111]
    ds_read_b64_tr_b16 v[92:93], v26 offset:57344
    buffer_load_dwordx4 v6, s[12:15], s33 offen offset:1024 lds
    v_mfma_f32_32x32x16_bf16 a[112:127], v[52:55], v[60:63], a[112:127]
    ds_read_b64_tr_b16 v[94:95], v26 offset:59392
    s_waitcnt lgkmcnt(10)
    v_mfma_f32_32x32x16_bf16 a[128:143], v[40:43], v[64:67], a[128:143]
    ds_read_b64_tr_b16 v[96:97], v27 offset:57344
    v_mfma_f32_32x32x16_bf16 a[144:159], v[44:47], v[64:67], a[144:159]
    ds_read_b64_tr_b16 v[98:99], v27 offset:59392
    v_mfma_f32_32x32x16_bf16 a[160:175], v[48:51], v[64:67], a[160:175]
    ds_read_b64_tr_b16 v[100:101], v28 offset:57344
    buffer_load_dwordx4 v7, s[12:15], s33 offen offset:2048 lds
    v_mfma_f32_32x32x16_bf16 a[176:191], v[52:55], v[64:67], a[176:191]
    ds_read_b64_tr_b16 v[102:103], v28 offset:59392
    s_waitcnt lgkmcnt(12)
    v_mfma_f32_32x32x16_bf16 a[192:207], v[40:43], v[68:71], a[192:207]
    v_mfma_f32_32x32x16_bf16 a[208:223], v[44:47], v[68:71], a[208:223]
    v_mfma_f32_32x32x16_bf16 a[224:239], v[48:51], v[68:71], a[224:239]
    buffer_load_dwordx4 v8, s[12:15], s33 offen offset:3072 lds
    v_mfma_f32_32x32x16_bf16 a[240:255], v[52:55], v[68:71], a[240:255]
    s_waitcnt vmcnt(18) lgkmcnt(0)
    s_barrier
    v_mfma_f32_32x32x16_bf16 a[0:15], v[72:75], v[88:91], a[0:15]
    ds_read_b128 v[40:43], v21 offset:0
    v_mfma_f32_32x32x16_bf16 a[16:31], v[76:79], v[88:91], a[16:31]
    ds_read_b64_tr_b16 v[56:57], v25 offset:0
    v_mfma_f32_32x32x16_bf16 a[32:47], v[80:83], v[88:91], a[32:47]
    ds_read_b64_tr_b16 v[58:59], v25 offset:2048
    s_add_u32 m0, s32, 49152
    s_mov_b32 s33, 4980736
    buffer_load_dwordx4 v5, s[12:15], s33 offen lds
    v_mfma_f32_32x32x16_bf16 a[48:63], v[84:87], v[88:91], a[48:63]
    ds_read_b128 v[44:47], v21 offset:4096
    v_mfma_f32_32x32x16_bf16 a[64:79], v[72:75], v[92:95], a[64:79]
    ds_read_b128 v[48:51], v21 offset:8192
    v_mfma_f32_32x32x16_bf16 a[80:95], v[76:79], v[92:95], a[80:95]
    ds_read_b128 v[52:55], v21 offset:12288
    v_mfma_f32_32x32x16_bf16 a[96:111], v[80:83], v[92:95], a[96:111]
    ds_read_b64_tr_b16 v[60:61], v26 offset:0
    buffer_load_dwordx4 v6, s[12:15], s33 offen offset:1024 lds
    v_mfma_f32_32x32x16_bf16 a[112:127], v[84:87], v[92:95], a[112:127]
    ds_read_b64_tr_b16 v[62:63], v26 offset:2048
    v_mfma_f32_32x32x16_bf16 a[128:143], v[72:75], v[96:99], a[128:143]
    ds_read_b64_tr_b16 v[64:65], v27 offset:0
    v_mfma_f32_32x32x16_bf16 a[144:159], v[76:79], v[96:99], a[144:159]
    ds_read_b64_tr_b16 v[66:67], v27 offset:2048
    v_mfma_f32_32x32x16_bf16 a[160:175], v[80:83], v[96:99], a[160:175]
    ds_read_b64_tr_b16 v[68:69], v28 offset:0
    buffer_load_dwordx4 v7, s[12:15], s33 offen offset:2048 lds
    v_mfma_f32_32x32x16_bf16 a[176:191], v[84:87], v[96:99], a[176:191]
    ds_read_b64_tr_b16 v[70:71], v28 offset:2048
    v_mfma_f32_32x32x16_bf16 a[192:207], v[72:75], v[100:103], a[192:207]
    v_mfma_f32_32x32x16_bf16 a[208:223], v[76:79], v[100:103], a[208:223]
    v_mfma_f32_32x32x16_bf16 a[224:239], v[80:83], v[100:103], a[224:239]
    buffer_load_dwordx4 v8, s[12:15], s33 offen offset:3072 lds
    v_mfma_f32_32x32x16_bf16 a[240:255], v[84:87], v[100:103], a[240:255]
    s_waitcnt lgkmcnt(9)
    v_mfma_f32_32x32x16_bf16 a[0:15], v[40:43], v[56:59], a[0:15]
    ds_read_b128 v[72:75], v22 offset:0
    s_waitcnt lgkmcnt(9)
    v_mfma_f32_32x32x16_bf16 a[16:31], v[44:47], v[56:59], a[16:31]
    ds_read_b64_tr_b16 v[88:89], v25 offset:8192
    s_waitcnt lgkmcnt(9)
    v_mfma_f32_32x32x16_bf16 a[32:47], v[48:51], v[56:59], a[32:47]
    ds_read_b64_tr_b16 v[90:91], v25 offset:10240
    s_add_u32 m0, s32, 98304
    s_mov_b32 s33, 1280
    buffer_load_dwordx4 v1, s[8:11], s33 offen lds
    s_waitcnt lgkmcnt(9)
    v_mfma_f32_32x32x16_bf16 a[48:63], v[52:55], v[56:59], a[48:63]
    ds_read_b128 v[76:79], v22 offset:4096
    s_waitcnt lgkmcnt(8)
    v_mfma_f32_32x32x16_bf16 a[64:79], v[40:43], v[60:63], a[64:79]
    ds_read_b128 v[80:83], v22 offset:8192
    v_mfma_f32_32x32x16_bf16 a[80:95], v[44:47], v[60:63], a[80:95]
    ds_read_b128 v[84:87], v22 offset:12288
    v_mfma_f32_32x32x16_bf16 a[96:111], v[48:51], v[60:63], a[96:111]
    ds_read_b64_tr_b16 v[92:93], v26 offset:8192
    buffer_load_dwordx4 v2, s[8:11], s33 offen offset:1024 lds
    v_mfma_f32_32x32x16_bf16 a[112:127], v[52:55], v[60:63], a[112:127]
    ds_read_b64_tr_b16 v[94:95], v26 offset:10240
    s_waitcnt lgkmcnt(10)
    v_mfma_f32_32x32x16_bf16 a[128:143], v[40:43], v[64:67], a[128:143]
    ds_read_b64_tr_b16 v[96:97], v27 offset:8192
    v_mfma_f32_32x32x16_bf16 a[144:159], v[44:47], v[64:67], a[144:159]
    ds_read_b64_tr_b16 v[98:99], v27 offset:10240
    v_mfma_f32_32x32x16_bf16 a[160:175], v[48:51], v[64:67], a[160:175]
    ds_read_b64_tr_b16 v[100:101], v28 offset:8192
    buffer_load_dwordx4 v3, s[8:11], s33 offen offset:2048 lds
    v_mfma_f32_32x32x16_bf16 a[176:191], v[52:55], v[64:67], a[176:191]
    ds_read_b64_tr_b16 v[102:103], v28 offset:10240
    s_waitcnt lgkmcnt(12)
    v_mfma_f32_32x32x16_bf16 a[192:207], v[40:43], v[68:71], a[192:207]
    v_mfma_f32_32x32x16_bf16 a[208:223], v[44:47], v[68:71], a[208:223]
    v_mfma_f32_32x32x16_bf16 a[224:239], v[48:51], v[68:71], a[224:239]
    buffer_load_dwordx4 v4, s[8:11], s33 offen offset:3072 lds
    s_mov_b32 s34, 8192
    buffer_store_dwordx4 v[224:227], v38, s[28:31], s34 offen sc1
    v_mfma_f32_32x32x16_bf16 a[240:255], v[52:55], v[68:71], a[240:255]
    s_waitcnt vmcnt(22) lgkmcnt(0)
    s_barrier
    v_mfma_f32_32x32x16_bf16 a[0:15], v[72:75], v[88:91], a[0:15]
    ds_read_b128 v[40:43], v23 offset:0
    v_mfma_f32_32x32x16_bf16 a[16:31], v[76:79], v[88:91], a[16:31]
    ds_read_b64_tr_b16 v[56:57], v25 offset:16384
    v_mfma_f32_32x32x16_bf16 a[32:47], v[80:83], v[88:91], a[32:47]
    ds_read_b64_tr_b16 v[58:59], v25 offset:18432
    s_add_u32 m0, s32, 114688
    s_mov_b32 s33, 263424
    buffer_load_dwordx4 v1, s[8:11], s33 offen lds
    v_mfma_f32_32x32x16_bf16 a[48:63], v[84:87], v[88:91], a[48:63]
    ds_read_b128 v[44:47], v23 offset:4096
    v_mfma_f32_32x32x16_bf16 a[64:79], v[72:75], v[92:95], a[64:79]
    ds_read_b128 v[48:51], v23 offset:8192
    v_mfma_f32_32x32x16_bf16 a[80:95], v[76:79], v[92:95], a[80:95]
    ds_read_b128 v[52:55], v23 offset:12288
    v_mfma_f32_32x32x16_bf16 a[96:111], v[80:83], v[92:95], a[96:111]
    ds_read_b64_tr_b16 v[60:61], v26 offset:16384
    buffer_load_dwordx4 v2, s[8:11], s33 offen offset:1024 lds
    v_mfma_f32_32x32x16_bf16 a[112:127], v[84:87], v[92:95], a[112:127]
    ds_read_b64_tr_b16 v[62:63], v26 offset:18432
    v_mfma_f32_32x32x16_bf16 a[128:143], v[72:75], v[96:99], a[128:143]
    ds_read_b64_tr_b16 v[64:65], v27 offset:16384
    v_mfma_f32_32x32x16_bf16 a[144:159], v[76:79], v[96:99], a[144:159]
    ds_read_b64_tr_b16 v[66:67], v27 offset:18432
    v_mfma_f32_32x32x16_bf16 a[160:175], v[80:83], v[96:99], a[160:175]
    ds_read_b64_tr_b16 v[68:69], v28 offset:16384
    buffer_load_dwordx4 v3, s[8:11], s33 offen offset:2048 lds
    v_mfma_f32_32x32x16_bf16 a[176:191], v[84:87], v[96:99], a[176:191]
    ds_read_b64_tr_b16 v[70:71], v28 offset:18432
    v_mfma_f32_32x32x16_bf16 a[192:207], v[72:75], v[100:103], a[192:207]
    v_mfma_f32_32x32x16_bf16 a[208:223], v[76:79], v[100:103], a[208:223]
    v_mfma_f32_32x32x16_bf16 a[224:239], v[80:83], v[100:103], a[224:239]
    buffer_load_dwordx4 v4, s[8:11], s33 offen offset:3072 lds
    v_mfma_f32_32x32x16_bf16 a[240:255], v[84:87], v[100:103], a[240:255]
    s_waitcnt lgkmcnt(9)
    v_mfma_f32_32x32x16_bf16 a[0:15], v[40:43], v[56:59], a[0:15]
    ds_read_b128 v[72:75], v24 offset:0
    s_waitcnt lgkmcnt(9)
    v_mfma_f32_32x32x16_bf16 a[16:31], v[44:47], v[56:59], a[16:31]
    ds_read_b64_tr_b16 v[88:89], v25 offset:24576
    s_waitcnt lgkmcnt(9)
    v_mfma_f32_32x32x16_bf16 a[32:47], v[48:51], v[56:59], a[32:47]
    ds_read_b64_tr_b16 v[90:91], v25 offset:26624
    s_add_u32 m0, s32, 0
    s_mov_b32 s33, 5242880
    buffer_load_dwordx4 v5, s[12:15], s33 offen lds
    s_waitcnt lgkmcnt(9)
    v_mfma_f32_32x32x16_bf16 a[48:63], v[52:55], v[56:59], a[48:63]
    ds_read_b128 v[76:79], v24 offset:4096
    s_waitcnt lgkmcnt(8)
    v_mfma_f32_32x32x16_bf16 a[64:79], v[40:43], v[60:63], a[64:79]
    ds_read_b128 v[80:83], v24 offset:8192
    v_mfma_f32_32x32x16_bf16 a[80:95], v[44:47], v[60:63], a[80:95]
    ds_read_b128 v[84:87], v24 offset:12288
    v_mfma_f32_32x32x16_bf16 a[96:111], v[48:51], v[60:63], a[96:111]
    ds_read_b64_tr_b16 v[92:93], v26 offset:24576
    buffer_load_dwordx4 v6, s[12:15], s33 offen offset:1024 lds
    v_mfma_f32_32x32x16_bf16 a[112:127], v[52:55], v[60:63], a[112:127]
    ds_read_b64_tr_b16 v[94:95], v26 offset:26624
    s_waitcnt lgkmcnt(10)
    v_mfma_f32_32x32x16_bf16 a[128:143], v[40:43], v[64:67], a[128:143]
    ds_read_b64_tr_b16 v[96:97], v27 offset:24576
    v_mfma_f32_32x32x16_bf16 a[144:159], v[44:47], v[64:67], a[144:159]
    ds_read_b64_tr_b16 v[98:99], v27 offset:26624
    v_mfma_f32_32x32x16_bf16 a[160:175], v[48:51], v[64:67], a[160:175]
    ds_read_b64_tr_b16 v[100:101], v28 offset:24576
    buffer_load_dwordx4 v7, s[12:15], s33 offen offset:2048 lds
    v_mfma_f32_32x32x16_bf16 a[176:191], v[52:55], v[64:67], a[176:191]
    ds_read_b64_tr_b16 v[102:103], v28 offset:26624
    s_waitcnt lgkmcnt(12)
    v_mfma_f32_32x32x16_bf16 a[192:207], v[40:43], v[68:71], a[192:207]
    v_mfma_f32_32x32x16_bf16 a[208:223], v[44:47], v[68:71], a[208:223]
    v_mfma_f32_32x32x16_bf16 a[224:239], v[48:51], v[68:71], a[224:239]
    buffer_load_dwordx4 v8, s[12:15], s33 offen offset:3072 lds
    v_mfma_f32_32x32x16_bf16 a[240:255], v[52:55], v[68:71], a[240:255]
    s_waitcnt vmcnt(17) lgkmcnt(0)
    s_barrier
    v_mfma_f32_32x32x16_bf16 a[0:15], v[72:75], v[88:91], a[0:15]
    ds_read_b128 v[40:43], v17 offset:0
    v_mfma_f32_32x32x16_bf16 a[16:31], v[76:79], v[88:91], a[16:31]
    ds_read_b64_tr_b16 v[56:57], v25 offset:32768
    v_mfma_f32_32x32x16_bf16 a[32:47], v[80:83], v[88:91], a[32:47]
    ds_read_b64_tr_b16 v[58:59], v25 offset:34816
    s_add_u32 m0, s32, 16384
    s_mov_b32 s33, 5505024
    buffer_load_dwordx4 v5, s[12:15], s33 offen lds
    v_mfma_f32_32x32x16_bf16 a[48:63], v[84:87], v[88:91], a[48:63]
    ds_read_b128 v[44:47], v17 offset:4096
    v_mfma_f32_32x32x16_bf16 a[64:79], v[72:75], v[92:95], a[64:79]
    ds_read_b128 v[48:51], v17 offset:8192
    v_mfma_f32_32x32x16_bf16 a[80:95], v[76:79], v[92:95], a[80:95]
    ds_read_b128 v[52:55], v17 offset:12288
    v_mfma_f32_32x32x16_bf16 a[96:111], v[80:83], v[92:95], a[96:111]
    ds_read_b64_tr_b16 v[60:61], v26 offset:32768
    buffer_load_dwordx4 v6, s[12:15], s33 offen offset:1024 lds
    v_mfma_f32_32x32x16_bf16 a[112:127], v[84:87], v[92:95], a[112:127]
    ds_read_b64_tr_b16 v[62:63], v26 offset:34816
    v_mfma_f32_32x32x16_bf16 a[128:143], v[72:75], v[96:99], a[128:143]
    ds_read_b64_tr_b16 v[64:65], v27 offset:32768
    v_mfma_f32_32x32x16_bf16 a[144:159], v[76:79], v[96:99], a[144:159]
    ds_read_b64_tr_b16 v[66:67], v27 offset:34816
    v_mfma_f32_32x32x16_bf16 a[160:175], v[80:83], v[96:99], a[160:175]
    ds_read_b64_tr_b16 v[68:69], v28 offset:32768
    buffer_load_dwordx4 v7, s[12:15], s33 offen offset:2048 lds
    v_mfma_f32_32x32x16_bf16 a[176:191], v[84:87], v[96:99], a[176:191]
    ds_read_b64_tr_b16 v[70:71], v28 offset:34816
    v_mfma_f32_32x32x16_bf16 a[192:207], v[72:75], v[100:103], a[192:207]
    v_mfma_f32_32x32x16_bf16 a[208:223], v[76:79], v[100:103], a[208:223]
    v_mfma_f32_32x32x16_bf16 a[224:239], v[80:83], v[100:103], a[224:239]
    buffer_load_dwordx4 v8, s[12:15], s33 offen offset:3072 lds
    s_mov_b32 s34, 9216
    buffer_store_dwordx4 v[228:231], v38, s[28:31], s34 offen sc1
    v_mfma_f32_32x32x16_bf16 a[240:255], v[84:87], v[100:103], a[240:255]
    s_waitcnt lgkmcnt(9)
    v_mfma_f32_32x32x16_bf16 a[0:15], v[40:43], v[56:59], a[0:15]
    ds_read_b128 v[72:75], v18 offset:0
    s_waitcnt lgkmcnt(9)
    v_mfma_f32_32x32x16_bf16 a[16:31], v[44:47], v[56:59], a[16:31]
    ds_read_b64_tr_b16 v[88:89], v25 offset:40960
    s_waitcnt lgkmcnt(9)
    v_mfma_f32_32x32x16_bf16 a[32:47], v[48:51], v[56:59], a[32:47]
    ds_read_b64_tr_b16 v[90:91], v25 offset:43008
    s_add_u32 m0, s32, 131072
    s_mov_b32 s33, 1408
    buffer_load_dwordx4 v1, s[8:11], s33 offen lds
    s_waitcnt lgkmcnt(9)
    v_mfma_f32_32x32x16_bf16 a[48:63], v[52:55], v[56:59], a[48:63]
    ds_read_b128 v[76:79], v18 offset:4096
    s_waitcnt lgkmcnt(8)
    v_mfma_f32_32x32x16_bf16 a[64:79], v[40:43], v[60:63], a[64:79]
    ds_read_b128 v[80:83], v18 offset:8192
    v_mfma_f32_32x32x16_bf16 a[80:95], v[44:47], v[60:63], a[80:95]
    ds_read_b128 v[84:87], v18 offset:12288
    v_mfma_f32_32x32x16_bf16 a[96:111], v[48:51], v[60:63], a[96:111]
    ds_read_b64_tr_b16 v[92:93], v26 offset:40960
    buffer_load_dwordx4 v2, s[8:11], s33 offen offset:1024 lds
    v_mfma_f32_32x32x16_bf16 a[112:127], v[52:55], v[60:63], a[112:127]
    ds_read_b64_tr_b16 v[94:95], v26 offset:43008
    s_waitcnt lgkmcnt(10)
    v_mfma_f32_32x32x16_bf16 a[128:143], v[40:43], v[64:67], a[128:143]
    ds_read_b64_tr_b16 v[96:97], v27 offset:40960
    v_mfma_f32_32x32x16_bf16 a[144:159], v[44:47], v[64:67], a[144:159]
    ds_read_b64_tr_b16 v[98:99], v27 offset:43008
    v_mfma_f32_32x32x16_bf16 a[160:175], v[48:51], v[64:67], a[160:175]
    ds_read_b64_tr_b16 v[100:101], v28 offset:40960
    buffer_load_dwordx4 v3, s[8:11], s33 offen offset:2048 lds
    v_mfma_f32_32x32x16_bf16 a[176:191], v[52:55], v[64:67], a[176:191]
    ds_read_b64_tr_b16 v[102:103], v28 offset:43008
    s_waitcnt lgkmcnt(12)
    v_mfma_f32_32x32x16_bf16 a[192:207], v[40:43], v[68:71], a[192:207]
    v_mfma_f32_32x32x16_bf16 a[208:223], v[44:47], v[68:71], a[208:223]
    v_mfma_f32_32x32x16_bf16 a[224:239], v[48:51], v[68:71], a[224:239]
    buffer_load_dwordx4 v4, s[8:11], s33 offen offset:3072 lds
    v_mfma_f32_32x32x16_bf16 a[240:255], v[52:55], v[68:71], a[240:255]
    s_waitcnt vmcnt(22) lgkmcnt(0)
    s_barrier
    v_mfma_f32_32x32x16_bf16 a[0:15], v[72:75], v[88:91], a[0:15]
    ds_read_b128 v[40:43], v19 offset:0
    v_mfma_f32_32x32x16_bf16 a[16:31], v[76:79], v[88:91], a[16:31]
    ds_read_b64_tr_b16 v[56:57], v25 offset:49152
    v_mfma_f32_32x32x16_bf16 a[32:47], v[80:83], v[88:91], a[32:47]
    ds_read_b64_tr_b16 v[58:59], v25 offset:51200
    s_add_u32 m0, s32, 147456
    s_mov_b32 s33, 263552
    buffer_load_dwordx4 v1, s[8:11], s33 offen lds
    v_mfma_f32_32x32x16_bf16 a[48:63], v[84:87], v[88:91], a[48:63]
    ds_read_b128 v[44:47], v19 offset:4096
    v_mfma_f32_32x32x16_bf16 a[64:79], v[72:75], v[92:95], a[64:79]
    ds_read_b128 v[48:51], v19 offset:8192
    v_mfma_f32_32x32x16_bf16 a[80:95], v[76:79], v[92:95], a[80:95]
    ds_read_b128 v[52:55], v19 offset:12288
    v_mfma_f32_32x32x16_bf16 a[96:111], v[80:83], v[92:95], a[96:111]
    ds_read_b64_tr_b16 v[60:61], v26 offset:49152
    buffer_load_dwordx4 v2, s[8:11], s33 offen offset:1024 lds
    v_mfma_f32_32x32x16_bf16 a[112:127], v[84:87], v[92:95], a[112:127]
    ds_read_b64_tr_b16 v[62:63], v26 offset:51200
    v_mfma_f32_32x32x16_bf16 a[128:143], v[72:75], v[96:99], a[128:143]
    ds_read_b64_tr_b16 v[64:65], v27 offset:49152
    v_mfma_f32_32x32x16_bf16 a[144:159], v[76:79], v[96:99], a[144:159]
    ds_read_b64_tr_b16 v[66:67], v27 offset:51200
    v_mfma_f32_32x32x16_bf16 a[160:175], v[80:83], v[96:99], a[160:175]
    ds_read_b64_tr_b16 v[68:69], v28 offset:49152
    buffer_load_dwordx4 v3, s[8:11], s33 offen offset:2048 lds
    v_mfma_f32_32x32x16_bf16 a[176:191], v[84:87], v[96:99], a[176:191]
    ds_read_b64_tr_b16 v[70:71], v28 offset:51200
    v_mfma_f32_32x32x16_bf16 a[192:207], v[72:75], v[100:103], a[192:207]
    v_mfma_f32_32x32x16_bf16 a[208:223], v[76:79], v[100:103], a[208:223]
    v_mfma_f32_32x32x16_bf16 a[224:239], v[80:83], v[100:103], a[224:239]
    buffer_load_dwordx4 v4, s[8:11], s33 offen offset:3072 lds
    v_mfma_f32_32x32x16_bf16 a[240:255], v[84:87], v[100:103], a[240:255]
    s_waitcnt lgkmcnt(9)
    v_mfma_f32_32x32x16_bf16 a[0:15], v[40:43], v[56:59], a[0:15]
    ds_read_b128 v[72:75], v20 offset:0
    s_waitcnt lgkmcnt(9)
    v_mfma_f32_32x32x16_bf16 a[16:31], v[44:47], v[56:59], a[16:31]
    ds_read_b64_tr_b16 v[88:89], v25 offset:57344
    s_waitcnt lgkmcnt(9)
    v_mfma_f32_32x32x16_bf16 a[32:47], v[48:51], v[56:59], a[32:47]
    ds_read_b64_tr_b16 v[90:91], v25 offset:59392
    s_add_u32 m0, s32, 32768
    s_mov_b32 s33, 5767168
    buffer_load_dwordx4 v5, s[12:15], s33 offen lds
    s_waitcnt lgkmcnt(9)
    v_mfma_f32_32x32x16_bf16 a[48:63], v[52:55], v[56:59], a[48:63]
    ds_read_b128 v[76:79], v20 offset:4096
    s_waitcnt lgkmcnt(8)
    v_mfma_f32_32x32x16_bf16 a[64:79], v[40:43], v[60:63], a[64:79]
    ds_read_b128 v[80:83], v20 offset:8192
    v_mfma_f32_32x32x16_bf16 a[80:95], v[44:47], v[60:63], a[80:95]
    ds_read_b128 v[84:87], v20 offset:12288
    v_mfma_f32_32x32x16_bf16 a[96:111], v[48:51], v[60:63], a[96:111]
    ds_read_b64_tr_b16 v[92:93], v26 offset:57344
    buffer_load_dwordx4 v6, s[12:15], s33 offen offset:1024 lds
    v_mfma_f32_32x32x16_bf16 a[112:127], v[52:55], v[60:63], a[112:127]
    ds_read_b64_tr_b16 v[94:95], v26 offset:59392
    s_waitcnt lgkmcnt(10)
    v_mfma_f32_32x32x16_bf16 a[128:143], v[40:43], v[64:67], a[128:143]
    ds_read_b64_tr_b16 v[96:97], v27 offset:57344
    v_mfma_f32_32x32x16_bf16 a[144:159], v[44:47], v[64:67], a[144:159]
    ds_read_b64_tr_b16 v[98:99], v27 offset:59392
    v_mfma_f32_32x32x16_bf16 a[160:175], v[48:51], v[64:67], a[160:175]
    ds_read_b64_tr_b16 v[100:101], v28 offset:57344
    buffer_load_dwordx4 v7, s[12:15], s33 offen offset:2048 lds
    v_mfma_f32_32x32x16_bf16 a[176:191], v[52:55], v[64:67], a[176:191]
    ds_read_b64_tr_b16 v[102:103], v28 offset:59392
    s_waitcnt lgkmcnt(12)
    v_mfma_f32_32x32x16_bf16 a[192:207], v[40:43], v[68:71], a[192:207]
    v_mfma_f32_32x32x16_bf16 a[208:223], v[44:47], v[68:71], a[208:223]
    v_mfma_f32_32x32x16_bf16 a[224:239], v[48:51], v[68:71], a[224:239]
    buffer_load_dwordx4 v8, s[12:15], s33 offen offset:3072 lds
    s_mov_b32 s34, 10240
    buffer_store_dwordx4 v[232:235], v38, s[28:31], s34 offen sc1
    v_mfma_f32_32x32x16_bf16 a[240:255], v[52:55], v[68:71], a[240:255]
    s_waitcnt vmcnt(18) lgkmcnt(0)
    s_barrier
    v_mfma_f32_32x32x16_bf16 a[0:15], v[72:75], v[88:91], a[0:15]
    ds_read_b128 v[40:43], v17 offset:32768
    v_mfma_f32_32x32x16_bf16 a[16:31], v[76:79], v[88:91], a[16:31]
    ds_read_b64_tr_b16 v[56:57], v25 offset:0
    v_mfma_f32_32x32x16_bf16 a[32:47], v[80:83], v[88:91], a[32:47]
    ds_read_b64_tr_b16 v[58:59], v25 offset:2048
    s_add_u32 m0, s32, 49152
    s_mov_b32 s33, 6029312
    buffer_load_dwordx4 v5, s[12:15], s33 offen lds
    v_mfma_f32_32x32x16_bf16 a[48:63], v[84:87], v[88:91], a[48:63]
    ds_read_b128 v[44:47], v17 offset:36864
    v_mfma_f32_32x32x16_bf16 a[64:79], v[72:75], v[92:95], a[64:79]
    ds_read_b128 v[48:51], v17 offset:40960
    v_mfma_f32_32x32x16_bf16 a[80:95], v[76:79], v[92:95], a[80:95]
    ds_read_b128 v[52:55], v17 offset:45056
    v_mfma_f32_32x32x16_bf16 a[96:111], v[80:83], v[92:95], a[96:111]
    ds_read_b64_tr_b16 v[60:61], v26 offset:0
    buffer_load_dwordx4 v6, s[12:15], s33 offen offset:1024 lds
    v_mfma_f32_32x32x16_bf16 a[112:127], v[84:87], v[92:95], a[112:127]
    ds_read_b64_tr_b16 v[62:63], v26 offset:2048
    v_mfma_f32_32x32x16_bf16 a[128:143], v[72:75], v[96:99], a[128:143]
    ds_read_b64_tr_b16 v[64:65], v27 offset:0
    v_mfma_f32_32x32x16_bf16 a[144:159], v[76:79], v[96:99], a[144:159]
    ds_read_b64_tr_b16 v[66:67], v27 offset:2048
    v_mfma_f32_32x32x16_bf16 a[160:175], v[80:83], v[96:99], a[160:175]
    ds_read_b64_tr_b16 v[68:69], v28 offset:0
    buffer_load_dwordx4 v7, s[12:15], s33 offen offset:2048 lds
    v_mfma_f32_32x32x16_bf16 a[176:191], v[84:87], v[96:99], a[176:191]
    ds_read_b64_tr_b16 v[70:71], v28 offset:2048
    v_mfma_f32_32x32x16_bf16 a[192:207], v[72:75], v[100:103], a[192:207]
    v_mfma_f32_32x32x16_bf16 a[208:223], v[76:79], v[100:103], a[208:223]
    v_mfma_f32_32x32x16_bf16 a[224:239], v[80:83], v[100:103], a[224:239]
    buffer_load_dwordx4 v8, s[12:15], s33 offen offset:3072 lds
    v_mfma_f32_32x32x16_bf16 a[240:255], v[84:87], v[100:103], a[240:255]
    s_waitcnt lgkmcnt(9)
    v_mfma_f32_32x32x16_bf16 a[0:15], v[40:43], v[56:59], a[0:15]
    ds_read_b128 v[72:75], v18 offset:32768
    s_waitcnt lgkmcnt(9)
    v_mfma_f32_32x32x16_bf16 a[16:31], v[44:47], v[56:59], a[16:31]
    ds_read_b64_tr_b16 v[88:89], v25 offset:8192
    s_waitcnt lgkmcnt(9)
    v_mfma_f32_32x32x16_bf16 a[32:47], v[48:51], v[56:59], a[32:47]
    ds_read_b64_tr_b16 v[90:91], v25 offset:10240
    s_add_u32 m0, s32, 65536
    s_mov_b32 s33, 1536
    buffer_load_dwordx4 v1, s[8:11], s33 offen lds
    s_waitcnt lgkmcnt(9)
    v_mfma_f32_32x32x16_bf16 a[48:63], v[52:55], v[56:59], a[48:63]
    ds_read_b128 v[76:79], v18 offset:36864
    s_waitcnt lgkmcnt(8)
    v_mfma_f32_32x32x16_bf16 a[64:79], v[40:43], v[60:63], a[64:79]
    ds_read_b128 v[80:83], v18 offset:40960
    v_mfma_f32_32x32x16_bf16 a[80:95], v[44:47], v[60:63], a[80:95]
    ds_read_b128 v[84:87], v18 offset:45056
    v_mfma_f32_32x32x16_bf16 a[96:111], v[48:51], v[60:63], a[96:111]
    ds_read_b64_tr_b16 v[92:93], v26 offset:8192
    buffer_load_dwordx4 v2, s[8:11], s33 offen offset:1024 lds
    v_mfma_f32_32x32x16_bf16 a[112:127], v[52:55], v[60:63], a[112:127]
    ds_read_b64_tr_b16 v[94:95], v26 offset:10240
    s_waitcnt lgkmcnt(10)
    v_mfma_f32_32x32x16_bf16 a[128:143], v[40:43], v[64:67], a[128:143]
    ds_read_b64_tr_b16 v[96:97], v27 offset:8192
    v_mfma_f32_32x32x16_bf16 a[144:159], v[44:47], v[64:67], a[144:159]
    ds_read_b64_tr_b16 v[98:99], v27 offset:10240
    v_mfma_f32_32x32x16_bf16 a[160:175], v[48:51], v[64:67], a[160:175]
    ds_read_b64_tr_b16 v[100:101], v28 offset:8192
    buffer_load_dwordx4 v3, s[8:11], s33 offen offset:2048 lds
    v_mfma_f32_32x32x16_bf16 a[176:191], v[52:55], v[64:67], a[176:191]
    ds_read_b64_tr_b16 v[102:103], v28 offset:10240
    s_waitcnt lgkmcnt(12)
    v_mfma_f32_32x32x16_bf16 a[192:207], v[40:43], v[68:71], a[192:207]
    v_mfma_f32_32x32x16_bf16 a[208:223], v[44:47], v[68:71], a[208:223]
    v_mfma_f32_32x32x16_bf16 a[224:239], v[48:51], v[68:71], a[224:239]
    buffer_load_dwordx4 v4, s[8:11], s33 offen offset:3072 lds
    v_mfma_f32_32x32x16_bf16 a[240:255], v[52:55], v[68:71], a[240:255]
    s_waitcnt vmcnt(22) lgkmcnt(0)
    s_barrier
    v_mfma_f32_32x32x16_bf16 a[0:15], v[72:75], v[88:91], a[0:15]
    ds_read_b128 v[40:43], v19 offset:32768
    v_mfma_f32_32x32x16_bf16 a[16:31], v[76:79], v[88:91], a[16:31]
    ds_read_b64_tr_b16 v[56:57], v25 offset:16384
    v_mfma_f32_32x32x16_bf16 a[32:47], v[80:83], v[88:91], a[32:47]
    ds_read_b64_tr_b16 v[58:59], v25 offset:18432
    s_add_u32 m0, s32, 81920
    s_mov_b32 s33, 263680
    buffer_load_dwordx4 v1, s[8:11], s33 offen lds
    v_mfma_f32_32x32x16_bf16 a[48:63], v[84:87], v[88:91], a[48:63]
    ds_read_b128 v[44:47], v19 offset:36864
    v_mfma_f32_32x32x16_bf16 a[64:79], v[72:75], v[92:95], a[64:79]
    ds_read_b128 v[48:51], v19 offset:40960
    v_mfma_f32_32x32x16_bf16 a[80:95], v[76:79], v[92:95], a[80:95]
    ds_read_b128 v[52:55], v19 offset:45056
    v_mfma_f32_32x32x16_bf16 a[96:111], v[80:83], v[92:95], a[96:111]
    ds_read_b64_tr_b16 v[60:61], v26 offset:16384
    buffer_load_dwordx4 v2, s[8:11], s33 offen offset:1024 lds
    v_mfma_f32_32x32x16_bf16 a[112:127], v[84:87], v[92:95], a[112:127]
    ds_read_b64_tr_b16 v[62:63], v26 offset:18432
    v_mfma_f32_32x32x16_bf16 a[128:143], v[72:75], v[96:99], a[128:143]
    ds_read_b64_tr_b16 v[64:65], v27 offset:16384
    v_mfma_f32_32x32x16_bf16 a[144:159], v[76:79], v[96:99], a[144:159]
    ds_read_b64_tr_b16 v[66:67], v27 offset:18432
    v_mfma_f32_32x32x16_bf16 a[160:175], v[80:83], v[96:99], a[160:175]
    ds_read_b64_tr_b16 v[68:69], v28 offset:16384
    buffer_load_dwordx4 v3, s[8:11], s33 offen offset:2048 lds
    v_mfma_f32_32x32x16_bf16 a[176:191], v[84:87], v[96:99], a[176:191]
    ds_read_b64_tr_b16 v[70:71], v28 offset:18432
    v_mfma_f32_32x32x16_bf16 a[192:207], v[72:75], v[100:103], a[192:207]
    v_mfma_f32_32x32x16_bf16 a[208:223], v[76:79], v[100:103], a[208:223]
    v_mfma_f32_32x32x16_bf16 a[224:239], v[80:83], v[100:103], a[224:239]
    buffer_load_dwordx4 v4, s[8:11], s33 offen offset:3072 lds
    s_mov_b32 s34, 11264
    buffer_store_dwordx4 v[236:239], v38, s[28:31], s34 offen sc1
    v_mfma_f32_32x32x16_bf16 a[240:255], v[84:87], v[100:103], a[240:255]
    s_waitcnt lgkmcnt(9)
    v_mfma_f32_32x32x16_bf16 a[0:15], v[40:43], v[56:59], a[0:15]
    ds_read_b128 v[72:75], v20 offset:32768
    s_waitcnt lgkmcnt(9)
    v_mfma_f32_32x32x16_bf16 a[16:31], v[44:47], v[56:59], a[16:31]
    ds_read_b64_tr_b16 v[88:89], v25 offset:24576
    s_waitcnt lgkmcnt(9)
    v_mfma_f32_32x32x16_bf16 a[32:47], v[48:51], v[56:59], a[32:47]
    ds_read_b64_tr_b16 v[90:91], v25 offset:26624
    s_add_u32 m0, s32, 0
    s_mov_b32 s33, 6291456
    buffer_load_dwordx4 v5, s[12:15], s33 offen lds
    s_waitcnt lgkmcnt(9)
    v_mfma_f32_32x32x16_bf16 a[48:63], v[52:55], v[56:59], a[48:63]
    ds_read_b128 v[76:79], v20 offset:36864
    s_waitcnt lgkmcnt(8)
    v_mfma_f32_32x32x16_bf16 a[64:79], v[40:43], v[60:63], a[64:79]
    ds_read_b128 v[80:83], v20 offset:40960
    v_mfma_f32_32x32x16_bf16 a[80:95], v[44:47], v[60:63], a[80:95]
    ds_read_b128 v[84:87], v20 offset:45056
    v_mfma_f32_32x32x16_bf16 a[96:111], v[48:51], v[60:63], a[96:111]
    ds_read_b64_tr_b16 v[92:93], v26 offset:24576
    buffer_load_dwordx4 v6, s[12:15], s33 offen offset:1024 lds
    v_mfma_f32_32x32x16_bf16 a[112:127], v[52:55], v[60:63], a[112:127]
    ds_read_b64_tr_b16 v[94:95], v26 offset:26624
    s_waitcnt lgkmcnt(10)
    v_mfma_f32_32x32x16_bf16 a[128:143], v[40:43], v[64:67], a[128:143]
    ds_read_b64_tr_b16 v[96:97], v27 offset:24576
    v_mfma_f32_32x32x16_bf16 a[144:159], v[44:47], v[64:67], a[144:159]
    ds_read_b64_tr_b16 v[98:99], v27 offset:26624
    v_mfma_f32_32x32x16_bf16 a[160:175], v[48:51], v[64:67], a[160:175]
    ds_read_b64_tr_b16 v[100:101], v28 offset:24576
    buffer_load_dwordx4 v7, s[12:15], s33 offen offset:2048 lds
    v_mfma_f32_32x32x16_bf16 a[176:191], v[52:55], v[64:67], a[176:191]
    ds_read_b64_tr_b16 v[102:103], v28 offset:26624
    s_waitcnt lgkmcnt(12)
    v_mfma_f32_32x32x16_bf16 a[192:207], v[40:43], v[68:71], a[192:207]
    v_mfma_f32_32x32x16_bf16 a[208:223], v[44:47], v[68:71], a[208:223]
    v_mfma_f32_32x32x16_bf16 a[224:239], v[48:51], v[68:71], a[224:239]
    buffer_load_dwordx4 v8, s[12:15], s33 offen offset:3072 lds
    v_mfma_f32_32x32x16_bf16 a[240:255], v[52:55], v[68:71], a[240:255]
    s_waitcnt vmcnt(18) lgkmcnt(0)
    s_barrier
    v_mfma_f32_32x32x16_bf16 a[0:15], v[72:75], v[88:91], a[0:15]
    ds_read_b128 v[40:43], v21 offset:0
    v_mfma_f32_32x32x16_bf16 a[16:31], v[76:79], v[88:91], a[16:31]
    ds_read_b64_tr_b16 v[56:57], v25 offset:32768
    v_mfma_f32_32x32x16_bf16 a[32:47], v[80:83], v[88:91], a[32:47]
    ds_read_b64_tr_b16 v[58:59], v25 offset:34816
    s_add_u32 m0, s32, 16384
    s_mov_b32 s33, 6553600
    buffer_load_dwordx4 v5, s[12:15], s33 offen lds
    v_mfma_f32_32x32x16_bf16 a[48:63], v[84:87], v[88:91], a[48:63]
    ds_read_b128 v[44:47], v21 offset:4096
    v_mfma_f32_32x32x16_bf16 a[64:79], v[72:75], v[92:95], a[64:79]
    ds_read_b128 v[48:51], v21 offset:8192
    v_mfma_f32_32x32x16_bf16 a[80:95], v[76:79], v[92:95], a[80:95]
    ds_read_b128 v[52:55], v21 offset:12288
    v_mfma_f32_32x32x16_bf16 a[96:111], v[80:83], v[92:95], a[96:111]
    ds_read_b64_tr_b16 v[60:61], v26 offset:32768
    buffer_load_dwordx4 v6, s[12:15], s33 offen offset:1024 lds
    v_mfma_f32_32x32x16_bf16 a[112:127], v[84:87], v[92:95], a[112:127]
    ds_read_b64_tr_b16 v[62:63], v26 offset:34816
    v_mfma_f32_32x32x16_bf16 a[128:143], v[72:75], v[96:99], a[128:143]
    ds_read_b64_tr_b16 v[64:65], v27 offset:32768
    v_mfma_f32_32x32x16_bf16 a[144:159], v[76:79], v[96:99], a[144:159]
    ds_read_b64_tr_b16 v[66:67], v27 offset:34816
    v_mfma_f32_32x32x16_bf16 a[160:175], v[80:83], v[96:99], a[160:175]
    ds_read_b64_tr_b16 v[68:69], v28 offset:32768
    buffer_load_dwordx4 v7, s[12:15], s33 offen offset:2048 lds
    v_mfma_f32_32x32x16_bf16 a[176:191], v[84:87], v[96:99], a[176:191]
    ds_read_b64_tr_b16 v[70:71], v28 offset:34816
    v_mfma_f32_32x32x16_bf16 a[192:207], v[72:75], v[100:103], a[192:207]
    v_mfma_f32_32x32x16_bf16 a[208:223], v[76:79], v[100:103], a[208:223]
    v_mfma_f32_32x32x16_bf16 a[224:239], v[80:83], v[100:103], a[224:239]
    buffer_load_dwordx4 v8, s[12:15], s33 offen offset:3072 lds
    v_mfma_f32_32x32x16_bf16 a[240:255], v[84:87], v[100:103], a[240:255]
    s_waitcnt lgkmcnt(9)
    v_mfma_f32_32x32x16_bf16 a[0:15], v[40:43], v[56:59], a[0:15]
    ds_read_b128 v[72:75], v22 offset:0
    s_waitcnt lgkmcnt(9)
    v_mfma_f32_32x32x16_bf16 a[16:31], v[44:47], v[56:59], a[16:31]
    ds_read_b64_tr_b16 v[88:89], v25 offset:40960
    s_waitcnt lgkmcnt(9)
    v_mfma_f32_32x32x16_bf16 a[32:47], v[48:51], v[56:59], a[32:47]
    ds_read_b64_tr_b16 v[90:91], v25 offset:43008
    s_add_u32 m0, s32, 98304
    s_mov_b32 s33, 1664
    buffer_load_dwordx4 v1, s[8:11], s33 offen lds
    s_waitcnt lgkmcnt(9)
    v_mfma_f32_32x32x16_bf16 a[48:63], v[52:55], v[56:59], a[48:63]
    ds_read_b128 v[76:79], v22 offset:4096
    s_waitcnt lgkmcnt(8)
    v_mfma_f32_32x32x16_bf16 a[64:79], v[40:43], v[60:63], a[64:79]
    ds_read_b128 v[80:83], v22 offset:8192
    v_mfma_f32_32x32x16_bf16 a[80:95], v[44:47], v[60:63], a[80:95]
    ds_read_b128 v[84:87], v22 offset:12288
    v_mfma_f32_32x32x16_bf16 a[96:111], v[48:51], v[60:63], a[96:111]
    ds_read_b64_tr_b16 v[92:93], v26 offset:40960
    buffer_load_dwordx4 v2, s[8:11], s33 offen offset:1024 lds
    v_mfma_f32_32x32x16_bf16 a[112:127], v[52:55], v[60:63], a[112:127]
    ds_read_b64_tr_b16 v[94:95], v26 offset:43008
    s_waitcnt lgkmcnt(10)
    v_mfma_f32_32x32x16_bf16 a[128:143], v[40:43], v[64:67], a[128:143]
    ds_read_b64_tr_b16 v[96:97], v27 offset:40960
    v_mfma_f32_32x32x16_bf16 a[144:159], v[44:47], v[64:67], a[144:159]
    ds_read_b64_tr_b16 v[98:99], v27 offset:43008
    v_mfma_f32_32x32x16_bf16 a[160:175], v[48:51], v[64:67], a[160:175]
    ds_read_b64_tr_b16 v[100:101], v28 offset:40960
    buffer_load_dwordx4 v3, s[8:11], s33 offen offset:2048 lds
    v_mfma_f32_32x32x16_bf16 a[176:191], v[52:55], v[64:67], a[176:191]
    ds_read_b64_tr_b16 v[102:103], v28 offset:43008
    s_waitcnt lgkmcnt(12)
    v_mfma_f32_32x32x16_bf16 a[192:207], v[40:43], v[68:71], a[192:207]
    v_mfma_f32_32x32x16_bf16 a[208:223], v[44:47], v[68:71], a[208:223]
    v_mfma_f32_32x32x16_bf16 a[224:239], v[48:51], v[68:71], a[224:239]
    buffer_load_dwordx4 v4, s[8:11], s33 offen offset:3072 lds
    s_mov_b32 s34, 12288
    buffer_store_dwordx4 v[240:243], v38, s[28:31], s34 offen sc1
    v_mfma_f32_32x32x16_bf16 a[240:255], v[52:55], v[68:71], a[240:255]
    s_waitcnt vmcnt(22) lgkmcnt(0)
    s_barrier
    v_mfma_f32_32x32x16_bf16 a[0:15], v[72:75], v[88:91], a[0:15]
    ds_read_b128 v[40:43], v23 offset:0
    v_mfma_f32_32x32x16_bf16 a[16:31], v[76:79], v[88:91], a[16:31]
    ds_read_b64_tr_b16 v[56:57], v25 offset:49152
    v_mfma_f32_32x32x16_bf16 a[32:47], v[80:83], v[88:91], a[32:47]
    ds_read_b64_tr_b16 v[58:59], v25 offset:51200
    s_add_u32 m0, s32, 114688
    s_mov_b32 s33, 263808
    buffer_load_dwordx4 v1, s[8:11], s33 offen lds
    v_mfma_f32_32x32x16_bf16 a[48:63], v[84:87], v[88:91], a[48:63]
    ds_read_b128 v[44:47], v23 offset:4096
    v_mfma_f32_32x32x16_bf16 a[64:79], v[72:75], v[92:95], a[64:79]
    ds_read_b128 v[48:51], v23 offset:8192
    v_mfma_f32_32x32x16_bf16 a[80:95], v[76:79], v[92:95], a[80:95]
    ds_read_b128 v[52:55], v23 offset:12288
    v_mfma_f32_32x32x16_bf16 a[96:111], v[80:83], v[92:95], a[96:111]
    ds_read_b64_tr_b16 v[60:61], v26 offset:49152
    buffer_load_dwordx4 v2, s[8:11], s33 offen offset:1024 lds
    v_mfma_f32_32x32x16_bf16 a[112:127], v[84:87], v[92:95], a[112:127]
    ds_read_b64_tr_b16 v[62:63], v26 offset:51200
    v_mfma_f32_32x32x16_bf16 a[128:143], v[72:75], v[96:99], a[128:143]
    ds_read_b64_tr_b16 v[64:65], v27 offset:49152
    v_mfma_f32_32x32x16_bf16 a[144:159], v[76:79], v[96:99], a[144:159]
    ds_read_b64_tr_b16 v[66:67], v27 offset:51200
    v_mfma_f32_32x32x16_bf16 a[160:175], v[80:83], v[96:99], a[160:175]
    ds_read_b64_tr_b16 v[68:69], v28 offset:49152
    buffer_load_dwordx4 v3, s[8:11], s33 offen offset:2048 lds
    v_mfma_f32_32x32x16_bf16 a[176:191], v[84:87], v[96:99], a[176:191]
    ds_read_b64_tr_b16 v[70:71], v28 offset:51200
    v_mfma_f32_32x32x16_bf16 a[192:207], v[72:75], v[100:103], a[192:207]
    v_mfma_f32_32x32x16_bf16 a[208:223], v[76:79], v[100:103], a[208:223]
    v_lshlrev_b32 v126, 2, v39
    buffer_load_dword v125, v126, s[60:63], 0 offen sc1
    v_mfma_f32_32x32x16_bf16 a[224:239], v[80:83], v[100:103], a[224:239]
    buffer_load_dwordx4 v4, s[8:11], s33 offen offset:3072 lds
    v_mfma_f32_32x32x16_bf16 a[240:255], v[84:87], v[100:103], a[240:255]
    s_waitcnt lgkmcnt(9)
    v_mfma_f32_32x32x16_bf16 a[0:15], v[40:43], v[56:59], a[0:15]
    ds_read_b128 v[72:75], v24 offset:0
    s_waitcnt lgkmcnt(9)
    v_mfma_f32_32x32x16_bf16 a[16:31], v[44:47], v[56:59], a[16:31]
    ds_read_b64_tr_b16 v[88:89], v25 offset:57344
    s_waitcnt lgkmcnt(9)
    v_mfma_f32_32x32x16_bf16 a[32:47], v[48:51], v[56:59], a[32:47]
    ds_read_b64_tr_b16 v[90:91], v25 offset:59392
    s_add_u32 m0, s32, 32768
    s_mov_b32 s33, 6815744
    buffer_load_dwordx4 v5, s[12:15], s33 offen lds
    s_waitcnt lgkmcnt(9)
    v_mfma_f32_32x32x16_bf16 a[48:63], v[52:55], v[56:59], a[48:63]
    ds_read_b128 v[76:79], v24 offset:4096
    s_waitcnt lgkmcnt(8)
    v_mfma_f32_32x32x16_bf16 a[64:79], v[40:43], v[60:63], a[64:79]
    ds_read_b128 v[80:83], v24 offset:8192
    v_mfma_f32_32x32x16_bf16 a[80:95], v[44:47], v[60:63], a[80:95]
    ds_read_b128 v[84:87], v24 offset:12288
    v_mfma_f32_32x32x16_bf16 a[96:111], v[48:51], v[60:63], a[96:111]
    ds_read_b64_tr_b16 v[92:93], v26 offset:57344
    buffer_load_dwordx4 v6, s[12:15], s33 offen offset:1024 lds
    v_mfma_f32_32x32x16_bf16 a[112:127], v[52:55], v[60:63], a[112:127]
    ds_read_b64_tr_b16 v[94:95], v26 offset:59392
    s_waitcnt lgkmcnt(10)
    v_mfma_f32_32x32x16_bf16 a[128:143], v[40:43], v[64:67], a[128:143]
    ds_read_b64_tr_b16 v[96:97], v27 offset:57344
    v_mfma_f32_32x32x16_bf16 a[144:159], v[44:47], v[64:67], a[144:159]
    ds_read_b64_tr_b16 v[98:99], v27 offset:59392
    v_mfma_f32_32x32x16_bf16 a[160:175], v[48:51], v[64:67], a[160:175]
    ds_read_b64_tr_b16 v[100:101], v28 offset:57344
    buffer_load_dwordx4 v7, s[12:15], s33 offen offset:2048 lds
    v_mfma_f32_32x32x16_bf16 a[176:191], v[52:55], v[64:67], a[176:191]
    ds_read_b64_tr_b16 v[102:103], v28 offset:59392
    s_waitcnt lgkmcnt(12)
    v_mfma_f32_32x32x16_bf16 a[192:207], v[40:43], v[68:71], a[192:207]
    v_mfma_f32_32x32x16_bf16 a[208:223], v[44:47], v[68:71], a[208:223]
    v_mfma_f32_32x32x16_bf16 a[224:239], v[48:51], v[68:71], a[224:239]
    buffer_load_dwordx4 v8, s[12:15], s33 offen offset:3072 lds
    v_mfma_f32_32x32x16_bf16 a[240:255], v[52:55], v[68:71], a[240:255]
    s_waitcnt vmcnt(18) lgkmcnt(0)
    s_barrier
    v_mfma_f32_32x32x16_bf16 a[0:15], v[72:75], v[88:91], a[0:15]
    ds_read_b128 v[40:43], v17 offset:0
    v_mfma_f32_32x32x16_bf16 a[16:31], v[76:79], v[88:91], a[16:31]
    ds_read_b64_tr_b16 v[56:57], v25 offset:0
    v_mfma_f32_32x32x16_bf16 a[32:47], v[80:83], v[88:91], a[32:47]
    ds_read_b64_tr_b16 v[58:59], v25 offset:2048
    s_add_u32 m0, s32, 49152
    s_mov_b32 s33, 7077888
    buffer_load_dwordx4 v5, s[12:15], s33 offen lds
    v_mfma_f32_32x32x16_bf16 a[48:63], v[84:87], v[88:91], a[48:63]
    ds_read_b128 v[44:47], v17 offset:4096
    v_mfma_f32_32x32x16_bf16 a[64:79], v[72:75], v[92:95], a[64:79]
    ds_read_b128 v[48:51], v17 offset:8192
    v_mfma_f32_32x32x16_bf16 a[80:95], v[76:79], v[92:95], a[80:95]
    ds_read_b128 v[52:55], v17 offset:12288
    v_mfma_f32_32x32x16_bf16 a[96:111], v[80:83], v[92:95], a[96:111]
    ds_read_b64_tr_b16 v[60:61], v26 offset:0
    buffer_load_dwordx4 v6, s[12:15], s33 offen offset:1024 lds
    v_mfma_f32_32x32x16_bf16 a[112:127], v[84:87], v[92:95], a[112:127]
    ds_read_b64_tr_b16 v[62:63], v26 offset:2048
    v_mfma_f32_32x32x16_bf16 a[128:143], v[72:75], v[96:99], a[128:143]
    ds_read_b64_tr_b16 v[64:65], v27 offset:0
    v_mfma_f32_32x32x16_bf16 a[144:159], v[76:79], v[96:99], a[144:159]
    ds_read_b64_tr_b16 v[66:67], v27 offset:2048
    v_mfma_f32_32x32x16_bf16 a[160:175], v[80:83], v[96:99], a[160:175]
    ds_read_b64_tr_b16 v[68:69], v28 offset:0
    buffer_load_dwordx4 v7, s[12:15], s33 offen offset:2048 lds
    v_mfma_f32_32x32x16_bf16 a[176:191], v[84:87], v[96:99], a[176:191]
    ds_read_b64_tr_b16 v[70:71], v28 offset:2048
    v_mfma_f32_32x32x16_bf16 a[192:207], v[72:75], v[100:103], a[192:207]
    v_mfma_f32_32x32x16_bf16 a[208:223], v[76:79], v[100:103], a[208:223]
    v_mfma_f32_32x32x16_bf16 a[224:239], v[80:83], v[100:103], a[224:239]
    buffer_load_dwordx4 v8, s[12:15], s33 offen offset:3072 lds
    s_mov_b32 s34, 13312
    buffer_store_dwordx4 v[244:247], v38, s[28:31], s34 offen sc1
    v_mfma_f32_32x32x16_bf16 a[240:255], v[84:87], v[100:103], a[240:255]
    s_waitcnt lgkmcnt(9)
    v_mfma_f32_32x32x16_bf16 a[0:15], v[40:43], v[56:59], a[0:15]
    ds_read_b128 v[72:75], v18 offset:0
    s_waitcnt lgkmcnt(9)
    v_mfma_f32_32x32x16_bf16 a[16:31], v[44:47], v[56:59], a[16:31]
    ds_read_b64_tr_b16 v[88:89], v25 offset:8192
    s_waitcnt lgkmcnt(9)
    v_mfma_f32_32x32x16_bf16 a[32:47], v[48:51], v[56:59], a[32:47]
    ds_read_b64_tr_b16 v[90:91], v25 offset:10240
    s_add_u32 m0, s32, 131072
    s_mov_b32 s33, 1792
    buffer_load_dwordx4 v1, s[8:11], s33 offen lds
    s_waitcnt lgkmcnt(9)
    v_mfma_f32_32x32x16_bf16 a[48:63], v[52:55], v[56:59], a[48:63]
    ds_read_b128 v[76:79], v18 offset:4096
    s_waitcnt lgkmcnt(8)
    v_mfma_f32_32x32x16_bf16 a[64:79], v[40:43], v[60:63], a[64:79]
    ds_read_b128 v[80:83], v18 offset:8192
    v_mfma_f32_32x32x16_bf16 a[80:95], v[44:47], v[60:63], a[80:95]
    ds_read_b128 v[84:87], v18 offset:12288
    v_mfma_f32_32x32x16_bf16 a[96:111], v[48:51], v[60:63], a[96:111]
    ds_read_b64_tr_b16 v[92:93], v26 offset:8192
    buffer_load_dwordx4 v2, s[8:11], s33 offen offset:1024 lds
    v_mfma_f32_32x32x16_bf16 a[112:127], v[52:55], v[60:63], a[112:127]
    ds_read_b64_tr_b16 v[94:95], v26 offset:10240
    s_waitcnt lgkmcnt(10)
    v_mfma_f32_32x32x16_bf16 a[128:143], v[40:43], v[64:67], a[128:143]
    ds_read_b64_tr_b16 v[96:97], v27 offset:8192
    v_mfma_f32_32x32x16_bf16 a[144:159], v[44:47], v[64:67], a[144:159]
    ds_read_b64_tr_b16 v[98:99], v27 offset:10240
    v_mfma_f32_32x32x16_bf16 a[160:175], v[48:51], v[64:67], a[160:175]
    ds_read_b64_tr_b16 v[100:101], v28 offset:8192
    buffer_load_dwordx4 v3, s[8:11], s33 offen offset:2048 lds
    v_mfma_f32_32x32x16_bf16 a[176:191], v[52:55], v[64:67], a[176:191]
    ds_read_b64_tr_b16 v[102:103], v28 offset:10240
    s_waitcnt lgkmcnt(12)
    v_mfma_f32_32x32x16_bf16 a[192:207], v[40:43], v[68:71], a[192:207]
    v_mfma_f32_32x32x16_bf16 a[208:223], v[44:47], v[68:71], a[208:223]
    v_mfma_f32_32x32x16_bf16 a[224:239], v[48:51], v[68:71], a[224:239]
    buffer_load_dwordx4 v4, s[8:11], s33 offen offset:3072 lds
    v_mfma_f32_32x32x16_bf16 a[240:255], v[52:55], v[68:71], a[240:255]
    s_waitcnt vmcnt(14) lgkmcnt(0)
    s_barrier
    s_mov_b32 s55, 0x01010101
    v_cmp_ne_u32 s[58:59], s55, v125
    s_cmp_eq_u64 s[58:59], 0
    s_cbranch_scc0 k1_c0slow_1
k1_c0ret_1:
    v_mfma_f32_32x32x16_bf16 a[0:15], v[72:75], v[88:91], a[0:15]
    ds_read_b128 v[40:43], v19 offset:0
    v_mfma_f32_32x32x16_bf16 a[16:31], v[76:79], v[88:91], a[16:31]
    ds_read_b64_tr_b16 v[56:57], v25 offset:16384
    v_mfma_f32_32x32x16_bf16 a[32:47], v[80:83], v[88:91], a[32:47]
    ds_read_b64_tr_b16 v[58:59], v25 offset:18432
    s_add_u32 m0, s32, 147456
    s_mov_b32 s33, 263936
    buffer_load_dwordx4 v1, s[8:11], s33 offen lds
    v_mfma_f32_32x32x16_bf16 a[48:63], v[84:87], v[88:91], a[48:63]
    ds_read_b128 v[44:47], v19 offset:4096
    v_mfma_f32_32x32x16_bf16 a[64:79], v[72:75], v[92:95], a[64:79]
    ds_read_b128 v[48:51], v19 offset:8192
    v_mfma_f32_32x32x16_bf16 a[80:95], v[76:79], v[92:95], a[80:95]
    ds_read_b128 v[52:55], v19 offset:12288
    v_mfma_f32_32x32x16_bf16 a[96:111], v[80:83], v[92:95], a[96:111]
    ds_read_b64_tr_b16 v[60:61], v26 offset:16384
    buffer_load_dwordx4 v2, s[8:11], s33 offen offset:1024 lds
    v_mfma_f32_32x32x16_bf16 a[112:127], v[84:87], v[92:95], a[112:127]
    ds_read_b64_tr_b16 v[62:63], v26 offset:18432
    v_mfma_f32_32x32x16_bf16 a[128:143], v[72:75], v[96:99], a[128:143]
    ds_read_b64_tr_b16 v[64:65], v27 offset:16384
    v_mfma_f32_32x32x16_bf16 a[144:159], v[76:79], v[96:99], a[144:159]
    ds_read_b64_tr_b16 v[66:67], v27 offset:18432
    v_mfma_f32_32x32x16_bf16 a[160:175], v[80:83], v[96:99], a[160:175]
    ds_read_b64_tr_b16 v[68:69], v28 offset:16384
    buffer_load_dwordx4 v3, s[8:11], s33 offen offset:2048 lds
    v_mfma_f32_32x32x16_bf16 a[176:191], v[84:87], v[96:99], a[176:191]
    ds_read_b64_tr_b16 v[70:71], v28 offset:18432
    v_mfma_f32_32x32x16_bf16 a[192:207], v[72:75], v[100:103], a[192:207]
    v_mfma_f32_32x32x16_bf16 a[208:223], v[76:79], v[100:103], a[208:223]
    v_mfma_f32_32x32x16_bf16 a[224:239], v[80:83], v[100:103], a[224:239]
    buffer_load_dwordx4 v4, s[8:11], s33 offen offset:3072 lds
    v_mfma_f32_32x32x16_bf16 a[240:255], v[84:87], v[100:103], a[240:255]
    s_waitcnt lgkmcnt(9)
    v_mfma_f32_32x32x16_bf16 a[0:15], v[40:43], v[56:59], a[0:15]
    ds_read_b128 v[72:75], v20 offset:0
    s_waitcnt lgkmcnt(9)
    v_mfma_f32_32x32x16_bf16 a[16:31], v[44:47], v[56:59], a[16:31]
    ds_read_b64_tr_b16 v[88:89], v25 offset:24576
    s_waitcnt lgkmcnt(9)
    v_mfma_f32_32x32x16_bf16 a[32:47], v[48:51], v[56:59], a[32:47]
    ds_read_b64_tr_b16 v[90:91], v25 offset:26624
    s_add_u32 m0, s32, 0
    s_mov_b32 s33, 7340032
    buffer_load_dwordx4 v5, s[12:15], s33 offen lds
    s_waitcnt lgkmcnt(9)
    v_mfma_f32_32x32x16_bf16 a[48:63], v[52:55], v[56:59], a[48:63]
    ds_read_b128 v[76:79], v20 offset:4096
    s_waitcnt lgkmcnt(8)
    v_mfma_f32_32x32x16_bf16 a[64:79], v[40:43], v[60:63], a[64:79]
    ds_read_b128 v[80:83], v20 offset:8192
    v_mfma_f32_32x32x16_bf16 a[80:95], v[44:47], v[60:63], a[80:95]
    ds_read_b128 v[84:87], v20 offset:12288
    v_mfma_f32_32x32x16_bf16 a[96:111], v[48:51], v[60:63], a[96:111]
    ds_read_b64_tr_b16 v[92:93], v26 offset:24576
    buffer_load_dwordx4 v6, s[12:15], s33 offen offset:1024 lds
    v_mfma_f32_32x32x16_bf16 a[112:127], v[52:55], v[60:63], a[112:127]
    ds_read_b64_tr_b16 v[94:95], v26 offset:26624
    s_waitcnt lgkmcnt(10)
    v_mfma_f32_32x32x16_bf16 a[128:143], v[40:43], v[64:67], a[128:143]
    ds_read_b64_tr_b16 v[96:97], v27 offset:24576
    v_mfma_f32_32x32x16_bf16 a[144:159], v[44:47], v[64:67], a[144:159]
    ds_read_b64_tr_b16 v[98:99], v27 offset:26624
    v_mfma_f32_32x32x16_bf16 a[160:175], v[48:51], v[64:67], a[160:175]
    ds_read_b64_tr_b16 v[100:101], v28 offset:24576
    buffer_load_dwordx4 v7, s[12:15], s33 offen offset:2048 lds
    v_mfma_f32_32x32x16_bf16 a[176:191], v[52:55], v[64:67], a[176:191]
    ds_read_b64_tr_b16 v[102:103], v28 offset:26624
    s_waitcnt lgkmcnt(12)
    v_mfma_f32_32x32x16_bf16 a[192:207], v[40:43], v[68:71], a[192:207]
    s_mov_b64 s[80:81], s[94:95]
    s_mov_b64 s[82:83], s[46:47]
    s_lshl_b32 s84, s2, 13
    s_mov_b32 s88, s54
    s_add_u32 s68, s80, s84
    s_addc_u32 s69, s81, 0
    s_mov_b32 s70, 8192
    s_mov_b32 s71, 0x20000
    s_lshr_b32 s85, s2, 2
    s_lshl_b32 s85, s85, 15
    s_and_b32 s86, s2, 3
    s_lshl_b32 s86, s86, 2
    s_add_u32 s85, s85, s86
    s_add_u32 s85, s85, 88080384
    s_add_u32 s72, s82, s85
    s_addc_u32 s73, s83, 0
    s_mov_b32 s74, 32756
    s_mov_b32 s75, 0x20000
    s_add_u32 s85, s84, 92274688
    s_add_u32 s76, s82, s85
    s_addc_u32 s77, s83, 0
    s_mov_b32 s78, 8192
    s_mov_b32 s79, 0x20000
    s_cmp_lt_u32 s2, 224
    s_cselect_b32 s70, s70, 0
    s_cselect_b32 s74, s74, 0
    s_cselect_b32 s78, s78, 0
    v_lshlrev_b32 v127, 4, v0
    s_movk_i32 s85, 0x1000
    v_mfma_f32_32x32x16_bf16 a[208:223], v[44:47], v[68:71], a[208:223]
    v_mfma_f32_32x32x16_bf16 a[224:239], v[48:51], v[68:71], a[224:239]
    buffer_load_dwordx4 v8, s[12:15], s33 offen offset:3072 lds
    s_mov_b32 s34, 14336
    buffer_store_dwordx4 v[248:251], v38, s[28:31], s34 offen sc1
    v_mfma_f32_32x32x16_bf16 a[240:255], v[52:55], v[68:71], a[240:255]
    s_waitcnt vmcnt(18) lgkmcnt(0)
    s_barrier
    v_mfma_f32_32x32x16_bf16 a[0:15], v[72:75], v[88:91], a[0:15]
    ds_read_b128 v[40:43], v17 offset:32768
    v_mfma_f32_32x32x16_bf16 a[16:31], v[76:79], v[88:91], a[16:31]
    ds_read_b64_tr_b16 v[56:57], v25 offset:32768
    v_mfma_f32_32x32x16_bf16 a[32:47], v[80:83], v[88:91], a[32:47]
    ds_read_b64_tr_b16 v[58:59], v25 offset:34816
    s_add_u32 m0, s32, 16384
    s_mov_b32 s33, 7602176
    buffer_load_dwordx4 v5, s[12:15], s33 offen lds
    v_mfma_f32_32x32x16_bf16 a[48:63], v[84:87], v[88:91], a[48:63]
    ds_read_b128 v[44:47], v17 offset:36864
    v_mfma_f32_32x32x16_bf16 a[64:79], v[72:75], v[92:95], a[64:79]
    ds_read_b128 v[48:51], v17 offset:40960
    v_mfma_f32_32x32x16_bf16 a[80:95], v[76:79], v[92:95], a[80:95]
    ds_read_b128 v[52:55], v17 offset:45056
    v_mfma_f32_32x32x16_bf16 a[96:111], v[80:83], v[92:95], a[96:111]
    ds_read_b64_tr_b16 v[60:61], v26 offset:32768
    buffer_load_dwordx4 v6, s[12:15], s33 offen offset:1024 lds
    v_mfma_f32_32x32x16_bf16 a[112:127], v[84:87], v[92:95], a[112:127]
    ds_read_b64_tr_b16 v[62:63], v26 offset:34816
    buffer_load_dwordx4 v[140:143], v127, s[68:71], 0 offen offset:16
    v_mfma_f32_32x32x16_bf16 a[128:143], v[72:75], v[96:99], a[128:143]
    ds_read_b64_tr_b16 v[64:65], v27 offset:32768
    v_mfma_f32_32x32x16_bf16 a[144:159], v[76:79], v[96:99], a[144:159]
    ds_read_b64_tr_b16 v[66:67], v27 offset:34816
    v_mfma_f32_32x32x16_bf16 a[160:175], v[80:83], v[96:99], a[160:175]
    ds_read_b64_tr_b16 v[68:69], v28 offset:32768
    buffer_load_dwordx4 v7, s[12:15], s33 offen offset:2048 lds
    v_mfma_f32_32x32x16_bf16 a[176:191], v[84:87], v[96:99], a[176:191]
    ds_read_b64_tr_b16 v[70:71], v28 offset:34816
    v_mfma_f32_32x32x16_bf16 a[192:207], v[72:75], v[100:103], a[192:207]
    v_mfma_f32_32x32x16_bf16 a[208:223], v[76:79], v[100:103], a[208:223]
    buffer_load_dwordx4 v[136:139], v127, s[68:71], 0 offen
    v_mfma_f32_32x32x16_bf16 a[224:239], v[80:83], v[100:103], a[224:239]
    buffer_load_dwordx4 v8, s[12:15], s33 offen offset:3072 lds
    v_mfma_f32_32x32x16_bf16 a[240:255], v[84:87], v[100:103], a[240:255]
    s_waitcnt lgkmcnt(9)
    v_mfma_f32_32x32x16_bf16 a[0:15], v[40:43], v[56:59], a[0:15]
    ds_read_b128 v[72:75], v18 offset:32768
    s_waitcnt lgkmcnt(9)
    v_mfma_f32_32x32x16_bf16 a[16:31], v[44:47], v[56:59], a[16:31]
    ds_read_b64_tr_b16 v[88:89], v25 offset:40960
    s_waitcnt lgkmcnt(9)
    v_mfma_f32_32x32x16_bf16 a[32:47], v[48:51], v[56:59], a[32:47]
    ds_read_b64_tr_b16 v[90:91], v25 offset:43008
    s_add_u32 m0, s32, 65536
    s_mov_b32 s33, 1920
    buffer_load_dwordx4 v1, s[8:11], s33 offen lds
    s_waitcnt lgkmcnt(9)
    v_mfma_f32_32x32x16_bf16 a[48:63], v[52:55], v[56:59], a[48:63]
    ds_read_b128 v[76:79], v18 offset:36864
    s_waitcnt lgkmcnt(8)
    v_mfma_f32_32x32x16_bf16 a[64:79], v[40:43], v[60:63], a[64:79]
    ds_read_b128 v[80:83], v18 offset:40960
    v_mfma_f32_32x32x16_bf16 a[80:95], v[44:47], v[60:63], a[80:95]
    ds_read_b128 v[84:87], v18 offset:45056
    v_mfma_f32_32x32x16_bf16 a[96:111], v[48:51], v[60:63], a[96:111]
    ds_read_b64_tr_b16 v[92:93], v26 offset:40960
    buffer_load_dwordx4 v2, s[8:11], s33 offen offset:1024 lds
    v_mfma_f32_32x32x16_bf16 a[112:127], v[52:55], v[60:63], a[112:127]
    ds_read_b64_tr_b16 v[94:95], v26 offset:43008
    buffer_load_dwordx4 v[148:151], v127, s[68:71], s85 offen offset:16
    s_waitcnt lgkmcnt(10)
    v_mfma_f32_32x32x16_bf16 a[128:143], v[40:43], v[64:67], a[128:143]
    ds_read_b64_tr_b16 v[96:97], v27 offset:40960
    v_mfma_f32_32x32x16_bf16 a[144:159], v[44:47], v[64:67], a[144:159]
    ds_read_b64_tr_b16 v[98:99], v27 offset:43008
    v_mfma_f32_32x32x16_bf16 a[160:175], v[48:51], v[64:67], a[160:175]
    ds_read_b64_tr_b16 v[100:101], v28 offset:40960
    buffer_load_dwordx4 v3, s[8:11], s33 offen offset:2048 lds
    v_mfma_f32_32x32x16_bf16 a[176:191], v[52:55], v[64:67], a[176:191]
    ds_read_b64_tr_b16 v[102:103], v28 offset:43008
    s_waitcnt lgkmcnt(12)
    v_mfma_f32_32x32x16_bf16 a[192:207], v[40:43], v[68:71], a[192:207]
    v_mfma_f32_32x32x16_bf16 a[208:223], v[44:47], v[68:71], a[208:223]
    buffer_load_dwordx4 v[144:147], v127, s[68:71], s85 offen
    v_mfma_f32_32x32x16_bf16 a[224:239], v[48:51], v[68:71], a[224:239]
    buffer_load_dwordx4 v4, s[8:11], s33 offen offset:3072 lds
    v_mfma_f32_32x32x16_bf16 a[240:255], v[52:55], v[68:71], a[240:255]
    s_waitcnt vmcnt(26) lgkmcnt(0)
    s_barrier
    v_mfma_f32_32x32x16_bf16 a[0:15], v[72:75], v[88:91], a[0:15]
    ds_read_b128 v[40:43], v19 offset:32768
    v_mfma_f32_32x32x16_bf16 a[16:31], v[76:79], v[88:91], a[16:31]
    ds_read_b64_tr_b16 v[56:57], v25 offset:49152
    v_mfma_f32_32x32x16_bf16 a[32:47], v[80:83], v[88:91], a[32:47]
    ds_read_b64_tr_b16 v[58:59], v25 offset:51200
    s_add_u32 m0, s32, 81920
    s_mov_b32 s33, 264064
    buffer_load_dwordx4 v1, s[8:11], s33 offen lds
    v_mfma_f32_32x32x16_bf16 a[48:63], v[84:87], v[88:91], a[48:63]
    ds_read_b128 v[44:47], v19 offset:36864
    v_mfma_f32_32x32x16_bf16 a[64:79], v[72:75], v[92:95], a[64:79]
    ds_read_b128 v[48:51], v19 offset:40960
    v_mfma_f32_32x32x16_bf16 a[80:95], v[76:79], v[92:95], a[80:95]
    ds_read_b128 v[52:55], v19 offset:45056
    v_mfma_f32_32x32x16_bf16 a[96:111], v[80:83], v[92:95], a[96:111]
    ds_read_b64_tr_b16 v[60:61], v26 offset:49152
    buffer_load_dwordx4 v2, s[8:11], s33 offen offset:1024 lds
    v_mfma_f32_32x32x16_bf16 a[112:127], v[84:87], v[92:95], a[112:127]
    ds_read_b64_tr_b16 v[62:63], v26 offset:51200
    s_movk_i32 s86, 4096
    buffer_load_dword v153, v127, s[72:75], s86 offen
    v_mfma_f32_32x32x16_bf16 a[128:143], v[72:75], v[96:99], a[128:143]
    ds_read_b64_tr_b16 v[64:65], v27 offset:49152
    v_mfma_f32_32x32x16_bf16 a[144:159], v[76:79], v[96:99], a[144:159]
    ds_read_b64_tr_b16 v[66:67], v27 offset:51200
    v_mfma_f32_32x32x16_bf16 a[160:175], v[80:83], v[96:99], a[160:175]
    ds_read_b64_tr_b16 v[68:69], v28 offset:49152
    buffer_load_dwordx4 v3, s[8:11], s33 offen offset:2048 lds
    v_mfma_f32_32x32x16_bf16 a[176:191], v[84:87], v[96:99], a[176:191]
    ds_read_b64_tr_b16 v[70:71], v28 offset:51200
    v_mfma_f32_32x32x16_bf16 a[192:207], v[72:75], v[100:103], a[192:207]
    v_mfma_f32_32x32x16_bf16 a[208:223], v[76:79], v[100:103], a[208:223]
    s_movk_i32 s86, 0
    buffer_load_dword v152, v127, s[72:75], s86 offen
    v_mfma_f32_32x32x16_bf16 a[224:239], v[80:83], v[100:103], a[224:239]
    buffer_load_dwordx4 v4, s[8:11], s33 offen offset:3072 lds
    s_mov_b32 s34, 15360
    buffer_store_dwordx4 v[252:255], v38, s[28:31], s34 offen sc1
    v_mfma_f32_32x32x16_bf16 a[240:255], v[84:87], v[100:103], a[240:255]
    s_waitcnt lgkmcnt(9)
    v_mfma_f32_32x32x16_bf16 a[0:15], v[40:43], v[56:59], a[0:15]
    ds_read_b128 v[72:75], v20 offset:32768
    s_waitcnt lgkmcnt(9)
    v_mfma_f32_32x32x16_bf16 a[16:31], v[44:47], v[56:59], a[16:31]
    ds_read_b64_tr_b16 v[88:89], v25 offset:57344
    s_waitcnt lgkmcnt(9)
    v_mfma_f32_32x32x16_bf16 a[32:47], v[48:51], v[56:59], a[32:47]
    ds_read_b64_tr_b16 v[90:91], v25 offset:59392
    s_add_u32 m0, s32, 32768
    s_mov_b32 s33, 7864320
    buffer_load_dwordx4 v5, s[12:15], s33 offen lds
    s_waitcnt lgkmcnt(9)
    v_mfma_f32_32x32x16_bf16 a[48:63], v[52:55], v[56:59], a[48:63]
    ds_read_b128 v[76:79], v20 offset:36864
    s_waitcnt lgkmcnt(8)
    v_mfma_f32_32x32x16_bf16 a[64:79], v[40:43], v[60:63], a[64:79]
    ds_read_b128 v[80:83], v20 offset:40960
    v_mfma_f32_32x32x16_bf16 a[80:95], v[44:47], v[60:63], a[80:95]
    ds_read_b128 v[84:87], v20 offset:45056
    v_mfma_f32_32x32x16_bf16 a[96:111], v[48:51], v[60:63], a[96:111]
    ds_read_b64_tr_b16 v[92:93], v26 offset:57344
    buffer_load_dwordx4 v6, s[12:15], s33 offen offset:1024 lds
    v_mfma_f32_32x32x16_bf16 a[112:127], v[52:55], v[60:63], a[112:127]
    ds_read_b64_tr_b16 v[94:95], v26 offset:59392
    s_movk_i32 s86, 12288
    buffer_load_dword v155, v127, s[72:75], s86 offen
    s_waitcnt lgkmcnt(10)
    v_mfma_f32_32x32x16_bf16 a[128:143], v[40:43], v[64:67], a[128:143]
    ds_read_b64_tr_b16 v[96:97], v27 offset:57344
    v_mfma_f32_32x32x16_bf16 a[144:159], v[44:47], v[64:67], a[144:159]
    ds_read_b64_tr_b16 v[98:99], v27 offset:59392
    v_mfma_f32_32x32x16_bf16 a[160:175], v[48:51], v[64:67], a[160:175]
    ds_read_b64_tr_b16 v[100:101], v28 offset:57344
    buffer_load_dwordx4 v7, s[12:15], s33 offen offset:2048 lds
    v_mfma_f32_32x32x16_bf16 a[176:191], v[52:55], v[64:67], a[176:191]
    ds_read_b64_tr_b16 v[102:103], v28 offset:59392
    s_waitcnt lgkmcnt(12)
    v_mfma_f32_32x32x16_bf16 a[192:207], v[40:43], v[68:71], a[192:207]
    v_mfma_f32_32x32x16_bf16 a[208:223], v[44:47], v[68:71], a[208:223]
    s_movk_i32 s86, 8192
    buffer_load_dword v154, v127, s[72:75], s86 offen
    v_mfma_f32_32x32x16_bf16 a[224:239], v[48:51], v[68:71], a[224:239]
    buffer_load_dwordx4 v8, s[12:15], s33 offen offset:3072 lds
    v_mfma_f32_32x32x16_bf16 a[240:255], v[52:55], v[68:71], a[240:255]
    s_waitcnt vmcnt(26) lgkmcnt(0)
    s_barrier
    v_mfma_f32_32x32x16_bf16 a[0:15], v[72:75], v[88:91], a[0:15]
    ds_read_b128 v[40:43], v21 offset:0
    v_mfma_f32_32x32x16_bf16 a[16:31], v[76:79], v[88:91], a[16:31]
    ds_read_b64_tr_b16 v[56:57], v25 offset:0
    v_mfma_f32_32x32x16_bf16 a[32:47], v[80:83], v[88:91], a[32:47]
    ds_read_b64_tr_b16 v[58:59], v25 offset:2048
    v_mfma_f32_32x32x16_bf16 a[48:63], v[84:87], v[88:91], a[48:63]
    ds_read_b128 v[44:47], v21 offset:4096
    v_mfma_f32_32x32x16_bf16 a[64:79], v[72:75], v[92:95], a[64:79]
    ds_read_b128 v[48:51], v21 offset:8192
    s_add_u32 m0, s32, 49152
    s_mov_b32 s33, 8126464
    buffer_load_dwordx4 v5, s[12:15], s33 offen lds
    v_mfma_f32_32x32x16_bf16 a[80:95], v[76:79], v[92:95], a[80:95]
    ds_read_b128 v[52:55], v21 offset:12288
    v_mfma_f32_32x32x16_bf16 a[96:111], v[80:83], v[92:95], a[96:111]
    ds_read_b64_tr_b16 v[60:61], v26 offset:0
    v_mfma_f32_32x32x16_bf16 a[112:127], v[84:87], v[92:95], a[112:127]
    ds_read_b64_tr_b16 v[62:63], v26 offset:2048
    s_movk_i32 s86, 20480
    buffer_load_dword v157, v127, s[72:75], s86 offen
    v_mfma_f32_32x32x16_bf16 a[128:143], v[72:75], v[96:99], a[128:143]
    v_mfma_f32_32x32x16_bf16 a[144:159], v[76:79], v[96:99], a[144:159]
    v_mfma_f32_32x32x16_bf16 a[160:175], v[80:83], v[96:99], a[160:175]
    v_mfma_f32_32x32x16_bf16 a[176:191], v[84:87], v[96:99], a[176:191]
    v_mfma_f32_32x32x16_bf16 a[192:207], v[72:75], v[100:103], a[192:207]
    buffer_load_dwordx4 v6, s[12:15], s33 offen offset:1024 lds
    v_mfma_f32_32x32x16_bf16 a[208:223], v[76:79], v[100:103], a[208:223]
    s_movk_i32 s86, 16384
    buffer_load_dword v156, v127, s[72:75], s86 offen
    v_mfma_f32_32x32x16_bf16 a[224:239], v[80:83], v[100:103], a[224:239]
    v_mfma_f32_32x32x16_bf16 a[240:255], v[84:87], v[100:103], a[240:255]
    s_waitcnt lgkmcnt(5)
    v_mfma_f32_32x32x16_bf16 a[0:15], v[40:43], v[56:59], a[0:15]
    ds_read_b128 v[72:75], v22 offset:0
    ds_read_b64_tr_b16 v[88:89], v25 offset:8192
    s_waitcnt lgkmcnt(6)
    v_mfma_f32_32x32x16_bf16 a[16:31], v[44:47], v[56:59], a[16:31]
    ds_read_b64_tr_b16 v[90:91], v25 offset:10240
    ds_read_b128 v[76:79], v22 offset:4096
    s_waitcnt lgkmcnt(7)
    v_mfma_f32_32x32x16_bf16 a[32:47], v[48:51], v[56:59], a[32:47]
    ds_read_b128 v[80:83], v22 offset:8192
    ds_read_b128 v[84:87], v22 offset:12288
    buffer_load_dwordx4 v7, s[12:15], s33 offen offset:2048 lds
    s_waitcnt lgkmcnt(8)
    v_mfma_f32_32x32x16_bf16 a[48:63], v[52:55], v[56:59], a[48:63]
    ds_read_b64_tr_b16 v[92:93], v26 offset:8192
    ds_read_b64_tr_b16 v[94:95], v26 offset:10240
    s_waitcnt lgkmcnt(8)
    v_mfma_f32_32x32x16_bf16 a[64:79], v[40:43], v[60:63], a[64:79]
    v_mfma_f32_32x32x16_bf16 a[80:95], v[44:47], v[60:63], a[80:95]
    v_mfma_f32_32x32x16_bf16 a[96:111], v[48:51], v[60:63], a[96:111]
    buffer_load_dwordx4 v8, s[12:15], s33 offen offset:3072 lds
    v_mfma_f32_32x32x16_bf16 a[112:127], v[52:55], v[60:63], a[112:127]
    s_movk_i32 s86, 24576
    buffer_load_dword v158, v127, s[72:75], s86 offen
    s_movk_i32 s86, 28672
    buffer_load_dword v159, v127, s[72:75], s86 offen
    s_waitcnt vmcnt(27) lgkmcnt(0)
    s_barrier
    v_mfma_f32_32x32x16_bf16 a[0:15], v[72:75], v[88:91], a[0:15]
    ds_read_b128 v[40:43], v23 offset:0
    ds_read_b64_tr_b16 v[56:57], v25 offset:16384
    v_mfma_f32_32x32x16_bf16 a[16:31], v[76:79], v[88:91], a[16:31]
    ds_read_b64_tr_b16 v[58:59], v25 offset:18432
    ds_read_b128 v[44:47], v23 offset:4096
    v_mfma_f32_32x32x16_bf16 a[32:47], v[80:83], v[88:91], a[32:47]
    ds_read_b128 v[48:51], v23 offset:8192
    ds_read_b128 v[52:55], v23 offset:12288
    v_mfma_f32_32x32x16_bf16 a[48:63], v[84:87], v[88:91], a[48:63]
    ds_read_b64_tr_b16 v[60:61], v26 offset:16384
    ds_read_b64_tr_b16 v[62:63], v26 offset:18432
    v_mfma_f32_32x32x16_bf16 a[64:79], v[72:75], v[92:95], a[64:79]
    v_mfma_f32_32x32x16_bf16 a[80:95], v[76:79], v[92:95], a[80:95]
    v_mfma_f32_32x32x16_bf16 a[96:111], v[80:83], v[92:95], a[96:111]
    v_mfma_f32_32x32x16_bf16 a[112:127], v[84:87], v[92:95], a[112:127]
    s_waitcnt lgkmcnt(5)
    v_mfma_f32_32x32x16_bf16 a[0:15], v[40:43], v[56:59], a[0:15]
    ds_read_b128 v[72:75], v24 offset:0
    ds_read_b64_tr_b16 v[88:89], v25 offset:24576
    s_waitcnt lgkmcnt(6)
    v_mfma_f32_32x32x16_bf16 a[16:31], v[44:47], v[56:59], a[16:31]
    ds_read_b64_tr_b16 v[90:91], v25 offset:26624
    ds_read_b128 v[76:79], v24 offset:4096
    s_waitcnt lgkmcnt(7)
    v_mfma_f32_32x32x16_bf16 a[32:47], v[48:51], v[56:59], a[32:47]
    ds_read_b128 v[80:83], v24 offset:8192
    ds_read_b128 v[84:87], v24 offset:12288
    s_waitcnt lgkmcnt(8)
    v_mfma_f32_32x32x16_bf16 a[48:63], v[52:55], v[56:59], a[48:63]
    ds_read_b64_tr_b16 v[92:93], v26 offset:24576
    ds_read_b64_tr_b16 v[94:95], v26 offset:26624
    s_waitcnt lgkmcnt(8)
    v_mfma_f32_32x32x16_bf16 a[64:79], v[40:43], v[60:63], a[64:79]
    v_mfma_f32_32x32x16_bf16 a[80:95], v[44:47], v[60:63], a[80:95]
    v_mfma_f32_32x32x16_bf16 a[96:111], v[48:51], v[60:63], a[96:111]
    v_mfma_f32_32x32x16_bf16 a[112:127], v[52:55], v[60:63], a[112:127]
    s_waitcnt vmcnt(8) lgkmcnt(0)
    s_barrier
    v_mfma_f32_32x32x16_bf16 a[0:15], v[72:75], v[88:91], a[0:15]
    ds_read_b128 v[40:43], v17 offset:0
    ds_read_b64_tr_b16 v[56:57], v25 offset:32768
    v_mfma_f32_32x32x16_bf16 a[16:31], v[76:79], v[88:91], a[16:31]
    ds_read_b64_tr_b16 v[58:59], v25 offset:34816
    ds_read_b128 v[44:47], v17 offset:4096
    v_mfma_f32_32x32x16_bf16 a[32:47], v[80:83], v[88:91], a[32:47]
    ds_read_b128 v[48:51], v17 offset:8192
    ds_read_b128 v[52:55], v17 offset:12288
    v_mfma_f32_32x32x16_bf16 a[48:63], v[84:87], v[88:91], a[48:63]
    ds_read_b64_tr_b16 v[60:61], v26 offset:32768
    ds_read_b64_tr_b16 v[62:63], v26 offset:34816
    v_mfma_f32_32x32x16_bf16 a[64:79], v[72:75], v[92:95], a[64:79]
    v_mfma_f32_32x32x16_bf16 a[80:95], v[76:79], v[92:95], a[80:95]
    v_mfma_f32_32x32x16_bf16 a[96:111], v[80:83], v[92:95], a[96:111]
    v_mfma_f32_32x32x16_bf16 a[112:127], v[84:87], v[92:95], a[112:127]
    s_waitcnt lgkmcnt(5)
    v_mfma_f32_32x32x16_bf16 a[0:15], v[40:43], v[56:59], a[0:15]
    ds_read_b128 v[72:75], v18 offset:0
    ds_read_b64_tr_b16 v[88:89], v25 offset:40960
    s_waitcnt lgkmcnt(6)
    v_mfma_f32_32x32x16_bf16 a[16:31], v[44:47], v[56:59], a[16:31]
    ds_read_b64_tr_b16 v[90:91], v25 offset:43008
    ds_read_b128 v[76:79], v18 offset:4096
    s_waitcnt lgkmcnt(7)
    v_mfma_f32_32x32x16_bf16 a[32:47], v[48:51], v[56:59], a[32:47]
    ds_read_b128 v[80:83], v18 offset:8192
    ds_read_b128 v[84:87], v18 offset:12288
    s_waitcnt lgkmcnt(8)
    v_mfma_f32_32x32x16_bf16 a[48:63], v[52:55], v[56:59], a[48:63]
    ds_read_b64_tr_b16 v[92:93], v26 offset:40960
    ds_read_b64_tr_b16 v[94:95], v26 offset:43008
    s_waitcnt lgkmcnt(8)
    v_mfma_f32_32x32x16_bf16 a[64:79], v[40:43], v[60:63], a[64:79]
    v_mfma_f32_32x32x16_bf16 a[80:95], v[44:47], v[60:63], a[80:95]
    v_mfma_f32_32x32x16_bf16 a[96:111], v[48:51], v[60:63], a[96:111]
    v_mfma_f32_32x32x16_bf16 a[112:127], v[52:55], v[60:63], a[112:127]
    s_waitcnt vmcnt(2) lgkmcnt(0)
    s_barrier
    v_mfma_f32_32x32x16_bf16 a[0:15], v[72:75], v[88:91], a[0:15]
    ds_read_b128 v[40:43], v19 offset:0
    ds_read_b64_tr_b16 v[56:57], v25 offset:49152
    v_mfma_f32_32x32x16_bf16 a[16:31], v[76:79], v[88:91], a[16:31]
    ds_read_b64_tr_b16 v[58:59], v25 offset:51200
    ds_read_b128 v[44:47], v19 offset:4096
    v_mfma_f32_32x32x16_bf16 a[32:47], v[80:83], v[88:91], a[32:47]
    ds_read_b128 v[48:51], v19 offset:8192
    ds_read_b128 v[52:55], v19 offset:12288
    v_mfma_f32_32x32x16_bf16 a[48:63], v[84:87], v[88:91], a[48:63]
    ds_read_b64_tr_b16 v[60:61], v26 offset:49152
    ds_read_b64_tr_b16 v[62:63], v26 offset:51200
    v_mfma_f32_32x32x16_bf16 a[64:79], v[72:75], v[92:95], a[64:79]
    v_mfma_f32_32x32x16_bf16 a[80:95], v[76:79], v[92:95], a[80:95]
    v_mfma_f32_32x32x16_bf16 a[96:111], v[80:83], v[92:95], a[96:111]
    v_mfma_f32_32x32x16_bf16 a[112:127], v[84:87], v[92:95], a[112:127]
    s_waitcnt lgkmcnt(5)
    v_mfma_f32_32x32x16_bf16 a[0:15], v[40:43], v[56:59], a[0:15]
    ds_read_b128 v[72:75], v20 offset:0
    ds_read_b64_tr_b16 v[88:89], v25 offset:57344
    s_waitcnt lgkmcnt(6)
    v_mfma_f32_32x32x16_bf16 a[16:31], v[44:47], v[56:59], a[16:31]
    ds_read_b64_tr_b16 v[90:91], v25 offset:59392
    ds_read_b128 v[76:79], v20 offset:4096
    s_waitcnt lgkmcnt(7)
    v_mfma_f32_32x32x16_bf16 a[32:47], v[48:51], v[56:59], a[32:47]
    ds_read_b128 v[80:83], v20 offset:8192
    ds_read_b128 v[84:87], v20 offset:12288
    s_waitcnt lgkmcnt(8)
    v_mfma_f32_32x32x16_bf16 a[48:63], v[52:55], v[56:59], a[48:63]
    ds_read_b64_tr_b16 v[92:93], v26 offset:57344
    ds_read_b64_tr_b16 v[94:95], v26 offset:59392
    s_waitcnt lgkmcnt(8)
    v_mfma_f32_32x32x16_bf16 a[64:79], v[40:43], v[60:63], a[64:79]
    v_mfma_f32_32x32x16_bf16 a[80:95], v[44:47], v[60:63], a[80:95]
    v_mfma_f32_32x32x16_bf16 a[96:111], v[48:51], v[60:63], a[96:111]
    v_mfma_f32_32x32x16_bf16 a[112:127], v[52:55], v[60:63], a[112:127]
    s_waitcnt lgkmcnt(0)
    s_barrier
    v_mfma_f32_32x32x16_bf16 a[0:15], v[72:75], v[88:91], a[0:15]
    ds_read_b128 v[40:43], v21 offset:0
    ds_read_b64_tr_b16 v[64:65], v27 offset:0
    v_mfma_f32_32x32x16_bf16 a[16:31], v[76:79], v[88:91], a[16:31]
    ds_read_b64_tr_b16 v[66:67], v27 offset:2048
    ds_read_b128 v[44:47], v21 offset:4096
    v_mfma_f32_32x32x16_bf16 a[32:47], v[80:83], v[88:91], a[32:47]
    ds_read_b128 v[48:51], v21 offset:8192
    ds_read_b128 v[52:55], v21 offset:12288
    v_mfma_f32_32x32x16_bf16 a[48:63], v[84:87], v[88:91], a[48:63]
    ds_read_b64_tr_b16 v[68:69], v28 offset:0
    ds_read_b64_tr_b16 v[70:71], v28 offset:2048
    v_mfma_f32_32x32x16_bf16 a[64:79], v[72:75], v[92:95], a[64:79]
    v_mfma_f32_32x32x16_bf16 a[80:95], v[76:79], v[92:95], a[80:95]
    v_mfma_f32_32x32x16_bf16 a[96:111], v[80:83], v[92:95], a[96:111]
    v_mfma_f32_32x32x16_bf16 a[112:127], v[84:87], v[92:95], a[112:127]
    s_waitcnt lgkmcnt(5)
    v_mfma_f32_32x32x16_bf16 a[128:143], v[40:43], v[64:67], a[128:143]
    ds_read_b128 v[72:75], v22 offset:0
    ds_read_b64_tr_b16 v[96:97], v27 offset:8192
    s_waitcnt lgkmcnt(6)
    v_mfma_f32_32x32x16_bf16 a[144:159], v[44:47], v[64:67], a[144:159]
    ds_read_b64_tr_b16 v[98:99], v27 offset:10240
    ds_read_b128 v[76:79], v22 offset:4096
    s_waitcnt lgkmcnt(7)
    v_mfma_f32_32x32x16_bf16 a[160:175], v[48:51], v[64:67], a[160:175]
    ds_read_b128 v[80:83], v22 offset:8192
    ds_read_b128 v[84:87], v22 offset:12288
    s_waitcnt lgkmcnt(8)
    v_mfma_f32_32x32x16_bf16 a[176:191], v[52:55], v[64:67], a[176:191]
    ds_read_b64_tr_b16 v[100:101], v28 offset:8192
    ds_read_b64_tr_b16 v[102:103], v28 offset:10240
    s_waitcnt lgkmcnt(8)
    v_mfma_f32_32x32x16_bf16 a[192:207], v[40:43], v[68:71], a[192:207]
    v_mfma_f32_32x32x16_bf16 a[208:223], v[44:47], v[68:71], a[208:223]
    v_mfma_f32_32x32x16_bf16 a[224:239], v[48:51], v[68:71], a[224:239]
    v_mfma_f32_32x32x16_bf16 a[240:255], v[52:55], v[68:71], a[240:255]
    s_waitcnt lgkmcnt(5)
    v_mfma_f32_32x32x16_bf16 a[128:143], v[72:75], v[96:99], a[128:143]
    ds_read_b128 v[40:43], v23 offset:0
    ds_read_b64_tr_b16 v[64:65], v27 offset:16384
    v_accvgpr_read_b32 v160, a0
    v_accvgpr_read_b32 v161, a1
    v_accvgpr_read_b32 v162, a2
    v_accvgpr_read_b32 v163, a3
    s_waitcnt lgkmcnt(6)
    v_mfma_f32_32x32x16_bf16 a[144:159], v[76:79], v[96:99], a[144:159]
    ds_read_b64_tr_b16 v[66:67], v27 offset:18432
    ds_read_b128 v[44:47], v23 offset:4096
    v_accvgpr_read_b32 v164, a4
    v_accvgpr_read_b32 v165, a5
    v_accvgpr_read_b32 v166, a6
    v_accvgpr_read_b32 v167, a7
    s_waitcnt lgkmcnt(7)
    v_mfma_f32_32x32x16_bf16 a[160:175], v[80:83], v[96:99], a[160:175]
    ds_read_b128 v[48:51], v23 offset:8192
    ds_read_b128 v[52:55], v23 offset:12288
    v_cvt_pk_bf16_f32 v176, v160, v161
    v_cvt_pk_bf16_f32 v177, v162, v163
    v_cvt_pk_bf16_f32 v178, v164, v165
    v_cvt_pk_bf16_f32 v179, v166, v167
    s_waitcnt lgkmcnt(8)
    v_mfma_f32_32x32x16_bf16 a[176:191], v[84:87], v[96:99], a[176:191]
    ds_read_b64_tr_b16 v[68:69], v28 offset:16384
    ds_read_b64_tr_b16 v[70:71], v28 offset:18432
    s_mov_b32 s34, 0
    buffer_store_dwordx4 v[176:179], v37, s[24:27], s34 offen sc1
    v_accvgpr_read_b32 v168, a8
    v_accvgpr_read_b32 v169, a9
    s_waitcnt lgkmcnt(8)
    v_mfma_f32_32x32x16_bf16 a[192:207], v[72:75], v[100:103], a[192:207]
    v_accvgpr_read_b32 v170, a10
    v_accvgpr_read_b32 v171, a11
    v_accvgpr_read_b32 v172, a12
    v_accvgpr_read_b32 v173, a13
    v_mfma_f32_32x32x16_bf16 a[208:223], v[76:79], v[100:103], a[208:223]
    v_accvgpr_read_b32 v174, a14
    v_accvgpr_read_b32 v175, a15
    v_cvt_pk_bf16_f32 v180, v168, v169
    v_cvt_pk_bf16_f32 v181, v170, v171
    v_mfma_f32_32x32x16_bf16 a[224:239], v[80:83], v[100:103], a[224:239]
    v_cvt_pk_bf16_f32 v182, v172, v173
    v_cvt_pk_bf16_f32 v183, v174, v175
    s_mov_b32 s34, 8192
    buffer_store_dwordx4 v[180:183], v37, s[24:27], s34 offen sc1
    v_mfma_f32_32x32x16_bf16 a[240:255], v[84:87], v[100:103], a[240:255]
    v_accvgpr_read_b32 v160, a16
    v_accvgpr_read_b32 v161, a17
    v_accvgpr_read_b32 v162, a18
    v_accvgpr_read_b32 v163, a19
    s_waitcnt lgkmcnt(5)
    v_mfma_f32_32x32x16_bf16 a[128:143], v[40:43], v[64:67], a[128:143]
    ds_read_b128 v[72:75], v24 offset:0
    ds_read_b64_tr_b16 v[96:97], v27 offset:24576
    v_accvgpr_read_b32 v164, a20
    v_accvgpr_read_b32 v165, a21
    v_accvgpr_read_b32 v166, a22
    v_accvgpr_read_b32 v167, a23
    s_waitcnt lgkmcnt(6)
    v_mfma_f32_32x32x16_bf16 a[144:159], v[44:47], v[64:67], a[144:159]
    ds_read_b64_tr_b16 v[98:99], v27 offset:26624
    ds_read_b128 v[76:79], v24 offset:4096
    v_cvt_pk_bf16_f32 v184, v160, v161
    v_cvt_pk_bf16_f32 v185, v162, v163
    v_cvt_pk_bf16_f32 v186, v164, v165
    v_cvt_pk_bf16_f32 v187, v166, v167
    s_waitcnt lgkmcnt(7)
    v_mfma_f32_32x32x16_bf16 a[160:175], v[48:51], v[64:67], a[160:175]
    ds_read_b128 v[80:83], v24 offset:8192
    ds_read_b128 v[84:87], v24 offset:12288
    s_mov_b32 s34, 16384
    buffer_store_dwordx4 v[184:187], v37, s[24:27], s34 offen sc1
    v_accvgpr_read_b32 v168, a24
    v_accvgpr_read_b32 v169, a25
    s_waitcnt lgkmcnt(8)
    v_mfma_f32_32x32x16_bf16 a[176:191], v[52:55], v[64:67], a[176:191]
    ds_read_b64_tr_b16 v[100:101], v28 offset:24576
    ds_read_b64_tr_b16 v[102:103], v28 offset:26624
    v_accvgpr_read_b32 v170, a26
    v_accvgpr_read_b32 v171, a27
    v_accvgpr_read_b32 v172, a28
    v_accvgpr_read_b32 v173, a29
    s_waitcnt lgkmcnt(8)
    v_mfma_f32_32x32x16_bf16 a[192:207], v[40:43], v[68:71], a[192:207]
    v_accvgpr_read_b32 v174, a30
    v_accvgpr_read_b32 v175, a31
    v_cvt_pk_bf16_f32 v188, v168, v169
    v_cvt_pk_bf16_f32 v189, v170, v171
    v_mfma_f32_32x32x16_bf16 a[208:223], v[44:47], v[68:71], a[208:223]
    v_cvt_pk_bf16_f32 v190, v172, v173
    v_cvt_pk_bf16_f32 v191, v174, v175
    s_mov_b32 s34, 24576
    buffer_store_dwordx4 v[188:191], v37, s[24:27], s34 offen sc1
    v_mfma_f32_32x32x16_bf16 a[224:239], v[48:51], v[68:71], a[224:239]
    v_accvgpr_read_b32 v160, a32
    v_accvgpr_read_b32 v161, a33
    v_accvgpr_read_b32 v162, a34
    v_accvgpr_read_b32 v163, a35
    v_mfma_f32_32x32x16_bf16 a[240:255], v[52:55], v[68:71], a[240:255]
    v_accvgpr_read_b32 v164, a36
    v_accvgpr_read_b32 v165, a37
    v_accvgpr_read_b32 v166, a38
    v_accvgpr_read_b32 v167, a39
    s_waitcnt lgkmcnt(5)
    v_mfma_f32_32x32x16_bf16 a[128:143], v[72:75], v[96:99], a[128:143]
    ds_read_b128 v[40:43], v17 offset:0
    ds_read_b64_tr_b16 v[64:65], v27 offset:32768
    v_cvt_pk_bf16_f32 v176, v160, v161
    v_cvt_pk_bf16_f32 v177, v162, v163
    v_cvt_pk_bf16_f32 v178, v164, v165
    v_cvt_pk_bf16_f32 v179, v166, v167
    s_waitcnt lgkmcnt(6)
    v_mfma_f32_32x32x16_bf16 a[144:159], v[76:79], v[96:99], a[144:159]
    ds_read_b64_tr_b16 v[66:67], v27 offset:34816
    ds_read_b128 v[44:47], v17 offset:4096
    s_mov_b32 s34, 32768
    buffer_store_dwordx4 v[176:179], v37, s[24:27], s34 offen sc1
    v_accvgpr_read_b32 v168, a40
    v_accvgpr_read_b32 v169, a41
    s_waitcnt lgkmcnt(7)
    v_mfma_f32_32x32x16_bf16 a[160:175], v[80:83], v[96:99], a[160:175]
    ds_read_b128 v[48:51], v17 offset:8192
    ds_read_b128 v[52:55], v17 offset:12288
    v_accvgpr_read_b32 v170, a42
    v_accvgpr_read_b32 v171, a43
    v_accvgpr_read_b32 v172, a44
    v_accvgpr_read_b32 v173, a45
    s_waitcnt lgkmcnt(8)
    v_mfma_f32_32x32x16_bf16 a[176:191], v[84:87], v[96:99], a[176:191]
    ds_read_b64_tr_b16 v[68:69], v28 offset:32768
    ds_read_b64_tr_b16 v[70:71], v28 offset:34816
    v_accvgpr_read_b32 v174, a46
    v_accvgpr_read_b32 v175, a47
    v_cvt_pk_bf16_f32 v180, v168, v169
    v_cvt_pk_bf16_f32 v181, v170, v171
    s_waitcnt lgkmcnt(8)
    v_mfma_f32_32x32x16_bf16 a[192:207], v[72:75], v[100:103], a[192:207]
    v_cvt_pk_bf16_f32 v182, v172, v173
    v_cvt_pk_bf16_f32 v183, v174, v175
    s_mov_b32 s34, 40960
    buffer_store_dwordx4 v[180:183], v37, s[24:27], s34 offen sc1
    v_mfma_f32_32x32x16_bf16 a[208:223], v[76:79], v[100:103], a[208:223]
    v_accvgpr_read_b32 v160, a48
    v_accvgpr_read_b32 v161, a49
    v_accvgpr_read_b32 v162, a50
    v_accvgpr_read_b32 v163, a51
    v_mfma_f32_32x32x16_bf16 a[224:239], v[80:83], v[100:103], a[224:239]
    v_accvgpr_read_b32 v164, a52
    v_accvgpr_read_b32 v165, a53
    v_accvgpr_read_b32 v166, a54
    v_accvgpr_read_b32 v167, a55
    v_mfma_f32_32x32x16_bf16 a[240:255], v[84:87], v[100:103], a[240:255]
    v_cvt_pk_bf16_f32 v184, v160, v161
    v_cvt_pk_bf16_f32 v185, v162, v163
    v_cvt_pk_bf16_f32 v186, v164, v165
    v_cvt_pk_bf16_f32 v187, v166, v167
    s_waitcnt lgkmcnt(5)
    v_mfma_f32_32x32x16_bf16 a[128:143], v[40:43], v[64:67], a[128:143]
    ds_read_b128 v[72:75], v18 offset:0
    ds_read_b64_tr_b16 v[96:97], v27 offset:40960
    s_mov_b32 s34, 49152
    buffer_store_dwordx4 v[184:187], v37, s[24:27], s34 offen sc1
    v_accvgpr_read_b32 v168, a56
    v_accvgpr_read_b32 v169, a57
    s_waitcnt lgkmcnt(6)
    v_mfma_f32_32x32x16_bf16 a[144:159], v[44:47], v[64:67], a[144:159]
    ds_read_b64_tr_b16 v[98:99], v27 offset:43008
    ds_read_b128 v[76:79], v18 offset:4096
    v_accvgpr_read_b32 v170, a58
    v_accvgpr_read_b32 v171, a59
    v_accvgpr_read_b32 v172, a60
    v_accvgpr_read_b32 v173, a61
    s_waitcnt lgkmcnt(7)
    v_mfma_f32_32x32x16_bf16 a[160:175], v[48:51], v[64:67], a[160:175]
    ds_read_b128 v[80:83], v18 offset:8192
    ds_read_b128 v[84:87], v18 offset:12288
    v_accvgpr_read_b32 v174, a62
    v_accvgpr_read_b32 v175, a63
    v_cvt_pk_bf16_f32 v188, v168, v169
    v_cvt_pk_bf16_f32 v189, v170, v171
    s_waitcnt lgkmcnt(8)
    v_mfma_f32_32x32x16_bf16 a[176:191], v[52:55], v[64:67], a[176:191]
    ds_read_b64_tr_b16 v[100:101], v28 offset:40960
    ds_read_b64_tr_b16 v[102:103], v28 offset:43008
    v_cvt_pk_bf16_f32 v190, v172, v173
    v_cvt_pk_bf16_f32 v191, v174, v175
    s_mov_b32 s34, 57344
    buffer_store_dwordx4 v[188:191], v37, s[24:27], s34 offen sc1
    s_waitcnt lgkmcnt(8)
    v_mfma_f32_32x32x16_bf16 a[192:207], v[40:43], v[68:71], a[192:207]
    v_accvgpr_read_b32 v160, a64
    v_accvgpr_read_b32 v161, a65
    v_accvgpr_read_b32 v162, a66
    v_accvgpr_read_b32 v163, a67
    v_mfma_f32_32x32x16_bf16 a[208:223], v[44:47], v[68:71], a[208:223]
    v_accvgpr_read_b32 v164, a68
    v_accvgpr_read_b32 v165, a69
    v_accvgpr_read_b32 v166, a70
    v_accvgpr_read_b32 v167, a71
    v_mfma_f32_32x32x16_bf16 a[224:239], v[48:51], v[68:71], a[224:239]
    v_cvt_pk_bf16_f32 v176, v160, v161
    v_cvt_pk_bf16_f32 v177, v162, v163
    v_cvt_pk_bf16_f32 v178, v164, v165
    v_cvt_pk_bf16_f32 v179, v166, v167
    v_mfma_f32_32x32x16_bf16 a[240:255], v[52:55], v[68:71], a[240:255]
    s_mov_b32 s34, 1024
    buffer_store_dwordx4 v[176:179], v37, s[24:27], s34 offen sc1
    v_accvgpr_read_b32 v168, a72
    v_accvgpr_read_b32 v169, a73
    s_waitcnt lgkmcnt(5)
    v_mfma_f32_32x32x16_bf16 a[128:143], v[72:75], v[96:99], a[128:143]
    ds_read_b128 v[40:43], v19 offset:0
    ds_read_b64_tr_b16 v[64:65], v27 offset:49152
    v_accvgpr_read_b32 v170, a74
    v_accvgpr_read_b32 v171, a75
    v_accvgpr_read_b32 v172, a76
    v_accvgpr_read_b32 v173, a77
    s_waitcnt lgkmcnt(6)
    v_mfma_f32_32x32x16_bf16 a[144:159], v[76:79], v[96:99], a[144:159]
    ds_read_b64_tr_b16 v[66:67], v27 offset:51200
    ds_read_b128 v[44:47], v19 offset:4096
    v_accvgpr_read_b32 v174, a78
    v_accvgpr_read_b32 v175, a79
    v_cvt_pk_bf16_f32 v180, v168, v169
    v_cvt_pk_bf16_f32 v181, v170, v171
    s_waitcnt lgkmcnt(7)
    v_mfma_f32_32x32x16_bf16 a[160:175], v[80:83], v[96:99], a[160:175]
    ds_read_b128 v[48:51], v19 offset:8192
    ds_read_b128 v[52:55], v19 offset:12288
    v_cvt_pk_bf16_f32 v182, v172, v173
    v_cvt_pk_bf16_f32 v183, v174, v175
    s_mov_b32 s34, 9216
    buffer_store_dwordx4 v[180:183], v37, s[24:27], s34 offen sc1
    s_waitcnt lgkmcnt(8)
    v_mfma_f32_32x32x16_bf16 a[176:191], v[84:87], v[96:99], a[176:191]
    ds_read_b64_tr_b16 v[68:69], v28 offset:49152
    ds_read_b64_tr_b16 v[70:71], v28 offset:51200
    v_accvgpr_read_b32 v160, a80
    v_accvgpr_read_b32 v161, a81
    v_accvgpr_read_b32 v162, a82
    v_accvgpr_read_b32 v163, a83
    s_waitcnt lgkmcnt(8)
    v_mfma_f32_32x32x16_bf16 a[192:207], v[72:75], v[100:103], a[192:207]
    v_accvgpr_read_b32 v164, a84
    v_accvgpr_read_b32 v165, a85
    v_accvgpr_read_b32 v166, a86
    v_accvgpr_read_b32 v167, a87
    v_mfma_f32_32x32x16_bf16 a[208:223], v[76:79], v[100:103], a[208:223]
    v_cvt_pk_bf16_f32 v184, v160, v161
    v_cvt_pk_bf16_f32 v185, v162, v163
    v_cvt_pk_bf16_f32 v186, v164, v165
    v_cvt_pk_bf16_f32 v187, v166, v167
    v_mfma_f32_32x32x16_bf16 a[224:239], v[80:83], v[100:103], a[224:239]
    s_mov_b32 s34, 17408
    buffer_store_dwordx4 v[184:187], v37, s[24:27], s34 offen sc1
    v_accvgpr_read_b32 v168, a88
    v_accvgpr_read_b32 v169, a89
    v_mfma_f32_32x32x16_bf16 a[240:255], v[84:87], v[100:103], a[240:255]
    v_accvgpr_read_b32 v170, a90
    v_accvgpr_read_b32 v171, a91
    v_accvgpr_read_b32 v172, a92
    v_accvgpr_read_b32 v173, a93
    s_waitcnt lgkmcnt(5)
    v_mfma_f32_32x32x16_bf16 a[128:143], v[40:43], v[64:67], a[128:143]
    ds_read_b128 v[72:75], v20 offset:0
    ds_read_b64_tr_b16 v[96:97], v27 offset:57344
    v_accvgpr_read_b32 v174, a94
    v_accvgpr_read_b32 v175, a95
    v_cvt_pk_bf16_f32 v188, v168, v169
    v_cvt_pk_bf16_f32 v189, v170, v171
    s_waitcnt lgkmcnt(6)
    v_mfma_f32_32x32x16_bf16 a[144:159], v[44:47], v[64:67], a[144:159]
    ds_read_b64_tr_b16 v[98:99], v27 offset:59392
    ds_read_b128 v[76:79], v20 offset:4096
    v_cvt_pk_bf16_f32 v190, v172, v173
    v_cvt_pk_bf16_f32 v191, v174, v175
    s_mov_b32 s34, 25600
    buffer_store_dwordx4 v[188:191], v37, s[24:27], s34 offen sc1
    s_waitcnt lgkmcnt(7)
    v_mfma_f32_32x32x16_bf16 a[160:175], v[48:51], v[64:67], a[160:175]
    ds_read_b128 v[80:83], v20 offset:8192
    ds_read_b128 v[84:87], v20 offset:12288
    v_accvgpr_read_b32 v160, a96
    v_accvgpr_read_b32 v161, a97
    v_accvgpr_read_b32 v162, a98
    v_accvgpr_read_b32 v163, a99
    s_waitcnt lgkmcnt(8)
    v_mfma_f32_32x32x16_bf16 a[176:191], v[52:55], v[64:67], a[176:191]
    ds_read_b64_tr_b16 v[100:101], v28 offset:57344
    ds_read_b64_tr_b16 v[102:103], v28 offset:59392
    v_accvgpr_read_b32 v164, a100
    v_accvgpr_read_b32 v165, a101
    v_accvgpr_read_b32 v166, a102
    v_accvgpr_read_b32 v167, a103
    s_waitcnt lgkmcnt(8)
    v_mfma_f32_32x32x16_bf16 a[192:207], v[40:43], v[68:71], a[192:207]
    v_cvt_pk_bf16_f32 v176, v160, v161
    v_cvt_pk_bf16_f32 v177, v162, v163
    v_cvt_pk_bf16_f32 v178, v164, v165
    v_cvt_pk_bf16_f32 v179, v166, v167
    v_mfma_f32_32x32x16_bf16 a[208:223], v[44:47], v[68:71], a[208:223]
    s_mov_b32 s34, 33792
    buffer_store_dwordx4 v[176:179], v37, s[24:27], s34 offen sc1
    v_accvgpr_read_b32 v168, a104
    v_accvgpr_read_b32 v169, a105
    v_mfma_f32_32x32x16_bf16 a[224:239], v[48:51], v[68:71], a[224:239]
    v_accvgpr_read_b32 v170, a106
    v_accvgpr_read_b32 v171, a107
    v_accvgpr_read_b32 v172, a108
    v_accvgpr_read_b32 v173, a109
    v_mfma_f32_32x32x16_bf16 a[240:255], v[52:55], v[68:71], a[240:255]
    v_accvgpr_read_b32 v174, a110
    v_accvgpr_read_b32 v175, a111
    v_cvt_pk_bf16_f32 v180, v168, v169
    v_cvt_pk_bf16_f32 v181, v170, v171
    s_waitcnt lgkmcnt(5)
    v_mfma_f32_32x32x16_bf16 a[128:143], v[72:75], v[96:99], a[128:143]
    v_cvt_pk_bf16_f32 v182, v172, v173
    v_cvt_pk_bf16_f32 v183, v174, v175
    s_mov_b32 s34, 41984
    buffer_store_dwordx4 v[180:183], v37, s[24:27], s34 offen sc1
    s_waitcnt lgkmcnt(4)
    v_mfma_f32_32x32x16_bf16 a[144:159], v[76:79], v[96:99], a[144:159]
    v_accvgpr_read_b32 v160, a112
    v_accvgpr_read_b32 v161, a113
    v_accvgpr_read_b32 v162, a114
    v_accvgpr_read_b32 v163, a115
    s_waitcnt lgkmcnt(3)
    v_mfma_f32_32x32x16_bf16 a[160:175], v[80:83], v[96:99], a[160:175]
    v_accvgpr_read_b32 v164, a116
    v_accvgpr_read_b32 v165, a117
    v_accvgpr_read_b32 v166, a118
    v_accvgpr_read_b32 v167, a119
    s_waitcnt lgkmcnt(2)
    v_mfma_f32_32x32x16_bf16 a[176:191], v[84:87], v[96:99], a[176:191]
    v_cvt_pk_bf16_f32 v184, v160, v161
    v_cvt_pk_bf16_f32 v185, v162, v163
    v_cvt_pk_bf16_f32 v186, v164, v165
    v_cvt_pk_bf16_f32 v187, v166, v167
    s_waitcnt lgkmcnt(0)
    v_mfma_f32_32x32x16_bf16 a[192:207], v[72:75], v[100:103], a[192:207]
    s_mov_b32 s34, 50176
    buffer_store_dwordx4 v[184:187], v37, s[24:27], s34 offen sc1
    v_accvgpr_read_b32 v168, a120
    v_accvgpr_read_b32 v169, a121
    v_mfma_f32_32x32x16_bf16 a[208:223], v[76:79], v[100:103], a[208:223]
    v_accvgpr_read_b32 v170, a122
    v_accvgpr_read_b32 v171, a123
    v_accvgpr_read_b32 v172, a124
    v_accvgpr_read_b32 v173, a125
    v_mfma_f32_32x32x16_bf16 a[224:239], v[80:83], v[100:103], a[224:239]
    v_accvgpr_read_b32 v174, a126
    v_accvgpr_read_b32 v175, a127
    v_cvt_pk_bf16_f32 v188, v168, v169
    v_cvt_pk_bf16_f32 v189, v170, v171
    v_mfma_f32_32x32x16_bf16 a[240:255], v[84:87], v[100:103], a[240:255]
    v_cvt_pk_bf16_f32 v190, v172, v173
    v_cvt_pk_bf16_f32 v191, v174, v175
    s_mov_b32 s34, 58368
    buffer_store_dwordx4 v[188:191], v37, s[24:27], s34 offen sc1
    s_nop 7
    s_nop 7
    v_accvgpr_read_b32 v160, a128
    v_accvgpr_read_b32 v161, a129
    v_accvgpr_read_b32 v162, a130
    v_accvgpr_read_b32 v163, a131
    v_accvgpr_read_b32 v164, a132
    v_accvgpr_read_b32 v165, a133
    v_accvgpr_read_b32 v166, a134
    v_accvgpr_read_b32 v167, a135
    v_cvt_pk_bf16_f32 v176, v160, v161
    v_cvt_pk_bf16_f32 v177, v162, v163
    v_cvt_pk_bf16_f32 v178, v164, v165
    v_cvt_pk_bf16_f32 v179, v166, v167
    s_mov_b32 s34, 2048
    buffer_store_dwordx4 v[176:179], v37, s[24:27], s34 offen sc1
    v_accvgpr_read_b32 v168, a136
    v_accvgpr_read_b32 v169, a137
    v_accvgpr_read_b32 v170, a138
    v_accvgpr_read_b32 v171, a139
    v_accvgpr_read_b32 v172, a140
    v_accvgpr_read_b32 v173, a141
    v_accvgpr_read_b32 v174, a142
    v_accvgpr_read_b32 v175, a143
    v_cvt_pk_bf16_f32 v180, v168, v169
    v_cvt_pk_bf16_f32 v181, v170, v171
    v_cvt_pk_bf16_f32 v182, v172, v173
    v_cvt_pk_bf16_f32 v183, v174, v175
    s_mov_b32 s34, 10240
    buffer_store_dwordx4 v[180:183], v37, s[24:27], s34 offen sc1
    v_accvgpr_read_b32 v160, a144
    v_accvgpr_read_b32 v161, a145
    v_accvgpr_read_b32 v162, a146
    v_accvgpr_read_b32 v163, a147
    v_accvgpr_read_b32 v164, a148
    v_accvgpr_read_b32 v165, a149
    v_accvgpr_read_b32 v166, a150
    v_accvgpr_read_b32 v167, a151
    v_cvt_pk_bf16_f32 v184, v160, v161
    v_cvt_pk_bf16_f32 v185, v162, v163
    v_cvt_pk_bf16_f32 v186, v164, v165
    v_cvt_pk_bf16_f32 v187, v166, v167
    s_mov_b32 s34, 18432
    buffer_store_dwordx4 v[184:187], v37, s[24:27], s34 offen sc1
    v_accvgpr_read_b32 v168, a152
    v_accvgpr_read_b32 v169, a153
    v_accvgpr_read_b32 v170, a154
    v_accvgpr_read_b32 v171, a155
    v_accvgpr_read_b32 v172, a156
    v_accvgpr_read_b32 v173, a157
    v_accvgpr_read_b32 v174, a158
    v_accvgpr_read_b32 v175, a159
    v_cvt_pk_bf16_f32 v188, v168, v169
    v_cvt_pk_bf16_f32 v189, v170, v171
    v_cvt_pk_bf16_f32 v190, v172, v173
    v_cvt_pk_bf16_f32 v191, v174, v175
    s_mov_b32 s34, 26624
    buffer_store_dwordx4 v[188:191], v37, s[24:27], s34 offen sc1
    v_accvgpr_read_b32 v160, a160
    v_accvgpr_read_b32 v161, a161
    v_accvgpr_read_b32 v162, a162
    v_accvgpr_read_b32 v163, a163
    v_accvgpr_read_b32 v164, a164
    v_accvgpr_read_b32 v165, a165
    v_accvgpr_read_b32 v166, a166
    v_accvgpr_read_b32 v167, a167
    v_cvt_pk_bf16_f32 v176, v160, v161
    v_cvt_pk_bf16_f32 v177, v162, v163
    v_cvt_pk_bf16_f32 v178, v164, v165
    v_cvt_pk_bf16_f32 v179, v166, v167
    s_mov_b32 s34, 34816
    buffer_store_dwordx4 v[176:179], v37, s[24:27], s34 offen sc1
    v_accvgpr_read_b32 v168, a168
    v_accvgpr_read_b32 v169, a169
    v_accvgpr_read_b32 v170, a170
    v_accvgpr_read_b32 v171, a171
    v_accvgpr_read_b32 v172, a172
    v_accvgpr_read_b32 v173, a173
    v_accvgpr_read_b32 v174, a174
    v_accvgpr_read_b32 v175, a175
    v_cvt_pk_bf16_f32 v180, v168, v169
    v_cvt_pk_bf16_f32 v181, v170, v171
    v_cvt_pk_bf16_f32 v182, v172, v173
    v_cvt_pk_bf16_f32 v183, v174, v175
    s_mov_b32 s34, 43008
    buffer_store_dwordx4 v[180:183], v37, s[24:27], s34 offen sc1
    v_accvgpr_read_b32 v160, a176
    v_accvgpr_read_b32 v161, a177
    v_accvgpr_read_b32 v162, a178
    v_accvgpr_read_b32 v163, a179
    v_accvgpr_read_b32 v164, a180
    v_accvgpr_read_b32 v165, a181
    v_accvgpr_read_b32 v166, a182
    v_accvgpr_read_b32 v167, a183
    v_cvt_pk_bf16_f32 v184, v160, v161
    v_cvt_pk_bf16_f32 v185, v162, v163
    v_cvt_pk_bf16_f32 v186, v164, v165
    v_cvt_pk_bf16_f32 v187, v166, v167
    s_mov_b32 s34, 51200
    buffer_store_dwordx4 v[184:187], v37, s[24:27], s34 offen sc1
    v_accvgpr_read_b32 v168, a184
    v_accvgpr_read_b32 v169, a185
    v_accvgpr_read_b32 v170, a186
    v_accvgpr_read_b32 v171, a187
    v_accvgpr_read_b32 v172, a188
    v_accvgpr_read_b32 v173, a189
    v_accvgpr_read_b32 v174, a190
    v_accvgpr_read_b32 v175, a191
    v_cvt_pk_bf16_f32 v188, v168, v169
    v_cvt_pk_bf16_f32 v189, v170, v171
    v_cvt_pk_bf16_f32 v190, v172, v173
    v_cvt_pk_bf16_f32 v191, v174, v175
    s_mov_b32 s34, 59392
    buffer_store_dwordx4 v[188:191], v37, s[24:27], s34 offen sc1
    v_accvgpr_read_b32 v160, a192
    v_accvgpr_read_b32 v161, a193
    v_accvgpr_read_b32 v162, a194
    v_accvgpr_read_b32 v163, a195
    v_accvgpr_read_b32 v164, a196
    v_accvgpr_read_b32 v165, a197
    v_accvgpr_read_b32 v166, a198
    v_accvgpr_read_b32 v167, a199
    v_cvt_pk_bf16_f32 v176, v160, v161
    v_cvt_pk_bf16_f32 v177, v162, v163
    v_cvt_pk_bf16_f32 v178, v164, v165
    v_cvt_pk_bf16_f32 v179, v166, v167
    s_mov_b32 s34, 3072
    buffer_store_dwordx4 v[176:179], v37, s[24:27], s34 offen sc1
    v_accvgpr_read_b32 v168, a200
    v_accvgpr_read_b32 v169, a201
    v_accvgpr_read_b32 v170, a202
    v_accvgpr_read_b32 v171, a203
    v_accvgpr_read_b32 v172, a204
    v_accvgpr_read_b32 v173, a205
    v_accvgpr_read_b32 v174, a206
    v_accvgpr_read_b32 v175, a207
    v_cvt_pk_bf16_f32 v180, v168, v169
    v_cvt_pk_bf16_f32 v181, v170, v171
    v_cvt_pk_bf16_f32 v182, v172, v173
    v_cvt_pk_bf16_f32 v183, v174, v175
    s_mov_b32 s34, 11264
    buffer_store_dwordx4 v[180:183], v37, s[24:27], s34 offen sc1
    v_accvgpr_read_b32 v160, a208
    v_accvgpr_read_b32 v161, a209
    v_accvgpr_read_b32 v162, a210
    v_accvgpr_read_b32 v163, a211
    v_accvgpr_read_b32 v164, a212
    v_accvgpr_read_b32 v165, a213
    v_accvgpr_read_b32 v166, a214
    v_accvgpr_read_b32 v167, a215
    v_cvt_pk_bf16_f32 v184, v160, v161
    v_cvt_pk_bf16_f32 v185, v162, v163
    v_cvt_pk_bf16_f32 v186, v164, v165
    v_cvt_pk_bf16_f32 v187, v166, v167
    s_mov_b32 s34, 19456
    buffer_store_dwordx4 v[184:187], v37, s[24:27], s34 offen sc1
    v_accvgpr_read_b32 v168, a216
    v_accvgpr_read_b32 v169, a217
    v_accvgpr_read_b32 v170, a218
    v_accvgpr_read_b32 v171, a219
    v_accvgpr_read_b32 v172, a220
    v_accvgpr_read_b32 v173, a221
    v_accvgpr_read_b32 v174, a222
    v_accvgpr_read_b32 v175, a223
    v_cvt_pk_bf16_f32 v188, v168, v169
    v_cvt_pk_bf16_f32 v189, v170, v171
    v_cvt_pk_bf16_f32 v190, v172, v173
    v_cvt_pk_bf16_f32 v191, v174, v175
    s_mov_b32 s34, 27648
    buffer_store_dwordx4 v[188:191], v37, s[24:27], s34 offen sc1
    v_accvgpr_read_b32 v160, a224
    v_accvgpr_read_b32 v161, a225
    v_accvgpr_read_b32 v162, a226
    v_accvgpr_read_b32 v163, a227
    v_accvgpr_read_b32 v164, a228
    v_accvgpr_read_b32 v165, a229
    v_accvgpr_read_b32 v166, a230
    v_accvgpr_read_b32 v167, a231
    v_cvt_pk_bf16_f32 v176, v160, v161
    v_cvt_pk_bf16_f32 v177, v162, v163
    v_cvt_pk_bf16_f32 v178, v164, v165
    v_cvt_pk_bf16_f32 v179, v166, v167
    s_mov_b32 s34, 35840
    buffer_store_dwordx4 v[176:179], v37, s[24:27], s34 offen sc1
    v_accvgpr_read_b32 v168, a232
    v_accvgpr_read_b32 v169, a233
    v_accvgpr_read_b32 v170, a234
    v_accvgpr_read_b32 v171, a235
    v_accvgpr_read_b32 v172, a236
    v_accvgpr_read_b32 v173, a237
    v_accvgpr_read_b32 v174, a238
    v_accvgpr_read_b32 v175, a239
    v_cvt_pk_bf16_f32 v180, v168, v169
    v_cvt_pk_bf16_f32 v181, v170, v171
    v_cvt_pk_bf16_f32 v182, v172, v173
    v_cvt_pk_bf16_f32 v183, v174, v175
    s_mov_b32 s34, 44032
    buffer_store_dwordx4 v[180:183], v37, s[24:27], s34 offen sc1
    v_accvgpr_read_b32 v160, a240
    v_accvgpr_read_b32 v161, a241
    v_accvgpr_read_b32 v162, a242
    v_accvgpr_read_b32 v163, a243
    v_accvgpr_read_b32 v164, a244
    v_accvgpr_read_b32 v165, a245
    v_accvgpr_read_b32 v166, a246
    v_accvgpr_read_b32 v167, a247
    v_cvt_pk_bf16_f32 v184, v160, v161
    v_cvt_pk_bf16_f32 v185, v162, v163
    v_cvt_pk_bf16_f32 v186, v164, v165
    v_cvt_pk_bf16_f32 v187, v166, v167
    s_mov_b32 s34, 52224
    buffer_store_dwordx4 v[184:187], v37, s[24:27], s34 offen sc1
    v_accvgpr_read_b32 v168, a248
    v_accvgpr_read_b32 v169, a249
    v_accvgpr_read_b32 v170, a250
    v_accvgpr_read_b32 v171, a251
    v_accvgpr_read_b32 v172, a252
    v_accvgpr_read_b32 v173, a253
    v_accvgpr_read_b32 v174, a254
    v_accvgpr_read_b32 v175, a255
    v_cvt_pk_bf16_f32 v188, v168, v169
    v_cvt_pk_bf16_f32 v189, v170, v171
    v_cvt_pk_bf16_f32 v190, v172, v173
    v_cvt_pk_bf16_f32 v191, v174, v175
    s_mov_b32 s34, 60416
    buffer_store_dwordx4 v[188:191], v37, s[24:27], s34 offen sc1
    s_barrier
    s_mul_i32 s55, s2, 14336
    s_add_u32 s8, s98, s55
    s_addc_u32 s9, s99, 0
    s_mov_b32 s10, 14336
    s_mov_b32 s11, 0x20000
    v_lshlrev_b32 v1, 4, v39
    s_mov_b32 m0, s32
    s_nop 0
    buffer_load_dwordx4 v1, s[8:11], s32 offen offset:0 lds
    buffer_load_dwordx4 v1, s[8:11], s32 offen offset:1024 lds
    buffer_load_dwordx4 v1, s[8:11], s32 offen offset:2048 lds
    buffer_load_dwordx4 v1, s[8:11], s32 offen offset:3072 lds
    v_lshlrev_b32 v41, 4, v0
    v_mov_b32 v72, 0
    v_mov_b32 v73, 0
    v_mov_b32 v74, 0
    v_mov_b32 v75, 0
    v_add_u32 v44, 140800, v41
    ds_write_b128 v44, v[72:75]
    v_add_u32 v45, 150016, v41
    ds_write_b128 v45, v[72:75]
    v_cmp_gt_u32 vcc, 32, v0
    s_and_saveexec_b64 s[86:87], vcc
    s_cbranch_execz b2_skipz_1
    ds_write_b128 v44, v[72:75] offset:4096
    ds_write_b128 v45, v[72:75] offset:4096
b2_skipz_1:
    s_mov_b64 exec, s[86:87]
    s_movk_i32 s85, 0x70
    v_lshrrev_b32 v46, 3, v0
    v_mul_u32_u24 v46, 4416, v46
    v_and_b32 v47, 7, v0
    v_lshlrev_b32 v47, 4, v47
    v_add3_u32 v46, v46, v47, 0
    v_add_u32 v46, 65536, v46
    v_cmp_gt_u32 vcc, 128, v0
    v_cmp_gt_u32 s[86:87], s85, v47
    s_and_b64 vcc, vcc, s[86:87]
    s_and_saveexec_b64 s[86:87], vcc
    s_cbranch_execz b2_skipz2_1
    ds_write_b128 v46, v[72:75]
b2_skipz2_1:
    s_mov_b64 exec, s[86:87]
    v_lshrrev_b32 v46, 3, v0
    v_mul_u32_u24 v46, 144, v46
    v_add_u32 v46, v46, v47
    v_add_u32 v44, 136192, v46
    v_sub_u32 v92, 255, v0
    v_lshrrev_b32 v93, 6, v92
    v_mul_u32_u24 v93, 144, v93
    v_and_b32 v92, 63, v92
    v_lshlrev_b32 v92, 1, v92
    v_add_u32 v92, v92, v93
    v_add_u32 v92, 136192, v92
    s_waitcnt vmcnt(36)
    ds_write_b16 v92, v152 offset:4032
    ds_write_b16 v92, v153 offset:3456
    ds_write_b16 v92, v154 offset:2880
    ds_write_b16 v92, v155 offset:2304
    ds_write_b16 v92, v156 offset:1728
    ds_write_b16 v92, v157 offset:1152
    ds_write_b16 v92, v158 offset:576
    ds_write_b16 v92, v159 offset:0
    v_add_u32 v45, 145408, v46
    ds_write_b16_d16_hi v92, v152 offset:13248
    ds_write_b16_d16_hi v92, v153 offset:12672
    ds_write_b16_d16_hi v92, v154 offset:12096
    ds_write_b16_d16_hi v92, v155 offset:11520
    ds_write_b16_d16_hi v92, v156 offset:10944
    ds_write_b16_d16_hi v92, v157 offset:10368
    ds_write_b16_d16_hi v92, v158 offset:9792
    ds_write_b16_d16_hi v92, v159 offset:9216
    v_cmp_eq_u32 vcc, 255, v0
    s_nop 1
    v_cndmask_b32 v140, v140, 0, vcc
    v_cndmask_b32 v141, v141, 0, vcc
    v_cndmask_b32 v142, v142, 0, vcc
    v_cndmask_b32 v143, v143, 0, vcc
    v_add_u32 v44, 65664, v41
    v_alignbit_b32 v76, v137, v136, 16
    v_alignbit_b32 v77, v138, v137, 16
    v_alignbit_b32 v78, v139, v138, 16
    v_alignbit_b32 v79, v140, v139, 16
    ds_write_b128 v44, v[76:79] offset:0
    v_mov_b32 v80, v137
    v_mov_b32 v81, v138
    v_mov_b32 v82, v139
    v_mov_b32 v83, v140
    ds_write_b128 v44, v[80:83] offset:4416
    v_alignbit_b32 v76, v138, v137, 16
    v_alignbit_b32 v77, v139, v138, 16
    v_alignbit_b32 v78, v140, v139, 16
    v_alignbit_b32 v79, v141, v140, 16
    ds_write_b128 v44, v[76:79] offset:8832
    ds_write_b128 v44, v[138:141] offset:13248
    v_alignbit_b32 v76, v139, v138, 16
    v_alignbit_b32 v77, v140, v139, 16
    v_alignbit_b32 v78, v141, v140, 16
    v_alignbit_b32 v79, v142, v141, 16
    ds_write_b128 v44, v[76:79] offset:17664
    v_mov_b32 v80, v139
    v_mov_b32 v81, v140
    v_mov_b32 v82, v141
    v_mov_b32 v83, v142
    ds_write_b128 v44, v[80:83] offset:22080
    v_alignbit_b32 v76, v140, v139, 16
    v_alignbit_b32 v77, v141, v140, 16
    v_alignbit_b32 v78, v142, v141, 16
    v_alignbit_b32 v79, v143, v142, 16
    ds_write_b128 v44, v[76:79] offset:26496
    ds_write_b128 v44, v[140:143] offset:30912
    v_add_u32 v44, 100992, v41
    v_alignbit_b32 v76, v145, v144, 16
    v_alignbit_b32 v77, v146, v145, 16
    v_alignbit_b32 v78, v147, v146, 16
    v_alignbit_b32 v79, v148, v147, 16
    ds_write_b128 v44, v[76:79] offset:0
    v_mov_b32 v80, v145
    v_mov_b32 v81, v146
    v_mov_b32 v82, v147
    v_mov_b32 v83, v148
    ds_write_b128 v44, v[80:83] offset:4416
    v_alignbit_b32 v76, v146, v145, 16
    v_alignbit_b32 v77, v147, v146, 16
    v_alignbit_b32 v78, v148, v147, 16
    v_alignbit_b32 v79, v149, v148, 16
    ds_write_b128 v44, v[76:79] offset:8832
    ds_write_b128 v44, v[146:149] offset:13248
    v_alignbit_b32 v76, v147, v146, 16
    v_alignbit_b32 v77, v148, v147, 16
    v_alignbit_b32 v78, v149, v148, 16
    v_alignbit_b32 v79, v150, v149, 16
    ds_write_b128 v44, v[76:79] offset:17664
    v_mov_b32 v80, v147
    v_mov_b32 v81, v148
    v_mov_b32 v82, v149
    v_mov_b32 v83, v150
    ds_write_b128 v44, v[80:83] offset:22080
    v_alignbit_b32 v76, v148, v147, 16
    v_alignbit_b32 v77, v149, v148, 16
    v_alignbit_b32 v78, v150, v149, 16
    v_alignbit_b32 v79, v151, v150, 16
    ds_write_b128 v44, v[76:79] offset:26496
    ds_write_b128 v44, v[148:151] offset:30912
    s_mov_b64 exec, 1
    s_cmp_eq_u32 s88, 0
    s_cbranch_scc0 b2_skip7_1
    v_mov_b32 v84, 0
    v_mov_b32 v85, 0
    v_mov_b32 v86, 0
    v_mov_b32 v87, 0
    v_mov_b32 v88, v136
    v_mov_b32 v89, v137
    v_mov_b32 v90, v138
    v_mov_b32 v91, v139
    v_mov_b32 v44, 65648
    v_alignbit_b32 v76, v85, v84, 16
    v_alignbit_b32 v77, v86, v85, 16
    v_alignbit_b32 v78, v87, v86, 16
    v_alignbit_b32 v79, v88, v87, 16
    ds_write_b128 v44, v[76:79] offset:0
    v_mov_b32 v80, v85
    v_mov_b32 v81, v86
    v_mov_b32 v82, v87
    v_mov_b32 v83, v88
    ds_write_b128 v44, v[80:83] offset:4416
    v_alignbit_b32 v76, v86, v85, 16
    v_alignbit_b32 v77, v87, v86, 16
    v_alignbit_b32 v78, v88, v87, 16
    v_alignbit_b32 v79, v89, v88, 16
    ds_write_b128 v44, v[76:79] offset:8832
    v_mov_b32 v80, v86
    v_mov_b32 v81, v87
    v_mov_b32 v82, v88
    v_mov_b32 v83, v89
    ds_write_b128 v44, v[80:83] offset:13248
    v_alignbit_b32 v76, v87, v86, 16
    v_alignbit_b32 v77, v88, v87, 16
    v_alignbit_b32 v78, v89, v88, 16
    v_alignbit_b32 v79, v90, v89, 16
    ds_write_b128 v44, v[76:79] offset:17664
    v_mov_b32 v80, v87
    v_mov_b32 v81, v88
    v_mov_b32 v82, v89
    v_mov_b32 v83, v90
    ds_write_b128 v44, v[80:83] offset:22080
    v_alignbit_b32 v76, v88, v87, 16
    v_alignbit_b32 v77, v89, v88, 16
    v_alignbit_b32 v78, v90, v89, 16
    v_alignbit_b32 v79, v91, v90, 16
    ds_write_b128 v44, v[76:79] offset:26496
    v_mov_b32 v80, v88
    v_mov_b32 v81, v89
    v_mov_b32 v82, v90
    v_mov_b32 v83, v91
    ds_write_b128 v44, v[80:83] offset:30912
    v_mov_b32 v84, 0
    v_mov_b32 v85, 0
    v_mov_b32 v86, 0
    v_mov_b32 v87, 0
    v_mov_b32 v88, v144
    v_mov_b32 v89, v145
    v_mov_b32 v90, v146
    v_mov_b32 v91, v147
    v_mov_b32 v44, 100976
    v_alignbit_b32 v76, v85, v84, 16
    v_alignbit_b32 v77, v86, v85, 16
    v_alignbit_b32 v78, v87, v86, 16
    v_alignbit_b32 v79, v88, v87, 16
    ds_write_b128 v44, v[76:79] offset:0
    v_mov_b32 v80, v85
    v_mov_b32 v81, v86
    v_mov_b32 v82, v87
    v_mov_b32 v83, v88
    ds_write_b128 v44, v[80:83] offset:4416
    v_alignbit_b32 v76, v86, v85, 16
    v_alignbit_b32 v77, v87, v86, 16
    v_alignbit_b32 v78, v88, v87, 16
    v_alignbit_b32 v79, v89, v88, 16
    ds_write_b128 v44, v[76:79] offset:8832
    v_mov_b32 v80, v86
    v_mov_b32 v81, v87
    v_mov_b32 v82, v88
    v_mov_b32 v83, v89
    ds_write_b128 v44, v[80:83] offset:13248
    v_alignbit_b32 v76, v87, v86, 16
    v_alignbit_b32 v77, v88, v87, 16
    v_alignbit_b32 v78, v89, v88, 16
    v_alignbit_b32 v79, v90, v89, 16
    ds_write_b128 v44, v[76:79] offset:17664
    v_mov_b32 v80, v87
    v_mov_b32 v81, v88
    v_mov_b32 v82, v89
    v_mov_b32 v83, v90
    ds_write_b128 v44, v[80:83] offset:22080
    v_alignbit_b32 v76, v88, v87, 16
    v_alignbit_b32 v77, v89, v88, 16
    v_alignbit_b32 v78, v90, v89, 16
    v_alignbit_b32 v79, v91, v90, 16
    ds_write_b128 v44, v[76:79] offset:26496
    v_mov_b32 v80, v88
    v_mov_b32 v81, v89
    v_mov_b32 v82, v90
    v_mov_b32 v83, v91
    ds_write_b128 v44, v[80:83] offset:30912
b2_skip7_1:
    s_mov_b64 exec, -1
    v_and_b32 v40, 63, v0
    v_and_b32 v41, 7, v0
    v_mul_u32_u24 v41, 4416, v41
    v_bfe_u32 v42, v0, 3, 2
    v_bfe_u32 v43, v0, 5, 1
    v_add_u32 v42, v42, v43
    v_lshlrev_b32 v42, 4, v42
    s_lshr_b32 s84, s88, 1
    s_and_b32 s85, s88, 1
    s_mul_i32 s86, s84, 35328
    s_lshl_b32 s87, s85, 11
    s_add_u32 s86, s86, s87
    s_add_u32 s86, s86, 65536
    v_add3_u32 v44, v41, v42, s86
    v_and_b32 v41, 31, v0
    v_sub_u32 v41, 31, v41
    v_mul_u32_u24 v41, 144, v41
    v_lshlrev_b32 v43, 4, v43
    s_mul_i32 s86, s84, 9216
    s_mul_i32 s87, s85, 2304
    s_add_u32 s86, s86, s87
    s_add_u32 s86, s86, 136192
    v_add3_u32 v45, v41, v43, s86
    s_branch k2_entry
k1_c0slow_1:
    s_mov_b32 s56, 0
k1_c0p_1_loop:
    buffer_load_dword v125, v126, s[60:63], 0 offen sc1
    s_waitcnt vmcnt(0)
    v_cmp_ne_u32 s[58:59], s55, v125
    s_add_u32 s56, s56, 1
    s_cmp_eq_u64 s[58:59], 0
    s_cbranch_scc1 k1_c0p_1_done
    s_sleep 6
    s_cmp_lt_u32 s56, 400000
    s_cbranch_scc1 k1_c0p_1_loop
k1_c0p_1_done:
    s_branch k1_c0ret_1
k2_entry:
    s_lshl_b32 s56, s48, 7
    s_lshr_b32 s57, s2, 4
    s_lshl_b32 s57, s57, 2
    s_add_u32 s56, s56, s57
    s_load_dwordx4 s[4:7], s[0:1], 104
    s_waitcnt lgkmcnt(0)
    s_barrier
    ds_read_b128 v[48:51], v44 offset:0
    ds_read_b128 v[52:55], v44 offset:32
    ds_read_b128 v[80:83], v45 offset:0
    ds_read_b128 v[56:59], v44 offset:64
    ds_read_b128 v[84:87], v45 offset:32
    ds_read_b128 v[60:63], v44 offset:96
    ds_read_b128 v[88:91], v45 offset:64
    ds_read_b128 v[64:67], v44 offset:128
    ds_read_b128 v[92:95], v45 offset:96
    ds_read_b128 v[68:71], v44 offset:160
    s_waitcnt lgkmcnt(7)
    v_mfma_f32_32x32x16_bf16 v[104:119], v[48:51], v[80:83], 0
    v_accvgpr_write_b32 a128, v192
    v_accvgpr_write_b32 a129, v193
    ds_read_b128 v[96:99], v45 offset:144
    s_waitcnt lgkmcnt(7)
    v_mfma_f32_32x32x16_bf16 v[120:135], v[56:59], v[80:83], 0
    v_accvgpr_write_b32 a130, v194
    v_accvgpr_write_b32 a131, v195
    ds_read_b128 v[72:75], v44 offset:192
    s_waitcnt lgkmcnt(7)
    v_mfma_f32_32x32x16_bf16 v[104:119], v[52:55], v[84:87], v[104:119]
    v_accvgpr_write_b32 a132, v196
    v_accvgpr_write_b32 a133, v197
    ds_read_b128 v[100:103], v45 offset:176
    s_waitcnt lgkmcnt(7)
    v_mfma_f32_32x32x16_bf16 v[120:135], v[60:63], v[84:87], v[120:135]
    v_accvgpr_write_b32 a134, v198
    v_accvgpr_write_b32 a135, v199
    ds_read_b128 v[76:79], v44 offset:224
    s_waitcnt lgkmcnt(7)
    v_mfma_f32_32x32x16_bf16 v[104:119], v[56:59], v[88:91], v[104:119]
    v_accvgpr_write_b32 a136, v200
    v_accvgpr_write_b32 a137, v201
    ds_read_b128 v[80:83], v45 offset:208
    s_waitcnt lgkmcnt(7)
    v_mfma_f32_32x32x16_bf16 v[120:135], v[64:67], v[88:91], v[120:135]
    v_accvgpr_write_b32 a138, v202
    v_accvgpr_write_b32 a139, v203
    ds_read_b128 v[48:51], v44 offset:256
    s_waitcnt lgkmcnt(7)
    v_mfma_f32_32x32x16_bf16 v[104:119], v[60:63], v[92:95], v[104:119]
    v_accvgpr_write_b32 a140, v204
    v_accvgpr_write_b32 a141, v205
    ds_read_b128 v[84:87], v45 offset:240
    s_waitcnt lgkmcnt(7)
    v_mfma_f32_32x32x16_bf16 v[120:135], v[68:71], v[92:95], v[120:135]
    v_accvgpr_write_b32 a142, v206
    v_accvgpr_write_b32 a143, v207
    ds_read_b128 v[52:55], v44 offset:288
    s_waitcnt lgkmcnt(7)
    v_mfma_f32_32x32x16_bf16 v[104:119], v[64:67], v[96:99], v[104:119]
    v_accvgpr_write_b32 a144, v208
    v_accvgpr_write_b32 a145, v209
    ds_read_b128 v[88:91], v45 offset:288
    s_waitcnt lgkmcnt(7)
    v_mfma_f32_32x32x16_bf16 v[120:135], v[72:75], v[96:99], v[120:135]
    v_accvgpr_write_b32 a146, v210
    v_accvgpr_write_b32 a147, v211
    ds_read_b128 v[56:59], v44 offset:320
    s_waitcnt lgkmcnt(7)
    v_mfma_f32_32x32x16_bf16 v[104:119], v[68:71], v[100:103], v[104:119]
    v_accvgpr_write_b32 a148, v212
    v_accvgpr_write_b32 a149, v213
    ds_read_b128 v[92:95], v45 offset:320
    s_waitcnt lgkmcnt(7)
    v_mfma_f32_32x32x16_bf16 v[120:135], v[76:79], v[100:103], v[120:135]
    v_accvgpr_write_b32 a150, v214
    v_accvgpr_write_b32 a151, v215
    ds_read_b128 v[60:63], v44 offset:352
    s_waitcnt lgkmcnt(7)
    v_mfma_f32_32x32x16_bf16 v[104:119], v[72:75], v[80:83], v[104:119]
    v_accvgpr_write_b32 a152, v216
    v_accvgpr_write_b32 a153, v217
    ds_read_b128 v[96:99], v45 offset:352
    s_waitcnt lgkmcnt(7)
    v_mfma_f32_32x32x16_bf16 v[120:135], v[48:51], v[80:83], v[120:135]
    v_accvgpr_write_b32 a154, v218
    v_accvgpr_write_b32 a155, v219
    ds_read_b128 v[64:67], v44 offset:384
    s_waitcnt lgkmcnt(7)
    v_mfma_f32_32x32x16_bf16 v[104:119], v[76:79], v[84:87], v[104:119]
    v_accvgpr_write_b32 a156, v220
    v_accvgpr_write_b32 a157, v221
    ds_read_b128 v[100:103], v45 offset:384
    s_waitcnt lgkmcnt(7)
    v_mfma_f32_32x32x16_bf16 v[120:135], v[52:55], v[84:87], v[120:135]
    v_accvgpr_write_b32 a158, v222
    v_accvgpr_write_b32 a159, v223
    ds_read_b128 v[68:71], v44 offset:416
    s_waitcnt vmcnt(0)
    s_barrier
    s_cmp_eq_u32 s54, 0
    s_cbranch_scc0 k2_sig1
    s_mov_b64 exec, 1
    v_mov_b32 v142, 0
    v_mov_b32 v143, 1
    buffer_store_dword v143, v142, s[64:67], s56 offen sc1
    s_mov_b64 exec, -1
k2_sig1:
    s_mov_b64 s[56:57], s[76:77]
    s_mov_b64 s[58:59], s[78:79]
    s_mov_b32 s61, s84
    s_mov_b32 s62, s85
    s_mov_b32 s60, s88
    s_and_b32 s66, s2, 7
    s_lshr_b32 s67, s2, 3
    s_and_b32 s68, s67, 1
    s_lshl_b32 s66, s66, 1
    s_add_u32 s66, s66, s68
    s_lshr_b32 s68, s67, 1
    s_and_b32 s68, s68, 7
    s_lshr_b32 s69, s67, 4
    s_mov_b32 s92, s69
    s_mov_b32 s93, s68
    s_mov_b32 s94, s66
    s_mov_b32 s77, s54
    v_and_b32 v13, 63, v0
    v_lshlrev_b32 v1, 4, v13
    s_lshl_b32 s32, s77, 13
    v_add_u32 v4, s32, v1
    s_lshl_b32 s70, s66, 20
    s_add_u32 s71, s70, 16777216
    s_add_u32 s8, s6, s71
    s_addc_u32 s9, s7, 0
    s_mov_b32 s10, 1048576
    s_mov_b32 s11, 0x20000
    s_add_u32 s71, s70, 33554432
    s_add_u32 s12, s6, s71
    s_addc_u32 s13, s7, 0
    s_mov_b32 s14, 1048576
    s_mov_b32 s15, 0x20000
    s_add_u32 s71, s70, 0
    s_add_u32 s16, s6, s71
    s_addc_u32 s17, s7, 0
    s_mov_b32 s18, 1048576
    s_mov_b32 s19, 0x20000
    s_lshl_b32 s71, s66, 15
    s_add_u32 s71, s71, 50331648
    s_add_u32 s20, s6, s71
    s_addc_u32 s21, s7, 0
    s_mov_b32 s22, 16777216
    s_mov_b32 s23, 0x20000
    s_lshl_b32 s71, s66, 3
    s_add_u32 s71, s71, s68
    s_lshl_b32 s71, s71, 2
    s_add_u32 s71, s71, s77
    s_lshl_b32 s76, s71, 2
    s_add_u32 s76, s76, 4096
    s_mul_i32 s71, s71, 17408
    s_add_u32 s71, s71, 67108864
    s_add_u32 s24, s6, s71
    s_addc_u32 s25, s7, 0
    s_mov_b32 s26, 17408
    s_mov_b32 s27, 0x20000
    s_add_u32 s84, s6, 96468992
    s_addc_u32 s85, s7, 0
    s_mov_b32 s86, 8192
    s_mov_b32 s87, 0x20000
    s_mov_b32 s88, s4
    s_mov_b32 s89, s5
    s_mov_b32 s90, 256
    s_mov_b32 s91, 0x20000
    s_sub_u32 s73, 15, s68
    s_lshl_b32 s71, s68, 1
    s_sub_u32 s47, 32, s71
    s_min_u32 s47, s47, 18
    s_sub_u32 s74, 32, s71
    s_sub_u32 s74, s74, s47
    s_mov_b32 s95, 2
    s_mov_b32 s36, 0
    s_mov_b32 s35, -1
    s_mov_b32 s45, 0
    s_mov_b32 s40, 0
    s_mov_b32 s78, 0
    s_mov_b32 s44, 0
    s_mov_b32 s46, s68
    s_cmp_eq_u32 s69, 0
    s_cbranch_scc0 k2_roleA
    s_mov_b32 s79, s68
    s_add_u32 s41, s71, 2
    s_lshl_b32 s82, s41, 15
    s_cmp_eq_u32 s74, 0
    s_cbranch_scc1 k2_common
    s_mov_b32 s45, s41
    s_mov_b32 s79, s73
    s_mov_b32 s41, s74
    s_mov_b32 s40, s47
    s_mov_b32 s44, 1
    s_sub_u32 s35, 32, s71
    s_lshl_b32 s35, s35, 15
    s_branch k2_common
k2_roleA:
    s_mov_b32 s79, s73
    s_mov_b32 s41, s47
    s_lshl_b32 s82, s41, 15
    s_mov_b32 s78, s74
    s_cmp_eq_u32 s74, 0
    s_cselect_b32 s44, 0, 2
k2_common:
    s_lshl_b32 s33, s40, 15
    s_mov_b32 s34, s33
    s_lshl_b32 s42, s79, 1
    s_lshl_b32 s43, s79, 7
    s_lshl_b32 s66, s77, 5
    s_add_u32 s43, s43, s66
    s_mov_b32 s38, 0
    s_mov_b32 s39, 0
    s_mov_b32 s37, 0
    v_mov_b32 v5, 0
    v_mov_b32 v6, 0
    v_mov_b32 v11, 0xff800000
    v_and_b32 v12, 31, v13
    v_lshrrev_b32 v14, 5, v13
    v_lshlrev_b32 v14, 2, v14
    v_sub_u32 v10, v12, v14
    v_mov_b32 v16, 0
    v_mov_b32 v17, 0
    v_mov_b32 v18, 0
    v_mov_b32 v19, 0
    v_mov_b32 v20, 0
    v_mov_b32 v21, 0
    v_mov_b32 v22, 0
    v_mov_b32 v23, 0
    v_mov_b32 v24, 0
    v_mov_b32 v25, 0
    v_mov_b32 v26, 0
    v_mov_b32 v27, 0
    v_mov_b32 v28, 0
    v_mov_b32 v29, 0
    v_mov_b32 v30, 0
    v_mov_b32 v31, 0
    v_mov_b32 v3, v1
    s_mov_b64 s[48:49], -1
    s_mov_b32 s50, 0xff7843b0
    s_mov_b32 s51, 1.0
    s_mov_b32 s52, 0x4b800000
    s_mov_b32 s53, 0
    s_lshl_b32 s72, s94, 7
    v_min_u32 v140, 15, v13
    v_lshlrev_b32 v140, 2, v140
    s_mov_b32 s64, s61
    s_mov_b32 s65, s62
    s_mov_b32 s68, s60
    s_waitcnt lgkmcnt(7)
    v_mfma_f32_32x32x16_bf16 v[104:119], v[48:51], v[88:91], v[104:119]
    v_lshrrev_b32 v145, 5, v13
    v_accvgpr_write_b32 a160, v224
    v_accvgpr_write_b32 a161, v225
    ds_read_b128 v[80:83], v45 offset:432
    s_waitcnt lgkmcnt(7)
    v_mfma_f32_32x32x16_bf16 v[120:135], v[56:59], v[88:91], v[120:135]
    v_accvgpr_write_b32 a162, v226
    v_accvgpr_write_b32 a163, v227
    ds_read_b128 v[72:75], v44 offset:448
    s_waitcnt lgkmcnt(7)
    v_mfma_f32_32x32x16_bf16 v[104:119], v[52:55], v[92:95], v[104:119]
    v_accvgpr_write_b32 a164, v228
    v_accvgpr_write_b32 a165, v229
    ds_read_b128 v[84:87], v45 offset:464
    s_waitcnt lgkmcnt(7)
    v_mfma_f32_32x32x16_bf16 v[120:135], v[60:63], v[92:95], v[120:135]
    v_lshlrev_b32 v145, 2, v145
    v_accvgpr_write_b32 a166, v230
    v_accvgpr_write_b32 a167, v231
    ds_read_b128 v[76:79], v44 offset:480
    s_waitcnt lgkmcnt(7)
    v_mfma_f32_32x32x16_bf16 v[104:119], v[56:59], v[96:99], v[104:119]
    v_accvgpr_write_b32 a168, v232
    v_accvgpr_write_b32 a169, v233
    ds_read_b128 v[88:91], v45 offset:496
    s_waitcnt lgkmcnt(7)
    v_mfma_f32_32x32x16_bf16 v[120:135], v[64:67], v[96:99], v[120:135]
    v_accvgpr_write_b32 a170, v234
    v_accvgpr_write_b32 a171, v235
    ds_read_b128 v[48:51], v44 offset:512
    s_waitcnt lgkmcnt(7)
    v_mfma_f32_32x32x16_bf16 v[104:119], v[60:63], v[100:103], v[104:119]
    v_bfe_u32 v146, v13, 2, 2
    v_accvgpr_write_b32 a172, v236
    v_accvgpr_write_b32 a173, v237
    ds_read_b128 v[92:95], v45 offset:528
    s_waitcnt lgkmcnt(7)
    v_mfma_f32_32x32x16_bf16 v[120:135], v[68:71], v[100:103], v[120:135]
    v_accvgpr_write_b32 a174, v238
    v_accvgpr_write_b32 a175, v239
    ds_read_b128 v[52:55], v44 offset:544
    s_waitcnt lgkmcnt(7)
    v_mfma_f32_32x32x16_bf16 v[104:119], v[64:67], v[80:83], v[104:119]
    v_accvgpr_write_b32 a176, v240
    v_accvgpr_write_b32 a177, v241
    ds_read_b128 v[96:99], v45 offset:576
    s_waitcnt lgkmcnt(7)
    v_mfma_f32_32x32x16_bf16 v[120:135], v[72:75], v[80:83], v[120:135]
    v_add_u32 v145, v145, v146
    v_accvgpr_write_b32 a178, v242
    v_accvgpr_write_b32 a179, v243
    ds_read_b128 v[56:59], v44 offset:576
    s_waitcnt lgkmcnt(7)
    v_mfma_f32_32x32x16_bf16 v[104:119], v[68:71], v[84:87], v[104:119]
    v_accvgpr_write_b32 a180, v244
    v_accvgpr_write_b32 a181, v245
    ds_read_b128 v[100:103], v45 offset:608
    s_waitcnt lgkmcnt(7)
    v_mfma_f32_32x32x16_bf16 v[120:135], v[76:79], v[84:87], v[120:135]
    v_accvgpr_write_b32 a182, v246
    v_accvgpr_write_b32 a183, v247
    ds_read_b128 v[60:63], v44 offset:608
    s_waitcnt lgkmcnt(7)
    v_mfma_f32_32x32x16_bf16 v[104:119], v[72:75], v[88:91], v[104:119]
    v_mul_u32_u24 v145, 896, v145
    v_accvgpr_write_b32 a184, v248
    v_accvgpr_write_b32 a185, v249
    ds_read_b128 v[80:83], v45 offset:640
    s_waitcnt lgkmcnt(7)
    v_mfma_f32_32x32x16_bf16 v[120:135], v[48:51], v[88:91], v[120:135]
    v_accvgpr_write_b32 a186, v250
    v_accvgpr_write_b32 a187, v251
    ds_read_b128 v[64:67], v44 offset:640
    s_waitcnt lgkmcnt(7)
    v_mfma_f32_32x32x16_bf16 v[104:119], v[76:79], v[92:95], v[104:119]
    v_accvgpr_write_b32 a188, v252
    v_accvgpr_write_b32 a189, v253
    ds_read_b128 v[84:87], v45 offset:672
    s_waitcnt lgkmcnt(7)
    v_mfma_f32_32x32x16_bf16 v[120:135], v[52:55], v[92:95], v[120:135]
    v_bfe_u32 v146, v13, 4, 1
    v_accvgpr_write_b32 a190, v254
    v_accvgpr_write_b32 a191, v255
    ds_read_b128 v[68:71], v44 offset:672
    s_waitcnt lgkmcnt(7)
    v_mfma_f32_32x32x16_bf16 v[104:119], v[48:51], v[96:99], v[104:119]
    v_accvgpr_write_b32 a192, v192
    v_accvgpr_write_b32 a193, v193
    ds_read_b128 v[88:91], v45 offset:720
    s_waitcnt lgkmcnt(7)
    v_mfma_f32_32x32x16_bf16 v[120:135], v[56:59], v[96:99], v[120:135]
    v_accvgpr_write_b32 a194, v194
    v_accvgpr_write_b32 a195, v195
    ds_read_b128 v[72:75], v44 offset:704
    s_waitcnt lgkmcnt(7)
    v_mfma_f32_32x32x16_bf16 v[104:119], v[52:55], v[100:103], v[104:119]
    v_lshlrev_b32 v146, 5, v146
    v_accvgpr_write_b32 a196, v196
    v_accvgpr_write_b32 a197, v197
    ds_read_b128 v[92:95], v45 offset:752
    s_waitcnt lgkmcnt(7)
    v_mfma_f32_32x32x16_bf16 v[120:135], v[60:63], v[100:103], v[120:135]
    v_accvgpr_write_b32 a198, v198
    v_accvgpr_write_b32 a199, v199
    ds_read_b128 v[76:79], v44 offset:736
    s_waitcnt lgkmcnt(7)
    v_mfma_f32_32x32x16_bf16 v[104:119], v[56:59], v[80:83], v[104:119]
    v_accvgpr_write_b32 a200, v200
    v_accvgpr_write_b32 a201, v201
    ds_read_b128 v[96:99], v45 offset:784
    s_waitcnt lgkmcnt(7)
    v_mfma_f32_32x32x16_bf16 v[120:135], v[64:67], v[80:83], v[120:135]
    v_add_u32 v145, v145, v146
    v_accvgpr_write_b32 a202, v202
    v_accvgpr_write_b32 a203, v203
    ds_read_b128 v[48:51], v44 offset:768
    s_waitcnt lgkmcnt(7)
    v_mfma_f32_32x32x16_bf16 v[104:119], v[60:63], v[84:87], v[104:119]
    v_accvgpr_write_b32 a204, v204
    v_accvgpr_write_b32 a205, v205
    ds_read_b128 v[100:103], v45 offset:816
    s_waitcnt lgkmcnt(7)
    v_mfma_f32_32x32x16_bf16 v[120:135], v[68:71], v[84:87], v[120:135]
    v_accvgpr_write_b32 a206, v206
    v_accvgpr_write_b32 a207, v207
    ds_read_b128 v[52:55], v44 offset:800
    s_waitcnt lgkmcnt(7)
    v_mfma_f32_32x32x16_bf16 v[104:119], v[64:67], v[88:91], v[104:119]
    v_and_b32 v146, 3, v13
    v_accvgpr_write_b32 a208, v208
    v_accvgpr_write_b32 a209, v209
    ds_read_b128 v[80:83], v45 offset:864
    s_waitcnt lgkmcnt(7)
    v_mfma_f32_32x32x16_bf16 v[120:135], v[72:75], v[88:91], v[120:135]
    v_accvgpr_write_b32 a210, v210
    v_accvgpr_write_b32 a211, v211
    ds_read_b128 v[56:59], v44 offset:832
    s_waitcnt lgkmcnt(7)
    v_mfma_f32_32x32x16_bf16 v[104:119], v[68:71], v[92:95], v[104:119]
    v_accvgpr_write_b32 a212, v212
    v_accvgpr_write_b32 a213, v213
    ds_read_b128 v[84:87], v45 offset:896
    s_waitcnt lgkmcnt(7)
    v_mfma_f32_32x32x16_bf16 v[120:135], v[76:79], v[92:95], v[120:135]
    v_lshlrev_b32 v146, 3, v146
    v_accvgpr_write_b32 a214, v214
    v_accvgpr_write_b32 a215, v215
    ds_read_b128 v[60:63], v44 offset:864
    s_waitcnt lgkmcnt(7)
    v_mfma_f32_32x32x16_bf16 v[104:119], v[72:75], v[96:99], v[104:119]
    v_accvgpr_write_b32 a216, v216
    v_accvgpr_write_b32 a217, v217
    ds_read_b128 v[88:91], v45 offset:928
    s_waitcnt lgkmcnt(7)
    v_mfma_f32_32x32x16_bf16 v[120:135], v[48:51], v[96:99], v[120:135]
    v_accvgpr_write_b32 a218, v218
    v_accvgpr_write_b32 a219, v219
    ds_read_b128 v[64:67], v44 offset:896
    s_waitcnt lgkmcnt(7)
    v_mfma_f32_32x32x16_bf16 v[104:119], v[76:79], v[100:103], v[104:119]
    v_accvgpr_write_b32 a220, v220
    v_accvgpr_write_b32 a221, v221
    ds_read_b128 v[92:95], v45 offset:960
    s_waitcnt lgkmcnt(7)
    v_mfma_f32_32x32x16_bf16 v[120:135], v[52:55], v[100:103], v[120:135]
    v_add_u32 v145, v145, v146
    v_accvgpr_write_b32 a222, v222
    v_accvgpr_write_b32 a223, v223
    ds_read_b128 v[68:71], v44 offset:928
    s_waitcnt lgkmcnt(7)
    v_mfma_f32_32x32x16_bf16 v[104:119], v[48:51], v[80:83], v[104:119]
    v_accvgpr_write_b32 a224, v224
    v_accvgpr_write_b32 a225, v225
    ds_read_b128 v[96:99], v45 offset:1008
    s_waitcnt lgkmcnt(7)
    v_mfma_f32_32x32x16_bf16 v[120:135], v[56:59], v[80:83], v[120:135]
    v_accvgpr_write_b32 a226, v226
    v_accvgpr_write_b32 a227, v227
    ds_read_b128 v[72:75], v44 offset:960
    s_waitcnt lgkmcnt(7)
    v_mfma_f32_32x32x16_bf16 v[104:119], v[52:55], v[84:87], v[104:119]
    s_lshl_b32 s60, s77, 6
    v_add_u32 v145, s60, v145
    s_lshl_b32 s60, s2, 11
    s_add_u32 s60, s60, 100663296
    s_add_u32 s28, s6, s60
    s_addc_u32 s29, s7, 0
    s_mov_b32 s30, 3147776
    s_mov_b32 s31, 0x20000
    s_lshr_b32 s60, s77, 1
    s_lshl_b32 s60, s60, 19
    s_and_b32 s61, s77, 1
    s_lshl_b32 s61, s61, 10
    s_add_u32 s60, s60, s61
    v_accvgpr_write_b32 a228, v228
    v_accvgpr_write_b32 a229, v229
    ds_read_b128 v[100:103], v45 offset:1040
    s_waitcnt lgkmcnt(7)
    v_mfma_f32_32x32x16_bf16 v[120:135], v[60:63], v[84:87], v[120:135]
    v_accvgpr_write_b32 a230, v230
    v_accvgpr_write_b32 a231, v231
    ds_read_b128 v[76:79], v44 offset:992
    s_waitcnt lgkmcnt(7)
    v_mfma_f32_32x32x16_bf16 v[104:119], v[56:59], v[88:91], v[104:119]
    v_accvgpr_write_b32 a232, v232
    v_accvgpr_write_b32 a233, v233
    ds_read_b128 v[80:83], v45 offset:1072
    s_waitcnt lgkmcnt(7)
    v_mfma_f32_32x32x16_bf16 v[120:135], v[64:67], v[88:91], v[120:135]
    ds_read_b64_tr_b16 v[148:149], v145 offset:0
    v_accvgpr_write_b32 a234, v234
    v_accvgpr_write_b32 a235, v235
    ds_read_b128 v[48:51], v44 offset:1024
    s_waitcnt lgkmcnt(8)
    v_mfma_f32_32x32x16_bf16 v[104:119], v[60:63], v[92:95], v[104:119]
    v_accvgpr_write_b32 a236, v236
    v_accvgpr_write_b32 a237, v237
    ds_read_b128 v[84:87], v45 offset:1104
    s_waitcnt lgkmcnt(8)
    v_mfma_f32_32x32x16_bf16 v[120:135], v[68:71], v[92:95], v[120:135]
    v_accvgpr_write_b32 a238, v238
    v_accvgpr_write_b32 a239, v239
    ds_read_b128 v[52:55], v44 offset:1056
    s_waitcnt lgkmcnt(8)
    v_mfma_f32_32x32x16_bf16 v[104:119], v[64:67], v[96:99], v[104:119]
    ds_read_b64_tr_b16 v[150:151], v145 offset:7168
    v_accvgpr_write_b32 a240, v240
    v_accvgpr_write_b32 a241, v241
    ds_read_b128 v[88:91], v45 offset:1152
    s_waitcnt lgkmcnt(9)
    v_mfma_f32_32x32x16_bf16 v[120:135], v[72:75], v[96:99], v[120:135]
    v_accvgpr_write_b32 a242, v242
    v_accvgpr_write_b32 a243, v243
    ds_read_b128 v[56:59], v44 offset:1088
    s_waitcnt lgkmcnt(9)
    v_mfma_f32_32x32x16_bf16 v[104:119], v[68:71], v[100:103], v[104:119]
    v_accvgpr_write_b32 a244, v244
    v_accvgpr_write_b32 a245, v245
    ds_read_b128 v[92:95], v45 offset:1184
    s_waitcnt lgkmcnt(9)
    v_mfma_f32_32x32x16_bf16 v[120:135], v[76:79], v[100:103], v[120:135]
    ds_read_b64_tr_b16 v[152:153], v145 offset:256
    v_accvgpr_write_b32 a246, v246
    v_accvgpr_write_b32 a247, v247
    ds_read_b128 v[60:63], v44 offset:1120
    s_waitcnt lgkmcnt(10)
    v_mfma_f32_32x32x16_bf16 v[104:119], v[72:75], v[80:83], v[104:119]
    v_accvgpr_write_b32 a248, v248
    v_accvgpr_write_b32 a249, v249
    ds_read_b128 v[96:99], v45 offset:1216
    s_waitcnt lgkmcnt(9)
    v_mfma_f32_32x32x16_bf16 v[120:135], v[48:51], v[80:83], v[120:135]
    v_accvgpr_write_b32 a250, v250
    v_accvgpr_write_b32 a251, v251
    ds_read_b128 v[64:67], v44 offset:1152
    s_waitcnt lgkmcnt(9)
    v_mfma_f32_32x32x16_bf16 v[104:119], v[76:79], v[84:87], v[104:119]
    ds_read_b64_tr_b16 v[154:155], v145 offset:7424
    v_accvgpr_write_b32 a252, v252
    v_accvgpr_write_b32 a253, v253
    ds_read_b128 v[100:103], v45 offset:1248
    s_waitcnt lgkmcnt(10)
    v_mfma_f32_32x32x16_bf16 v[120:135], v[52:55], v[84:87], v[120:135]
    v_accvgpr_write_b32 a254, v254
    v_accvgpr_write_b32 a255, v255
    ds_read_b128 v[68:71], v44 offset:1184
    s_waitcnt lgkmcnt(9)
    v_mfma_f32_32x32x16_bf16 v[104:119], v[48:51], v[88:91], v[104:119]
    v_accvgpr_write_b32 a0, 0
    v_accvgpr_write_b32 a1, 0
    ds_read_b128 v[80:83], v45 offset:1296
    s_waitcnt lgkmcnt(9)
    v_mfma_f32_32x32x16_bf16 v[120:135], v[56:59], v[88:91], v[120:135]
    ds_read_b64_tr_b16 v[156:157], v145 offset:512
    v_accvgpr_write_b32 a2, 0
    v_accvgpr_write_b32 a3, 0
    ds_read_b128 v[72:75], v44 offset:1216
    s_waitcnt lgkmcnt(10)
    v_mfma_f32_32x32x16_bf16 v[104:119], v[52:55], v[92:95], v[104:119]
    v_accvgpr_write_b32 a4, 0
    v_accvgpr_write_b32 a5, 0
    ds_read_b128 v[84:87], v45 offset:1328
    s_waitcnt lgkmcnt(9)
    v_mfma_f32_32x32x16_bf16 v[120:135], v[60:63], v[92:95], v[120:135]
    v_accvgpr_write_b32 a6, 0
    v_accvgpr_write_b32 a7, 0
    ds_read_b128 v[76:79], v44 offset:1248
    s_waitcnt lgkmcnt(9)
    v_mfma_f32_32x32x16_bf16 v[104:119], v[56:59], v[96:99], v[104:119]
    ds_read_b64_tr_b16 v[158:159], v145 offset:7680
    v_accvgpr_write_b32 a8, 0
    v_accvgpr_write_b32 a9, 0
    ds_read_b128 v[88:91], v45 offset:1360
    s_waitcnt lgkmcnt(10)
    v_mfma_f32_32x32x16_bf16 v[120:135], v[64:67], v[96:99], v[120:135]
    v_accvgpr_write_b32 a10, 0
    v_accvgpr_write_b32 a11, 0
    ds_read_b128 v[48:51], v44 offset:1280
    s_waitcnt lgkmcnt(9)
    v_mfma_f32_32x32x16_bf16 v[104:119], v[60:63], v[100:103], v[104:119]
    v_accvgpr_write_b32 a12, 0
    v_accvgpr_write_b32 a13, 0
    ds_read_b128 v[92:95], v45 offset:1392
    s_waitcnt lgkmcnt(9)
    v_mfma_f32_32x32x16_bf16 v[120:135], v[68:71], v[100:103], v[120:135]
    ds_read_b64_tr_b16 v[160:161], v145 offset:768
    v_accvgpr_write_b32 a14, 0
    v_accvgpr_write_b32 a15, 0
    ds_read_b128 v[52:55], v44 offset:1312
    s_waitcnt lgkmcnt(10)
    v_mfma_f32_32x32x16_bf16 v[104:119], v[64:67], v[80:83], v[104:119]
    v_accvgpr_write_b32 a16, 0
    v_accvgpr_write_b32 a17, 0
    ds_read_b128 v[96:99], v45 offset:1440
    s_waitcnt lgkmcnt(9)
    v_mfma_f32_32x32x16_bf16 v[120:135], v[72:75], v[80:83], v[120:135]
    v_accvgpr_write_b32 a18, 0
    v_accvgpr_write_b32 a19, 0
    ds_read_b128 v[56:59], v44 offset:1344
    s_waitcnt lgkmcnt(9)
    v_mfma_f32_32x32x16_bf16 v[104:119], v[68:71], v[84:87], v[104:119]
    ds_read_b64_tr_b16 v[162:163], v145 offset:7936
    v_accvgpr_write_b32 a20, 0
    v_accvgpr_write_b32 a21, 0
    ds_read_b128 v[100:103], v45 offset:1472
    s_waitcnt lgkmcnt(10)
    v_mfma_f32_32x32x16_bf16 v[120:135], v[76:79], v[84:87], v[120:135]
    v_accvgpr_write_b32 a22, 0
    v_accvgpr_write_b32 a23, 0
    ds_read_b128 v[60:63], v44 offset:1376
    s_waitcnt lgkmcnt(9)
    v_mfma_f32_32x32x16_bf16 v[104:119], v[72:75], v[88:91], v[104:119]
    v_accvgpr_write_b32 a24, 0
    v_accvgpr_write_b32 a25, 0
    ds_read_b128 v[80:83], v45 offset:1504
    s_waitcnt lgkmcnt(9)
    v_mfma_f32_32x32x16_bf16 v[120:135], v[48:51], v[88:91], v[120:135]
    v_accvgpr_write_b32 a26, 0
    v_accvgpr_write_b32 a27, 0
    ds_read_b128 v[64:67], v44 offset:1408
    s_waitcnt lgkmcnt(9)
    v_mfma_f32_32x32x16_bf16 v[104:119], v[76:79], v[92:95], v[104:119]
    v_accvgpr_write_b32 a28, 0
    v_accvgpr_write_b32 a29, 0
    ds_read_b128 v[84:87], v45 offset:1536
    s_waitcnt lgkmcnt(8)
    v_mfma_f32_32x32x16_bf16 v[120:135], v[52:55], v[92:95], v[120:135]
    v_accvgpr_write_b32 a30, 0
    v_accvgpr_write_b32 a31, 0
    ds_read_b128 v[68:71], v44 offset:1440
    s_waitcnt lgkmcnt(6)
    s_nop 0
    s_cmp_eq_u32 s77, 0
    s_cbranch_scc0 k2_poll1_skip
    s_mov_b32 s69, 0
k2_poll1_loop:
    buffer_load_dword v141, v140, s[84:87], s72 offen sc1
    s_waitcnt vmcnt(0)
    v_cmp_ne_u32 s[70:71], 1, v141
    s_add_u32 s69, s69, 1
    s_cmp_eq_u64 s[70:71], 0
    s_cbranch_scc1 k2_poll1_done
    s_sleep 6
    s_cmp_lt_u32 s69, 400000
    s_cbranch_scc1 k2_poll1_loop
k2_poll1_done:
k2_poll1_skip:
    s_barrier
    s_cmp_eq_u32 s45, 0
    s_cbranch_scc1 k2_noq
    s_lshl_b32 s75, s79, 2
    s_add_u32 s75, s75, s77
    s_lshl_b32 s75, s75, 14
    buffer_load_dwordx4 a[128:131], v1, s[16:19], s75 offen offset:0
    buffer_load_dwordx4 a[132:135], v1, s[16:19], s75 offen offset:1024
    buffer_load_dwordx4 a[136:139], v1, s[16:19], s75 offen offset:2048
    buffer_load_dwordx4 a[140:143], v1, s[16:19], s75 offen offset:3072
    s_add_u32 s75, s75, 0x1000
    buffer_load_dwordx4 a[144:147], v1, s[16:19], s75 offen offset:0
    buffer_load_dwordx4 a[148:151], v1, s[16:19], s75 offen offset:1024
    buffer_load_dwordx4 a[152:155], v1, s[16:19], s75 offen offset:2048
    buffer_load_dwordx4 a[156:159], v1, s[16:19], s75 offen offset:3072
    s_add_u32 s75, s75, 0x1000
    buffer_load_dwordx4 a[160:163], v1, s[16:19], s75 offen offset:0
    buffer_load_dwordx4 a[164:167], v1, s[16:19], s75 offen offset:1024
    buffer_load_dwordx4 a[168:171], v1, s[16:19], s75 offen offset:2048
    buffer_load_dwordx4 a[172:175], v1, s[16:19], s75 offen offset:3072
    s_add_u32 s75, s75, 0x1000
    buffer_load_dwordx4 a[176:179], v1, s[16:19], s75 offen offset:0
    buffer_load_dwordx4 a[180:183], v1, s[16:19], s75 offen offset:1024
    buffer_load_dwordx4 a[184:187], v1, s[16:19], s75 offen offset:2048
    buffer_load_dwordx4 a[188:191], v1, s[16:19], s75 offen offset:3072
k2_noq:
    v_mfma_f32_32x32x16_bf16 v[104:119], v[48:51], v[96:99], v[104:119]
    s_mov_b32 s74, 0
    s_add_u32 m0, s74, s32
    s_nop 0
    buffer_load_dwordx4 v4, s[8:11], s33 offen lds
    v_accvgpr_write_b32 a32, 0
    v_accvgpr_write_b32 a33, 0
    ds_read_b128 v[88:91], v45 offset:1584
    v_mfma_f32_32x32x16_bf16 v[120:135], v[56:59], v[96:99], v[120:135]
    buffer_load_dwordx4 v4, s[8:11], s33 offen offset:1024 lds
    v_accvgpr_write_b32 a34, 0
    v_accvgpr_write_b32 a35, 0
    ds_read_b128 v[72:75], v44 offset:1472
    s_waitcnt lgkmcnt(7)
    v_mfma_f32_32x32x16_bf16 v[104:119], v[52:55], v[100:103], v[104:119]
    v_accvgpr_write_b32 a36, 0
    v_accvgpr_write_b32 a37, 0
    ds_read_b128 v[92:95], v45 offset:1616
    s_waitcnt lgkmcnt(7)
    v_mfma_f32_32x32x16_bf16 v[120:135], v[60:63], v[100:103], v[120:135]
    buffer_load_dwordx4 v4, s[8:11], s33 offen offset:2048 lds
    v_accvgpr_write_b32 a38, 0
    v_accvgpr_write_b32 a39, 0
    ds_read_b128 v[76:79], v44 offset:1504
    s_waitcnt lgkmcnt(7)
    v_mfma_f32_32x32x16_bf16 v[104:119], v[56:59], v[80:83], v[104:119]
    buffer_load_dwordx4 v4, s[8:11], s33 offen offset:3072 lds
    v_accvgpr_write_b32 a40, 0
    v_accvgpr_write_b32 a41, 0
    ds_read_b128 v[96:99], v45 offset:1648
    s_waitcnt lgkmcnt(7)
    v_mfma_f32_32x32x16_bf16 v[120:135], v[64:67], v[80:83], v[120:135]
    v_accvgpr_write_b32 a42, 0
    v_accvgpr_write_b32 a43, 0
    ds_read_b128 v[48:51], v44 offset:1536
    s_waitcnt lgkmcnt(7)
    v_mfma_f32_32x32x16_bf16 v[104:119], v[60:63], v[84:87], v[104:119]
    s_add_u32 m0, m0, 0x1000
    s_add_u32 s80, s33, 0x1000
    buffer_load_dwordx4 v4, s[8:11], s80 offen lds
    v_accvgpr_write_b32 a44, 0
    v_accvgpr_write_b32 a45, 0
    ds_read_b128 v[100:103], v45 offset:1680
    s_waitcnt lgkmcnt(7)
    v_mfma_f32_32x32x16_bf16 v[120:135], v[68:71], v[84:87], v[120:135]
    v_accvgpr_write_b32 a46, 0
    v_accvgpr_write_b32 a47, 0
    ds_read_b128 v[52:55], v44 offset:1568
    s_waitcnt lgkmcnt(7)
    v_mfma_f32_32x32x16_bf16 v[104:119], v[64:67], v[88:91], v[104:119]
    buffer_load_dwordx4 v4, s[8:11], s80 offen offset:1024 lds
    v_accvgpr_write_b32 a48, 0
    v_accvgpr_write_b32 a49, 0
    ds_read_b128 v[80:83], v45 offset:1728
    s_waitcnt lgkmcnt(7)
    v_mfma_f32_32x32x16_bf16 v[120:135], v[72:75], v[88:91], v[120:135]
    buffer_load_dwordx4 v4, s[8:11], s80 offen offset:2048 lds
    v_accvgpr_write_b32 a50, 0
    v_accvgpr_write_b32 a51, 0
    ds_read_b128 v[56:59], v44 offset:1600
    s_waitcnt lgkmcnt(7)
    v_mfma_f32_32x32x16_bf16 v[104:119], v[68:71], v[92:95], v[104:119]
    v_accvgpr_write_b32 a52, 0
    v_accvgpr_write_b32 a53, 0
    ds_read_b128 v[84:87], v45 offset:1760
    s_waitcnt lgkmcnt(7)
    v_mfma_f32_32x32x16_bf16 v[120:135], v[76:79], v[92:95], v[120:135]
    buffer_load_dwordx4 v4, s[8:11], s80 offen offset:3072 lds
    s_add_u32 s33, s33, 0x8000
    s_cmp_eq_u32 s33, s35
    s_cselect_b32 s33, s36, s33
    s_cmp_eq_u32 s33, s82
    s_cselect_b32 s33, 0x40000000, s33
    v_accvgpr_write_b32 a54, 0
    v_accvgpr_write_b32 a55, 0
    ds_read_b128 v[60:63], v44 offset:1632
    s_waitcnt lgkmcnt(7)
    v_mfma_f32_32x32x16_bf16 v[104:119], v[72:75], v[96:99], v[104:119]
    s_mov_b32 s74, 32768
    s_add_u32 m0, s74, s32
    s_nop 0
    buffer_load_dwordx4 v4, s[8:11], s33 offen lds
    v_accvgpr_write_b32 a56, 0
    v_accvgpr_write_b32 a57, 0
    ds_read_b128 v[88:91], v45 offset:1792
    s_waitcnt lgkmcnt(7)
    v_mfma_f32_32x32x16_bf16 v[120:135], v[48:51], v[96:99], v[120:135]
    v_accvgpr_write_b32 a58, 0
    v_accvgpr_write_b32 a59, 0
    ds_read_b128 v[64:67], v44 offset:1664
    s_waitcnt lgkmcnt(7)
    v_mfma_f32_32x32x16_bf16 v[104:119], v[76:79], v[100:103], v[104:119]
    buffer_load_dwordx4 v4, s[8:11], s33 offen offset:1024 lds
    v_accvgpr_write_b32 a60, 0
    v_accvgpr_write_b32 a61, 0
    ds_read_b128 v[92:95], v45 offset:1824
    s_waitcnt lgkmcnt(7)
    v_mfma_f32_32x32x16_bf16 v[120:135], v[52:55], v[100:103], v[120:135]
    v_accvgpr_write_b32 a62, 0
    v_accvgpr_write_b32 a63, 0
    ds_read_b128 v[68:71], v44 offset:1696
    s_waitcnt lgkmcnt(7)
    v_mfma_f32_32x32x16_bf16 v[104:119], v[48:51], v[80:83], v[104:119]
    buffer_load_dwordx4 v4, s[8:11], s33 offen offset:2048 lds
    v_accvgpr_write_b32 a64, 0
    v_accvgpr_write_b32 a65, 0
    ds_read_b128 v[96:99], v45 offset:1872
    s_waitcnt lgkmcnt(7)
    v_mfma_f32_32x32x16_bf16 v[120:135], v[56:59], v[80:83], v[120:135]
    buffer_load_dwordx4 v4, s[8:11], s33 offen offset:3072 lds
    v_accvgpr_write_b32 a66, 0
    v_accvgpr_write_b32 a67, 0
    ds_read_b128 v[72:75], v44 offset:1728
    s_waitcnt lgkmcnt(7)
    v_mfma_f32_32x32x16_bf16 v[104:119], v[52:55], v[84:87], v[104:119]
    v_accvgpr_write_b32 a68, 0
    v_accvgpr_write_b32 a69, 0
    ds_read_b128 v[100:103], v45 offset:1904
    s_waitcnt lgkmcnt(7)
    v_mfma_f32_32x32x16_bf16 v[120:135], v[60:63], v[84:87], v[120:135]
    s_add_u32 m0, m0, 0x1000
    s_add_u32 s80, s33, 0x1000
    buffer_load_dwordx4 v4, s[8:11], s80 offen lds
    v_accvgpr_write_b32 a70, 0
    v_accvgpr_write_b32 a71, 0
    ds_read_b128 v[76:79], v44 offset:1760
    s_waitcnt lgkmcnt(7)
    v_mfma_f32_32x32x16_bf16 v[104:119], v[56:59], v[88:91], v[104:119]
    buffer_load_dwordx4 v4, s[8:11], s80 offen offset:1024 lds
    v_accvgpr_write_b32 a72, 0
    v_accvgpr_write_b32 a73, 0
    ds_read_b128 v[80:83], v45 offset:1936
    s_waitcnt lgkmcnt(7)
    v_mfma_f32_32x32x16_bf16 v[120:135], v[64:67], v[88:91], v[120:135]
    v_accvgpr_write_b32 a74, 0
    v_accvgpr_write_b32 a75, 0
    ds_read_b128 v[48:51], v44 offset:1792
    s_waitcnt lgkmcnt(7)
    v_mfma_f32_32x32x16_bf16 v[104:119], v[60:63], v[92:95], v[104:119]
    buffer_load_dwordx4 v4, s[8:11], s80 offen offset:2048 lds
    v_accvgpr_write_b32 a76, 0
    v_accvgpr_write_b32 a77, 0
    ds_read_b128 v[84:87], v45 offset:1968
    s_waitcnt lgkmcnt(7)
    v_mfma_f32_32x32x16_bf16 v[120:135], v[68:71], v[92:95], v[120:135]
    v_accvgpr_write_b32 a78, 0
    v_accvgpr_write_b32 a79, 0
    ds_read_b128 v[52:55], v44 offset:1824
    s_waitcnt lgkmcnt(7)
    v_mfma_f32_32x32x16_bf16 v[104:119], v[64:67], v[96:99], v[104:119]
    buffer_load_dwordx4 v4, s[8:11], s80 offen offset:3072 lds
    s_add_u32 s33, s33, 0x8000
    s_cmp_eq_u32 s33, s35
    s_cselect_b32 s33, s36, s33
    s_cmp_eq_u32 s33, s82
    s_cselect_b32 s33, 0x40000000, s33
    v_accvgpr_write_b32 a80, 0
    v_accvgpr_write_b32 a81, 0
    ds_read_b128 v[88:91], v45 offset:2016
    s_waitcnt lgkmcnt(7)
    v_mfma_f32_32x32x16_bf16 v[120:135], v[72:75], v[96:99], v[120:135]
    s_add_u32 s61, s60, 0
    buffer_store_dwordx4 v[148:151], v1, s[28:31], s61 offen sc1
    v_accvgpr_write_b32 a82, 0
    v_accvgpr_write_b32 a83, 0
    ds_read_b128 v[56:59], v44 offset:1856
    s_waitcnt lgkmcnt(7)
    v_mfma_f32_32x32x16_bf16 v[104:119], v[68:71], v[100:103], v[104:119]
    v_accvgpr_write_b32 a84, 0
    v_accvgpr_write_b32 a85, 0
    ds_read_b128 v[92:95], v45 offset:2048
    s_waitcnt lgkmcnt(7)
    v_mfma_f32_32x32x16_bf16 v[120:135], v[76:79], v[100:103], v[120:135]
    s_add_u32 s61, s60, 1048576
    buffer_store_dwordx4 v[152:155], v1, s[28:31], s61 offen sc1
    v_accvgpr_write_b32 a86, 0
    v_accvgpr_write_b32 a87, 0
    ds_read_b128 v[60:63], v44 offset:1888
    s_waitcnt lgkmcnt(7)
    v_mfma_f32_32x32x16_bf16 v[104:119], v[72:75], v[80:83], v[104:119]
    s_add_u32 s61, s60, 2097152
    buffer_store_dwordx4 v[156:159], v1, s[28:31], s61 offen sc1
    v_accvgpr_write_b32 a88, 0
    v_accvgpr_write_b32 a89, 0
    ds_read_b128 v[96:99], v45 offset:2080
    s_waitcnt lgkmcnt(7)
    v_mfma_f32_32x32x16_bf16 v[120:135], v[48:51], v[80:83], v[120:135]
    v_accvgpr_write_b32 a90, 0
    v_accvgpr_write_b32 a91, 0
    ds_read_b128 v[64:67], v44 offset:1920
    s_waitcnt lgkmcnt(7)
    v_mfma_f32_32x32x16_bf16 v[104:119], v[76:79], v[84:87], v[104:119]
    s_add_u32 s61, s60, 3145728
    buffer_store_dwordx4 v[160:163], v1, s[28:31], s61 offen sc1
    v_accvgpr_write_b32 a92, 0
    v_accvgpr_write_b32 a93, 0
    ds_read_b128 v[100:103], v45 offset:2112
    s_waitcnt lgkmcnt(7)
    v_mfma_f32_32x32x16_bf16 v[120:135], v[52:55], v[84:87], v[120:135]
    v_accvgpr_write_b32 a94, 0
    v_accvgpr_write_b32 a95, 0
    ds_read_b128 v[68:71], v44 offset:1952
    s_waitcnt lgkmcnt(7)
    v_mfma_f32_32x32x16_bf16 v[104:119], v[48:51], v[88:91], v[104:119]
    v_accvgpr_write_b32 a96, 0
    v_accvgpr_write_b32 a97, 0
    ds_read_b128 v[80:83], v45 offset:2160
    s_waitcnt lgkmcnt(7)
    v_mfma_f32_32x32x16_bf16 v[120:135], v[56:59], v[88:91], v[120:135]
    v_accvgpr_write_b32 a98, 0
    v_accvgpr_write_b32 a99, 0
    ds_read_b128 v[72:75], v44 offset:1984
    s_waitcnt lgkmcnt(7)
    v_mfma_f32_32x32x16_bf16 v[104:119], v[52:55], v[92:95], v[104:119]
    v_accvgpr_write_b32 a100, 0
    v_accvgpr_write_b32 a101, 0
    ds_read_b128 v[84:87], v45 offset:2192
    s_waitcnt lgkmcnt(7)
    v_mfma_f32_32x32x16_bf16 v[120:135], v[60:63], v[92:95], v[120:135]
    v_accvgpr_write_b32 a102, 0
    v_accvgpr_write_b32 a103, 0
    ds_read_b128 v[76:79], v44 offset:2016
    s_waitcnt lgkmcnt(7)
    v_mfma_f32_32x32x16_bf16 v[104:119], v[56:59], v[96:99], v[104:119]
    v_accvgpr_write_b32 a104, 0
    v_accvgpr_write_b32 a105, 0
    ds_read_b128 v[88:91], v45 offset:2224
    s_waitcnt lgkmcnt(7)
    v_mfma_f32_32x32x16_bf16 v[120:135], v[64:67], v[96:99], v[120:135]
    v_accvgpr_write_b32 a106, 0
    v_accvgpr_write_b32 a107, 0
    ds_read_b128 v[48:51], v44 offset:2048
    s_waitcnt lgkmcnt(7)
    v_mfma_f32_32x32x16_bf16 v[104:119], v[60:63], v[100:103], v[104:119]
    v_accvgpr_write_b32 a108, 0
    v_accvgpr_write_b32 a109, 0
    ds_read_b128 v[92:95], v45 offset:2256
    s_waitcnt lgkmcnt(7)
    v_mfma_f32_32x32x16_bf16 v[120:135], v[68:71], v[100:103], v[120:135]
    v_accvgpr_write_b32 a110, 0
    v_accvgpr_write_b32 a111, 0
    ds_read_b128 v[52:55], v44 offset:2080
    s_waitcnt lgkmcnt(7)
    v_mfma_f32_32x32x16_bf16 v[104:119], v[64:67], v[80:83], v[104:119]
    v_accvgpr_write_b32 a112, 0
    v_accvgpr_write_b32 a113, 0
    s_waitcnt lgkmcnt(6)
    v_mfma_f32_32x32x16_bf16 v[120:135], v[72:75], v[80:83], v[120:135]
    v_accvgpr_write_b32 a114, 0
    v_accvgpr_write_b32 a115, 0
    s_waitcnt lgkmcnt(5)
    v_mfma_f32_32x32x16_bf16 v[104:119], v[68:71], v[84:87], v[104:119]
    v_accvgpr_write_b32 a116, 0
    v_accvgpr_write_b32 a117, 0
    s_waitcnt lgkmcnt(4)
    v_mfma_f32_32x32x16_bf16 v[120:135], v[76:79], v[84:87], v[120:135]
    v_accvgpr_write_b32 a118, 0
    v_accvgpr_write_b32 a119, 0
    s_waitcnt lgkmcnt(3)
    v_mfma_f32_32x32x16_bf16 v[104:119], v[72:75], v[88:91], v[104:119]
    v_accvgpr_write_b32 a120, 0
    v_accvgpr_write_b32 a121, 0
    s_waitcnt lgkmcnt(2)
    v_mfma_f32_32x32x16_bf16 v[120:135], v[48:51], v[88:91], v[120:135]
    v_accvgpr_write_b32 a122, 0
    v_accvgpr_write_b32 a123, 0
    s_waitcnt lgkmcnt(1)
    v_mfma_f32_32x32x16_bf16 v[104:119], v[76:79], v[92:95], v[104:119]
    v_accvgpr_write_b32 a124, 0
    v_accvgpr_write_b32 a125, 0
    s_waitcnt lgkmcnt(0)
    v_mfma_f32_32x32x16_bf16 v[120:135], v[52:55], v[92:95], v[120:135]
    v_accvgpr_write_b32 a126, 0
    v_accvgpr_write_b32 a127, 0
    s_nop 15
    s_waitcnt lgkmcnt(0)
    s_barrier
    v_lshlrev_b32 v41, 4, v40
    s_lshl_b32 s66, s68, 12
    s_add_u32 s66, s66, 65536
    v_add_u32 v42, s66, v41
    s_xor_b32 s67, s68, 1
    s_lshl_b32 s67, s67, 12
    s_add_u32 s67, s67, 65536
    v_add_u32 v43, s67, v41
    s_cmp_eq_u32 s65, 0
    s_cbranch_scc1 b2_noswap_r
    v_swap_b32 v104, v120
    v_swap_b32 v105, v121
    v_swap_b32 v106, v122
    v_swap_b32 v107, v123
    v_swap_b32 v108, v124
    v_swap_b32 v109, v125
    v_swap_b32 v110, v126
    v_swap_b32 v111, v127
    v_swap_b32 v112, v128
    v_swap_b32 v113, v129
    v_swap_b32 v114, v130
    v_swap_b32 v115, v131
    v_swap_b32 v116, v132
    v_swap_b32 v117, v133
    v_swap_b32 v118, v134
    v_swap_b32 v119, v135
b2_noswap_r:
    ds_write_b128 v42, v[120:123] offset:0
    ds_write_b128 v42, v[124:127] offset:1024
    ds_write_b128 v42, v[128:131] offset:2048
    ds_write_b128 v42, v[132:135] offset:3072
    s_waitcnt lgkmcnt(0)
    s_barrier
    ds_read_b128 v[48:51], v43 offset:0
    ds_read_b128 v[52:55], v43 offset:1024
    ds_read_b128 v[56:59], v43 offset:2048
    ds_read_b128 v[60:63], v43 offset:3072
    s_waitcnt lgkmcnt(3)
    v_add_f32 v104, v104, v48
    v_add_f32 v105, v105, v49
    v_add_f32 v106, v106, v50
    v_add_f32 v107, v107, v51
    s_waitcnt lgkmcnt(2)
    v_add_f32 v108, v108, v52
    v_add_f32 v109, v109, v53
    v_add_f32 v110, v110, v54
    v_add_f32 v111, v111, v55
    s_waitcnt lgkmcnt(1)
    v_add_f32 v112, v112, v56
    v_add_f32 v113, v113, v57
    v_add_f32 v114, v114, v58
    v_add_f32 v115, v115, v59
    s_waitcnt lgkmcnt(0)
    v_add_f32 v116, v116, v60
    v_add_f32 v117, v117, v61
    v_add_f32 v118, v118, v62
    v_add_f32 v119, v119, v63
    v_cvt_pk_bf16_f32 v64, v104, v105
    v_cvt_pk_bf16_f32 v65, v106, v107
    v_cvt_pk_bf16_f32 v66, v108, v109
    v_cvt_pk_bf16_f32 v67, v110, v111
    v_cvt_pk_bf16_f32 v68, v112, v113
    v_cvt_pk_bf16_f32 v69, v114, v115
    v_cvt_pk_bf16_f32 v70, v116, v117
    v_cvt_pk_bf16_f32 v71, v118, v119
    v_and_b32 v41, 31, v0
    v_lshlrev_b32 v41, 7, v41
    v_bfe_u32 v42, v0, 5, 1
    v_lshlrev_b32 v42, 3, v42
    s_lshl_b32 s66, s64, 12
    s_lshl_b32 s67, s65, 6
    s_add_u32 s66, s66, s67
    s_add_u32 s66, s66, 81920
    v_add3_u32 v41, v41, v42, s66
    ds_write_b64 v41, v[64:65] offset:0
    ds_write_b64 v41, v[66:67] offset:16
    ds_write_b64 v41, v[68:69] offset:32
    ds_write_b64 v41, v[70:71] offset:48
    v_lshlrev_b32 v41, 4, v0
    v_add_u32 v42, 81920, v41
    s_waitcnt lgkmcnt(0)
    s_barrier
    ds_read_b128 v[64:67], v42
    ds_read_b128 v[68:71], v42 offset:4096
    v_add_u32 v43, 4096, v41
    s_waitcnt lgkmcnt(0)
    buffer_store_dwordx4 v[64:67], v41, s[56:59], 0 offen sc1
    buffer_store_dwordx4 v[68:71], v43, s[56:59], 0 offen sc1
    s_waitcnt vmcnt(14)
    s_barrier
    ds_read_b128 v[128:131], v3 offset:0
    ds_read_b128 v[132:135], v3 offset:16384
    ds_read_b128 v[136:139], v3 offset:1024
    ds_read_b128 v[140:143], v3 offset:17408
    ds_read_b128 v[144:147], v3 offset:2048
    ds_read_b128 v[148:151], v3 offset:18432
    ds_read_b128 v[152:155], v3 offset:3072
    ds_read_b128 v[156:159], v3 offset:19456
    ds_read_b128 v[160:163], v3 offset:4096
    s_waitcnt lgkmcnt(7)
    v_mfma_f32_32x32x16_bf16 v[32:47], v[128:131], a[128:131], v[16:31]
    ds_read_b128 v[164:167], v3 offset:20480
    s_mov_b32 s37, s38
    s_mov_b32 s38, s39
    s_add_u32 s39, s39, 0x8000
    s_cmp_eq_u32 s39, 0x28000
    s_cselect_b32 s39, 0, s39
    v_add_u32 v2, s39, v1
    v_mfma_f32_32x32x16_bf16 v[48:63], v[132:135], a[128:131], v[16:31]
    ds_read_b128 v[168:171], v3 offset:5120
    s_mov_b32 s74, 65536
    s_add_u32 m0, s74, s32
    s_nop 0
    buffer_load_dwordx4 v4, s[12:15], s34 offen lds
    s_waitcnt lgkmcnt(7)
    v_mfma_f32_32x32x16_bf16 v[32:47], v[136:139], a[132:135], v[32:47]
    ds_read_b128 v[172:175], v3 offset:21504
    buffer_load_dwordx4 v4, s[12:15], s34 offen offset:1024 lds
    v_mfma_f32_32x32x16_bf16 v[48:63], v[140:143], a[132:135], v[48:63]
    ds_read_b128 v[176:179], v3 offset:6144
    buffer_load_dwordx4 v4, s[12:15], s34 offen offset:2048 lds
    s_waitcnt lgkmcnt(7)
    v_mfma_f32_32x32x16_bf16 v[32:47], v[144:147], a[136:139], v[32:47]
    ds_read_b128 v[180:183], v3 offset:22528
    buffer_load_dwordx4 v4, s[12:15], s34 offen offset:3072 lds
    v_mfma_f32_32x32x16_bf16 v[48:63], v[148:151], a[136:139], v[48:63]
    ds_read_b128 v[184:187], v3 offset:7168
    s_waitcnt lgkmcnt(7)
    v_mfma_f32_32x32x16_bf16 v[32:47], v[152:155], a[140:143], v[32:47]
    ds_read_b128 v[188:191], v3 offset:23552
    s_add_u32 m0, m0, 0x1000
    s_add_u32 s80, s34, 0x1000
    buffer_load_dwordx4 v4, s[12:15], s80 offen lds
    v_mfma_f32_32x32x16_bf16 v[48:63], v[156:159], a[140:143], v[48:63]
    ds_read_b128 v[128:131], v3 offset:8192
    buffer_load_dwordx4 v4, s[12:15], s80 offen offset:1024 lds
    s_waitcnt lgkmcnt(7)
    v_mfma_f32_32x32x16_bf16 v[32:47], v[160:163], a[144:147], v[32:47]
    ds_read_b128 v[132:135], v3 offset:24576
    buffer_load_dwordx4 v4, s[12:15], s80 offen offset:2048 lds
    v_mfma_f32_32x32x16_bf16 v[48:63], v[164:167], a[144:147], v[48:63]
    ds_read_b128 v[136:139], v3 offset:9216
    s_waitcnt lgkmcnt(7)
    v_mfma_f32_32x32x16_bf16 v[32:47], v[168:171], a[148:151], v[32:47]
    ds_read_b128 v[140:143], v3 offset:25600
    buffer_load_dwordx4 v4, s[12:15], s80 offen offset:3072 lds
    s_add_u32 s34, s34, 0x8000
    s_cmp_eq_u32 s34, s35
    s_cselect_b32 s34, s36, s34
    s_cmp_eq_u32 s34, s82
    s_cselect_b32 s34, 0x40000000, s34
    v_mfma_f32_32x32x16_bf16 v[48:63], v[172:175], a[148:151], v[48:63]
    ds_read_b128 v[144:147], v3 offset:10240
    s_mov_b32 s74, 98304
    s_add_u32 m0, s74, s32
    s_nop 0
    buffer_load_dwordx4 v4, s[8:11], s33 offen lds
    s_waitcnt lgkmcnt(7)
    v_mfma_f32_32x32x16_bf16 v[32:47], v[176:179], a[152:155], v[32:47]
    ds_read_b128 v[148:151], v3 offset:26624
    buffer_load_dwordx4 v4, s[8:11], s33 offen offset:1024 lds
    v_mfma_f32_32x32x16_bf16 v[48:63], v[180:183], a[152:155], v[48:63]
    ds_read_b128 v[152:155], v3 offset:11264
    buffer_load_dwordx4 v4, s[8:11], s33 offen offset:2048 lds
    s_waitcnt lgkmcnt(7)
    v_mfma_f32_32x32x16_bf16 v[32:47], v[184:187], a[156:159], v[32:47]
    ds_read_b128 v[156:159], v3 offset:27648
    v_mfma_f32_32x32x16_bf16 v[48:63], v[188:191], a[156:159], v[48:63]
    ds_read_b128 v[160:163], v3 offset:12288
    buffer_load_dwordx4 v4, s[8:11], s33 offen offset:3072 lds
    s_waitcnt lgkmcnt(7)
    v_mfma_f32_32x32x16_bf16 v[32:47], v[128:131], a[160:163], v[32:47]
    ds_read_b128 v[164:167], v3 offset:28672
    s_add_u32 m0, m0, 0x1000
    s_add_u32 s80, s33, 0x1000
    buffer_load_dwordx4 v4, s[8:11], s80 offen lds
    v_mfma_f32_32x32x16_bf16 v[48:63], v[132:135], a[160:163], v[48:63]
    ds_read_b128 v[168:171], v3 offset:13312
    buffer_load_dwordx4 v4, s[8:11], s80 offen offset:1024 lds
    s_waitcnt lgkmcnt(7)
    v_mfma_f32_32x32x16_bf16 v[32:47], v[136:139], a[164:167], v[32:47]
    ds_read_b128 v[172:175], v3 offset:29696
    v_mfma_f32_32x32x16_bf16 v[48:63], v[140:143], a[164:167], v[48:63]
    ds_read_b128 v[176:179], v3 offset:14336
    buffer_load_dwordx4 v4, s[8:11], s80 offen offset:2048 lds
    s_waitcnt lgkmcnt(7)
    v_mfma_f32_32x32x16_bf16 v[32:47], v[144:147], a[168:171], v[32:47]
    ds_read_b128 v[180:183], v3 offset:30720
    buffer_load_dwordx4 v4, s[8:11], s80 offen offset:3072 lds
    s_add_u32 s33, s33, 0x8000
    s_cmp_eq_u32 s33, s35
    s_cselect_b32 s33, s36, s33
    s_cmp_eq_u32 s33, s82
    s_cselect_b32 s33, 0x40000000, s33
    v_mfma_f32_32x32x16_bf16 v[48:63], v[148:151], a[168:171], v[48:63]
    ds_read_b128 v[184:187], v3 offset:15360
    s_mov_b32 s74, 131072
    s_add_u32 m0, s74, s32
    s_nop 0
    buffer_load_dwordx4 v4, s[12:15], s34 offen lds
    s_waitcnt lgkmcnt(7)
    v_mfma_f32_32x32x16_bf16 v[32:47], v[152:155], a[172:175], v[32:47]
    ds_read_b128 v[188:191], v3 offset:31744
    buffer_load_dwordx4 v4, s[12:15], s34 offen offset:1024 lds
    v_mfma_f32_32x32x16_bf16 v[48:63], v[156:159], a[172:175], v[48:63]
    s_waitcnt lgkmcnt(6)
    v_mfma_f32_32x32x16_bf16 v[32:47], v[160:163], a[176:179], v[32:47]
    buffer_load_dwordx4 v4, s[12:15], s34 offen offset:2048 lds
    v_mfma_f32_32x32x16_bf16 v[48:63], v[164:167], a[176:179], v[48:63]
    s_waitcnt vmcnt(25) lgkmcnt(0)
    s_barrier
    ds_read_b128 v[128:131], v2 offset:0
    ds_read_b128 v[132:135], v2 offset:16384
    buffer_load_dwordx4 v4, s[12:15], s34 offen offset:3072 lds
    v_mfma_f32_32x32x16_bf16 v[32:47], v[168:171], a[180:183], v[32:47]
    ds_read_b128 v[136:139], v2 offset:1024
    ds_read_b128 v[140:143], v2 offset:17408
    s_add_u32 m0, m0, 0x1000
    s_add_u32 s80, s34, 0x1000
    buffer_load_dwordx4 v4, s[12:15], s80 offen lds
    v_mfma_f32_32x32x16_bf16 v[48:63], v[172:175], a[180:183], v[48:63]
    ds_read_b128 v[144:147], v2 offset:2048
    v_mfma_f32_32x32x16_bf16 v[32:47], v[176:179], a[184:187], v[32:47]
    ds_read_b128 v[148:151], v2 offset:18432
    buffer_load_dwordx4 v4, s[12:15], s80 offen offset:1024 lds
    v_mfma_f32_32x32x16_bf16 v[48:63], v[180:183], a[184:187], v[48:63]
    ds_read_b128 v[152:155], v2 offset:3072
    buffer_load_dwordx4 v4, s[12:15], s80 offen offset:2048 lds
    v_mfma_f32_32x32x16_bf16 v[32:47], v[184:187], a[188:191], v[32:47]
    ds_read_b128 v[156:159], v2 offset:19456
    buffer_load_dwordx4 v4, s[12:15], s80 offen offset:3072 lds
    s_add_u32 s34, s34, 0x8000
    s_cmp_eq_u32 s34, s35
    s_cselect_b32 s34, s36, s34
    s_cmp_eq_u32 s34, s82
    s_cselect_b32 s34, 0x40000000, s34
    v_mfma_f32_32x32x16_bf16 v[48:63], v[188:191], a[188:191], v[48:63]
    ds_read_b128 v[160:163], v2 offset:4096
    s_branch k2_precheck
k2_spec_p0:
    s_mov_b32 s53, 0
    s_branch k2_next
k2_spec_p1:
    s_mov_b32 s53, 1
k2_next:
    s_cmp_eq_u32 s95, 0
    s_cbranch_scc1 k2_nopend
    s_waitcnt vmcnt(16)
    s_mov_b64 exec, 1
    s_cmp_eq_u32 s95, 2
    s_cbranch_scc1 k2_pend2
    v_mov_b32 v252, 0
    v_mov_b32 v253, 1
    buffer_store_dword v253, v252, s[84:87], s76 offen sc1
    s_branch k2_pendx
k2_pend2:
    s_cmp_eq_u32 s77, 0
    s_cbranch_scc0 k2_pendx
    s_lshl_b32 s66, s2, 2
    s_add_u32 s66, s66, 6144
    v_mov_b32 v252, 0
    v_mov_b32 v253, 1
    buffer_store_dword v253, v252, s[84:87], s66 offen sc1
k2_pendx:
    s_mov_b64 exec, -1
    s_mov_b32 s95, 0
k2_nopend:
    s_cmp_eq_u32 s41, 0
    s_cbranch_scc1 k2_segend
k2_precheck:
    s_cmp_eq_u32 s41, 1
    s_cbranch_scc0 k2_dispatch
    s_cmp_eq_u32 s78, 0
    s_cbranch_scc1 k2_nopre
    v_mov_b32 v252, 0
    s_mov_b32 s66, 0
k2_pollb_loop:
    buffer_load_dword v253, v252, s[84:87], s76 offen sc1
    s_waitcnt vmcnt(0)
    v_cmp_ne_u32 s[58:59], 1, v253
    s_add_u32 s66, s66, 1
    s_cmp_eq_u64 s[58:59], 0
    s_cbranch_scc1 k2_pollb_done
    s_sleep 6
    s_cmp_lt_u32 s66, 400000
    s_cbranch_scc1 k2_pollb_loop
k2_pollb_done:
    s_mov_b32 s66, 0
    buffer_load_dwordx4 a[192:195], v1, s[24:27], s66 offen offset:0 sc1
    buffer_load_dwordx4 a[196:199], v1, s[24:27], s66 offen offset:1024 sc1
    buffer_load_dwordx4 a[200:203], v1, s[24:27], s66 offen offset:2048 sc1
    buffer_load_dwordx4 a[204:207], v1, s[24:27], s66 offen offset:3072 sc1
    s_add_u32 s66, s66, 0x1000
    buffer_load_dwordx4 a[208:211], v1, s[24:27], s66 offen offset:0 sc1
    buffer_load_dwordx4 a[212:215], v1, s[24:27], s66 offen offset:1024 sc1
    buffer_load_dwordx4 a[216:219], v1, s[24:27], s66 offen offset:2048 sc1
    buffer_load_dwordx4 a[220:223], v1, s[24:27], s66 offen offset:3072 sc1
    s_add_u32 s66, s66, 0x1000
    buffer_load_dwordx4 a[224:227], v1, s[24:27], s66 offen offset:0 sc1
    buffer_load_dwordx4 a[228:231], v1, s[24:27], s66 offen offset:1024 sc1
    buffer_load_dwordx4 a[232:235], v1, s[24:27], s66 offen offset:2048 sc1
    buffer_load_dwordx4 a[236:239], v1, s[24:27], s66 offen offset:3072 sc1
    s_add_u32 s66, s66, 0x1000
    buffer_load_dwordx4 a[240:243], v1, s[24:27], s66 offen offset:0 sc1
    buffer_load_dwordx4 a[244:247], v1, s[24:27], s66 offen offset:1024 sc1
    buffer_load_dwordx4 a[248:251], v1, s[24:27], s66 offen offset:2048 sc1
    buffer_load_dwordx4 a[252:255], v1, s[24:27], s66 offen offset:3072 sc1
    v_lshrrev_b32 v252, 2, v1
    s_movk_i32 s66, 0x4000
    buffer_load_dword v251, v252, s[24:27], s66 offen sc1
    s_mov_b32 s78, 0
k2_nopre:
    s_cmp_eq_u32 s45, 0
    s_cbranch_scc1 k2_displast
    s_nop 7
    s_nop 7
    v_accvgpr_mov_b32 a128, a192
    v_accvgpr_mov_b32 a129, a193
    v_accvgpr_mov_b32 a130, a194
    v_accvgpr_mov_b32 a131, a195
    v_accvgpr_mov_b32 a132, a196
    v_accvgpr_mov_b32 a133, a197
    v_accvgpr_mov_b32 a134, a198
    v_accvgpr_mov_b32 a135, a199
    v_accvgpr_mov_b32 a136, a200
    v_accvgpr_mov_b32 a137, a201
    v_accvgpr_mov_b32 a138, a202
    v_accvgpr_mov_b32 a139, a203
    v_accvgpr_mov_b32 a140, a204
    v_accvgpr_mov_b32 a141, a205
    v_accvgpr_mov_b32 a142, a206
    v_accvgpr_mov_b32 a143, a207
    v_accvgpr_mov_b32 a144, a208
    v_accvgpr_mov_b32 a145, a209
    v_accvgpr_mov_b32 a146, a210
    v_accvgpr_mov_b32 a147, a211
    v_accvgpr_mov_b32 a148, a212
    v_accvgpr_mov_b32 a149, a213
    v_accvgpr_mov_b32 a150, a214
    v_accvgpr_mov_b32 a151, a215
    v_accvgpr_mov_b32 a152, a216
    v_accvgpr_mov_b32 a153, a217
    v_accvgpr_mov_b32 a154, a218
    v_accvgpr_mov_b32 a155, a219
    v_accvgpr_mov_b32 a156, a220
    v_accvgpr_mov_b32 a157, a221
    v_accvgpr_mov_b32 a158, a222
    v_accvgpr_mov_b32 a159, a223
    v_accvgpr_mov_b32 a160, a224
    v_accvgpr_mov_b32 a161, a225
    v_accvgpr_mov_b32 a162, a226
    v_accvgpr_mov_b32 a163, a227
    v_accvgpr_mov_b32 a164, a228
    v_accvgpr_mov_b32 a165, a229
    v_accvgpr_mov_b32 a166, a230
    v_accvgpr_mov_b32 a167, a231
    v_accvgpr_mov_b32 a168, a232
    v_accvgpr_mov_b32 a169, a233
    v_accvgpr_mov_b32 a170, a234
    v_accvgpr_mov_b32 a171, a235
    v_accvgpr_mov_b32 a172, a236
    v_accvgpr_mov_b32 a173, a237
    v_accvgpr_mov_b32 a174, a238
    v_accvgpr_mov_b32 a175, a239
    v_accvgpr_mov_b32 a176, a240
    v_accvgpr_mov_b32 a177, a241
    v_accvgpr_mov_b32 a178, a242
    v_accvgpr_mov_b32 a179, a243
    v_accvgpr_mov_b32 a180, a244
    v_accvgpr_mov_b32 a181, a245
    v_accvgpr_mov_b32 a182, a246
    v_accvgpr_mov_b32 a183, a247
    v_accvgpr_mov_b32 a184, a248
    v_accvgpr_mov_b32 a185, a249
    v_accvgpr_mov_b32 a186, a250
    v_accvgpr_mov_b32 a187, a251
    v_accvgpr_mov_b32 a188, a252
    v_accvgpr_mov_b32 a189, a253
    v_accvgpr_mov_b32 a190, a254
    v_accvgpr_mov_b32 a191, a255
    v_mov_b32 v16, 0
    v_mov_b32 v17, 0
    v_mov_b32 v18, 0
    v_mov_b32 v19, 0
    v_mov_b32 v20, 0
    v_mov_b32 v21, 0
    v_mov_b32 v22, 0
    v_mov_b32 v23, 0
    v_mov_b32 v24, 0
    v_mov_b32 v25, 0
    v_mov_b32 v26, 0
    v_mov_b32 v27, 0
    v_mov_b32 v28, 0
    v_mov_b32 v29, 0
    v_mov_b32 v30, 0
    v_mov_b32 v31, 0
    s_mov_b32 s51, 0
    s_nop 1
k2_dispatch:
    s_add_u32 s81, s40, s41
    s_sub_u32 s81, s81, 1
    s_min_u32 s81, s81, s42
    s_cmp_lg_u32 s95, 0
    s_cselect_b32 s81, 0, s81
    s_cmp_ge_u32 s40, s42
    s_cbranch_scc1 k2_dispm
    s_cmp_eq_u32 s53, 0
    s_cbranch_scc1 body_p0_m0
    s_branch body_p1_m0
k2_dispm:
    s_cmp_eq_u32 s53, 0
    s_cbranch_scc1 body_p0_m1
    s_branch body_p1_m1
k2_displast:
    s_cmp_eq_u32 s53, 0
    s_cbranch_scc1 body_p0_last
    s_branch body_p1_last
body_p0_m0:
    s_waitcnt lgkmcnt(7)
    v_mfma_f32_32x32x16_bf16 v[64:79], v[128:131], a[128:131], v[16:31]
    ds_read_b128 v[164:167], v2 offset:20480
    s_mov_b32 s37, s38
    s_mov_b32 s38, s39
    v_exp_f32 v112, v32
    v_mfma_f32_32x32x16_bf16 v[80:95], v[132:135], a[128:131], v[16:31]
    ds_read_b128 v[168:171], v2 offset:5120
    s_add_u32 s39, s39, 0x8000
    s_cmp_eq_u32 s39, 0x28000
    s_cselect_b32 s39, 0, s39
    s_waitcnt lgkmcnt(7)
    v_mfma_f32_32x32x16_bf16 v[64:79], v[136:139], a[132:135], v[64:79]
    ds_read_b128 v[172:175], v2 offset:21504
    v_add_u32 v3, s39, v1
    s_add_u32 m0, s37, s32
    s_nop 0
    buffer_load_dwordx4 v4, s[8:11], s33 offen lds
    v_mfma_f32_32x32x16_bf16 v[80:95], v[140:143], a[132:135], v[80:95]
    ds_read_b128 v[176:179], v2 offset:6144
    v_exp_f32 v113, v33
    s_waitcnt lgkmcnt(7)
    v_mfma_f32_32x32x16_bf16 v[64:79], v[144:147], a[136:139], v[64:79]
    ds_read_b128 v[180:183], v2 offset:22528
    buffer_load_dwordx4 v4, s[8:11], s33 offen offset:1024 lds
    v_exp_f32 v114, v34
    v_mfma_f32_32x32x16_bf16 v[80:95], v[148:151], a[136:139], v[80:95]
    ds_read_b128 v[184:187], v2 offset:7168
    v_exp_f32 v115, v35
    v_add_f32 v7, v112, v113
    s_waitcnt lgkmcnt(7)
    v_mfma_f32_32x32x16_bf16 v[64:79], v[152:155], a[140:143], v[64:79]
    ds_read_b128 v[188:191], v2 offset:23552
    v_cvt_pk_bf16_f32 v96, v112, v113
    v_exp_f32 v116, v36
    v_add_f32 v8, v114, v115
    v_mfma_f32_32x32x16_bf16 v[80:95], v[156:159], a[140:143], v[80:95]
    ds_read_b128 v[128:131], v2 offset:8192
    buffer_load_dwordx4 v4, s[8:11], s33 offen offset:2048 lds
    v_cvt_pk_bf16_f32 v97, v114, v115
    s_waitcnt lgkmcnt(7)
    v_mfma_f32_32x32x16_bf16 v[64:79], v[160:163], a[144:147], v[64:79]
    ds_read_b128 v[132:135], v2 offset:24576
    v_exp_f32 v117, v37
    v_exp_f32 v118, v38
    v_mfma_f32_32x32x16_bf16 v[80:95], v[164:167], a[144:147], v[80:95]
    ds_read_b128 v[136:139], v2 offset:9216
    v_add_f32 v7, v7, v116
    v_exp_f32 v119, v39
    s_waitcnt lgkmcnt(7)
    v_mfma_f32_32x32x16_bf16 v[64:79], v[168:171], a[148:151], v[64:79]
    ds_read_b128 v[140:143], v2 offset:25600
    buffer_load_dwordx4 v4, s[8:11], s33 offen offset:3072 lds
    v_add_f32 v7, v7, v117
    v_cvt_pk_bf16_f32 v98, v116, v117
    v_mfma_f32_32x32x16_bf16 v[80:95], v[172:175], a[148:151], v[80:95]
    ds_read_b128 v[144:147], v2 offset:10240
    v_exp_f32 v120, v40
    v_add_f32 v8, v8, v118
    s_waitcnt lgkmcnt(7)
    v_mfma_f32_32x32x16_bf16 v[64:79], v[176:179], a[152:155], v[64:79]
    ds_read_b128 v[148:151], v2 offset:26624
    v_exp_f32 v121, v41
    v_add_f32 v8, v8, v119
    v_cvt_pk_bf16_f32 v99, v118, v119
    v_mfma_f32_32x32x16_bf16 v[80:95], v[180:183], a[152:155], v[80:95]
    ds_read_b128 v[152:155], v2 offset:11264
    s_add_u32 m0, m0, 0x1000
    s_add_u32 s80, s33, 0x1000
    buffer_load_dwordx4 v4, s[8:11], s80 offen lds
    s_waitcnt lgkmcnt(7)
    v_mfma_f32_32x32x16_bf16 v[64:79], v[184:187], a[156:159], v[64:79]
    ds_read_b128 v[156:159], v2 offset:27648
    v_exp_f32 v122, v42
    v_add_f32 v7, v7, v120
    v_mfma_f32_32x32x16_bf16 v[80:95], v[188:191], a[156:159], v[80:95]
    ds_read_b128 v[160:163], v2 offset:12288
    buffer_load_dwordx4 v4, s[8:11], s80 offen offset:1024 lds
    v_exp_f32 v123, v43
    s_waitcnt lgkmcnt(7)
    v_mfma_f32_32x32x16_bf16 v[64:79], v[128:131], a[160:163], v[64:79]
    ds_read_b128 v[164:167], v2 offset:28672
    v_add_f32 v7, v7, v121
    v_cvt_pk_bf16_f32 v100, v120, v121
    v_exp_f32 v124, v44
    v_mfma_f32_32x32x16_bf16 v[80:95], v[132:135], a[160:163], v[80:95]
    ds_read_b128 v[168:171], v2 offset:13312
    v_add_f32 v8, v8, v122
    v_exp_f32 v125, v45
    s_waitcnt lgkmcnt(7)
    v_mfma_f32_32x32x16_bf16 v[64:79], v[136:139], a[164:167], v[64:79]
    ds_read_b128 v[172:175], v2 offset:29696
    buffer_load_dwordx4 v4, s[8:11], s80 offen offset:2048 lds
    v_add_f32 v8, v8, v123
    v_cvt_pk_bf16_f32 v101, v122, v123
    v_mfma_f32_32x32x16_bf16 v[80:95], v[140:143], a[164:167], v[80:95]
    ds_read_b128 v[176:179], v2 offset:14336
    v_exp_f32 v126, v46
    v_add_f32 v7, v7, v124
    s_waitcnt lgkmcnt(7)
    v_mfma_f32_32x32x16_bf16 v[64:79], v[144:147], a[168:171], v[64:79]
    ds_read_b128 v[180:183], v2 offset:30720
    v_exp_f32 v127, v47
    v_add_f32 v7, v7, v125
    v_cvt_pk_bf16_f32 v102, v124, v125
    v_mfma_f32_32x32x16_bf16 v[80:95], v[148:151], a[168:171], v[80:95]
    ds_read_b128 v[184:187], v2 offset:15360
    buffer_load_dwordx4 v4, s[8:11], s80 offen offset:3072 lds
    v_add_f32 v8, v8, v126
    v_add_f32 v8, v8, v127
    s_waitcnt lgkmcnt(7)
    v_mfma_f32_32x32x16_bf16 v[64:79], v[152:155], a[172:175], v[64:79]
    ds_read_b128 v[188:191], v2 offset:31744
    v_cvt_pk_bf16_f32 v103, v126, v127
    v_add_f32 v7, v7, v8
    v_mfma_f32_32x32x16_bf16 v[80:95], v[156:159], a[172:175], v[80:95]
    v_cmp_nle_f32 s[54:55], v7, s52
    s_or_b64 s[54:55], s[54:55], s[48:49]
    s_cbranch_scc1 body_p0_m0_slow0
body_p0_m0_ret0:
    v_add_f32 v6, v6, v7
    s_waitcnt lgkmcnt(6)
    v_mfma_f32_32x32x16_bf16 v[64:79], v[160:163], a[176:179], v[64:79]
    s_add_u32 s33, s33, 0x8000
    s_cmp_eq_u32 s33, s35
    s_cselect_b32 s33, s36, s33
    s_cmp_eq_u32 s33, s82
    s_cselect_b32 s33, 0x40000000, s33
    v_mfma_f32_32x32x16_bf16 v[80:95], v[164:167], a[176:179], v[80:95]
    s_waitcnt vmcnt(24)
    s_waitcnt lgkmcnt(0)
    s_barrier
    ds_read_b128 v[128:131], v3 offset:0
    ds_read_b128 v[132:135], v3 offset:1024
    v_mfma_f32_32x32x16_bf16 v[64:79], v[168:171], a[180:183], v[64:79]
    ds_read_b128 v[136:139], v3 offset:2048
    ds_read_b128 v[140:143], v3 offset:3072
    v_exp_f32 v112, v48
    v_mfma_f32_32x32x16_bf16 v[80:95], v[172:175], a[180:183], v[80:95]
    ds_read_b128 v[144:147], v3 offset:4096
    v_exp_f32 v113, v49
    v_mfma_f32_32x32x16_bf16 v[64:79], v[176:179], a[184:187], v[64:79]
    ds_read_b128 v[148:151], v3 offset:5120
    v_exp_f32 v114, v50
    v_exp_f32 v115, v51
    v_mfma_f32_32x32x16_bf16 v[80:95], v[180:183], a[184:187], v[80:95]
    ds_read_b128 v[152:155], v3 offset:6144
    v_add_f32 v7, v112, v113
    v_cvt_pk_bf16_f32 v104, v112, v113
    v_mfma_f32_32x32x16_bf16 v[64:79], v[184:187], a[188:191], v[64:79]
    ds_read_b128 v[156:159], v3 offset:7168
    v_exp_f32 v116, v52
    v_add_f32 v8, v114, v115
    v_cvt_pk_bf16_f32 v105, v114, v115
    v_mfma_f32_32x32x16_bf16 v[80:95], v[188:191], a[188:191], v[80:95]
    ds_read_b128 v[160:163], v3 offset:8192
    v_exp_f32 v117, v53
    s_waitcnt lgkmcnt(7)
    v_mfma_f32_32x32x16_bf16 a[0:15], v[128:131], v[96:99], a[0:15]
    ds_read_b128 v[164:167], v3 offset:9216
    s_mov_b32 s37, s38
    s_mov_b32 s38, s39
    v_exp_f32 v118, v54
    v_mfma_f32_32x32x16_bf16 a[16:31], v[132:135], v[96:99], a[16:31]
    ds_read_b128 v[168:171], v3 offset:10240
    s_add_u32 s39, s39, 0x8000
    s_cmp_eq_u32 s39, 0x28000
    s_cselect_b32 s39, 0, s39
    s_waitcnt lgkmcnt(7)
    v_mfma_f32_32x32x16_bf16 a[32:47], v[136:139], v[96:99], a[32:47]
    ds_read_b128 v[172:175], v3 offset:11264
    v_add_u32 v2, s39, v1
    v_add_f32 v7, v7, v116
    v_exp_f32 v119, v55
    v_mfma_f32_32x32x16_bf16 a[48:63], v[140:143], v[96:99], a[48:63]
    ds_read_b128 v[176:179], v3 offset:12288
    v_add_f32 v7, v7, v117
    v_cvt_pk_bf16_f32 v106, v116, v117
    s_waitcnt lgkmcnt(7)
    v_mfma_f32_32x32x16_bf16 a[64:79], v[144:147], v[96:99], a[64:79]
    ds_read_b128 v[180:183], v3 offset:13312
    v_exp_f32 v120, v56
    v_add_f32 v8, v8, v118
    v_mfma_f32_32x32x16_bf16 a[80:95], v[148:151], v[96:99], a[80:95]
    ds_read_b128 v[184:187], v3 offset:14336
    v_exp_f32 v121, v57
    v_add_f32 v8, v8, v119
    s_waitcnt lgkmcnt(7)
    v_mfma_f32_32x32x16_bf16 a[96:111], v[152:155], v[96:99], a[96:111]
    ds_read_b128 v[188:191], v3 offset:15360
    v_cvt_pk_bf16_f32 v107, v118, v119
    v_exp_f32 v122, v58
    v_add_f32 v7, v7, v120
    v_mfma_f32_32x32x16_bf16 a[112:127], v[156:159], v[96:99], a[112:127]
    ds_read_b128 v[128:131], v3 offset:16384
    v_exp_f32 v123, v59
    v_add_f32 v7, v7, v121
    s_waitcnt lgkmcnt(7)
    v_mfma_f32_32x32x16_bf16 a[0:15], v[160:163], v[100:103], a[0:15]
    ds_read_b128 v[132:135], v3 offset:17408
    v_cvt_pk_bf16_f32 v108, v120, v121
    v_exp_f32 v124, v60
    v_add_f32 v8, v8, v122
    v_mfma_f32_32x32x16_bf16 a[16:31], v[164:167], v[100:103], a[16:31]
    ds_read_b128 v[136:139], v3 offset:18432
    v_exp_f32 v125, v61
    v_add_f32 v8, v8, v123
    s_waitcnt lgkmcnt(7)
    v_mfma_f32_32x32x16_bf16 a[32:47], v[168:171], v[100:103], a[32:47]
    ds_read_b128 v[140:143], v3 offset:19456
    v_cvt_pk_bf16_f32 v109, v122, v123
    v_exp_f32 v126, v62
    v_add_f32 v7, v7, v124
    v_mfma_f32_32x32x16_bf16 a[48:63], v[172:175], v[100:103], a[48:63]
    ds_read_b128 v[144:147], v3 offset:20480
    v_exp_f32 v127, v63
    v_add_f32 v7, v7, v125
    s_waitcnt lgkmcnt(7)
    v_mfma_f32_32x32x16_bf16 a[64:79], v[176:179], v[100:103], a[64:79]
    ds_read_b128 v[148:151], v3 offset:21504
    v_cvt_pk_bf16_f32 v110, v124, v125
    v_add_f32 v8, v8, v126
    v_add_f32 v8, v8, v127
    v_cvt_pk_bf16_f32 v111, v126, v127
    v_mfma_f32_32x32x16_bf16 a[80:95], v[180:183], v[100:103], a[80:95]
    ds_read_b128 v[152:155], v3 offset:22528
    v_add_f32 v7, v7, v8
    s_waitcnt lgkmcnt(7)
    v_mfma_f32_32x32x16_bf16 a[96:111], v[184:187], v[100:103], a[96:111]
    ds_read_b128 v[156:159], v3 offset:23552
    v_mfma_f32_32x32x16_bf16 a[112:127], v[188:191], v[100:103], a[112:127]
    ds_read_b128 v[160:163], v3 offset:24576
    v_cmp_nle_f32 s[54:55], v7, s52
    s_cmp_lg_u64 s[54:55], 0
    s_cbranch_scc1 body_p0_m0_slow1
body_p0_m0_ret1:
    v_add_f32 v6, v6, v7
    s_waitcnt lgkmcnt(7)
    v_mfma_f32_32x32x16_bf16 a[0:15], v[128:131], v[104:107], a[0:15]
    ds_read_b128 v[164:167], v3 offset:25600
    s_add_u32 m0, s37, s32
    s_nop 0
    buffer_load_dwordx4 v4, s[12:15], s34 offen lds
    v_mfma_f32_32x32x16_bf16 a[16:31], v[132:135], v[104:107], a[16:31]
    ds_read_b128 v[168:171], v3 offset:26624
    buffer_load_dwordx4 v4, s[12:15], s34 offen offset:1024 lds
    s_waitcnt lgkmcnt(7)
    v_mfma_f32_32x32x16_bf16 a[32:47], v[136:139], v[104:107], a[32:47]
    ds_read_b128 v[172:175], v3 offset:27648
    v_mfma_f32_32x32x16_bf16 a[48:63], v[140:143], v[104:107], a[48:63]
    ds_read_b128 v[176:179], v3 offset:28672
    buffer_load_dwordx4 v4, s[12:15], s34 offen offset:2048 lds
    s_waitcnt lgkmcnt(7)
    v_mfma_f32_32x32x16_bf16 a[64:79], v[144:147], v[104:107], a[64:79]
    ds_read_b128 v[180:183], v3 offset:29696
    v_mfma_f32_32x32x16_bf16 a[80:95], v[148:151], v[104:107], a[80:95]
    ds_read_b128 v[184:187], v3 offset:30720
    buffer_load_dwordx4 v4, s[12:15], s34 offen offset:3072 lds
    s_waitcnt lgkmcnt(7)
    v_mfma_f32_32x32x16_bf16 a[96:111], v[152:155], v[104:107], a[96:111]
    ds_read_b128 v[188:191], v3 offset:31744
    v_mfma_f32_32x32x16_bf16 a[112:127], v[156:159], v[104:107], a[112:127]
    s_add_u32 m0, m0, 0x1000
    s_add_u32 s80, s34, 0x1000
    buffer_load_dwordx4 v4, s[12:15], s80 offen lds
    s_waitcnt lgkmcnt(6)
    v_mfma_f32_32x32x16_bf16 a[0:15], v[160:163], v[108:111], a[0:15]
    v_mfma_f32_32x32x16_bf16 a[16:31], v[164:167], v[108:111], a[16:31]
    s_waitcnt vmcnt(21)
    s_waitcnt lgkmcnt(0)
    s_barrier
    ds_read_b128 v[128:131], v2 offset:0
    ds_read_b128 v[132:135], v2 offset:16384
    v_mfma_f32_32x32x16_bf16 a[32:47], v[168:171], v[108:111], a[32:47]
    ds_read_b128 v[136:139], v2 offset:1024
    ds_read_b128 v[140:143], v2 offset:17408
    buffer_load_dwordx4 v4, s[12:15], s80 offen offset:1024 lds
    v_mfma_f32_32x32x16_bf16 a[48:63], v[172:175], v[108:111], a[48:63]
    ds_read_b128 v[144:147], v2 offset:2048
    buffer_load_dwordx4 v4, s[12:15], s80 offen offset:2048 lds
    v_mfma_f32_32x32x16_bf16 a[64:79], v[176:179], v[108:111], a[64:79]
    ds_read_b128 v[148:151], v2 offset:18432
    v_mfma_f32_32x32x16_bf16 a[80:95], v[180:183], v[108:111], a[80:95]
    ds_read_b128 v[152:155], v2 offset:3072
    buffer_load_dwordx4 v4, s[12:15], s80 offen offset:3072 lds
    s_add_u32 s40, s40, 1
    s_sub_u32 s41, s41, 1
    v_mfma_f32_32x32x16_bf16 a[96:111], v[184:187], v[108:111], a[96:111]
    ds_read_b128 v[156:159], v2 offset:19456
    v_mfma_f32_32x32x16_bf16 a[112:127], v[188:191], v[108:111], a[112:127]
    ds_read_b128 v[160:163], v2 offset:4096
    s_add_u32 s34, s34, 0x8000
    s_cmp_eq_u32 s34, s35
    s_cselect_b32 s34, s36, s34
    s_cmp_eq_u32 s34, s82
    s_cselect_b32 s34, 0x40000000, s34
    s_cmp_ge_u32 s40, s81
    s_cbranch_scc1 k2_spec_p1
    s_branch body_p1_m0
body_p0_m0_slow0:
    s_call_b64 s[56:57], slow_p0_s0
    s_branch body_p0_m0_ret0
body_p0_m0_slow1:
    s_call_b64 s[56:57], slow_p0_s1
    s_branch body_p0_m0_ret1
body_p0_m1:
    s_waitcnt lgkmcnt(7)
    v_mfma_f32_32x32x16_bf16 v[64:79], v[128:131], a[128:131], v[16:31]
    ds_read_b128 v[164:167], v2 offset:20480
    s_mov_b32 s37, s38
    s_mov_b32 s38, s39
    s_lshl_b32 s66, s40, 6
    s_sub_u32 s66, s43, s66
    v_mfma_f32_32x32x16_bf16 v[80:95], v[132:135], a[128:131], v[16:31]
    ds_read_b128 v[168:171], v2 offset:5120
    s_add_u32 s39, s39, 0x8000
    s_cmp_eq_u32 s39, 0x28000
    s_cselect_b32 s39, 0, s39
    s_waitcnt lgkmcnt(7)
    v_mfma_f32_32x32x16_bf16 v[64:79], v[136:139], a[132:135], v[64:79]
    ds_read_b128 v[172:175], v2 offset:21504
    v_add_u32 v3, s39, v1
    s_add_u32 m0, s37, s32
    s_nop 0
    buffer_load_dwordx4 v4, s[8:11], s33 offen lds
    v_mfma_f32_32x32x16_bf16 v[80:95], v[140:143], a[132:135], v[80:95]
    ds_read_b128 v[176:179], v2 offset:6144
    v_add_u32 v9, s66, v10
    v_cmp_gt_i32 s[58:59], 0, v9
    v_cmp_gt_i32 s[60:61], 1, v9
    s_waitcnt lgkmcnt(7)
    v_mfma_f32_32x32x16_bf16 v[64:79], v[144:147], a[136:139], v[64:79]
    ds_read_b128 v[180:183], v2 offset:22528
    buffer_load_dwordx4 v4, s[8:11], s33 offen offset:1024 lds
    v_cmp_gt_i32 s[62:63], 2, v9
    v_cmp_gt_i32 s[64:65], 3, v9
    v_cndmask_b32 v32, v32, v11, s[58:59]
    v_mfma_f32_32x32x16_bf16 v[80:95], v[148:151], a[136:139], v[80:95]
    ds_read_b128 v[184:187], v2 offset:7168
    v_cmp_gt_i32 s[58:59], 8, v9
    v_cndmask_b32 v33, v33, v11, s[60:61]
    v_cmp_gt_i32 s[60:61], 9, v9
    s_waitcnt lgkmcnt(7)
    v_mfma_f32_32x32x16_bf16 v[64:79], v[152:155], a[140:143], v[64:79]
    ds_read_b128 v[188:191], v2 offset:23552
    v_cndmask_b32 v34, v34, v11, s[62:63]
    v_cmp_gt_i32 s[62:63], 10, v9
    v_cndmask_b32 v35, v35, v11, s[64:65]
    v_cmp_gt_i32 s[64:65], 11, v9
    v_mfma_f32_32x32x16_bf16 v[80:95], v[156:159], a[140:143], v[80:95]
    ds_read_b128 v[128:131], v2 offset:8192
    buffer_load_dwordx4 v4, s[8:11], s33 offen offset:2048 lds
    v_cndmask_b32 v36, v36, v11, s[58:59]
    v_cmp_gt_i32 s[58:59], 16, v9
    s_waitcnt lgkmcnt(7)
    v_mfma_f32_32x32x16_bf16 v[64:79], v[160:163], a[144:147], v[64:79]
    ds_read_b128 v[132:135], v2 offset:24576
    v_cndmask_b32 v37, v37, v11, s[60:61]
    v_cmp_gt_i32 s[60:61], 17, v9
    v_cndmask_b32 v38, v38, v11, s[62:63]
    v_cmp_gt_i32 s[62:63], 18, v9
    v_mfma_f32_32x32x16_bf16 v[80:95], v[164:167], a[144:147], v[80:95]
    ds_read_b128 v[136:139], v2 offset:9216
    v_cndmask_b32 v39, v39, v11, s[64:65]
    v_cmp_gt_i32 s[64:65], 19, v9
    v_cndmask_b32 v40, v40, v11, s[58:59]
    s_waitcnt lgkmcnt(7)
    v_mfma_f32_32x32x16_bf16 v[64:79], v[168:171], a[148:151], v[64:79]
    ds_read_b128 v[140:143], v2 offset:25600
    buffer_load_dwordx4 v4, s[8:11], s33 offen offset:3072 lds
    v_cmp_gt_i32 s[58:59], 24, v9
    v_cndmask_b32 v41, v41, v11, s[60:61]
    v_cmp_gt_i32 s[60:61], 25, v9
    v_mfma_f32_32x32x16_bf16 v[80:95], v[172:175], a[148:151], v[80:95]
    ds_read_b128 v[144:147], v2 offset:10240
    v_cndmask_b32 v42, v42, v11, s[62:63]
    v_cmp_gt_i32 s[62:63], 26, v9
    v_cndmask_b32 v43, v43, v11, s[64:65]
    s_waitcnt lgkmcnt(7)
    v_mfma_f32_32x32x16_bf16 v[64:79], v[176:179], a[152:155], v[64:79]
    ds_read_b128 v[148:151], v2 offset:26624
    v_cmp_gt_i32 s[64:65], 27, v9
    v_cndmask_b32 v44, v44, v11, s[58:59]
    v_cndmask_b32 v45, v45, v11, s[60:61]
    v_cndmask_b32 v46, v46, v11, s[62:63]
    v_mfma_f32_32x32x16_bf16 v[80:95], v[180:183], a[152:155], v[80:95]
    ds_read_b128 v[152:155], v2 offset:11264
    s_add_u32 m0, m0, 0x1000
    s_add_u32 s80, s33, 0x1000
    buffer_load_dwordx4 v4, s[8:11], s80 offen lds
    s_waitcnt lgkmcnt(7)
    v_mfma_f32_32x32x16_bf16 v[64:79], v[184:187], a[156:159], v[64:79]
    ds_read_b128 v[156:159], v2 offset:27648
    v_cndmask_b32 v47, v47, v11, s[64:65]
    v_exp_f32 v112, v32
    v_mfma_f32_32x32x16_bf16 v[80:95], v[188:191], a[156:159], v[80:95]
    ds_read_b128 v[160:163], v2 offset:12288
    buffer_load_dwordx4 v4, s[8:11], s80 offen offset:1024 lds
    v_exp_f32 v113, v33
    s_waitcnt lgkmcnt(7)
    v_mfma_f32_32x32x16_bf16 v[64:79], v[128:131], a[160:163], v[64:79]
    ds_read_b128 v[164:167], v2 offset:28672
    v_exp_f32 v114, v34
    v_exp_f32 v115, v35
    v_mfma_f32_32x32x16_bf16 v[80:95], v[132:135], a[160:163], v[80:95]
    ds_read_b128 v[168:171], v2 offset:13312
    v_add_f32 v7, v112, v113
    v_cvt_pk_bf16_f32 v96, v112, v113
    s_waitcnt lgkmcnt(7)
    v_mfma_f32_32x32x16_bf16 v[64:79], v[136:139], a[164:167], v[64:79]
    ds_read_b128 v[172:175], v2 offset:29696
    buffer_load_dwordx4 v4, s[8:11], s80 offen offset:2048 lds
    v_exp_f32 v116, v36
    v_add_f32 v8, v114, v115
    v_mfma_f32_32x32x16_bf16 v[80:95], v[140:143], a[164:167], v[80:95]
    ds_read_b128 v[176:179], v2 offset:14336
    v_cvt_pk_bf16_f32 v97, v114, v115
    v_exp_f32 v117, v37
    s_waitcnt lgkmcnt(7)
    v_mfma_f32_32x32x16_bf16 v[64:79], v[144:147], a[168:171], v[64:79]
    ds_read_b128 v[180:183], v2 offset:30720
    v_exp_f32 v118, v38
    v_add_f32 v7, v7, v116
    v_mfma_f32_32x32x16_bf16 v[80:95], v[148:151], a[168:171], v[80:95]
    ds_read_b128 v[184:187], v2 offset:15360
    buffer_load_dwordx4 v4, s[8:11], s80 offen offset:3072 lds
    v_exp_f32 v119, v39
    s_waitcnt lgkmcnt(7)
    v_mfma_f32_32x32x16_bf16 v[64:79], v[152:155], a[172:175], v[64:79]
    ds_read_b128 v[188:191], v2 offset:31744
    v_add_f32 v7, v7, v117
    v_cvt_pk_bf16_f32 v98, v116, v117
    v_exp_f32 v120, v40
    v_mfma_f32_32x32x16_bf16 v[80:95], v[156:159], a[172:175], v[80:95]
    v_add_f32 v8, v8, v118
    v_exp_f32 v121, v41
    v_add_f32 v8, v8, v119
    s_waitcnt lgkmcnt(6)
    v_mfma_f32_32x32x16_bf16 v[64:79], v[160:163], a[176:179], v[64:79]
    s_add_u32 s33, s33, 0x8000
    s_cmp_eq_u32 s33, s35
    s_cselect_b32 s33, s36, s33
    s_cmp_eq_u32 s33, s82
    s_cselect_b32 s33, 0x40000000, s33
    v_mfma_f32_32x32x16_bf16 v[80:95], v[164:167], a[176:179], v[80:95]
    s_waitcnt vmcnt(24)
    s_waitcnt lgkmcnt(0)
    s_barrier
    ds_read_b128 v[128:131], v3 offset:0
    ds_read_b128 v[132:135], v3 offset:1024
    v_mfma_f32_32x32x16_bf16 v[64:79], v[168:171], a[180:183], v[64:79]
    ds_read_b128 v[136:139], v3 offset:2048
    ds_read_b128 v[140:143], v3 offset:3072
    v_cvt_pk_bf16_f32 v99, v118, v119
    v_exp_f32 v122, v42
    v_mfma_f32_32x32x16_bf16 v[80:95], v[172:175], a[180:183], v[80:95]
    ds_read_b128 v[144:147], v3 offset:4096
    v_add_f32 v7, v7, v120
    v_exp_f32 v123, v43
    v_mfma_f32_32x32x16_bf16 v[64:79], v[176:179], a[184:187], v[64:79]
    ds_read_b128 v[148:151], v3 offset:5120
    v_add_f32 v7, v7, v121
    v_cvt_pk_bf16_f32 v100, v120, v121
    v_exp_f32 v124, v44
    v_mfma_f32_32x32x16_bf16 v[80:95], v[180:183], a[184:187], v[80:95]
    ds_read_b128 v[152:155], v3 offset:6144
    v_add_f32 v8, v8, v122
    v_exp_f32 v125, v45
    v_mfma_f32_32x32x16_bf16 v[64:79], v[184:187], a[188:191], v[64:79]
    ds_read_b128 v[156:159], v3 offset:7168
    v_add_f32 v8, v8, v123
    v_cvt_pk_bf16_f32 v101, v122, v123
    v_exp_f32 v126, v46
    v_add_f32 v7, v7, v124
    v_exp_f32 v127, v47
    v_add_f32 v7, v7, v125
    v_cvt_pk_bf16_f32 v102, v124, v125
    v_add_f32 v8, v8, v126
    v_add_f32 v8, v8, v127
    v_cvt_pk_bf16_f32 v103, v126, v127
    v_add_f32 v7, v7, v8
    v_cmp_nle_f32 s[54:55], v7, s52
    s_or_b64 s[54:55], s[54:55], s[48:49]
    s_cbranch_scc1 body_p0_m1_slow0
body_p0_m1_ret0:
    v_add_f32 v6, v6, v7
    v_mfma_f32_32x32x16_bf16 v[80:95], v[188:191], a[188:191], v[80:95]
    ds_read_b128 v[160:163], v3 offset:8192
    s_lshl_b32 s66, s40, 6
    s_sub_u32 s66, s43, s66
    s_sub_u32 s66, s66, 32
    s_waitcnt lgkmcnt(7)
    v_mfma_f32_32x32x16_bf16 a[0:15], v[128:131], v[96:99], a[0:15]
    ds_read_b128 v[164:167], v3 offset:9216
    s_mov_b32 s37, s38
    s_mov_b32 s38, s39
    v_add_u32 v9, s66, v10
    v_cmp_gt_i32 s[58:59], 0, v9
    v_mfma_f32_32x32x16_bf16 a[16:31], v[132:135], v[96:99], a[16:31]
    ds_read_b128 v[168:171], v3 offset:10240
    s_add_u32 s39, s39, 0x8000
    s_cmp_eq_u32 s39, 0x28000
    s_cselect_b32 s39, 0, s39
    s_waitcnt lgkmcnt(7)
    v_mfma_f32_32x32x16_bf16 a[32:47], v[136:139], v[96:99], a[32:47]
    ds_read_b128 v[172:175], v3 offset:11264
    v_add_u32 v2, s39, v1
    v_cmp_gt_i32 s[60:61], 1, v9
    v_cmp_gt_i32 s[62:63], 2, v9
    v_cmp_gt_i32 s[64:65], 3, v9
    v_mfma_f32_32x32x16_bf16 a[48:63], v[140:143], v[96:99], a[48:63]
    ds_read_b128 v[176:179], v3 offset:12288
    v_cndmask_b32 v48, v48, v11, s[58:59]
    v_cmp_gt_i32 s[58:59], 8, v9
    v_cndmask_b32 v49, v49, v11, s[60:61]
    s_waitcnt lgkmcnt(7)
    v_mfma_f32_32x32x16_bf16 a[64:79], v[144:147], v[96:99], a[64:79]
    ds_read_b128 v[180:183], v3 offset:13312
    v_cmp_gt_i32 s[60:61], 9, v9
    v_cndmask_b32 v50, v50, v11, s[62:63]
    v_cmp_gt_i32 s[62:63], 10, v9
    v_cndmask_b32 v51, v51, v11, s[64:65]
    v_mfma_f32_32x32x16_bf16 a[80:95], v[148:151], v[96:99], a[80:95]
    ds_read_b128 v[184:187], v3 offset:14336
    v_cmp_gt_i32 s[64:65], 11, v9
    v_cndmask_b32 v52, v52, v11, s[58:59]
    v_cmp_gt_i32 s[58:59], 16, v9
    s_waitcnt lgkmcnt(7)
    v_mfma_f32_32x32x16_bf16 a[96:111], v[152:155], v[96:99], a[96:111]
    ds_read_b128 v[188:191], v3 offset:15360
    v_cndmask_b32 v53, v53, v11, s[60:61]
    v_cmp_gt_i32 s[60:61], 17, v9
    v_cndmask_b32 v54, v54, v11, s[62:63]
    v_cmp_gt_i32 s[62:63], 18, v9
    v_mfma_f32_32x32x16_bf16 a[112:127], v[156:159], v[96:99], a[112:127]
    ds_read_b128 v[128:131], v3 offset:16384
    v_cndmask_b32 v55, v55, v11, s[64:65]
    v_cmp_gt_i32 s[64:65], 19, v9
    v_cndmask_b32 v56, v56, v11, s[58:59]
    s_waitcnt lgkmcnt(7)
    v_mfma_f32_32x32x16_bf16 a[0:15], v[160:163], v[100:103], a[0:15]
    ds_read_b128 v[132:135], v3 offset:17408
    v_cmp_gt_i32 s[58:59], 24, v9
    v_cndmask_b32 v57, v57, v11, s[60:61]
    v_cmp_gt_i32 s[60:61], 25, v9
    v_cndmask_b32 v58, v58, v11, s[62:63]
    v_mfma_f32_32x32x16_bf16 a[16:31], v[164:167], v[100:103], a[16:31]
    ds_read_b128 v[136:139], v3 offset:18432
    v_cmp_gt_i32 s[62:63], 26, v9
    v_cndmask_b32 v59, v59, v11, s[64:65]
    v_cmp_gt_i32 s[64:65], 27, v9
    s_waitcnt lgkmcnt(7)
    v_mfma_f32_32x32x16_bf16 a[32:47], v[168:171], v[100:103], a[32:47]
    ds_read_b128 v[140:143], v3 offset:19456
    v_cndmask_b32 v60, v60, v11, s[58:59]
    v_cndmask_b32 v61, v61, v11, s[60:61]
    v_cndmask_b32 v62, v62, v11, s[62:63]
    v_cndmask_b32 v63, v63, v11, s[64:65]
    v_mfma_f32_32x32x16_bf16 a[48:63], v[172:175], v[100:103], a[48:63]
    ds_read_b128 v[144:147], v3 offset:20480
    v_exp_f32 v112, v48
    s_waitcnt lgkmcnt(7)
    v_mfma_f32_32x32x16_bf16 a[64:79], v[176:179], v[100:103], a[64:79]
    ds_read_b128 v[148:151], v3 offset:21504
    v_exp_f32 v113, v49
    v_exp_f32 v114, v50
    v_mfma_f32_32x32x16_bf16 a[80:95], v[180:183], v[100:103], a[80:95]
    ds_read_b128 v[152:155], v3 offset:22528
    v_exp_f32 v115, v51
    v_add_f32 v7, v112, v113
    s_waitcnt lgkmcnt(7)
    v_mfma_f32_32x32x16_bf16 a[96:111], v[184:187], v[100:103], a[96:111]
    ds_read_b128 v[156:159], v3 offset:23552
    v_cvt_pk_bf16_f32 v104, v112, v113
    v_exp_f32 v116, v52
    v_add_f32 v8, v114, v115
    v_cvt_pk_bf16_f32 v105, v114, v115
    v_exp_f32 v117, v53
    v_exp_f32 v118, v54
    v_add_f32 v7, v7, v116
    v_exp_f32 v119, v55
    v_add_f32 v7, v7, v117
    v_cvt_pk_bf16_f32 v106, v116, v117
    v_exp_f32 v120, v56
    v_add_f32 v8, v8, v118
    v_exp_f32 v121, v57
    v_add_f32 v8, v8, v119
    v_cvt_pk_bf16_f32 v107, v118, v119
    v_exp_f32 v122, v58
    v_add_f32 v7, v7, v120
    v_exp_f32 v123, v59
    v_add_f32 v7, v7, v121
    v_cvt_pk_bf16_f32 v108, v120, v121
    v_exp_f32 v124, v60
    v_add_f32 v8, v8, v122
    v_exp_f32 v125, v61
    v_add_f32 v8, v8, v123
    v_cvt_pk_bf16_f32 v109, v122, v123
    v_exp_f32 v126, v62
    v_add_f32 v7, v7, v124
    v_exp_f32 v127, v63
    v_add_f32 v7, v7, v125
    v_cvt_pk_bf16_f32 v110, v124, v125
    v_add_f32 v8, v8, v126
    v_add_f32 v8, v8, v127
    v_cvt_pk_bf16_f32 v111, v126, v127
    v_add_f32 v7, v7, v8
    v_mfma_f32_32x32x16_bf16 a[112:127], v[188:191], v[100:103], a[112:127]
    ds_read_b128 v[160:163], v3 offset:24576
    v_cmp_nle_f32 s[54:55], v7, s52
    s_cmp_lg_u64 s[54:55], 0
    s_cbranch_scc1 body_p0_m1_slow1
body_p0_m1_ret1:
    v_add_f32 v6, v6, v7
    s_waitcnt lgkmcnt(7)
    v_mfma_f32_32x32x16_bf16 a[0:15], v[128:131], v[104:107], a[0:15]
    ds_read_b128 v[164:167], v3 offset:25600
    s_add_u32 m0, s37, s32
    s_nop 0
    buffer_load_dwordx4 v4, s[12:15], s34 offen lds
    v_mfma_f32_32x32x16_bf16 a[16:31], v[132:135], v[104:107], a[16:31]
    ds_read_b128 v[168:171], v3 offset:26624
    buffer_load_dwordx4 v4, s[12:15], s34 offen offset:1024 lds
    s_waitcnt lgkmcnt(7)
    v_mfma_f32_32x32x16_bf16 a[32:47], v[136:139], v[104:107], a[32:47]
    ds_read_b128 v[172:175], v3 offset:27648
    v_mfma_f32_32x32x16_bf16 a[48:63], v[140:143], v[104:107], a[48:63]
    ds_read_b128 v[176:179], v3 offset:28672
    buffer_load_dwordx4 v4, s[12:15], s34 offen offset:2048 lds
    s_waitcnt lgkmcnt(7)
    v_mfma_f32_32x32x16_bf16 a[64:79], v[144:147], v[104:107], a[64:79]
    ds_read_b128 v[180:183], v3 offset:29696
    v_mfma_f32_32x32x16_bf16 a[80:95], v[148:151], v[104:107], a[80:95]
    ds_read_b128 v[184:187], v3 offset:30720
    buffer_load_dwordx4 v4, s[12:15], s34 offen offset:3072 lds
    s_waitcnt lgkmcnt(7)
    v_mfma_f32_32x32x16_bf16 a[96:111], v[152:155], v[104:107], a[96:111]
    ds_read_b128 v[188:191], v3 offset:31744
    v_mfma_f32_32x32x16_bf16 a[112:127], v[156:159], v[104:107], a[112:127]
    s_add_u32 m0, m0, 0x1000
    s_add_u32 s80, s34, 0x1000
    buffer_load_dwordx4 v4, s[12:15], s80 offen lds
    s_waitcnt lgkmcnt(6)
    v_mfma_f32_32x32x16_bf16 a[0:15], v[160:163], v[108:111], a[0:15]
    v_mfma_f32_32x32x16_bf16 a[16:31], v[164:167], v[108:111], a[16:31]
    s_waitcnt vmcnt(21)
    s_waitcnt lgkmcnt(0)
    s_barrier
    ds_read_b128 v[128:131], v2 offset:0
    ds_read_b128 v[132:135], v2 offset:16384
    v_mfma_f32_32x32x16_bf16 a[32:47], v[168:171], v[108:111], a[32:47]
    ds_read_b128 v[136:139], v2 offset:1024
    ds_read_b128 v[140:143], v2 offset:17408
    buffer_load_dwordx4 v4, s[12:15], s80 offen offset:1024 lds
    v_mfma_f32_32x32x16_bf16 a[48:63], v[172:175], v[108:111], a[48:63]
    ds_read_b128 v[144:147], v2 offset:2048
    buffer_load_dwordx4 v4, s[12:15], s80 offen offset:2048 lds
    v_mfma_f32_32x32x16_bf16 a[64:79], v[176:179], v[108:111], a[64:79]
    ds_read_b128 v[148:151], v2 offset:18432
    v_mfma_f32_32x32x16_bf16 a[80:95], v[180:183], v[108:111], a[80:95]
    ds_read_b128 v[152:155], v2 offset:3072
    buffer_load_dwordx4 v4, s[12:15], s80 offen offset:3072 lds
    s_add_u32 s40, s40, 1
    s_sub_u32 s41, s41, 1
    v_mfma_f32_32x32x16_bf16 a[96:111], v[184:187], v[108:111], a[96:111]
    ds_read_b128 v[156:159], v2 offset:19456
    v_mfma_f32_32x32x16_bf16 a[112:127], v[188:191], v[108:111], a[112:127]
    ds_read_b128 v[160:163], v2 offset:4096
    s_add_u32 s34, s34, 0x8000
    s_cmp_eq_u32 s34, s35
    s_cselect_b32 s34, s36, s34
    s_cmp_eq_u32 s34, s82
    s_cselect_b32 s34, 0x40000000, s34
    s_cmp_ge_u32 s40, s81
    s_branch k2_spec_p1
body_p0_m1_slow0:
    s_call_b64 s[56:57], slow_p0_s0
    s_branch body_p0_m1_ret0
body_p0_m1_slow1:
    s_call_b64 s[56:57], slow_p0_s1
    s_branch body_p0_m1_ret1
body_p1_m0:
    s_waitcnt lgkmcnt(7)
    v_mfma_f32_32x32x16_bf16 v[32:47], v[128:131], a[128:131], v[16:31]
    ds_read_b128 v[164:167], v2 offset:20480
    s_mov_b32 s37, s38
    s_mov_b32 s38, s39
    v_exp_f32 v112, v64
    v_mfma_f32_32x32x16_bf16 v[48:63], v[132:135], a[128:131], v[16:31]
    ds_read_b128 v[168:171], v2 offset:5120
    s_add_u32 s39, s39, 0x8000
    s_cmp_eq_u32 s39, 0x28000
    s_cselect_b32 s39, 0, s39
    s_waitcnt lgkmcnt(7)
    v_mfma_f32_32x32x16_bf16 v[32:47], v[136:139], a[132:135], v[32:47]
    ds_read_b128 v[172:175], v2 offset:21504
    v_add_u32 v3, s39, v1
    s_add_u32 m0, s37, s32
    s_nop 0
    buffer_load_dwordx4 v4, s[8:11], s33 offen lds
    v_mfma_f32_32x32x16_bf16 v[48:63], v[140:143], a[132:135], v[48:63]
    ds_read_b128 v[176:179], v2 offset:6144
    v_exp_f32 v113, v65
    s_waitcnt lgkmcnt(7)
    v_mfma_f32_32x32x16_bf16 v[32:47], v[144:147], a[136:139], v[32:47]
    ds_read_b128 v[180:183], v2 offset:22528
    buffer_load_dwordx4 v4, s[8:11], s33 offen offset:1024 lds
    v_exp_f32 v114, v66
    v_mfma_f32_32x32x16_bf16 v[48:63], v[148:151], a[136:139], v[48:63]
    ds_read_b128 v[184:187], v2 offset:7168
    v_exp_f32 v115, v67
    v_add_f32 v7, v112, v113
    s_waitcnt lgkmcnt(7)
    v_mfma_f32_32x32x16_bf16 v[32:47], v[152:155], a[140:143], v[32:47]
    ds_read_b128 v[188:191], v2 offset:23552
    v_cvt_pk_bf16_f32 v96, v112, v113
    v_exp_f32 v116, v68
    v_add_f32 v8, v114, v115
    v_mfma_f32_32x32x16_bf16 v[48:63], v[156:159], a[140:143], v[48:63]
    ds_read_b128 v[128:131], v2 offset:8192
    buffer_load_dwordx4 v4, s[8:11], s33 offen offset:2048 lds
    v_cvt_pk_bf16_f32 v97, v114, v115
    s_waitcnt lgkmcnt(7)
    v_mfma_f32_32x32x16_bf16 v[32:47], v[160:163], a[144:147], v[32:47]
    ds_read_b128 v[132:135], v2 offset:24576
    v_exp_f32 v117, v69
    v_exp_f32 v118, v70
    v_mfma_f32_32x32x16_bf16 v[48:63], v[164:167], a[144:147], v[48:63]
    ds_read_b128 v[136:139], v2 offset:9216
    v_add_f32 v7, v7, v116
    v_exp_f32 v119, v71
    s_waitcnt lgkmcnt(7)
    v_mfma_f32_32x32x16_bf16 v[32:47], v[168:171], a[148:151], v[32:47]
    ds_read_b128 v[140:143], v2 offset:25600
    buffer_load_dwordx4 v4, s[8:11], s33 offen offset:3072 lds
    v_add_f32 v7, v7, v117
    v_cvt_pk_bf16_f32 v98, v116, v117
    v_mfma_f32_32x32x16_bf16 v[48:63], v[172:175], a[148:151], v[48:63]
    ds_read_b128 v[144:147], v2 offset:10240
    v_exp_f32 v120, v72
    v_add_f32 v8, v8, v118
    s_waitcnt lgkmcnt(7)
    v_mfma_f32_32x32x16_bf16 v[32:47], v[176:179], a[152:155], v[32:47]
    ds_read_b128 v[148:151], v2 offset:26624
    v_exp_f32 v121, v73
    v_add_f32 v8, v8, v119
    v_cvt_pk_bf16_f32 v99, v118, v119
    v_mfma_f32_32x32x16_bf16 v[48:63], v[180:183], a[152:155], v[48:63]
    ds_read_b128 v[152:155], v2 offset:11264
    s_add_u32 m0, m0, 0x1000
    s_add_u32 s80, s33, 0x1000
    buffer_load_dwordx4 v4, s[8:11], s80 offen lds
    s_waitcnt lgkmcnt(7)
    v_mfma_f32_32x32x16_bf16 v[32:47], v[184:187], a[156:159], v[32:47]
    ds_read_b128 v[156:159], v2 offset:27648
    v_exp_f32 v122, v74
    v_add_f32 v7, v7, v120
    v_mfma_f32_32x32x16_bf16 v[48:63], v[188:191], a[156:159], v[48:63]
    ds_read_b128 v[160:163], v2 offset:12288
    buffer_load_dwordx4 v4, s[8:11], s80 offen offset:1024 lds
    v_exp_f32 v123, v75
    s_waitcnt lgkmcnt(7)
    v_mfma_f32_32x32x16_bf16 v[32:47], v[128:131], a[160:163], v[32:47]
    ds_read_b128 v[164:167], v2 offset:28672
    v_add_f32 v7, v7, v121
    v_cvt_pk_bf16_f32 v100, v120, v121
    v_exp_f32 v124, v76
    v_mfma_f32_32x32x16_bf16 v[48:63], v[132:135], a[160:163], v[48:63]
    ds_read_b128 v[168:171], v2 offset:13312
    v_add_f32 v8, v8, v122
    v_exp_f32 v125, v77
    s_waitcnt lgkmcnt(7)
    v_mfma_f32_32x32x16_bf16 v[32:47], v[136:139], a[164:167], v[32:47]
    ds_read_b128 v[172:175], v2 offset:29696
    buffer_load_dwordx4 v4, s[8:11], s80 offen offset:2048 lds
    v_add_f32 v8, v8, v123
    v_cvt_pk_bf16_f32 v101, v122, v123
    v_mfma_f32_32x32x16_bf16 v[48:63], v[140:143], a[164:167], v[48:63]
    ds_read_b128 v[176:179], v2 offset:14336
    v_exp_f32 v126, v78
    v_add_f32 v7, v7, v124
    s_waitcnt lgkmcnt(7)
    v_mfma_f32_32x32x16_bf16 v[32:47], v[144:147], a[168:171], v[32:47]
    ds_read_b128 v[180:183], v2 offset:30720
    v_exp_f32 v127, v79
    v_add_f32 v7, v7, v125
    v_cvt_pk_bf16_f32 v102, v124, v125
    v_mfma_f32_32x32x16_bf16 v[48:63], v[148:151], a[168:171], v[48:63]
    ds_read_b128 v[184:187], v2 offset:15360
    buffer_load_dwordx4 v4, s[8:11], s80 offen offset:3072 lds
    v_add_f32 v8, v8, v126
    v_add_f32 v8, v8, v127
    s_waitcnt lgkmcnt(7)
    v_mfma_f32_32x32x16_bf16 v[32:47], v[152:155], a[172:175], v[32:47]
    ds_read_b128 v[188:191], v2 offset:31744
    v_cvt_pk_bf16_f32 v103, v126, v127
    v_add_f32 v7, v7, v8
    v_mfma_f32_32x32x16_bf16 v[48:63], v[156:159], a[172:175], v[48:63]
    v_cmp_nle_f32 s[54:55], v7, s52
    s_or_b64 s[54:55], s[54:55], s[48:49]
    s_cbranch_scc1 body_p1_m0_slow0
body_p1_m0_ret0:
    v_add_f32 v6, v6, v7
    s_waitcnt lgkmcnt(6)
    v_mfma_f32_32x32x16_bf16 v[32:47], v[160:163], a[176:179], v[32:47]
    s_add_u32 s33, s33, 0x8000
    s_cmp_eq_u32 s33, s35
    s_cselect_b32 s33, s36, s33
    s_cmp_eq_u32 s33, s82
    s_cselect_b32 s33, 0x40000000, s33
    v_mfma_f32_32x32x16_bf16 v[48:63], v[164:167], a[176:179], v[48:63]
    s_waitcnt vmcnt(24)
    s_waitcnt lgkmcnt(0)
    s_barrier
    ds_read_b128 v[128:131], v3 offset:0
    ds_read_b128 v[132:135], v3 offset:1024
    v_mfma_f32_32x32x16_bf16 v[32:47], v[168:171], a[180:183], v[32:47]
    ds_read_b128 v[136:139], v3 offset:2048
    ds_read_b128 v[140:143], v3 offset:3072
    v_exp_f32 v112, v80
    v_mfma_f32_32x32x16_bf16 v[48:63], v[172:175], a[180:183], v[48:63]
    ds_read_b128 v[144:147], v3 offset:4096
    v_exp_f32 v113, v81
    v_mfma_f32_32x32x16_bf16 v[32:47], v[176:179], a[184:187], v[32:47]
    ds_read_b128 v[148:151], v3 offset:5120
    v_exp_f32 v114, v82
    v_exp_f32 v115, v83
    v_mfma_f32_32x32x16_bf16 v[48:63], v[180:183], a[184:187], v[48:63]
    ds_read_b128 v[152:155], v3 offset:6144
    v_add_f32 v7, v112, v113
    v_cvt_pk_bf16_f32 v104, v112, v113
    v_mfma_f32_32x32x16_bf16 v[32:47], v[184:187], a[188:191], v[32:47]
    ds_read_b128 v[156:159], v3 offset:7168
    v_exp_f32 v116, v84
    v_add_f32 v8, v114, v115
    v_cvt_pk_bf16_f32 v105, v114, v115
    v_mfma_f32_32x32x16_bf16 v[48:63], v[188:191], a[188:191], v[48:63]
    ds_read_b128 v[160:163], v3 offset:8192
    v_exp_f32 v117, v85
    s_waitcnt lgkmcnt(7)
    v_mfma_f32_32x32x16_bf16 a[0:15], v[128:131], v[96:99], a[0:15]
    ds_read_b128 v[164:167], v3 offset:9216
    s_mov_b32 s37, s38
    s_mov_b32 s38, s39
    v_exp_f32 v118, v86
    v_mfma_f32_32x32x16_bf16 a[16:31], v[132:135], v[96:99], a[16:31]
    ds_read_b128 v[168:171], v3 offset:10240
    s_add_u32 s39, s39, 0x8000
    s_cmp_eq_u32 s39, 0x28000
    s_cselect_b32 s39, 0, s39
    s_waitcnt lgkmcnt(7)
    v_mfma_f32_32x32x16_bf16 a[32:47], v[136:139], v[96:99], a[32:47]
    ds_read_b128 v[172:175], v3 offset:11264
    v_add_u32 v2, s39, v1
    v_add_f32 v7, v7, v116
    v_exp_f32 v119, v87
    v_mfma_f32_32x32x16_bf16 a[48:63], v[140:143], v[96:99], a[48:63]
    ds_read_b128 v[176:179], v3 offset:12288
    v_add_f32 v7, v7, v117
    v_cvt_pk_bf16_f32 v106, v116, v117
    s_waitcnt lgkmcnt(7)
    v_mfma_f32_32x32x16_bf16 a[64:79], v[144:147], v[96:99], a[64:79]
    ds_read_b128 v[180:183], v3 offset:13312
    v_exp_f32 v120, v88
    v_add_f32 v8, v8, v118
    v_mfma_f32_32x32x16_bf16 a[80:95], v[148:151], v[96:99], a[80:95]
    ds_read_b128 v[184:187], v3 offset:14336
    v_exp_f32 v121, v89
    v_add_f32 v8, v8, v119
    s_waitcnt lgkmcnt(7)
    v_mfma_f32_32x32x16_bf16 a[96:111], v[152:155], v[96:99], a[96:111]
    ds_read_b128 v[188:191], v3 offset:15360
    v_cvt_pk_bf16_f32 v107, v118, v119
    v_exp_f32 v122, v90
    v_add_f32 v7, v7, v120
    v_mfma_f32_32x32x16_bf16 a[112:127], v[156:159], v[96:99], a[112:127]
    ds_read_b128 v[128:131], v3 offset:16384
    v_exp_f32 v123, v91
    v_add_f32 v7, v7, v121
    s_waitcnt lgkmcnt(7)
    v_mfma_f32_32x32x16_bf16 a[0:15], v[160:163], v[100:103], a[0:15]
    ds_read_b128 v[132:135], v3 offset:17408
    v_cvt_pk_bf16_f32 v108, v120, v121
    v_exp_f32 v124, v92
    v_add_f32 v8, v8, v122
    v_mfma_f32_32x32x16_bf16 a[16:31], v[164:167], v[100:103], a[16:31]
    ds_read_b128 v[136:139], v3 offset:18432
    v_exp_f32 v125, v93
    v_add_f32 v8, v8, v123
    s_waitcnt lgkmcnt(7)
    v_mfma_f32_32x32x16_bf16 a[32:47], v[168:171], v[100:103], a[32:47]
    ds_read_b128 v[140:143], v3 offset:19456
    v_cvt_pk_bf16_f32 v109, v122, v123
    v_exp_f32 v126, v94
    v_add_f32 v7, v7, v124
    v_mfma_f32_32x32x16_bf16 a[48:63], v[172:175], v[100:103], a[48:63]
    ds_read_b128 v[144:147], v3 offset:20480
    v_exp_f32 v127, v95
    v_add_f32 v7, v7, v125
    s_waitcnt lgkmcnt(7)
    v_mfma_f32_32x32x16_bf16 a[64:79], v[176:179], v[100:103], a[64:79]
    ds_read_b128 v[148:151], v3 offset:21504
    v_cvt_pk_bf16_f32 v110, v124, v125
    v_add_f32 v8, v8, v126
    v_add_f32 v8, v8, v127
    v_cvt_pk_bf16_f32 v111, v126, v127
    v_mfma_f32_32x32x16_bf16 a[80:95], v[180:183], v[100:103], a[80:95]
    ds_read_b128 v[152:155], v3 offset:22528
    v_add_f32 v7, v7, v8
    s_waitcnt lgkmcnt(7)
    v_mfma_f32_32x32x16_bf16 a[96:111], v[184:187], v[100:103], a[96:111]
    ds_read_b128 v[156:159], v3 offset:23552
    v_mfma_f32_32x32x16_bf16 a[112:127], v[188:191], v[100:103], a[112:127]
    ds_read_b128 v[160:163], v3 offset:24576
    v_cmp_nle_f32 s[54:55], v7, s52
    s_cmp_lg_u64 s[54:55], 0
    s_cbranch_scc1 body_p1_m0_slow1
body_p1_m0_ret1:
    v_add_f32 v6, v6, v7
    s_waitcnt lgkmcnt(7)
    v_mfma_f32_32x32x16_bf16 a[0:15], v[128:131], v[104:107], a[0:15]
    ds_read_b128 v[164:167], v3 offset:25600
    s_add_u32 m0, s37, s32
    s_nop 0
    buffer_load_dwordx4 v4, s[12:15], s34 offen lds
    v_mfma_f32_32x32x16_bf16 a[16:31], v[132:135], v[104:107], a[16:31]
    ds_read_b128 v[168:171], v3 offset:26624
    buffer_load_dwordx4 v4, s[12:15], s34 offen offset:1024 lds
    s_waitcnt lgkmcnt(7)
    v_mfma_f32_32x32x16_bf16 a[32:47], v[136:139], v[104:107], a[32:47]
    ds_read_b128 v[172:175], v3 offset:27648
    v_mfma_f32_32x32x16_bf16 a[48:63], v[140:143], v[104:107], a[48:63]
    ds_read_b128 v[176:179], v3 offset:28672
    buffer_load_dwordx4 v4, s[12:15], s34 offen offset:2048 lds
    s_waitcnt lgkmcnt(7)
    v_mfma_f32_32x32x16_bf16 a[64:79], v[144:147], v[104:107], a[64:79]
    ds_read_b128 v[180:183], v3 offset:29696
    v_mfma_f32_32x32x16_bf16 a[80:95], v[148:151], v[104:107], a[80:95]
    ds_read_b128 v[184:187], v3 offset:30720
    buffer_load_dwordx4 v4, s[12:15], s34 offen offset:3072 lds
    s_waitcnt lgkmcnt(7)
    v_mfma_f32_32x32x16_bf16 a[96:111], v[152:155], v[104:107], a[96:111]
    ds_read_b128 v[188:191], v3 offset:31744
    v_mfma_f32_32x32x16_bf16 a[112:127], v[156:159], v[104:107], a[112:127]
    s_add_u32 m0, m0, 0x1000
    s_add_u32 s80, s34, 0x1000
    buffer_load_dwordx4 v4, s[12:15], s80 offen lds
    s_waitcnt lgkmcnt(6)
    v_mfma_f32_32x32x16_bf16 a[0:15], v[160:163], v[108:111], a[0:15]
    v_mfma_f32_32x32x16_bf16 a[16:31], v[164:167], v[108:111], a[16:31]
    s_waitcnt vmcnt(21)
    s_waitcnt lgkmcnt(0)
    s_barrier
    ds_read_b128 v[128:131], v2 offset:0
    ds_read_b128 v[132:135], v2 offset:16384
    v_mfma_f32_32x32x16_bf16 a[32:47], v[168:171], v[108:111], a[32:47]
    ds_read_b128 v[136:139], v2 offset:1024
    ds_read_b128 v[140:143], v2 offset:17408
    buffer_load_dwordx4 v4, s[12:15], s80 offen offset:1024 lds
    v_mfma_f32_32x32x16_bf16 a[48:63], v[172:175], v[108:111], a[48:63]
    ds_read_b128 v[144:147], v2 offset:2048
    buffer_load_dwordx4 v4, s[12:15], s80 offen offset:2048 lds
    v_mfma_f32_32x32x16_bf16 a[64:79], v[176:179], v[108:111], a[64:79]
    ds_read_b128 v[148:151], v2 offset:18432
    v_mfma_f32_32x32x16_bf16 a[80:95], v[180:183], v[108:111], a[80:95]
    ds_read_b128 v[152:155], v2 offset:3072
    buffer_load_dwordx4 v4, s[12:15], s80 offen offset:3072 lds
    s_add_u32 s40, s40, 1
    s_sub_u32 s41, s41, 1
    v_mfma_f32_32x32x16_bf16 a[96:111], v[184:187], v[108:111], a[96:111]
    ds_read_b128 v[156:159], v2 offset:19456
    v_mfma_f32_32x32x16_bf16 a[112:127], v[188:191], v[108:111], a[112:127]
    ds_read_b128 v[160:163], v2 offset:4096
    s_add_u32 s34, s34, 0x8000
    s_cmp_eq_u32 s34, s35
    s_cselect_b32 s34, s36, s34
    s_cmp_eq_u32 s34, s82
    s_cselect_b32 s34, 0x40000000, s34
    s_cmp_ge_u32 s40, s81
    s_cbranch_scc1 k2_spec_p0
    s_branch body_p0_m0
body_p1_m0_slow0:
    s_call_b64 s[56:57], slow_p1_s0
    s_branch body_p1_m0_ret0
body_p1_m0_slow1:
    s_call_b64 s[56:57], slow_p1_s1
    s_branch body_p1_m0_ret1
body_p1_m1:
    s_waitcnt lgkmcnt(7)
    v_mfma_f32_32x32x16_bf16 v[32:47], v[128:131], a[128:131], v[16:31]
    ds_read_b128 v[164:167], v2 offset:20480
    s_mov_b32 s37, s38
    s_mov_b32 s38, s39
    s_lshl_b32 s66, s40, 6
    s_sub_u32 s66, s43, s66
    v_mfma_f32_32x32x16_bf16 v[48:63], v[132:135], a[128:131], v[16:31]
    ds_read_b128 v[168:171], v2 offset:5120
    s_add_u32 s39, s39, 0x8000
    s_cmp_eq_u32 s39, 0x28000
    s_cselect_b32 s39, 0, s39
    s_waitcnt lgkmcnt(7)
    v_mfma_f32_32x32x16_bf16 v[32:47], v[136:139], a[132:135], v[32:47]
    ds_read_b128 v[172:175], v2 offset:21504
    v_add_u32 v3, s39, v1
    s_add_u32 m0, s37, s32
    s_nop 0
    buffer_load_dwordx4 v4, s[8:11], s33 offen lds
    v_mfma_f32_32x32x16_bf16 v[48:63], v[140:143], a[132:135], v[48:63]
    ds_read_b128 v[176:179], v2 offset:6144
    v_add_u32 v9, s66, v10
    v_cmp_gt_i32 s[58:59], 0, v9
    v_cmp_gt_i32 s[60:61], 1, v9
    s_waitcnt lgkmcnt(7)
    v_mfma_f32_32x32x16_bf16 v[32:47], v[144:147], a[136:139], v[32:47]
    ds_read_b128 v[180:183], v2 offset:22528
    buffer_load_dwordx4 v4, s[8:11], s33 offen offset:1024 lds
    v_cmp_gt_i32 s[62:63], 2, v9
    v_cmp_gt_i32 s[64:65], 3, v9
    v_cndmask_b32 v64, v64, v11, s[58:59]
    v_mfma_f32_32x32x16_bf16 v[48:63], v[148:151], a[136:139], v[48:63]
    ds_read_b128 v[184:187], v2 offset:7168
    v_cmp_gt_i32 s[58:59], 8, v9
    v_cndmask_b32 v65, v65, v11, s[60:61]
    v_cmp_gt_i32 s[60:61], 9, v9
    s_waitcnt lgkmcnt(7)
    v_mfma_f32_32x32x16_bf16 v[32:47], v[152:155], a[140:143], v[32:47]
    ds_read_b128 v[188:191], v2 offset:23552
    v_cndmask_b32 v66, v66, v11, s[62:63]
    v_cmp_gt_i32 s[62:63], 10, v9
    v_cndmask_b32 v67, v67, v11, s[64:65]
    v_cmp_gt_i32 s[64:65], 11, v9
    v_mfma_f32_32x32x16_bf16 v[48:63], v[156:159], a[140:143], v[48:63]
    ds_read_b128 v[128:131], v2 offset:8192
    buffer_load_dwordx4 v4, s[8:11], s33 offen offset:2048 lds
    v_cndmask_b32 v68, v68, v11, s[58:59]
    v_cmp_gt_i32 s[58:59], 16, v9
    s_waitcnt lgkmcnt(7)
    v_mfma_f32_32x32x16_bf16 v[32:47], v[160:163], a[144:147], v[32:47]
    ds_read_b128 v[132:135], v2 offset:24576
    v_cndmask_b32 v69, v69, v11, s[60:61]
    v_cmp_gt_i32 s[60:61], 17, v9
    v_cndmask_b32 v70, v70, v11, s[62:63]
    v_cmp_gt_i32 s[62:63], 18, v9
    v_mfma_f32_32x32x16_bf16 v[48:63], v[164:167], a[144:147], v[48:63]
    ds_read_b128 v[136:139], v2 offset:9216
    v_cndmask_b32 v71, v71, v11, s[64:65]
    v_cmp_gt_i32 s[64:65], 19, v9
    v_cndmask_b32 v72, v72, v11, s[58:59]
    s_waitcnt lgkmcnt(7)
    v_mfma_f32_32x32x16_bf16 v[32:47], v[168:171], a[148:151], v[32:47]
    ds_read_b128 v[140:143], v2 offset:25600
    buffer_load_dwordx4 v4, s[8:11], s33 offen offset:3072 lds
    v_cmp_gt_i32 s[58:59], 24, v9
    v_cndmask_b32 v73, v73, v11, s[60:61]
    v_cmp_gt_i32 s[60:61], 25, v9
    v_mfma_f32_32x32x16_bf16 v[48:63], v[172:175], a[148:151], v[48:63]
    ds_read_b128 v[144:147], v2 offset:10240
    v_cndmask_b32 v74, v74, v11, s[62:63]
    v_cmp_gt_i32 s[62:63], 26, v9
    v_cndmask_b32 v75, v75, v11, s[64:65]
    s_waitcnt lgkmcnt(7)
    v_mfma_f32_32x32x16_bf16 v[32:47], v[176:179], a[152:155], v[32:47]
    ds_read_b128 v[148:151], v2 offset:26624
    v_cmp_gt_i32 s[64:65], 27, v9
    v_cndmask_b32 v76, v76, v11, s[58:59]
    v_cndmask_b32 v77, v77, v11, s[60:61]
    v_cndmask_b32 v78, v78, v11, s[62:63]
    v_mfma_f32_32x32x16_bf16 v[48:63], v[180:183], a[152:155], v[48:63]
    ds_read_b128 v[152:155], v2 offset:11264
    s_add_u32 m0, m0, 0x1000
    s_add_u32 s80, s33, 0x1000
    buffer_load_dwordx4 v4, s[8:11], s80 offen lds
    s_waitcnt lgkmcnt(7)
    v_mfma_f32_32x32x16_bf16 v[32:47], v[184:187], a[156:159], v[32:47]
    ds_read_b128 v[156:159], v2 offset:27648
    v_cndmask_b32 v79, v79, v11, s[64:65]
    v_exp_f32 v112, v64
    v_mfma_f32_32x32x16_bf16 v[48:63], v[188:191], a[156:159], v[48:63]
    ds_read_b128 v[160:163], v2 offset:12288
    buffer_load_dwordx4 v4, s[8:11], s80 offen offset:1024 lds
    v_exp_f32 v113, v65
    s_waitcnt lgkmcnt(7)
    v_mfma_f32_32x32x16_bf16 v[32:47], v[128:131], a[160:163], v[32:47]
    ds_read_b128 v[164:167], v2 offset:28672
    v_exp_f32 v114, v66
    v_exp_f32 v115, v67
    v_mfma_f32_32x32x16_bf16 v[48:63], v[132:135], a[160:163], v[48:63]
    ds_read_b128 v[168:171], v2 offset:13312
    v_add_f32 v7, v112, v113
    v_cvt_pk_bf16_f32 v96, v112, v113
    s_waitcnt lgkmcnt(7)
    v_mfma_f32_32x32x16_bf16 v[32:47], v[136:139], a[164:167], v[32:47]
    ds_read_b128 v[172:175], v2 offset:29696
    buffer_load_dwordx4 v4, s[8:11], s80 offen offset:2048 lds
    v_exp_f32 v116, v68
    v_add_f32 v8, v114, v115
    v_mfma_f32_32x32x16_bf16 v[48:63], v[140:143], a[164:167], v[48:63]
    ds_read_b128 v[176:179], v2 offset:14336
    v_cvt_pk_bf16_f32 v97, v114, v115
    v_exp_f32 v117, v69
    s_waitcnt lgkmcnt(7)
    v_mfma_f32_32x32x16_bf16 v[32:47], v[144:147], a[168:171], v[32:47]
    ds_read_b128 v[180:183], v2 offset:30720
    v_exp_f32 v118, v70
    v_add_f32 v7, v7, v116
    v_mfma_f32_32x32x16_bf16 v[48:63], v[148:151], a[168:171], v[48:63]
    ds_read_b128 v[184:187], v2 offset:15360
    buffer_load_dwordx4 v4, s[8:11], s80 offen offset:3072 lds
    v_exp_f32 v119, v71
    s_waitcnt lgkmcnt(7)
    v_mfma_f32_32x32x16_bf16 v[32:47], v[152:155], a[172:175], v[32:47]
    ds_read_b128 v[188:191], v2 offset:31744
    v_add_f32 v7, v7, v117
    v_cvt_pk_bf16_f32 v98, v116, v117
    v_exp_f32 v120, v72
    v_mfma_f32_32x32x16_bf16 v[48:63], v[156:159], a[172:175], v[48:63]
    v_add_f32 v8, v8, v118
    v_exp_f32 v121, v73
    v_add_f32 v8, v8, v119
    s_waitcnt lgkmcnt(6)
    v_mfma_f32_32x32x16_bf16 v[32:47], v[160:163], a[176:179], v[32:47]
    s_add_u32 s33, s33, 0x8000
    s_cmp_eq_u32 s33, s35
    s_cselect_b32 s33, s36, s33
    s_cmp_eq_u32 s33, s82
    s_cselect_b32 s33, 0x40000000, s33
    v_mfma_f32_32x32x16_bf16 v[48:63], v[164:167], a[176:179], v[48:63]
    s_waitcnt vmcnt(24)
    s_waitcnt lgkmcnt(0)
    s_barrier
    ds_read_b128 v[128:131], v3 offset:0
    ds_read_b128 v[132:135], v3 offset:1024
    v_mfma_f32_32x32x16_bf16 v[32:47], v[168:171], a[180:183], v[32:47]
    ds_read_b128 v[136:139], v3 offset:2048
    ds_read_b128 v[140:143], v3 offset:3072
    v_cvt_pk_bf16_f32 v99, v118, v119
    v_exp_f32 v122, v74
    v_mfma_f32_32x32x16_bf16 v[48:63], v[172:175], a[180:183], v[48:63]
    ds_read_b128 v[144:147], v3 offset:4096
    v_add_f32 v7, v7, v120
    v_exp_f32 v123, v75
    v_mfma_f32_32x32x16_bf16 v[32:47], v[176:179], a[184:187], v[32:47]
    ds_read_b128 v[148:151], v3 offset:5120
    v_add_f32 v7, v7, v121
    v_cvt_pk_bf16_f32 v100, v120, v121
    v_exp_f32 v124, v76
    v_mfma_f32_32x32x16_bf16 v[48:63], v[180:183], a[184:187], v[48:63]
    ds_read_b128 v[152:155], v3 offset:6144
    v_add_f32 v8, v8, v122
    v_exp_f32 v125, v77
    v_mfma_f32_32x32x16_bf16 v[32:47], v[184:187], a[188:191], v[32:47]
    ds_read_b128 v[156:159], v3 offset:7168
    v_add_f32 v8, v8, v123
    v_cvt_pk_bf16_f32 v101, v122, v123
    v_exp_f32 v126, v78
    v_add_f32 v7, v7, v124
    v_exp_f32 v127, v79
    v_add_f32 v7, v7, v125
    v_cvt_pk_bf16_f32 v102, v124, v125
    v_add_f32 v8, v8, v126
    v_add_f32 v8, v8, v127
    v_cvt_pk_bf16_f32 v103, v126, v127
    v_add_f32 v7, v7, v8
    v_cmp_nle_f32 s[54:55], v7, s52
    s_or_b64 s[54:55], s[54:55], s[48:49]
    s_cbranch_scc1 body_p1_m1_slow0
body_p1_m1_ret0:
    v_add_f32 v6, v6, v7
    v_mfma_f32_32x32x16_bf16 v[48:63], v[188:191], a[188:191], v[48:63]
    ds_read_b128 v[160:163], v3 offset:8192
    s_lshl_b32 s66, s40, 6
    s_sub_u32 s66, s43, s66
    s_sub_u32 s66, s66, 32
    s_waitcnt lgkmcnt(7)
    v_mfma_f32_32x32x16_bf16 a[0:15], v[128:131], v[96:99], a[0:15]
    ds_read_b128 v[164:167], v3 offset:9216
    s_mov_b32 s37, s38
    s_mov_b32 s38, s39
    v_add_u32 v9, s66, v10
    v_cmp_gt_i32 s[58:59], 0, v9
    v_mfma_f32_32x32x16_bf16 a[16:31], v[132:135], v[96:99], a[16:31]
    ds_read_b128 v[168:171], v3 offset:10240
    s_add_u32 s39, s39, 0x8000
    s_cmp_eq_u32 s39, 0x28000
    s_cselect_b32 s39, 0, s39
    s_waitcnt lgkmcnt(7)
    v_mfma_f32_32x32x16_bf16 a[32:47], v[136:139], v[96:99], a[32:47]
    ds_read_b128 v[172:175], v3 offset:11264
    v_add_u32 v2, s39, v1
    v_cmp_gt_i32 s[60:61], 1, v9
    v_cmp_gt_i32 s[62:63], 2, v9
    v_cmp_gt_i32 s[64:65], 3, v9
    v_mfma_f32_32x32x16_bf16 a[48:63], v[140:143], v[96:99], a[48:63]
    ds_read_b128 v[176:179], v3 offset:12288
    v_cndmask_b32 v80, v80, v11, s[58:59]
    v_cmp_gt_i32 s[58:59], 8, v9
    v_cndmask_b32 v81, v81, v11, s[60:61]
    s_waitcnt lgkmcnt(7)
    v_mfma_f32_32x32x16_bf16 a[64:79], v[144:147], v[96:99], a[64:79]
    ds_read_b128 v[180:183], v3 offset:13312
    v_cmp_gt_i32 s[60:61], 9, v9
    v_cndmask_b32 v82, v82, v11, s[62:63]
    v_cmp_gt_i32 s[62:63], 10, v9
    v_cndmask_b32 v83, v83, v11, s[64:65]
    v_mfma_f32_32x32x16_bf16 a[80:95], v[148:151], v[96:99], a[80:95]
    ds_read_b128 v[184:187], v3 offset:14336
    v_cmp_gt_i32 s[64:65], 11, v9
    v_cndmask_b32 v84, v84, v11, s[58:59]
    v_cmp_gt_i32 s[58:59], 16, v9
    s_waitcnt lgkmcnt(7)
    v_mfma_f32_32x32x16_bf16 a[96:111], v[152:155], v[96:99], a[96:111]
    ds_read_b128 v[188:191], v3 offset:15360
    v_cndmask_b32 v85, v85, v11, s[60:61]
    v_cmp_gt_i32 s[60:61], 17, v9
    v_cndmask_b32 v86, v86, v11, s[62:63]
    v_cmp_gt_i32 s[62:63], 18, v9
    v_mfma_f32_32x32x16_bf16 a[112:127], v[156:159], v[96:99], a[112:127]
    ds_read_b128 v[128:131], v3 offset:16384
    v_cndmask_b32 v87, v87, v11, s[64:65]
    v_cmp_gt_i32 s[64:65], 19, v9
    v_cndmask_b32 v88, v88, v11, s[58:59]
    s_waitcnt lgkmcnt(7)
    v_mfma_f32_32x32x16_bf16 a[0:15], v[160:163], v[100:103], a[0:15]
    ds_read_b128 v[132:135], v3 offset:17408
    v_cmp_gt_i32 s[58:59], 24, v9
    v_cndmask_b32 v89, v89, v11, s[60:61]
    v_cmp_gt_i32 s[60:61], 25, v9
    v_cndmask_b32 v90, v90, v11, s[62:63]
    v_mfma_f32_32x32x16_bf16 a[16:31], v[164:167], v[100:103], a[16:31]
    ds_read_b128 v[136:139], v3 offset:18432
    v_cmp_gt_i32 s[62:63], 26, v9
    v_cndmask_b32 v91, v91, v11, s[64:65]
    v_cmp_gt_i32 s[64:65], 27, v9
    s_waitcnt lgkmcnt(7)
    v_mfma_f32_32x32x16_bf16 a[32:47], v[168:171], v[100:103], a[32:47]
    ds_read_b128 v[140:143], v3 offset:19456
    v_cndmask_b32 v92, v92, v11, s[58:59]
    v_cndmask_b32 v93, v93, v11, s[60:61]
    v_cndmask_b32 v94, v94, v11, s[62:63]
    v_cndmask_b32 v95, v95, v11, s[64:65]
    v_mfma_f32_32x32x16_bf16 a[48:63], v[172:175], v[100:103], a[48:63]
    ds_read_b128 v[144:147], v3 offset:20480
    v_exp_f32 v112, v80
    s_waitcnt lgkmcnt(7)
    v_mfma_f32_32x32x16_bf16 a[64:79], v[176:179], v[100:103], a[64:79]
    ds_read_b128 v[148:151], v3 offset:21504
    v_exp_f32 v113, v81
    v_exp_f32 v114, v82
    v_mfma_f32_32x32x16_bf16 a[80:95], v[180:183], v[100:103], a[80:95]
    ds_read_b128 v[152:155], v3 offset:22528
    v_exp_f32 v115, v83
    v_add_f32 v7, v112, v113
    s_waitcnt lgkmcnt(7)
    v_mfma_f32_32x32x16_bf16 a[96:111], v[184:187], v[100:103], a[96:111]
    ds_read_b128 v[156:159], v3 offset:23552
    v_cvt_pk_bf16_f32 v104, v112, v113
    v_exp_f32 v116, v84
    v_add_f32 v8, v114, v115
    v_cvt_pk_bf16_f32 v105, v114, v115
    v_exp_f32 v117, v85
    v_exp_f32 v118, v86
    v_add_f32 v7, v7, v116
    v_exp_f32 v119, v87
    v_add_f32 v7, v7, v117
    v_cvt_pk_bf16_f32 v106, v116, v117
    v_exp_f32 v120, v88
    v_add_f32 v8, v8, v118
    v_exp_f32 v121, v89
    v_add_f32 v8, v8, v119
    v_cvt_pk_bf16_f32 v107, v118, v119
    v_exp_f32 v122, v90
    v_add_f32 v7, v7, v120
    v_exp_f32 v123, v91
    v_add_f32 v7, v7, v121
    v_cvt_pk_bf16_f32 v108, v120, v121
    v_exp_f32 v124, v92
    v_add_f32 v8, v8, v122
    v_exp_f32 v125, v93
    v_add_f32 v8, v8, v123
    v_cvt_pk_bf16_f32 v109, v122, v123
    v_exp_f32 v126, v94
    v_add_f32 v7, v7, v124
    v_exp_f32 v127, v95
    v_add_f32 v7, v7, v125
    v_cvt_pk_bf16_f32 v110, v124, v125
    v_add_f32 v8, v8, v126
    v_add_f32 v8, v8, v127
    v_cvt_pk_bf16_f32 v111, v126, v127
    v_add_f32 v7, v7, v8
    v_mfma_f32_32x32x16_bf16 a[112:127], v[188:191], v[100:103], a[112:127]
    ds_read_b128 v[160:163], v3 offset:24576
    v_cmp_nle_f32 s[54:55], v7, s52
    s_cmp_lg_u64 s[54:55], 0
    s_cbranch_scc1 body_p1_m1_slow1
body_p1_m1_ret1:
    v_add_f32 v6, v6, v7
    s_waitcnt lgkmcnt(7)
    v_mfma_f32_32x32x16_bf16 a[0:15], v[128:131], v[104:107], a[0:15]
    ds_read_b128 v[164:167], v3 offset:25600
    s_add_u32 m0, s37, s32
    s_nop 0
    buffer_load_dwordx4 v4, s[12:15], s34 offen lds
    v_mfma_f32_32x32x16_bf16 a[16:31], v[132:135], v[104:107], a[16:31]
    ds_read_b128 v[168:171], v3 offset:26624
    buffer_load_dwordx4 v4, s[12:15], s34 offen offset:1024 lds
    s_waitcnt lgkmcnt(7)
    v_mfma_f32_32x32x16_bf16 a[32:47], v[136:139], v[104:107], a[32:47]
    ds_read_b128 v[172:175], v3 offset:27648
    v_mfma_f32_32x32x16_bf16 a[48:63], v[140:143], v[104:107], a[48:63]
    ds_read_b128 v[176:179], v3 offset:28672
    buffer_load_dwordx4 v4, s[12:15], s34 offen offset:2048 lds
    s_waitcnt lgkmcnt(7)
    v_mfma_f32_32x32x16_bf16 a[64:79], v[144:147], v[104:107], a[64:79]
    ds_read_b128 v[180:183], v3 offset:29696
    v_mfma_f32_32x32x16_bf16 a[80:95], v[148:151], v[104:107], a[80:95]
    ds_read_b128 v[184:187], v3 offset:30720
    buffer_load_dwordx4 v4, s[12:15], s34 offen offset:3072 lds
    s_waitcnt lgkmcnt(7)
    v_mfma_f32_32x32x16_bf16 a[96:111], v[152:155], v[104:107], a[96:111]
    ds_read_b128 v[188:191], v3 offset:31744
    v_mfma_f32_32x32x16_bf16 a[112:127], v[156:159], v[104:107], a[112:127]
    s_add_u32 m0, m0, 0x1000
    s_add_u32 s80, s34, 0x1000
    buffer_load_dwordx4 v4, s[12:15], s80 offen lds
    s_waitcnt lgkmcnt(6)
    v_mfma_f32_32x32x16_bf16 a[0:15], v[160:163], v[108:111], a[0:15]
    v_mfma_f32_32x32x16_bf16 a[16:31], v[164:167], v[108:111], a[16:31]
    s_waitcnt vmcnt(21)
    s_waitcnt lgkmcnt(0)
    s_barrier
    ds_read_b128 v[128:131], v2 offset:0
    ds_read_b128 v[132:135], v2 offset:16384
    v_mfma_f32_32x32x16_bf16 a[32:47], v[168:171], v[108:111], a[32:47]
    ds_read_b128 v[136:139], v2 offset:1024
    ds_read_b128 v[140:143], v2 offset:17408
    buffer_load_dwordx4 v4, s[12:15], s80 offen offset:1024 lds
    v_mfma_f32_32x32x16_bf16 a[48:63], v[172:175], v[108:111], a[48:63]
    ds_read_b128 v[144:147], v2 offset:2048
    buffer_load_dwordx4 v4, s[12:15], s80 offen offset:2048 lds
    v_mfma_f32_32x32x16_bf16 a[64:79], v[176:179], v[108:111], a[64:79]
    ds_read_b128 v[148:151], v2 offset:18432
    v_mfma_f32_32x32x16_bf16 a[80:95], v[180:183], v[108:111], a[80:95]
    ds_read_b128 v[152:155], v2 offset:3072
    buffer_load_dwordx4 v4, s[12:15], s80 offen offset:3072 lds
    s_add_u32 s40, s40, 1
    s_sub_u32 s41, s41, 1
    v_mfma_f32_32x32x16_bf16 a[96:111], v[184:187], v[108:111], a[96:111]
    ds_read_b128 v[156:159], v2 offset:19456
    v_mfma_f32_32x32x16_bf16 a[112:127], v[188:191], v[108:111], a[112:127]
    ds_read_b128 v[160:163], v2 offset:4096
    s_add_u32 s34, s34, 0x8000
    s_cmp_eq_u32 s34, s35
    s_cselect_b32 s34, s36, s34
    s_cmp_eq_u32 s34, s82
    s_cselect_b32 s34, 0x40000000, s34
    s_cmp_ge_u32 s40, s81
    s_branch k2_spec_p0
body_p1_m1_slow0:
    s_call_b64 s[56:57], slow_p1_s0
    s_branch body_p1_m1_ret0
body_p1_m1_slow1:
    s_call_b64 s[56:57], slow_p1_s1
    s_branch body_p1_m1_ret1
body_p0_last:
    s_mov_b32 s37, s38
    s_mov_b32 s38, s39
    s_add_u32 s39, s39, 0x8000
    s_cmp_eq_u32 s39, 0x28000
    s_cselect_b32 s39, 0, s39
    v_add_u32 v3, s39, v1
    s_lshl_b32 s66, s40, 6
    s_sub_u32 s66, s43, s66
    v_add_u32 v9, s66, v10
    v_cmp_gt_i32 s[58:59], 0, v9
    v_cmp_gt_i32 s[60:61], 1, v9
    v_cmp_gt_i32 s[62:63], 2, v9
    v_cmp_gt_i32 s[64:65], 3, v9
    v_cndmask_b32 v32, v32, v11, s[58:59]
    v_cmp_gt_i32 s[58:59], 8, v9
    v_cndmask_b32 v33, v33, v11, s[60:61]
    v_cmp_gt_i32 s[60:61], 9, v9
    v_cndmask_b32 v34, v34, v11, s[62:63]
    v_cmp_gt_i32 s[62:63], 10, v9
    v_cndmask_b32 v35, v35, v11, s[64:65]
    v_cmp_gt_i32 s[64:65], 11, v9
    v_cndmask_b32 v36, v36, v11, s[58:59]
    v_cmp_gt_i32 s[58:59], 16, v9
    v_cndmask_b32 v37, v37, v11, s[60:61]
    v_cmp_gt_i32 s[60:61], 17, v9
    v_cndmask_b32 v38, v38, v11, s[62:63]
    v_cmp_gt_i32 s[62:63], 18, v9
    v_cndmask_b32 v39, v39, v11, s[64:65]
    v_cmp_gt_i32 s[64:65], 19, v9
    v_cndmask_b32 v40, v40, v11, s[58:59]
    v_cmp_gt_i32 s[58:59], 24, v9
    v_cndmask_b32 v41, v41, v11, s[60:61]
    v_cmp_gt_i32 s[60:61], 25, v9
    v_cndmask_b32 v42, v42, v11, s[62:63]
    v_cmp_gt_i32 s[62:63], 26, v9
    v_cndmask_b32 v43, v43, v11, s[64:65]
    v_cmp_gt_i32 s[64:65], 27, v9
    v_cndmask_b32 v44, v44, v11, s[58:59]
    v_cndmask_b32 v45, v45, v11, s[60:61]
    v_cndmask_b32 v46, v46, v11, s[62:63]
    v_cndmask_b32 v47, v47, v11, s[64:65]
    v_exp_f32 v112, v32
    v_exp_f32 v113, v33
    v_exp_f32 v114, v34
    v_exp_f32 v115, v35
    v_add_f32 v7, v112, v113
    s_waitcnt vmcnt(16) lgkmcnt(0)
    s_barrier
    ds_read_b128 v[128:131], v3 offset:0
    ds_read_b128 v[132:135], v3 offset:1024
    ds_read_b128 v[136:139], v3 offset:2048
    ds_read_b128 v[140:143], v3 offset:3072
    ds_read_b128 v[144:147], v3 offset:4096
    ds_read_b128 v[148:151], v3 offset:5120
    ds_read_b128 v[152:155], v3 offset:6144
    ds_read_b128 v[156:159], v3 offset:7168
    ds_read_b128 v[160:163], v3 offset:8192
    ds_read_b128 v[164:167], v3 offset:9216
    v_cvt_pk_bf16_f32 v96, v112, v113
    v_exp_f32 v116, v36
    v_add_f32 v8, v114, v115
    v_cvt_pk_bf16_f32 v97, v114, v115
    v_exp_f32 v117, v37
    v_exp_f32 v118, v38
    v_add_f32 v7, v7, v116
    v_exp_f32 v119, v39
    v_add_f32 v7, v7, v117
    v_cvt_pk_bf16_f32 v98, v116, v117
    v_exp_f32 v120, v40
    v_add_f32 v8, v8, v118
    v_exp_f32 v121, v41
    v_add_f32 v8, v8, v119
    v_cvt_pk_bf16_f32 v99, v118, v119
    v_exp_f32 v122, v42
    v_add_f32 v7, v7, v120
    v_exp_f32 v123, v43
    v_add_f32 v7, v7, v121
    v_cvt_pk_bf16_f32 v100, v120, v121
    v_exp_f32 v124, v44
    v_add_f32 v8, v8, v122
    v_exp_f32 v125, v45
    v_add_f32 v8, v8, v123
    v_cvt_pk_bf16_f32 v101, v122, v123
    v_exp_f32 v126, v46
    v_add_f32 v7, v7, v124
    v_exp_f32 v127, v47
    v_add_f32 v7, v7, v125
    v_cvt_pk_bf16_f32 v102, v124, v125
    v_add_f32 v8, v8, v126
    v_add_f32 v8, v8, v127
    v_cvt_pk_bf16_f32 v103, v126, v127
    v_add_f32 v7, v7, v8
    v_cmp_nle_f32 s[54:55], v7, s52
    s_or_b64 s[54:55], s[54:55], s[48:49]
    s_cbranch_scc1 body_p0_last_slow0
body_p0_last_ret0:
    v_add_f32 v6, v6, v7
    s_nop 0
    s_waitcnt lgkmcnt(8)
    v_mfma_f32_32x32x16_bf16 a[0:15], v[128:131], v[96:99], a[0:15]
    s_lshl_b32 s66, s40, 6
    s_sub_u32 s66, s43, s66
    s_sub_u32 s66, s66, 32
    v_add_u32 v9, s66, v10
    v_cmp_gt_i32 s[58:59], 0, v9
    v_mfma_f32_32x32x16_bf16 a[16:31], v[132:135], v[96:99], a[16:31]
    ds_read_b128 v[168:171], v3 offset:10240
    v_cmp_gt_i32 s[60:61], 1, v9
    v_cmp_gt_i32 s[62:63], 2, v9
    v_cmp_gt_i32 s[64:65], 3, v9
    v_cndmask_b32 v48, v48, v11, s[58:59]
    s_waitcnt lgkmcnt(7)
    v_mfma_f32_32x32x16_bf16 a[32:47], v[136:139], v[96:99], a[32:47]
    ds_read_b128 v[172:175], v3 offset:11264
    v_cmp_gt_i32 s[58:59], 8, v9
    v_cndmask_b32 v49, v49, v11, s[60:61]
    v_cmp_gt_i32 s[60:61], 9, v9
    v_cndmask_b32 v50, v50, v11, s[62:63]
    v_mfma_f32_32x32x16_bf16 a[48:63], v[140:143], v[96:99], a[48:63]
    ds_read_b128 v[176:179], v3 offset:12288
    v_cmp_gt_i32 s[62:63], 10, v9
    v_cndmask_b32 v51, v51, v11, s[64:65]
    v_cmp_gt_i32 s[64:65], 11, v9
    v_cndmask_b32 v52, v52, v11, s[58:59]
    s_waitcnt lgkmcnt(7)
    v_mfma_f32_32x32x16_bf16 a[64:79], v[144:147], v[96:99], a[64:79]
    ds_read_b128 v[180:183], v3 offset:13312
    v_cmp_gt_i32 s[58:59], 16, v9
    v_cndmask_b32 v53, v53, v11, s[60:61]
    v_cmp_gt_i32 s[60:61], 17, v9
    v_cndmask_b32 v54, v54, v11, s[62:63]
    v_mfma_f32_32x32x16_bf16 a[80:95], v[148:151], v[96:99], a[80:95]
    ds_read_b128 v[184:187], v3 offset:14336
    v_cmp_gt_i32 s[62:63], 18, v9
    v_cndmask_b32 v55, v55, v11, s[64:65]
    v_cmp_gt_i32 s[64:65], 19, v9
    v_cndmask_b32 v56, v56, v11, s[58:59]
    s_waitcnt lgkmcnt(7)
    v_mfma_f32_32x32x16_bf16 a[96:111], v[152:155], v[96:99], a[96:111]
    ds_read_b128 v[188:191], v3 offset:15360
    v_cmp_gt_i32 s[58:59], 24, v9
    v_cndmask_b32 v57, v57, v11, s[60:61]
    v_cmp_gt_i32 s[60:61], 25, v9
    v_cndmask_b32 v58, v58, v11, s[62:63]
    v_mfma_f32_32x32x16_bf16 a[112:127], v[156:159], v[96:99], a[112:127]
    ds_read_b128 v[128:131], v3 offset:16384
    v_cmp_gt_i32 s[62:63], 26, v9
    v_cndmask_b32 v59, v59, v11, s[64:65]
    v_cmp_gt_i32 s[64:65], 27, v9
    v_cndmask_b32 v60, v60, v11, s[58:59]
    s_waitcnt lgkmcnt(7)
    v_mfma_f32_32x32x16_bf16 a[0:15], v[160:163], v[100:103], a[0:15]
    ds_read_b128 v[132:135], v3 offset:17408
    v_cndmask_b32 v61, v61, v11, s[60:61]
    v_cndmask_b32 v62, v62, v11, s[62:63]
    v_cndmask_b32 v63, v63, v11, s[64:65]
    v_mfma_f32_32x32x16_bf16 a[16:31], v[164:167], v[100:103], a[16:31]
    ds_read_b128 v[136:139], v3 offset:18432
    v_exp_f32 v112, v48
    v_exp_f32 v113, v49
    s_waitcnt lgkmcnt(7)
    v_mfma_f32_32x32x16_bf16 a[32:47], v[168:171], v[100:103], a[32:47]
    ds_read_b128 v[140:143], v3 offset:19456
    v_exp_f32 v114, v50
    v_exp_f32 v115, v51
    v_mfma_f32_32x32x16_bf16 a[48:63], v[172:175], v[100:103], a[48:63]
    ds_read_b128 v[144:147], v3 offset:20480
    v_add_f32 v7, v112, v113
    v_cvt_pk_bf16_f32 v104, v112, v113
    v_exp_f32 v116, v52
    s_waitcnt lgkmcnt(7)
    v_mfma_f32_32x32x16_bf16 a[64:79], v[176:179], v[100:103], a[64:79]
    ds_read_b128 v[148:151], v3 offset:21504
    v_add_f32 v8, v114, v115
    v_cvt_pk_bf16_f32 v105, v114, v115
    v_exp_f32 v117, v53
    v_mfma_f32_32x32x16_bf16 a[80:95], v[180:183], v[100:103], a[80:95]
    ds_read_b128 v[152:155], v3 offset:22528
    v_exp_f32 v118, v54
    v_add_f32 v7, v7, v116
    s_waitcnt lgkmcnt(7)
    v_mfma_f32_32x32x16_bf16 a[96:111], v[184:187], v[100:103], a[96:111]
    ds_read_b128 v[156:159], v3 offset:23552
    v_exp_f32 v119, v55
    v_add_f32 v7, v7, v117
    v_cvt_pk_bf16_f32 v106, v116, v117
    v_exp_f32 v120, v56
    v_add_f32 v8, v8, v118
    v_exp_f32 v121, v57
    v_add_f32 v8, v8, v119
    v_cvt_pk_bf16_f32 v107, v118, v119
    v_exp_f32 v122, v58
    v_add_f32 v7, v7, v120
    v_exp_f32 v123, v59
    v_add_f32 v7, v7, v121
    v_cvt_pk_bf16_f32 v108, v120, v121
    v_exp_f32 v124, v60
    v_add_f32 v8, v8, v122
    v_exp_f32 v125, v61
    v_add_f32 v8, v8, v123
    v_cvt_pk_bf16_f32 v109, v122, v123
    v_exp_f32 v126, v62
    v_add_f32 v7, v7, v124
    v_exp_f32 v127, v63
    v_add_f32 v7, v7, v125
    v_cvt_pk_bf16_f32 v110, v124, v125
    v_add_f32 v8, v8, v126
    v_add_f32 v8, v8, v127
    v_cvt_pk_bf16_f32 v111, v126, v127
    v_add_f32 v7, v7, v8
    v_mfma_f32_32x32x16_bf16 a[112:127], v[188:191], v[100:103], a[112:127]
    ds_read_b128 v[160:163], v3 offset:24576
    v_cmp_nle_f32 s[54:55], v7, s52
    s_cmp_lg_u64 s[54:55], 0
    s_cbranch_scc1 body_p0_last_slow1
body_p0_last_ret1:
    v_add_f32 v6, v6, v7
    s_waitcnt lgkmcnt(7)
    v_mfma_f32_32x32x16_bf16 a[0:15], v[128:131], v[104:107], a[0:15]
    ds_read_b128 v[164:167], v3 offset:25600
    v_mfma_f32_32x32x16_bf16 a[16:31], v[132:135], v[104:107], a[16:31]
    ds_read_b128 v[168:171], v3 offset:26624
    s_waitcnt lgkmcnt(7)
    v_mfma_f32_32x32x16_bf16 a[32:47], v[136:139], v[104:107], a[32:47]
    ds_read_b128 v[172:175], v3 offset:27648
    v_mfma_f32_32x32x16_bf16 a[48:63], v[140:143], v[104:107], a[48:63]
    ds_read_b128 v[176:179], v3 offset:28672
    s_waitcnt lgkmcnt(7)
    v_mfma_f32_32x32x16_bf16 a[64:79], v[144:147], v[104:107], a[64:79]
    ds_read_b128 v[180:183], v3 offset:29696
    v_mfma_f32_32x32x16_bf16 a[80:95], v[148:151], v[104:107], a[80:95]
    ds_read_b128 v[184:187], v3 offset:30720
    s_waitcnt lgkmcnt(7)
    v_mfma_f32_32x32x16_bf16 a[96:111], v[152:155], v[104:107], a[96:111]
    ds_read_b128 v[188:191], v3 offset:31744
    v_mfma_f32_32x32x16_bf16 a[112:127], v[156:159], v[104:107], a[112:127]
    s_waitcnt lgkmcnt(6)
    v_mfma_f32_32x32x16_bf16 a[0:15], v[160:163], v[108:111], a[0:15]
    v_mfma_f32_32x32x16_bf16 a[16:31], v[164:167], v[108:111], a[16:31]
    s_waitcnt lgkmcnt(4)
    v_mfma_f32_32x32x16_bf16 a[32:47], v[168:171], v[108:111], a[32:47]
    v_mfma_f32_32x32x16_bf16 a[48:63], v[172:175], v[108:111], a[48:63]
    s_waitcnt lgkmcnt(2)
    v_mfma_f32_32x32x16_bf16 a[64:79], v[176:179], v[108:111], a[64:79]
    v_mfma_f32_32x32x16_bf16 a[80:95], v[180:183], v[108:111], a[80:95]
    s_waitcnt lgkmcnt(0)
    v_mfma_f32_32x32x16_bf16 a[96:111], v[184:187], v[108:111], a[96:111]
    v_mfma_f32_32x32x16_bf16 a[112:127], v[188:191], v[108:111], a[112:127]
    s_mov_b32 s41, 0
    s_branch k2_next
body_p0_last_slow0:
    s_call_b64 s[56:57], slow_p0_s0
    s_branch body_p0_last_ret0
body_p0_last_slow1:
    s_call_b64 s[56:57], slow_p0_s1
    s_branch body_p0_last_ret1
body_p1_last:
    s_mov_b32 s37, s38
    s_mov_b32 s38, s39
    s_add_u32 s39, s39, 0x8000
    s_cmp_eq_u32 s39, 0x28000
    s_cselect_b32 s39, 0, s39
    v_add_u32 v3, s39, v1
    s_lshl_b32 s66, s40, 6
    s_sub_u32 s66, s43, s66
    v_add_u32 v9, s66, v10
    v_cmp_gt_i32 s[58:59], 0, v9
    v_cmp_gt_i32 s[60:61], 1, v9
    v_cmp_gt_i32 s[62:63], 2, v9
    v_cmp_gt_i32 s[64:65], 3, v9
    v_cndmask_b32 v64, v64, v11, s[58:59]
    v_cmp_gt_i32 s[58:59], 8, v9
    v_cndmask_b32 v65, v65, v11, s[60:61]
    v_cmp_gt_i32 s[60:61], 9, v9
    v_cndmask_b32 v66, v66, v11, s[62:63]
    v_cmp_gt_i32 s[62:63], 10, v9
    v_cndmask_b32 v67, v67, v11, s[64:65]
    v_cmp_gt_i32 s[64:65], 11, v9
    v_cndmask_b32 v68, v68, v11, s[58:59]
    v_cmp_gt_i32 s[58:59], 16, v9
    v_cndmask_b32 v69, v69, v11, s[60:61]
    v_cmp_gt_i32 s[60:61], 17, v9
    v_cndmask_b32 v70, v70, v11, s[62:63]
    v_cmp_gt_i32 s[62:63], 18, v9
    v_cndmask_b32 v71, v71, v11, s[64:65]
    v_cmp_gt_i32 s[64:65], 19, v9
    v_cndmask_b32 v72, v72, v11, s[58:59]
    v_cmp_gt_i32 s[58:59], 24, v9
    v_cndmask_b32 v73, v73, v11, s[60:61]
    v_cmp_gt_i32 s[60:61], 25, v9
    v_cndmask_b32 v74, v74, v11, s[62:63]
    v_cmp_gt_i32 s[62:63], 26, v9
    v_cndmask_b32 v75, v75, v11, s[64:65]
    v_cmp_gt_i32 s[64:65], 27, v9
    v_cndmask_b32 v76, v76, v11, s[58:59]
    v_cndmask_b32 v77, v77, v11, s[60:61]
    v_cndmask_b32 v78, v78, v11, s[62:63]
    v_cndmask_b32 v79, v79, v11, s[64:65]
    v_exp_f32 v112, v64
    v_exp_f32 v113, v65
    v_exp_f32 v114, v66
    v_exp_f32 v115, v67
    v_add_f32 v7, v112, v113
    s_waitcnt vmcnt(16) lgkmcnt(0)
    s_barrier
    ds_read_b128 v[128:131], v3 offset:0
    ds_read_b128 v[132:135], v3 offset:1024
    ds_read_b128 v[136:139], v3 offset:2048
    ds_read_b128 v[140:143], v3 offset:3072
    ds_read_b128 v[144:147], v3 offset:4096
    ds_read_b128 v[148:151], v3 offset:5120
    ds_read_b128 v[152:155], v3 offset:6144
    ds_read_b128 v[156:159], v3 offset:7168
    ds_read_b128 v[160:163], v3 offset:8192
    ds_read_b128 v[164:167], v3 offset:9216
    v_cvt_pk_bf16_f32 v96, v112, v113
    v_exp_f32 v116, v68
    v_add_f32 v8, v114, v115
    v_cvt_pk_bf16_f32 v97, v114, v115
    v_exp_f32 v117, v69
    v_exp_f32 v118, v70
    v_add_f32 v7, v7, v116
    v_exp_f32 v119, v71
    v_add_f32 v7, v7, v117
    v_cvt_pk_bf16_f32 v98, v116, v117
    v_exp_f32 v120, v72
    v_add_f32 v8, v8, v118
    v_exp_f32 v121, v73
    v_add_f32 v8, v8, v119
    v_cvt_pk_bf16_f32 v99, v118, v119
    v_exp_f32 v122, v74
    v_add_f32 v7, v7, v120
    v_exp_f32 v123, v75
    v_add_f32 v7, v7, v121
    v_cvt_pk_bf16_f32 v100, v120, v121
    v_exp_f32 v124, v76
    v_add_f32 v8, v8, v122
    v_exp_f32 v125, v77
    v_add_f32 v8, v8, v123
    v_cvt_pk_bf16_f32 v101, v122, v123
    v_exp_f32 v126, v78
    v_add_f32 v7, v7, v124
    v_exp_f32 v127, v79
    v_add_f32 v7, v7, v125
    v_cvt_pk_bf16_f32 v102, v124, v125
    v_add_f32 v8, v8, v126
    v_add_f32 v8, v8, v127
    v_cvt_pk_bf16_f32 v103, v126, v127
    v_add_f32 v7, v7, v8
    v_cmp_nle_f32 s[54:55], v7, s52
    s_or_b64 s[54:55], s[54:55], s[48:49]
    s_cbranch_scc1 body_p1_last_slow0
body_p1_last_ret0:
    v_add_f32 v6, v6, v7
    s_nop 0
    s_waitcnt lgkmcnt(8)
    v_mfma_f32_32x32x16_bf16 a[0:15], v[128:131], v[96:99], a[0:15]
    s_lshl_b32 s66, s40, 6
    s_sub_u32 s66, s43, s66
    s_sub_u32 s66, s66, 32
    v_add_u32 v9, s66, v10
    v_cmp_gt_i32 s[58:59], 0, v9
    v_mfma_f32_32x32x16_bf16 a[16:31], v[132:135], v[96:99], a[16:31]
    ds_read_b128 v[168:171], v3 offset:10240
    v_cmp_gt_i32 s[60:61], 1, v9
    v_cmp_gt_i32 s[62:63], 2, v9
    v_cmp_gt_i32 s[64:65], 3, v9
    v_cndmask_b32 v80, v80, v11, s[58:59]
    s_waitcnt lgkmcnt(7)
    v_mfma_f32_32x32x16_bf16 a[32:47], v[136:139], v[96:99], a[32:47]
    ds_read_b128 v[172:175], v3 offset:11264
    v_cmp_gt_i32 s[58:59], 8, v9
    v_cndmask_b32 v81, v81, v11, s[60:61]
    v_cmp_gt_i32 s[60:61], 9, v9
    v_cndmask_b32 v82, v82, v11, s[62:63]
    v_mfma_f32_32x32x16_bf16 a[48:63], v[140:143], v[96:99], a[48:63]
    ds_read_b128 v[176:179], v3 offset:12288
    v_cmp_gt_i32 s[62:63], 10, v9
    v_cndmask_b32 v83, v83, v11, s[64:65]
    v_cmp_gt_i32 s[64:65], 11, v9
    v_cndmask_b32 v84, v84, v11, s[58:59]
    s_waitcnt lgkmcnt(7)
    v_mfma_f32_32x32x16_bf16 a[64:79], v[144:147], v[96:99], a[64:79]
    ds_read_b128 v[180:183], v3 offset:13312
    v_cmp_gt_i32 s[58:59], 16, v9
    v_cndmask_b32 v85, v85, v11, s[60:61]
    v_cmp_gt_i32 s[60:61], 17, v9
    v_cndmask_b32 v86, v86, v11, s[62:63]
    v_mfma_f32_32x32x16_bf16 a[80:95], v[148:151], v[96:99], a[80:95]
    ds_read_b128 v[184:187], v3 offset:14336
    v_cmp_gt_i32 s[62:63], 18, v9
    v_cndmask_b32 v87, v87, v11, s[64:65]
    v_cmp_gt_i32 s[64:65], 19, v9
    v_cndmask_b32 v88, v88, v11, s[58:59]
    s_waitcnt lgkmcnt(7)
    v_mfma_f32_32x32x16_bf16 a[96:111], v[152:155], v[96:99], a[96:111]
    ds_read_b128 v[188:191], v3 offset:15360
    v_cmp_gt_i32 s[58:59], 24, v9
    v_cndmask_b32 v89, v89, v11, s[60:61]
    v_cmp_gt_i32 s[60:61], 25, v9
    v_cndmask_b32 v90, v90, v11, s[62:63]
    v_mfma_f32_32x32x16_bf16 a[112:127], v[156:159], v[96:99], a[112:127]
    ds_read_b128 v[128:131], v3 offset:16384
    v_cmp_gt_i32 s[62:63], 26, v9
    v_cndmask_b32 v91, v91, v11, s[64:65]
    v_cmp_gt_i32 s[64:65], 27, v9
    v_cndmask_b32 v92, v92, v11, s[58:59]
    s_waitcnt lgkmcnt(7)
    v_mfma_f32_32x32x16_bf16 a[0:15], v[160:163], v[100:103], a[0:15]
    ds_read_b128 v[132:135], v3 offset:17408
    v_cndmask_b32 v93, v93, v11, s[60:61]
    v_cndmask_b32 v94, v94, v11, s[62:63]
    v_cndmask_b32 v95, v95, v11, s[64:65]
    v_mfma_f32_32x32x16_bf16 a[16:31], v[164:167], v[100:103], a[16:31]
    ds_read_b128 v[136:139], v3 offset:18432
    v_exp_f32 v112, v80
    v_exp_f32 v113, v81
    s_waitcnt lgkmcnt(7)
    v_mfma_f32_32x32x16_bf16 a[32:47], v[168:171], v[100:103], a[32:47]
    ds_read_b128 v[140:143], v3 offset:19456
    v_exp_f32 v114, v82
    v_exp_f32 v115, v83
    v_mfma_f32_32x32x16_bf16 a[48:63], v[172:175], v[100:103], a[48:63]
    ds_read_b128 v[144:147], v3 offset:20480
    v_add_f32 v7, v112, v113
    v_cvt_pk_bf16_f32 v104, v112, v113
    v_exp_f32 v116, v84
    s_waitcnt lgkmcnt(7)
    v_mfma_f32_32x32x16_bf16 a[64:79], v[176:179], v[100:103], a[64:79]
    ds_read_b128 v[148:151], v3 offset:21504
    v_add_f32 v8, v114, v115
    v_cvt_pk_bf16_f32 v105, v114, v115
    v_exp_f32 v117, v85
    v_mfma_f32_32x32x16_bf16 a[80:95], v[180:183], v[100:103], a[80:95]
    ds_read_b128 v[152:155], v3 offset:22528
    v_exp_f32 v118, v86
    v_add_f32 v7, v7, v116
    s_waitcnt lgkmcnt(7)
    v_mfma_f32_32x32x16_bf16 a[96:111], v[184:187], v[100:103], a[96:111]
    ds_read_b128 v[156:159], v3 offset:23552
    v_exp_f32 v119, v87
    v_add_f32 v7, v7, v117
    v_cvt_pk_bf16_f32 v106, v116, v117
    v_exp_f32 v120, v88
    v_add_f32 v8, v8, v118
    v_exp_f32 v121, v89
    v_add_f32 v8, v8, v119
    v_cvt_pk_bf16_f32 v107, v118, v119
    v_exp_f32 v122, v90
    v_add_f32 v7, v7, v120
    v_exp_f32 v123, v91
    v_add_f32 v7, v7, v121
    v_cvt_pk_bf16_f32 v108, v120, v121
    v_exp_f32 v124, v92
    v_add_f32 v8, v8, v122
    v_exp_f32 v125, v93
    v_add_f32 v8, v8, v123
    v_cvt_pk_bf16_f32 v109, v122, v123
    v_exp_f32 v126, v94
    v_add_f32 v7, v7, v124
    v_exp_f32 v127, v95
    v_add_f32 v7, v7, v125
    v_cvt_pk_bf16_f32 v110, v124, v125
    v_add_f32 v8, v8, v126
    v_add_f32 v8, v8, v127
    v_cvt_pk_bf16_f32 v111, v126, v127
    v_add_f32 v7, v7, v8
    v_mfma_f32_32x32x16_bf16 a[112:127], v[188:191], v[100:103], a[112:127]
    ds_read_b128 v[160:163], v3 offset:24576
    v_cmp_nle_f32 s[54:55], v7, s52
    s_cmp_lg_u64 s[54:55], 0
    s_cbranch_scc1 body_p1_last_slow1
body_p1_last_ret1:
    v_add_f32 v6, v6, v7
    s_waitcnt lgkmcnt(7)
    v_mfma_f32_32x32x16_bf16 a[0:15], v[128:131], v[104:107], a[0:15]
    ds_read_b128 v[164:167], v3 offset:25600
    v_mfma_f32_32x32x16_bf16 a[16:31], v[132:135], v[104:107], a[16:31]
    ds_read_b128 v[168:171], v3 offset:26624
    s_waitcnt lgkmcnt(7)
    v_mfma_f32_32x32x16_bf16 a[32:47], v[136:139], v[104:107], a[32:47]
    ds_read_b128 v[172:175], v3 offset:27648
    v_mfma_f32_32x32x16_bf16 a[48:63], v[140:143], v[104:107], a[48:63]
    ds_read_b128 v[176:179], v3 offset:28672
    s_waitcnt lgkmcnt(7)
    v_mfma_f32_32x32x16_bf16 a[64:79], v[144:147], v[104:107], a[64:79]
    ds_read_b128 v[180:183], v3 offset:29696
    v_mfma_f32_32x32x16_bf16 a[80:95], v[148:151], v[104:107], a[80:95]
    ds_read_b128 v[184:187], v3 offset:30720
    s_waitcnt lgkmcnt(7)
    v_mfma_f32_32x32x16_bf16 a[96:111], v[152:155], v[104:107], a[96:111]
    ds_read_b128 v[188:191], v3 offset:31744
    v_mfma_f32_32x32x16_bf16 a[112:127], v[156:159], v[104:107], a[112:127]
    s_waitcnt lgkmcnt(6)
    v_mfma_f32_32x32x16_bf16 a[0:15], v[160:163], v[108:111], a[0:15]
    v_mfma_f32_32x32x16_bf16 a[16:31], v[164:167], v[108:111], a[16:31]
    s_waitcnt lgkmcnt(4)
    v_mfma_f32_32x32x16_bf16 a[32:47], v[168:171], v[108:111], a[32:47]
    v_mfma_f32_32x32x16_bf16 a[48:63], v[172:175], v[108:111], a[48:63]
    s_waitcnt lgkmcnt(2)
    v_mfma_f32_32x32x16_bf16 a[64:79], v[176:179], v[108:111], a[64:79]
    v_mfma_f32_32x32x16_bf16 a[80:95], v[180:183], v[108:111], a[80:95]
    s_waitcnt lgkmcnt(0)
    v_mfma_f32_32x32x16_bf16 a[96:111], v[184:187], v[108:111], a[96:111]
    v_mfma_f32_32x32x16_bf16 a[112:127], v[188:191], v[108:111], a[112:127]
    s_mov_b32 s41, 0
    s_branch k2_next
body_p1_last_slow0:
    s_call_b64 s[56:57], slow_p1_s0
    s_branch body_p1_last_ret0
body_p1_last_slow1:
    s_call_b64 s[56:57], slow_p1_s1
    s_branch body_p1_last_ret1
slow_p0_s0:
    s_nop 15
    s_nop 3
    v_max3_f32 v12, v32, v33, v34
    v_max3_f32 v12, v12, v35, v36
    v_max3_f32 v12, v12, v37, v38
    v_max3_f32 v12, v12, v39, v40
    v_max3_f32 v12, v12, v41, v42
    v_max3_f32 v12, v12, v43, v44
    v_max3_f32 v12, v12, v45, v46
    v_max_f32 v12, v12, v47
    v_mov_b32 v13, v12
    s_nop 1
    v_permlane32_swap_b32 v12, v13
    s_nop 1
    v_max_f32 v12, v12, v13
    v_max_f32 v12, s50, v12
    s_mov_b32 s66, 0xff61b1e6
    v_cmp_ge_f32 vcc, s66, v12
    s_nop 1
    v_cndmask_b32 v12, v12, 0, vcc
    v_add_f32 v5, v5, v12
    v_mul_f32 v14, s51, v12
    v_sub_f32 v32, v32, v12
    v_sub_f32 v33, v33, v12
    v_sub_f32 v34, v34, v12
    v_sub_f32 v35, v35, v12
    v_sub_f32 v36, v36, v12
    v_sub_f32 v37, v37, v12
    v_sub_f32 v38, v38, v12
    v_sub_f32 v39, v39, v12
    v_sub_f32 v40, v40, v12
    v_sub_f32 v41, v41, v12
    v_sub_f32 v42, v42, v12
    v_sub_f32 v43, v43, v12
    v_sub_f32 v44, v44, v12
    v_sub_f32 v45, v45, v12
    v_sub_f32 v46, v46, v12
    v_sub_f32 v47, v47, v12
    v_sub_f32 v48, v48, v12
    v_sub_f32 v49, v49, v12
    v_sub_f32 v50, v50, v12
    v_sub_f32 v51, v51, v12
    v_sub_f32 v52, v52, v12
    v_sub_f32 v53, v53, v12
    v_sub_f32 v54, v54, v12
    v_sub_f32 v55, v55, v12
    v_sub_f32 v56, v56, v12
    v_sub_f32 v57, v57, v12
    v_sub_f32 v58, v58, v12
    v_sub_f32 v59, v59, v12
    v_sub_f32 v60, v60, v12
    v_sub_f32 v61, v61, v12
    v_sub_f32 v62, v62, v12
    v_sub_f32 v63, v63, v12
    v_sub_f32 v64, v64, v14
    v_sub_f32 v65, v65, v14
    v_sub_f32 v66, v66, v14
    v_sub_f32 v67, v67, v14
    v_sub_f32 v68, v68, v14
    v_sub_f32 v69, v69, v14
    v_sub_f32 v70, v70, v14
    v_sub_f32 v71, v71, v14
    v_sub_f32 v72, v72, v14
    v_sub_f32 v73, v73, v14
    v_sub_f32 v74, v74, v14
    v_sub_f32 v75, v75, v14
    v_sub_f32 v76, v76, v14
    v_sub_f32 v77, v77, v14
    v_sub_f32 v78, v78, v14
    v_sub_f32 v79, v79, v14
    v_sub_f32 v80, v80, v14
    v_sub_f32 v81, v81, v14
    v_sub_f32 v82, v82, v14
    v_sub_f32 v83, v83, v14
    v_sub_f32 v84, v84, v14
    v_sub_f32 v85, v85, v14
    v_sub_f32 v86, v86, v14
    v_sub_f32 v87, v87, v14
    v_sub_f32 v88, v88, v14
    v_sub_f32 v89, v89, v14
    v_sub_f32 v90, v90, v14
    v_sub_f32 v91, v91, v14
    v_sub_f32 v92, v92, v14
    v_sub_f32 v93, v93, v14
    v_sub_f32 v94, v94, v14
    v_sub_f32 v95, v95, v14
    v_sub_f32 v16, v16, v14
    v_sub_f32 v17, v17, v14
    v_sub_f32 v18, v18, v14
    v_sub_f32 v19, v19, v14
    v_sub_f32 v20, v20, v14
    v_sub_f32 v21, v21, v14
    v_sub_f32 v22, v22, v14
    v_sub_f32 v23, v23, v14
    v_sub_f32 v24, v24, v14
    v_sub_f32 v25, v25, v14
    v_sub_f32 v26, v26, v14
    v_sub_f32 v27, v27, v14
    v_sub_f32 v28, v28, v14
    v_sub_f32 v29, v29, v14
    v_sub_f32 v30, v30, v14
    v_sub_f32 v31, v31, v14
    s_cmp_lg_u64 s[48:49], 0
    s_cbranch_scc1 slow_p0_s0_norescale
    v_exp_f32 v13, -v12
    s_nop 0
    v_mul_f32 v6, v6, v13
    v_accvgpr_read_b32 v192, a0
    v_accvgpr_read_b32 v193, a1
    v_accvgpr_read_b32 v194, a2
    v_accvgpr_read_b32 v195, a3
    v_accvgpr_read_b32 v196, a4
    v_accvgpr_read_b32 v197, a5
    v_accvgpr_read_b32 v198, a6
    v_accvgpr_read_b32 v199, a7
    v_mul_f32 v192, v192, v13
    v_mul_f32 v193, v193, v13
    v_mul_f32 v194, v194, v13
    v_mul_f32 v195, v195, v13
    v_mul_f32 v196, v196, v13
    v_mul_f32 v197, v197, v13
    v_mul_f32 v198, v198, v13
    v_mul_f32 v199, v199, v13
    v_accvgpr_write_b32 a0, v192
    v_accvgpr_write_b32 a1, v193
    v_accvgpr_write_b32 a2, v194
    v_accvgpr_write_b32 a3, v195
    v_accvgpr_write_b32 a4, v196
    v_accvgpr_write_b32 a5, v197
    v_accvgpr_write_b32 a6, v198
    v_accvgpr_write_b32 a7, v199
    v_accvgpr_read_b32 v192, a8
    v_accvgpr_read_b32 v193, a9
    v_accvgpr_read_b32 v194, a10
    v_accvgpr_read_b32 v195, a11
    v_accvgpr_read_b32 v196, a12
    v_accvgpr_read_b32 v197, a13
    v_accvgpr_read_b32 v198, a14
    v_accvgpr_read_b32 v199, a15
    v_mul_f32 v192, v192, v13
    v_mul_f32 v193, v193, v13
    v_mul_f32 v194, v194, v13
    v_mul_f32 v195, v195, v13
    v_mul_f32 v196, v196, v13
    v_mul_f32 v197, v197, v13
    v_mul_f32 v198, v198, v13
    v_mul_f32 v199, v199, v13
    v_accvgpr_write_b32 a8, v192
    v_accvgpr_write_b32 a9, v193
    v_accvgpr_write_b32 a10, v194
    v_accvgpr_write_b32 a11, v195
    v_accvgpr_write_b32 a12, v196
    v_accvgpr_write_b32 a13, v197
    v_accvgpr_write_b32 a14, v198
    v_accvgpr_write_b32 a15, v199
    v_accvgpr_read_b32 v192, a16
    v_accvgpr_read_b32 v193, a17
    v_accvgpr_read_b32 v194, a18
    v_accvgpr_read_b32 v195, a19
    v_accvgpr_read_b32 v196, a20
    v_accvgpr_read_b32 v197, a21
    v_accvgpr_read_b32 v198, a22
    v_accvgpr_read_b32 v199, a23
    v_mul_f32 v192, v192, v13
    v_mul_f32 v193, v193, v13
    v_mul_f32 v194, v194, v13
    v_mul_f32 v195, v195, v13
    v_mul_f32 v196, v196, v13
    v_mul_f32 v197, v197, v13
    v_mul_f32 v198, v198, v13
    v_mul_f32 v199, v199, v13
    v_accvgpr_write_b32 a16, v192
    v_accvgpr_write_b32 a17, v193
    v_accvgpr_write_b32 a18, v194
    v_accvgpr_write_b32 a19, v195
    v_accvgpr_write_b32 a20, v196
    v_accvgpr_write_b32 a21, v197
    v_accvgpr_write_b32 a22, v198
    v_accvgpr_write_b32 a23, v199
    v_accvgpr_read_b32 v192, a24
    v_accvgpr_read_b32 v193, a25
    v_accvgpr_read_b32 v194, a26
    v_accvgpr_read_b32 v195, a27
    v_accvgpr_read_b32 v196, a28
    v_accvgpr_read_b32 v197, a29
    v_accvgpr_read_b32 v198, a30
    v_accvgpr_read_b32 v199, a31
    v_mul_f32 v192, v192, v13
    v_mul_f32 v193, v193, v13
    v_mul_f32 v194, v194, v13
    v_mul_f32 v195, v195, v13
    v_mul_f32 v196, v196, v13
    v_mul_f32 v197, v197, v13
    v_mul_f32 v198, v198, v13
    v_mul_f32 v199, v199, v13
    v_accvgpr_write_b32 a24, v192
    v_accvgpr_write_b32 a25, v193
    v_accvgpr_write_b32 a26, v194
    v_accvgpr_write_b32 a27, v195
    v_accvgpr_write_b32 a28, v196
    v_accvgpr_write_b32 a29, v197
    v_accvgpr_write_b32 a30, v198
    v_accvgpr_write_b32 a31, v199
    v_accvgpr_read_b32 v192, a32
    v_accvgpr_read_b32 v193, a33
    v_accvgpr_read_b32 v194, a34
    v_accvgpr_read_b32 v195, a35
    v_accvgpr_read_b32 v196, a36
    v_accvgpr_read_b32 v197, a37
    v_accvgpr_read_b32 v198, a38
    v_accvgpr_read_b32 v199, a39
    v_mul_f32 v192, v192, v13
    v_mul_f32 v193, v193, v13
    v_mul_f32 v194, v194, v13
    v_mul_f32 v195, v195, v13
    v_mul_f32 v196, v196, v13
    v_mul_f32 v197, v197, v13
    v_mul_f32 v198, v198, v13
    v_mul_f32 v199, v199, v13
    v_accvgpr_write_b32 a32, v192
    v_accvgpr_write_b32 a33, v193
    v_accvgpr_write_b32 a34, v194
    v_accvgpr_write_b32 a35, v195
    v_accvgpr_write_b32 a36, v196
    v_accvgpr_write_b32 a37, v197
    v_accvgpr_write_b32 a38, v198
    v_accvgpr_write_b32 a39, v199
    v_accvgpr_read_b32 v192, a40
    v_accvgpr_read_b32 v193, a41
    v_accvgpr_read_b32 v194, a42
    v_accvgpr_read_b32 v195, a43
    v_accvgpr_read_b32 v196, a44
    v_accvgpr_read_b32 v197, a45
    v_accvgpr_read_b32 v198, a46
    v_accvgpr_read_b32 v199, a47
    v_mul_f32 v192, v192, v13
    v_mul_f32 v193, v193, v13
    v_mul_f32 v194, v194, v13
    v_mul_f32 v195, v195, v13
    v_mul_f32 v196, v196, v13
    v_mul_f32 v197, v197, v13
    v_mul_f32 v198, v198, v13
    v_mul_f32 v199, v199, v13
    v_accvgpr_write_b32 a40, v192
    v_accvgpr_write_b32 a41, v193
    v_accvgpr_write_b32 a42, v194
    v_accvgpr_write_b32 a43, v195
    v_accvgpr_write_b32 a44, v196
    v_accvgpr_write_b32 a45, v197
    v_accvgpr_write_b32 a46, v198
    v_accvgpr_write_b32 a47, v199
    v_accvgpr_read_b32 v192, a48
    v_accvgpr_read_b32 v193, a49
    v_accvgpr_read_b32 v194, a50
    v_accvgpr_read_b32 v195, a51
    v_accvgpr_read_b32 v196, a52
    v_accvgpr_read_b32 v197, a53
    v_accvgpr_read_b32 v198, a54
    v_accvgpr_read_b32 v199, a55
    v_mul_f32 v192, v192, v13
    v_mul_f32 v193, v193, v13
    v_mul_f32 v194, v194, v13
    v_mul_f32 v195, v195, v13
    v_mul_f32 v196, v196, v13
    v_mul_f32 v197, v197, v13
    v_mul_f32 v198, v198, v13
    v_mul_f32 v199, v199, v13
    v_accvgpr_write_b32 a48, v192
    v_accvgpr_write_b32 a49, v193
    v_accvgpr_write_b32 a50, v194
    v_accvgpr_write_b32 a51, v195
    v_accvgpr_write_b32 a52, v196
    v_accvgpr_write_b32 a53, v197
    v_accvgpr_write_b32 a54, v198
    v_accvgpr_write_b32 a55, v199
    v_accvgpr_read_b32 v192, a56
    v_accvgpr_read_b32 v193, a57
    v_accvgpr_read_b32 v194, a58
    v_accvgpr_read_b32 v195, a59
    v_accvgpr_read_b32 v196, a60
    v_accvgpr_read_b32 v197, a61
    v_accvgpr_read_b32 v198, a62
    v_accvgpr_read_b32 v199, a63
    v_mul_f32 v192, v192, v13
    v_mul_f32 v193, v193, v13
    v_mul_f32 v194, v194, v13
    v_mul_f32 v195, v195, v13
    v_mul_f32 v196, v196, v13
    v_mul_f32 v197, v197, v13
    v_mul_f32 v198, v198, v13
    v_mul_f32 v199, v199, v13
    v_accvgpr_write_b32 a56, v192
    v_accvgpr_write_b32 a57, v193
    v_accvgpr_write_b32 a58, v194
    v_accvgpr_write_b32 a59, v195
    v_accvgpr_write_b32 a60, v196
    v_accvgpr_write_b32 a61, v197
    v_accvgpr_write_b32 a62, v198
    v_accvgpr_write_b32 a63, v199
    v_accvgpr_read_b32 v192, a64
    v_accvgpr_read_b32 v193, a65
    v_accvgpr_read_b32 v194, a66
    v_accvgpr_read_b32 v195, a67
    v_accvgpr_read_b32 v196, a68
    v_accvgpr_read_b32 v197, a69
    v_accvgpr_read_b32 v198, a70
    v_accvgpr_read_b32 v199, a71
    v_mul_f32 v192, v192, v13
    v_mul_f32 v193, v193, v13
    v_mul_f32 v194, v194, v13
    v_mul_f32 v195, v195, v13
    v_mul_f32 v196, v196, v13
    v_mul_f32 v197, v197, v13
    v_mul_f32 v198, v198, v13
    v_mul_f32 v199, v199, v13
    v_accvgpr_write_b32 a64, v192
    v_accvgpr_write_b32 a65, v193
    v_accvgpr_write_b32 a66, v194
    v_accvgpr_write_b32 a67, v195
    v_accvgpr_write_b32 a68, v196
    v_accvgpr_write_b32 a69, v197
    v_accvgpr_write_b32 a70, v198
    v_accvgpr_write_b32 a71, v199
    v_accvgpr_read_b32 v192, a72
    v_accvgpr_read_b32 v193, a73
    v_accvgpr_read_b32 v194, a74
    v_accvgpr_read_b32 v195, a75
    v_accvgpr_read_b32 v196, a76
    v_accvgpr_read_b32 v197, a77
    v_accvgpr_read_b32 v198, a78
    v_accvgpr_read_b32 v199, a79
    v_mul_f32 v192, v192, v13
    v_mul_f32 v193, v193, v13
    v_mul_f32 v194, v194, v13
    v_mul_f32 v195, v195, v13
    v_mul_f32 v196, v196, v13
    v_mul_f32 v197, v197, v13
    v_mul_f32 v198, v198, v13
    v_mul_f32 v199, v199, v13
    v_accvgpr_write_b32 a72, v192
    v_accvgpr_write_b32 a73, v193
    v_accvgpr_write_b32 a74, v194
    v_accvgpr_write_b32 a75, v195
    v_accvgpr_write_b32 a76, v196
    v_accvgpr_write_b32 a77, v197
    v_accvgpr_write_b32 a78, v198
    v_accvgpr_write_b32 a79, v199
    v_accvgpr_read_b32 v192, a80
    v_accvgpr_read_b32 v193, a81
    v_accvgpr_read_b32 v194, a82
    v_accvgpr_read_b32 v195, a83
    v_accvgpr_read_b32 v196, a84
    v_accvgpr_read_b32 v197, a85
    v_accvgpr_read_b32 v198, a86
    v_accvgpr_read_b32 v199, a87
    v_mul_f32 v192, v192, v13
    v_mul_f32 v193, v193, v13
    v_mul_f32 v194, v194, v13
    v_mul_f32 v195, v195, v13
    v_mul_f32 v196, v196, v13
    v_mul_f32 v197, v197, v13
    v_mul_f32 v198, v198, v13
    v_mul_f32 v199, v199, v13
    v_accvgpr_write_b32 a80, v192
    v_accvgpr_write_b32 a81, v193
    v_accvgpr_write_b32 a82, v194
    v_accvgpr_write_b32 a83, v195
    v_accvgpr_write_b32 a84, v196
    v_accvgpr_write_b32 a85, v197
    v_accvgpr_write_b32 a86, v198
    v_accvgpr_write_b32 a87, v199
    v_accvgpr_read_b32 v192, a88
    v_accvgpr_read_b32 v193, a89
    v_accvgpr_read_b32 v194, a90
    v_accvgpr_read_b32 v195, a91
    v_accvgpr_read_b32 v196, a92
    v_accvgpr_read_b32 v197, a93
    v_accvgpr_read_b32 v198, a94
    v_accvgpr_read_b32 v199, a95
    v_mul_f32 v192, v192, v13
    v_mul_f32 v193, v193, v13
    v_mul_f32 v194, v194, v13
    v_mul_f32 v195, v195, v13
    v_mul_f32 v196, v196, v13
    v_mul_f32 v197, v197, v13
    v_mul_f32 v198, v198, v13
    v_mul_f32 v199, v199, v13
    v_accvgpr_write_b32 a88, v192
    v_accvgpr_write_b32 a89, v193
    v_accvgpr_write_b32 a90, v194
    v_accvgpr_write_b32 a91, v195
    v_accvgpr_write_b32 a92, v196
    v_accvgpr_write_b32 a93, v197
    v_accvgpr_write_b32 a94, v198
    v_accvgpr_write_b32 a95, v199
    v_accvgpr_read_b32 v192, a96
    v_accvgpr_read_b32 v193, a97
    v_accvgpr_read_b32 v194, a98
    v_accvgpr_read_b32 v195, a99
    v_accvgpr_read_b32 v196, a100
    v_accvgpr_read_b32 v197, a101
    v_accvgpr_read_b32 v198, a102
    v_accvgpr_read_b32 v199, a103
    v_mul_f32 v192, v192, v13
    v_mul_f32 v193, v193, v13
    v_mul_f32 v194, v194, v13
    v_mul_f32 v195, v195, v13
    v_mul_f32 v196, v196, v13
    v_mul_f32 v197, v197, v13
    v_mul_f32 v198, v198, v13
    v_mul_f32 v199, v199, v13
    v_accvgpr_write_b32 a96, v192
    v_accvgpr_write_b32 a97, v193
    v_accvgpr_write_b32 a98, v194
    v_accvgpr_write_b32 a99, v195
    v_accvgpr_write_b32 a100, v196
    v_accvgpr_write_b32 a101, v197
    v_accvgpr_write_b32 a102, v198
    v_accvgpr_write_b32 a103, v199
    v_accvgpr_read_b32 v192, a104
    v_accvgpr_read_b32 v193, a105
    v_accvgpr_read_b32 v194, a106
    v_accvgpr_read_b32 v195, a107
    v_accvgpr_read_b32 v196, a108
    v_accvgpr_read_b32 v197, a109
    v_accvgpr_read_b32 v198, a110
    v_accvgpr_read_b32 v199, a111
    v_mul_f32 v192, v192, v13
    v_mul_f32 v193, v193, v13
    v_mul_f32 v194, v194, v13
    v_mul_f32 v195, v195, v13
    v_mul_f32 v196, v196, v13
    v_mul_f32 v197, v197, v13
    v_mul_f32 v198, v198, v13
    v_mul_f32 v199, v199, v13
    v_accvgpr_write_b32 a104, v192
    v_accvgpr_write_b32 a105, v193
    v_accvgpr_write_b32 a106, v194
    v_accvgpr_write_b32 a107, v195
    v_accvgpr_write_b32 a108, v196
    v_accvgpr_write_b32 a109, v197
    v_accvgpr_write_b32 a110, v198
    v_accvgpr_write_b32 a111, v199
    v_accvgpr_read_b32 v192, a112
    v_accvgpr_read_b32 v193, a113
    v_accvgpr_read_b32 v194, a114
    v_accvgpr_read_b32 v195, a115
    v_accvgpr_read_b32 v196, a116
    v_accvgpr_read_b32 v197, a117
    v_accvgpr_read_b32 v198, a118
    v_accvgpr_read_b32 v199, a119
    v_mul_f32 v192, v192, v13
    v_mul_f32 v193, v193, v13
    v_mul_f32 v194, v194, v13
    v_mul_f32 v195, v195, v13
    v_mul_f32 v196, v196, v13
    v_mul_f32 v197, v197, v13
    v_mul_f32 v198, v198, v13
    v_mul_f32 v199, v199, v13
    v_accvgpr_write_b32 a112, v192
    v_accvgpr_write_b32 a113, v193
    v_accvgpr_write_b32 a114, v194
    v_accvgpr_write_b32 a115, v195
    v_accvgpr_write_b32 a116, v196
    v_accvgpr_write_b32 a117, v197
    v_accvgpr_write_b32 a118, v198
    v_accvgpr_write_b32 a119, v199
    v_accvgpr_read_b32 v192, a120
    v_accvgpr_read_b32 v193, a121
    v_accvgpr_read_b32 v194, a122
    v_accvgpr_read_b32 v195, a123
    v_accvgpr_read_b32 v196, a124
    v_accvgpr_read_b32 v197, a125
    v_accvgpr_read_b32 v198, a126
    v_accvgpr_read_b32 v199, a127
    v_mul_f32 v192, v192, v13
    v_mul_f32 v193, v193, v13
    v_mul_f32 v194, v194, v13
    v_mul_f32 v195, v195, v13
    v_mul_f32 v196, v196, v13
    v_mul_f32 v197, v197, v13
    v_mul_f32 v198, v198, v13
    v_mul_f32 v199, v199, v13
    v_accvgpr_write_b32 a120, v192
    v_accvgpr_write_b32 a121, v193
    v_accvgpr_write_b32 a122, v194
    v_accvgpr_write_b32 a123, v195
    v_accvgpr_write_b32 a124, v196
    v_accvgpr_write_b32 a125, v197
    v_accvgpr_write_b32 a126, v198
    v_accvgpr_write_b32 a127, v199
slow_p0_s0_norescale:
    s_mov_b64 s[48:49], 0
    s_mov_b32 s50, 0
    v_exp_f32 v112, v32
    v_exp_f32 v113, v33
    v_exp_f32 v114, v34
    v_exp_f32 v115, v35
    v_add_f32 v7, v112, v113
    v_cvt_pk_bf16_f32 v96, v112, v113
    v_exp_f32 v116, v36
    v_add_f32 v8, v114, v115
    v_cvt_pk_bf16_f32 v97, v114, v115
    v_exp_f32 v117, v37
    v_exp_f32 v118, v38
    v_add_f32 v7, v7, v116
    v_exp_f32 v119, v39
    v_add_f32 v7, v7, v117
    v_cvt_pk_bf16_f32 v98, v116, v117
    v_exp_f32 v120, v40
    v_add_f32 v8, v8, v118
    v_exp_f32 v121, v41
    v_add_f32 v8, v8, v119
    v_cvt_pk_bf16_f32 v99, v118, v119
    v_exp_f32 v122, v42
    v_add_f32 v7, v7, v120
    v_exp_f32 v123, v43
    v_add_f32 v7, v7, v121
    v_cvt_pk_bf16_f32 v100, v120, v121
    v_exp_f32 v124, v44
    v_add_f32 v8, v8, v122
    v_exp_f32 v125, v45
    v_add_f32 v8, v8, v123
    v_cvt_pk_bf16_f32 v101, v122, v123
    v_exp_f32 v126, v46
    v_add_f32 v7, v7, v124
    v_exp_f32 v127, v47
    v_add_f32 v7, v7, v125
    v_cvt_pk_bf16_f32 v102, v124, v125
    v_add_f32 v8, v8, v126
    v_add_f32 v8, v8, v127
    v_cvt_pk_bf16_f32 v103, v126, v127
    v_add_f32 v7, v7, v8
    s_nop 1
    s_setpc_b64 s[56:57]
slow_p0_s1:
    s_nop 15
    s_nop 3
    v_max3_f32 v12, v48, v49, v50
    v_max3_f32 v12, v12, v51, v52
    v_max3_f32 v12, v12, v53, v54
    v_max3_f32 v12, v12, v55, v56
    v_max3_f32 v12, v12, v57, v58
    v_max3_f32 v12, v12, v59, v60
    v_max3_f32 v12, v12, v61, v62
    v_max_f32 v12, v12, v63
    v_mov_b32 v13, v12
    s_nop 1
    v_permlane32_swap_b32 v12, v13
    s_nop 1
    v_max_f32 v12, v12, v13
    v_max_f32 v12, s50, v12
    s_mov_b32 s66, 0xff61b1e6
    v_cmp_ge_f32 vcc, s66, v12
    s_nop 1
    v_cndmask_b32 v12, v12, 0, vcc
    v_add_f32 v5, v5, v12
    v_mul_f32 v14, s51, v12
    v_sub_f32 v48, v48, v12
    v_sub_f32 v49, v49, v12
    v_sub_f32 v50, v50, v12
    v_sub_f32 v51, v51, v12
    v_sub_f32 v52, v52, v12
    v_sub_f32 v53, v53, v12
    v_sub_f32 v54, v54, v12
    v_sub_f32 v55, v55, v12
    v_sub_f32 v56, v56, v12
    v_sub_f32 v57, v57, v12
    v_sub_f32 v58, v58, v12
    v_sub_f32 v59, v59, v12
    v_sub_f32 v60, v60, v12
    v_sub_f32 v61, v61, v12
    v_sub_f32 v62, v62, v12
    v_sub_f32 v63, v63, v12
    v_sub_f32 v64, v64, v14
    v_sub_f32 v65, v65, v14
    v_sub_f32 v66, v66, v14
    v_sub_f32 v67, v67, v14
    v_sub_f32 v68, v68, v14
    v_sub_f32 v69, v69, v14
    v_sub_f32 v70, v70, v14
    v_sub_f32 v71, v71, v14
    v_sub_f32 v72, v72, v14
    v_sub_f32 v73, v73, v14
    v_sub_f32 v74, v74, v14
    v_sub_f32 v75, v75, v14
    v_sub_f32 v76, v76, v14
    v_sub_f32 v77, v77, v14
    v_sub_f32 v78, v78, v14
    v_sub_f32 v79, v79, v14
    v_sub_f32 v80, v80, v14
    v_sub_f32 v81, v81, v14
    v_sub_f32 v82, v82, v14
    v_sub_f32 v83, v83, v14
    v_sub_f32 v84, v84, v14
    v_sub_f32 v85, v85, v14
    v_sub_f32 v86, v86, v14
    v_sub_f32 v87, v87, v14
    v_sub_f32 v88, v88, v14
    v_sub_f32 v89, v89, v14
    v_sub_f32 v90, v90, v14
    v_sub_f32 v91, v91, v14
    v_sub_f32 v92, v92, v14
    v_sub_f32 v93, v93, v14
    v_sub_f32 v94, v94, v14
    v_sub_f32 v95, v95, v14
    v_sub_f32 v16, v16, v14
    v_sub_f32 v17, v17, v14
    v_sub_f32 v18, v18, v14
    v_sub_f32 v19, v19, v14
    v_sub_f32 v20, v20, v14
    v_sub_f32 v21, v21, v14
    v_sub_f32 v22, v22, v14
    v_sub_f32 v23, v23, v14
    v_sub_f32 v24, v24, v14
    v_sub_f32 v25, v25, v14
    v_sub_f32 v26, v26, v14
    v_sub_f32 v27, v27, v14
    v_sub_f32 v28, v28, v14
    v_sub_f32 v29, v29, v14
    v_sub_f32 v30, v30, v14
    v_sub_f32 v31, v31, v14
    s_cmp_lg_u64 s[48:49], 0
    s_cbranch_scc1 slow_p0_s1_norescale
    v_exp_f32 v13, -v12
    s_nop 0
    v_mul_f32 v6, v6, v13
    v_accvgpr_read_b32 v192, a0
    v_accvgpr_read_b32 v193, a1
    v_accvgpr_read_b32 v194, a2
    v_accvgpr_read_b32 v195, a3
    v_accvgpr_read_b32 v196, a4
    v_accvgpr_read_b32 v197, a5
    v_accvgpr_read_b32 v198, a6
    v_accvgpr_read_b32 v199, a7
    v_mul_f32 v192, v192, v13
    v_mul_f32 v193, v193, v13
    v_mul_f32 v194, v194, v13
    v_mul_f32 v195, v195, v13
    v_mul_f32 v196, v196, v13
    v_mul_f32 v197, v197, v13
    v_mul_f32 v198, v198, v13
    v_mul_f32 v199, v199, v13
    v_accvgpr_write_b32 a0, v192
    v_accvgpr_write_b32 a1, v193
    v_accvgpr_write_b32 a2, v194
    v_accvgpr_write_b32 a3, v195
    v_accvgpr_write_b32 a4, v196
    v_accvgpr_write_b32 a5, v197
    v_accvgpr_write_b32 a6, v198
    v_accvgpr_write_b32 a7, v199
    v_accvgpr_read_b32 v192, a8
    v_accvgpr_read_b32 v193, a9
    v_accvgpr_read_b32 v194, a10
    v_accvgpr_read_b32 v195, a11
    v_accvgpr_read_b32 v196, a12
    v_accvgpr_read_b32 v197, a13
    v_accvgpr_read_b32 v198, a14
    v_accvgpr_read_b32 v199, a15
    v_mul_f32 v192, v192, v13
    v_mul_f32 v193, v193, v13
    v_mul_f32 v194, v194, v13
    v_mul_f32 v195, v195, v13
    v_mul_f32 v196, v196, v13
    v_mul_f32 v197, v197, v13
    v_mul_f32 v198, v198, v13
    v_mul_f32 v199, v199, v13
    v_accvgpr_write_b32 a8, v192
    v_accvgpr_write_b32 a9, v193
    v_accvgpr_write_b32 a10, v194
    v_accvgpr_write_b32 a11, v195
    v_accvgpr_write_b32 a12, v196
    v_accvgpr_write_b32 a13, v197
    v_accvgpr_write_b32 a14, v198
    v_accvgpr_write_b32 a15, v199
    v_accvgpr_read_b32 v192, a16
    v_accvgpr_read_b32 v193, a17
    v_accvgpr_read_b32 v194, a18
    v_accvgpr_read_b32 v195, a19
    v_accvgpr_read_b32 v196, a20
    v_accvgpr_read_b32 v197, a21
    v_accvgpr_read_b32 v198, a22
    v_accvgpr_read_b32 v199, a23
    v_mul_f32 v192, v192, v13
    v_mul_f32 v193, v193, v13
    v_mul_f32 v194, v194, v13
    v_mul_f32 v195, v195, v13
    v_mul_f32 v196, v196, v13
    v_mul_f32 v197, v197, v13
    v_mul_f32 v198, v198, v13
    v_mul_f32 v199, v199, v13
    v_accvgpr_write_b32 a16, v192
    v_accvgpr_write_b32 a17, v193
    v_accvgpr_write_b32 a18, v194
    v_accvgpr_write_b32 a19, v195
    v_accvgpr_write_b32 a20, v196
    v_accvgpr_write_b32 a21, v197
    v_accvgpr_write_b32 a22, v198
    v_accvgpr_write_b32 a23, v199
    v_accvgpr_read_b32 v192, a24
    v_accvgpr_read_b32 v193, a25
    v_accvgpr_read_b32 v194, a26
    v_accvgpr_read_b32 v195, a27
    v_accvgpr_read_b32 v196, a28
    v_accvgpr_read_b32 v197, a29
    v_accvgpr_read_b32 v198, a30
    v_accvgpr_read_b32 v199, a31
    v_mul_f32 v192, v192, v13
    v_mul_f32 v193, v193, v13
    v_mul_f32 v194, v194, v13
    v_mul_f32 v195, v195, v13
    v_mul_f32 v196, v196, v13
    v_mul_f32 v197, v197, v13
    v_mul_f32 v198, v198, v13
    v_mul_f32 v199, v199, v13
    v_accvgpr_write_b32 a24, v192
    v_accvgpr_write_b32 a25, v193
    v_accvgpr_write_b32 a26, v194
    v_accvgpr_write_b32 a27, v195
    v_accvgpr_write_b32 a28, v196
    v_accvgpr_write_b32 a29, v197
    v_accvgpr_write_b32 a30, v198
    v_accvgpr_write_b32 a31, v199
    v_accvgpr_read_b32 v192, a32
    v_accvgpr_read_b32 v193, a33
    v_accvgpr_read_b32 v194, a34
    v_accvgpr_read_b32 v195, a35
    v_accvgpr_read_b32 v196, a36
    v_accvgpr_read_b32 v197, a37
    v_accvgpr_read_b32 v198, a38
    v_accvgpr_read_b32 v199, a39
    v_mul_f32 v192, v192, v13
    v_mul_f32 v193, v193, v13
    v_mul_f32 v194, v194, v13
    v_mul_f32 v195, v195, v13
    v_mul_f32 v196, v196, v13
    v_mul_f32 v197, v197, v13
    v_mul_f32 v198, v198, v13
    v_mul_f32 v199, v199, v13
    v_accvgpr_write_b32 a32, v192
    v_accvgpr_write_b32 a33, v193
    v_accvgpr_write_b32 a34, v194
    v_accvgpr_write_b32 a35, v195
    v_accvgpr_write_b32 a36, v196
    v_accvgpr_write_b32 a37, v197
    v_accvgpr_write_b32 a38, v198
    v_accvgpr_write_b32 a39, v199
    v_accvgpr_read_b32 v192, a40
    v_accvgpr_read_b32 v193, a41
    v_accvgpr_read_b32 v194, a42
    v_accvgpr_read_b32 v195, a43
    v_accvgpr_read_b32 v196, a44
    v_accvgpr_read_b32 v197, a45
    v_accvgpr_read_b32 v198, a46
    v_accvgpr_read_b32 v199, a47
    v_mul_f32 v192, v192, v13
    v_mul_f32 v193, v193, v13
    v_mul_f32 v194, v194, v13
    v_mul_f32 v195, v195, v13
    v_mul_f32 v196, v196, v13
    v_mul_f32 v197, v197, v13
    v_mul_f32 v198, v198, v13
    v_mul_f32 v199, v199, v13
    v_accvgpr_write_b32 a40, v192
    v_accvgpr_write_b32 a41, v193
    v_accvgpr_write_b32 a42, v194
    v_accvgpr_write_b32 a43, v195
    v_accvgpr_write_b32 a44, v196
    v_accvgpr_write_b32 a45, v197
    v_accvgpr_write_b32 a46, v198
    v_accvgpr_write_b32 a47, v199
    v_accvgpr_read_b32 v192, a48
    v_accvgpr_read_b32 v193, a49
    v_accvgpr_read_b32 v194, a50
    v_accvgpr_read_b32 v195, a51
    v_accvgpr_read_b32 v196, a52
    v_accvgpr_read_b32 v197, a53
    v_accvgpr_read_b32 v198, a54
    v_accvgpr_read_b32 v199, a55
    v_mul_f32 v192, v192, v13
    v_mul_f32 v193, v193, v13
    v_mul_f32 v194, v194, v13
    v_mul_f32 v195, v195, v13
    v_mul_f32 v196, v196, v13
    v_mul_f32 v197, v197, v13
    v_mul_f32 v198, v198, v13
    v_mul_f32 v199, v199, v13
    v_accvgpr_write_b32 a48, v192
    v_accvgpr_write_b32 a49, v193
    v_accvgpr_write_b32 a50, v194
    v_accvgpr_write_b32 a51, v195
    v_accvgpr_write_b32 a52, v196
    v_accvgpr_write_b32 a53, v197
    v_accvgpr_write_b32 a54, v198
    v_accvgpr_write_b32 a55, v199
    v_accvgpr_read_b32 v192, a56
    v_accvgpr_read_b32 v193, a57
    v_accvgpr_read_b32 v194, a58
    v_accvgpr_read_b32 v195, a59
    v_accvgpr_read_b32 v196, a60
    v_accvgpr_read_b32 v197, a61
    v_accvgpr_read_b32 v198, a62
    v_accvgpr_read_b32 v199, a63
    v_mul_f32 v192, v192, v13
    v_mul_f32 v193, v193, v13
    v_mul_f32 v194, v194, v13
    v_mul_f32 v195, v195, v13
    v_mul_f32 v196, v196, v13
    v_mul_f32 v197, v197, v13
    v_mul_f32 v198, v198, v13
    v_mul_f32 v199, v199, v13
    v_accvgpr_write_b32 a56, v192
    v_accvgpr_write_b32 a57, v193
    v_accvgpr_write_b32 a58, v194
    v_accvgpr_write_b32 a59, v195
    v_accvgpr_write_b32 a60, v196
    v_accvgpr_write_b32 a61, v197
    v_accvgpr_write_b32 a62, v198
    v_accvgpr_write_b32 a63, v199
    v_accvgpr_read_b32 v192, a64
    v_accvgpr_read_b32 v193, a65
    v_accvgpr_read_b32 v194, a66
    v_accvgpr_read_b32 v195, a67
    v_accvgpr_read_b32 v196, a68
    v_accvgpr_read_b32 v197, a69
    v_accvgpr_read_b32 v198, a70
    v_accvgpr_read_b32 v199, a71
    v_mul_f32 v192, v192, v13
    v_mul_f32 v193, v193, v13
    v_mul_f32 v194, v194, v13
    v_mul_f32 v195, v195, v13
    v_mul_f32 v196, v196, v13
    v_mul_f32 v197, v197, v13
    v_mul_f32 v198, v198, v13
    v_mul_f32 v199, v199, v13
    v_accvgpr_write_b32 a64, v192
    v_accvgpr_write_b32 a65, v193
    v_accvgpr_write_b32 a66, v194
    v_accvgpr_write_b32 a67, v195
    v_accvgpr_write_b32 a68, v196
    v_accvgpr_write_b32 a69, v197
    v_accvgpr_write_b32 a70, v198
    v_accvgpr_write_b32 a71, v199
    v_accvgpr_read_b32 v192, a72
    v_accvgpr_read_b32 v193, a73
    v_accvgpr_read_b32 v194, a74
    v_accvgpr_read_b32 v195, a75
    v_accvgpr_read_b32 v196, a76
    v_accvgpr_read_b32 v197, a77
    v_accvgpr_read_b32 v198, a78
    v_accvgpr_read_b32 v199, a79
    v_mul_f32 v192, v192, v13
    v_mul_f32 v193, v193, v13
    v_mul_f32 v194, v194, v13
    v_mul_f32 v195, v195, v13
    v_mul_f32 v196, v196, v13
    v_mul_f32 v197, v197, v13
    v_mul_f32 v198, v198, v13
    v_mul_f32 v199, v199, v13
    v_accvgpr_write_b32 a72, v192
    v_accvgpr_write_b32 a73, v193
    v_accvgpr_write_b32 a74, v194
    v_accvgpr_write_b32 a75, v195
    v_accvgpr_write_b32 a76, v196
    v_accvgpr_write_b32 a77, v197
    v_accvgpr_write_b32 a78, v198
    v_accvgpr_write_b32 a79, v199
    v_accvgpr_read_b32 v192, a80
    v_accvgpr_read_b32 v193, a81
    v_accvgpr_read_b32 v194, a82
    v_accvgpr_read_b32 v195, a83
    v_accvgpr_read_b32 v196, a84
    v_accvgpr_read_b32 v197, a85
    v_accvgpr_read_b32 v198, a86
    v_accvgpr_read_b32 v199, a87
    v_mul_f32 v192, v192, v13
    v_mul_f32 v193, v193, v13
    v_mul_f32 v194, v194, v13
    v_mul_f32 v195, v195, v13
    v_mul_f32 v196, v196, v13
    v_mul_f32 v197, v197, v13
    v_mul_f32 v198, v198, v13
    v_mul_f32 v199, v199, v13
    v_accvgpr_write_b32 a80, v192
    v_accvgpr_write_b32 a81, v193
    v_accvgpr_write_b32 a82, v194
    v_accvgpr_write_b32 a83, v195
    v_accvgpr_write_b32 a84, v196
    v_accvgpr_write_b32 a85, v197
    v_accvgpr_write_b32 a86, v198
    v_accvgpr_write_b32 a87, v199
    v_accvgpr_read_b32 v192, a88
    v_accvgpr_read_b32 v193, a89
    v_accvgpr_read_b32 v194, a90
    v_accvgpr_read_b32 v195, a91
    v_accvgpr_read_b32 v196, a92
    v_accvgpr_read_b32 v197, a93
    v_accvgpr_read_b32 v198, a94
    v_accvgpr_read_b32 v199, a95
    v_mul_f32 v192, v192, v13
    v_mul_f32 v193, v193, v13
    v_mul_f32 v194, v194, v13
    v_mul_f32 v195, v195, v13
    v_mul_f32 v196, v196, v13
    v_mul_f32 v197, v197, v13
    v_mul_f32 v198, v198, v13
    v_mul_f32 v199, v199, v13
    v_accvgpr_write_b32 a88, v192
    v_accvgpr_write_b32 a89, v193
    v_accvgpr_write_b32 a90, v194
    v_accvgpr_write_b32 a91, v195
    v_accvgpr_write_b32 a92, v196
    v_accvgpr_write_b32 a93, v197
    v_accvgpr_write_b32 a94, v198
    v_accvgpr_write_b32 a95, v199
    v_accvgpr_read_b32 v192, a96
    v_accvgpr_read_b32 v193, a97
    v_accvgpr_read_b32 v194, a98
    v_accvgpr_read_b32 v195, a99
    v_accvgpr_read_b32 v196, a100
    v_accvgpr_read_b32 v197, a101
    v_accvgpr_read_b32 v198, a102
    v_accvgpr_read_b32 v199, a103
    v_mul_f32 v192, v192, v13
    v_mul_f32 v193, v193, v13
    v_mul_f32 v194, v194, v13
    v_mul_f32 v195, v195, v13
    v_mul_f32 v196, v196, v13
    v_mul_f32 v197, v197, v13
    v_mul_f32 v198, v198, v13
    v_mul_f32 v199, v199, v13
    v_accvgpr_write_b32 a96, v192
    v_accvgpr_write_b32 a97, v193
    v_accvgpr_write_b32 a98, v194
    v_accvgpr_write_b32 a99, v195
    v_accvgpr_write_b32 a100, v196
    v_accvgpr_write_b32 a101, v197
    v_accvgpr_write_b32 a102, v198
    v_accvgpr_write_b32 a103, v199
    v_accvgpr_read_b32 v192, a104
    v_accvgpr_read_b32 v193, a105
    v_accvgpr_read_b32 v194, a106
    v_accvgpr_read_b32 v195, a107
    v_accvgpr_read_b32 v196, a108
    v_accvgpr_read_b32 v197, a109
    v_accvgpr_read_b32 v198, a110
    v_accvgpr_read_b32 v199, a111
    v_mul_f32 v192, v192, v13
    v_mul_f32 v193, v193, v13
    v_mul_f32 v194, v194, v13
    v_mul_f32 v195, v195, v13
    v_mul_f32 v196, v196, v13
    v_mul_f32 v197, v197, v13
    v_mul_f32 v198, v198, v13
    v_mul_f32 v199, v199, v13
    v_accvgpr_write_b32 a104, v192
    v_accvgpr_write_b32 a105, v193
    v_accvgpr_write_b32 a106, v194
    v_accvgpr_write_b32 a107, v195
    v_accvgpr_write_b32 a108, v196
    v_accvgpr_write_b32 a109, v197
    v_accvgpr_write_b32 a110, v198
    v_accvgpr_write_b32 a111, v199
    v_accvgpr_read_b32 v192, a112
    v_accvgpr_read_b32 v193, a113
    v_accvgpr_read_b32 v194, a114
    v_accvgpr_read_b32 v195, a115
    v_accvgpr_read_b32 v196, a116
    v_accvgpr_read_b32 v197, a117
    v_accvgpr_read_b32 v198, a118
    v_accvgpr_read_b32 v199, a119
    v_mul_f32 v192, v192, v13
    v_mul_f32 v193, v193, v13
    v_mul_f32 v194, v194, v13
    v_mul_f32 v195, v195, v13
    v_mul_f32 v196, v196, v13
    v_mul_f32 v197, v197, v13
    v_mul_f32 v198, v198, v13
    v_mul_f32 v199, v199, v13
    v_accvgpr_write_b32 a112, v192
    v_accvgpr_write_b32 a113, v193
    v_accvgpr_write_b32 a114, v194
    v_accvgpr_write_b32 a115, v195
    v_accvgpr_write_b32 a116, v196
    v_accvgpr_write_b32 a117, v197
    v_accvgpr_write_b32 a118, v198
    v_accvgpr_write_b32 a119, v199
    v_accvgpr_read_b32 v192, a120
    v_accvgpr_read_b32 v193, a121
    v_accvgpr_read_b32 v194, a122
    v_accvgpr_read_b32 v195, a123
    v_accvgpr_read_b32 v196, a124
    v_accvgpr_read_b32 v197, a125
    v_accvgpr_read_b32 v198, a126
    v_accvgpr_read_b32 v199, a127
    v_mul_f32 v192, v192, v13
    v_mul_f32 v193, v193, v13
    v_mul_f32 v194, v194, v13
    v_mul_f32 v195, v195, v13
    v_mul_f32 v196, v196, v13
    v_mul_f32 v197, v197, v13
    v_mul_f32 v198, v198, v13
    v_mul_f32 v199, v199, v13
    v_accvgpr_write_b32 a120, v192
    v_accvgpr_write_b32 a121, v193
    v_accvgpr_write_b32 a122, v194
    v_accvgpr_write_b32 a123, v195
    v_accvgpr_write_b32 a124, v196
    v_accvgpr_write_b32 a125, v197
    v_accvgpr_write_b32 a126, v198
    v_accvgpr_write_b32 a127, v199
slow_p0_s1_norescale:
    s_mov_b64 s[48:49], 0
    s_mov_b32 s50, 0
    v_exp_f32 v112, v48
    v_exp_f32 v113, v49
    v_exp_f32 v114, v50
    v_exp_f32 v115, v51
    v_add_f32 v7, v112, v113
    v_cvt_pk_bf16_f32 v104, v112, v113
    v_exp_f32 v116, v52
    v_add_f32 v8, v114, v115
    v_cvt_pk_bf16_f32 v105, v114, v115
    v_exp_f32 v117, v53
    v_exp_f32 v118, v54
    v_add_f32 v7, v7, v116
    v_exp_f32 v119, v55
    v_add_f32 v7, v7, v117
    v_cvt_pk_bf16_f32 v106, v116, v117
    v_exp_f32 v120, v56
    v_add_f32 v8, v8, v118
    v_exp_f32 v121, v57
    v_add_f32 v8, v8, v119
    v_cvt_pk_bf16_f32 v107, v118, v119
    v_exp_f32 v122, v58
    v_add_f32 v7, v7, v120
    v_exp_f32 v123, v59
    v_add_f32 v7, v7, v121
    v_cvt_pk_bf16_f32 v108, v120, v121
    v_exp_f32 v124, v60
    v_add_f32 v8, v8, v122
    v_exp_f32 v125, v61
    v_add_f32 v8, v8, v123
    v_cvt_pk_bf16_f32 v109, v122, v123
    v_exp_f32 v126, v62
    v_add_f32 v7, v7, v124
    v_exp_f32 v127, v63
    v_add_f32 v7, v7, v125
    v_cvt_pk_bf16_f32 v110, v124, v125
    v_add_f32 v8, v8, v126
    v_add_f32 v8, v8, v127
    v_cvt_pk_bf16_f32 v111, v126, v127
    v_add_f32 v7, v7, v8
    s_nop 1
    s_setpc_b64 s[56:57]
slow_p1_s0:
    s_nop 15
    s_nop 3
    v_max3_f32 v12, v64, v65, v66
    v_max3_f32 v12, v12, v67, v68
    v_max3_f32 v12, v12, v69, v70
    v_max3_f32 v12, v12, v71, v72
    v_max3_f32 v12, v12, v73, v74
    v_max3_f32 v12, v12, v75, v76
    v_max3_f32 v12, v12, v77, v78
    v_max_f32 v12, v12, v79
    v_mov_b32 v13, v12
    s_nop 1
    v_permlane32_swap_b32 v12, v13
    s_nop 1
    v_max_f32 v12, v12, v13
    v_max_f32 v12, s50, v12
    s_mov_b32 s66, 0xff61b1e6
    v_cmp_ge_f32 vcc, s66, v12
    s_nop 1
    v_cndmask_b32 v12, v12, 0, vcc
    v_add_f32 v5, v5, v12
    v_mul_f32 v14, s51, v12
    v_sub_f32 v64, v64, v12
    v_sub_f32 v65, v65, v12
    v_sub_f32 v66, v66, v12
    v_sub_f32 v67, v67, v12
    v_sub_f32 v68, v68, v12
    v_sub_f32 v69, v69, v12
    v_sub_f32 v70, v70, v12
    v_sub_f32 v71, v71, v12
    v_sub_f32 v72, v72, v12
    v_sub_f32 v73, v73, v12
    v_sub_f32 v74, v74, v12
    v_sub_f32 v75, v75, v12
    v_sub_f32 v76, v76, v12
    v_sub_f32 v77, v77, v12
    v_sub_f32 v78, v78, v12
    v_sub_f32 v79, v79, v12
    v_sub_f32 v80, v80, v12
    v_sub_f32 v81, v81, v12
    v_sub_f32 v82, v82, v12
    v_sub_f32 v83, v83, v12
    v_sub_f32 v84, v84, v12
    v_sub_f32 v85, v85, v12
    v_sub_f32 v86, v86, v12
    v_sub_f32 v87, v87, v12
    v_sub_f32 v88, v88, v12
    v_sub_f32 v89, v89, v12
    v_sub_f32 v90, v90, v12
    v_sub_f32 v91, v91, v12
    v_sub_f32 v92, v92, v12
    v_sub_f32 v93, v93, v12
    v_sub_f32 v94, v94, v12
    v_sub_f32 v95, v95, v12
    v_sub_f32 v32, v32, v14
    v_sub_f32 v33, v33, v14
    v_sub_f32 v34, v34, v14
    v_sub_f32 v35, v35, v14
    v_sub_f32 v36, v36, v14
    v_sub_f32 v37, v37, v14
    v_sub_f32 v38, v38, v14
    v_sub_f32 v39, v39, v14
    v_sub_f32 v40, v40, v14
    v_sub_f32 v41, v41, v14
    v_sub_f32 v42, v42, v14
    v_sub_f32 v43, v43, v14
    v_sub_f32 v44, v44, v14
    v_sub_f32 v45, v45, v14
    v_sub_f32 v46, v46, v14
    v_sub_f32 v47, v47, v14
    v_sub_f32 v48, v48, v14
    v_sub_f32 v49, v49, v14
    v_sub_f32 v50, v50, v14
    v_sub_f32 v51, v51, v14
    v_sub_f32 v52, v52, v14
    v_sub_f32 v53, v53, v14
    v_sub_f32 v54, v54, v14
    v_sub_f32 v55, v55, v14
    v_sub_f32 v56, v56, v14
    v_sub_f32 v57, v57, v14
    v_sub_f32 v58, v58, v14
    v_sub_f32 v59, v59, v14
    v_sub_f32 v60, v60, v14
    v_sub_f32 v61, v61, v14
    v_sub_f32 v62, v62, v14
    v_sub_f32 v63, v63, v14
    v_sub_f32 v16, v16, v14
    v_sub_f32 v17, v17, v14
    v_sub_f32 v18, v18, v14
    v_sub_f32 v19, v19, v14
    v_sub_f32 v20, v20, v14
    v_sub_f32 v21, v21, v14
    v_sub_f32 v22, v22, v14
    v_sub_f32 v23, v23, v14
    v_sub_f32 v24, v24, v14
    v_sub_f32 v25, v25, v14
    v_sub_f32 v26, v26, v14
    v_sub_f32 v27, v27, v14
    v_sub_f32 v28, v28, v14
    v_sub_f32 v29, v29, v14
    v_sub_f32 v30, v30, v14
    v_sub_f32 v31, v31, v14
    s_cmp_lg_u64 s[48:49], 0
    s_cbranch_scc1 slow_p1_s0_norescale
    v_exp_f32 v13, -v12
    s_nop 0
    v_mul_f32 v6, v6, v13
    v_accvgpr_read_b32 v192, a0
    v_accvgpr_read_b32 v193, a1
    v_accvgpr_read_b32 v194, a2
    v_accvgpr_read_b32 v195, a3
    v_accvgpr_read_b32 v196, a4
    v_accvgpr_read_b32 v197, a5
    v_accvgpr_read_b32 v198, a6
    v_accvgpr_read_b32 v199, a7
    v_mul_f32 v192, v192, v13
    v_mul_f32 v193, v193, v13
    v_mul_f32 v194, v194, v13
    v_mul_f32 v195, v195, v13
    v_mul_f32 v196, v196, v13
    v_mul_f32 v197, v197, v13
    v_mul_f32 v198, v198, v13
    v_mul_f32 v199, v199, v13
    v_accvgpr_write_b32 a0, v192
    v_accvgpr_write_b32 a1, v193
    v_accvgpr_write_b32 a2, v194
    v_accvgpr_write_b32 a3, v195
    v_accvgpr_write_b32 a4, v196
    v_accvgpr_write_b32 a5, v197
    v_accvgpr_write_b32 a6, v198
    v_accvgpr_write_b32 a7, v199
    v_accvgpr_read_b32 v192, a8
    v_accvgpr_read_b32 v193, a9
    v_accvgpr_read_b32 v194, a10
    v_accvgpr_read_b32 v195, a11
    v_accvgpr_read_b32 v196, a12
    v_accvgpr_read_b32 v197, a13
    v_accvgpr_read_b32 v198, a14
    v_accvgpr_read_b32 v199, a15
    v_mul_f32 v192, v192, v13
    v_mul_f32 v193, v193, v13
    v_mul_f32 v194, v194, v13
    v_mul_f32 v195, v195, v13
    v_mul_f32 v196, v196, v13
    v_mul_f32 v197, v197, v13
    v_mul_f32 v198, v198, v13
    v_mul_f32 v199, v199, v13
    v_accvgpr_write_b32 a8, v192
    v_accvgpr_write_b32 a9, v193
    v_accvgpr_write_b32 a10, v194
    v_accvgpr_write_b32 a11, v195
    v_accvgpr_write_b32 a12, v196
    v_accvgpr_write_b32 a13, v197
    v_accvgpr_write_b32 a14, v198
    v_accvgpr_write_b32 a15, v199
    v_accvgpr_read_b32 v192, a16
    v_accvgpr_read_b32 v193, a17
    v_accvgpr_read_b32 v194, a18
    v_accvgpr_read_b32 v195, a19
    v_accvgpr_read_b32 v196, a20
    v_accvgpr_read_b32 v197, a21
    v_accvgpr_read_b32 v198, a22
    v_accvgpr_read_b32 v199, a23
    v_mul_f32 v192, v192, v13
    v_mul_f32 v193, v193, v13
    v_mul_f32 v194, v194, v13
    v_mul_f32 v195, v195, v13
    v_mul_f32 v196, v196, v13
    v_mul_f32 v197, v197, v13
    v_mul_f32 v198, v198, v13
    v_mul_f32 v199, v199, v13
    v_accvgpr_write_b32 a16, v192
    v_accvgpr_write_b32 a17, v193
    v_accvgpr_write_b32 a18, v194
    v_accvgpr_write_b32 a19, v195
    v_accvgpr_write_b32 a20, v196
    v_accvgpr_write_b32 a21, v197
    v_accvgpr_write_b32 a22, v198
    v_accvgpr_write_b32 a23, v199
    v_accvgpr_read_b32 v192, a24
    v_accvgpr_read_b32 v193, a25
    v_accvgpr_read_b32 v194, a26
    v_accvgpr_read_b32 v195, a27
    v_accvgpr_read_b32 v196, a28
    v_accvgpr_read_b32 v197, a29
    v_accvgpr_read_b32 v198, a30
    v_accvgpr_read_b32 v199, a31
    v_mul_f32 v192, v192, v13
    v_mul_f32 v193, v193, v13
    v_mul_f32 v194, v194, v13
    v_mul_f32 v195, v195, v13
    v_mul_f32 v196, v196, v13
    v_mul_f32 v197, v197, v13
    v_mul_f32 v198, v198, v13
    v_mul_f32 v199, v199, v13
    v_accvgpr_write_b32 a24, v192
    v_accvgpr_write_b32 a25, v193
    v_accvgpr_write_b32 a26, v194
    v_accvgpr_write_b32 a27, v195
    v_accvgpr_write_b32 a28, v196
    v_accvgpr_write_b32 a29, v197
    v_accvgpr_write_b32 a30, v198
    v_accvgpr_write_b32 a31, v199
    v_accvgpr_read_b32 v192, a32
    v_accvgpr_read_b32 v193, a33
    v_accvgpr_read_b32 v194, a34
    v_accvgpr_read_b32 v195, a35
    v_accvgpr_read_b32 v196, a36
    v_accvgpr_read_b32 v197, a37
    v_accvgpr_read_b32 v198, a38
    v_accvgpr_read_b32 v199, a39
    v_mul_f32 v192, v192, v13
    v_mul_f32 v193, v193, v13
    v_mul_f32 v194, v194, v13
    v_mul_f32 v195, v195, v13
    v_mul_f32 v196, v196, v13
    v_mul_f32 v197, v197, v13
    v_mul_f32 v198, v198, v13
    v_mul_f32 v199, v199, v13
    v_accvgpr_write_b32 a32, v192
    v_accvgpr_write_b32 a33, v193
    v_accvgpr_write_b32 a34, v194
    v_accvgpr_write_b32 a35, v195
    v_accvgpr_write_b32 a36, v196
    v_accvgpr_write_b32 a37, v197
    v_accvgpr_write_b32 a38, v198
    v_accvgpr_write_b32 a39, v199
    v_accvgpr_read_b32 v192, a40
    v_accvgpr_read_b32 v193, a41
    v_accvgpr_read_b32 v194, a42
    v_accvgpr_read_b32 v195, a43
    v_accvgpr_read_b32 v196, a44
    v_accvgpr_read_b32 v197, a45
    v_accvgpr_read_b32 v198, a46
    v_accvgpr_read_b32 v199, a47
    v_mul_f32 v192, v192, v13
    v_mul_f32 v193, v193, v13
    v_mul_f32 v194, v194, v13
    v_mul_f32 v195, v195, v13
    v_mul_f32 v196, v196, v13
    v_mul_f32 v197, v197, v13
    v_mul_f32 v198, v198, v13
    v_mul_f32 v199, v199, v13
    v_accvgpr_write_b32 a40, v192
    v_accvgpr_write_b32 a41, v193
    v_accvgpr_write_b32 a42, v194
    v_accvgpr_write_b32 a43, v195
    v_accvgpr_write_b32 a44, v196
    v_accvgpr_write_b32 a45, v197
    v_accvgpr_write_b32 a46, v198
    v_accvgpr_write_b32 a47, v199
    v_accvgpr_read_b32 v192, a48
    v_accvgpr_read_b32 v193, a49
    v_accvgpr_read_b32 v194, a50
    v_accvgpr_read_b32 v195, a51
    v_accvgpr_read_b32 v196, a52
    v_accvgpr_read_b32 v197, a53
    v_accvgpr_read_b32 v198, a54
    v_accvgpr_read_b32 v199, a55
    v_mul_f32 v192, v192, v13
    v_mul_f32 v193, v193, v13
    v_mul_f32 v194, v194, v13
    v_mul_f32 v195, v195, v13
    v_mul_f32 v196, v196, v13
    v_mul_f32 v197, v197, v13
    v_mul_f32 v198, v198, v13
    v_mul_f32 v199, v199, v13
    v_accvgpr_write_b32 a48, v192
    v_accvgpr_write_b32 a49, v193
    v_accvgpr_write_b32 a50, v194
    v_accvgpr_write_b32 a51, v195
    v_accvgpr_write_b32 a52, v196
    v_accvgpr_write_b32 a53, v197
    v_accvgpr_write_b32 a54, v198
    v_accvgpr_write_b32 a55, v199
    v_accvgpr_read_b32 v192, a56
    v_accvgpr_read_b32 v193, a57
    v_accvgpr_read_b32 v194, a58
    v_accvgpr_read_b32 v195, a59
    v_accvgpr_read_b32 v196, a60
    v_accvgpr_read_b32 v197, a61
    v_accvgpr_read_b32 v198, a62
    v_accvgpr_read_b32 v199, a63
    v_mul_f32 v192, v192, v13
    v_mul_f32 v193, v193, v13
    v_mul_f32 v194, v194, v13
    v_mul_f32 v195, v195, v13
    v_mul_f32 v196, v196, v13
    v_mul_f32 v197, v197, v13
    v_mul_f32 v198, v198, v13
    v_mul_f32 v199, v199, v13
    v_accvgpr_write_b32 a56, v192
    v_accvgpr_write_b32 a57, v193
    v_accvgpr_write_b32 a58, v194
    v_accvgpr_write_b32 a59, v195
    v_accvgpr_write_b32 a60, v196
    v_accvgpr_write_b32 a61, v197
    v_accvgpr_write_b32 a62, v198
    v_accvgpr_write_b32 a63, v199
    v_accvgpr_read_b32 v192, a64
    v_accvgpr_read_b32 v193, a65
    v_accvgpr_read_b32 v194, a66
    v_accvgpr_read_b32 v195, a67
    v_accvgpr_read_b32 v196, a68
    v_accvgpr_read_b32 v197, a69
    v_accvgpr_read_b32 v198, a70
    v_accvgpr_read_b32 v199, a71
    v_mul_f32 v192, v192, v13
    v_mul_f32 v193, v193, v13
    v_mul_f32 v194, v194, v13
    v_mul_f32 v195, v195, v13
    v_mul_f32 v196, v196, v13
    v_mul_f32 v197, v197, v13
    v_mul_f32 v198, v198, v13
    v_mul_f32 v199, v199, v13
    v_accvgpr_write_b32 a64, v192
    v_accvgpr_write_b32 a65, v193
    v_accvgpr_write_b32 a66, v194
    v_accvgpr_write_b32 a67, v195
    v_accvgpr_write_b32 a68, v196
    v_accvgpr_write_b32 a69, v197
    v_accvgpr_write_b32 a70, v198
    v_accvgpr_write_b32 a71, v199
    v_accvgpr_read_b32 v192, a72
    v_accvgpr_read_b32 v193, a73
    v_accvgpr_read_b32 v194, a74
    v_accvgpr_read_b32 v195, a75
    v_accvgpr_read_b32 v196, a76
    v_accvgpr_read_b32 v197, a77
    v_accvgpr_read_b32 v198, a78
    v_accvgpr_read_b32 v199, a79
    v_mul_f32 v192, v192, v13
    v_mul_f32 v193, v193, v13
    v_mul_f32 v194, v194, v13
    v_mul_f32 v195, v195, v13
    v_mul_f32 v196, v196, v13
    v_mul_f32 v197, v197, v13
    v_mul_f32 v198, v198, v13
    v_mul_f32 v199, v199, v13
    v_accvgpr_write_b32 a72, v192
    v_accvgpr_write_b32 a73, v193
    v_accvgpr_write_b32 a74, v194
    v_accvgpr_write_b32 a75, v195
    v_accvgpr_write_b32 a76, v196
    v_accvgpr_write_b32 a77, v197
    v_accvgpr_write_b32 a78, v198
    v_accvgpr_write_b32 a79, v199
    v_accvgpr_read_b32 v192, a80
    v_accvgpr_read_b32 v193, a81
    v_accvgpr_read_b32 v194, a82
    v_accvgpr_read_b32 v195, a83
    v_accvgpr_read_b32 v196, a84
    v_accvgpr_read_b32 v197, a85
    v_accvgpr_read_b32 v198, a86
    v_accvgpr_read_b32 v199, a87
    v_mul_f32 v192, v192, v13
    v_mul_f32 v193, v193, v13
    v_mul_f32 v194, v194, v13
    v_mul_f32 v195, v195, v13
    v_mul_f32 v196, v196, v13
    v_mul_f32 v197, v197, v13
    v_mul_f32 v198, v198, v13
    v_mul_f32 v199, v199, v13
    v_accvgpr_write_b32 a80, v192
    v_accvgpr_write_b32 a81, v193
    v_accvgpr_write_b32 a82, v194
    v_accvgpr_write_b32 a83, v195
    v_accvgpr_write_b32 a84, v196
    v_accvgpr_write_b32 a85, v197
    v_accvgpr_write_b32 a86, v198
    v_accvgpr_write_b32 a87, v199
    v_accvgpr_read_b32 v192, a88
    v_accvgpr_read_b32 v193, a89
    v_accvgpr_read_b32 v194, a90
    v_accvgpr_read_b32 v195, a91
    v_accvgpr_read_b32 v196, a92
    v_accvgpr_read_b32 v197, a93
    v_accvgpr_read_b32 v198, a94
    v_accvgpr_read_b32 v199, a95
    v_mul_f32 v192, v192, v13
    v_mul_f32 v193, v193, v13
    v_mul_f32 v194, v194, v13
    v_mul_f32 v195, v195, v13
    v_mul_f32 v196, v196, v13
    v_mul_f32 v197, v197, v13
    v_mul_f32 v198, v198, v13
    v_mul_f32 v199, v199, v13
    v_accvgpr_write_b32 a88, v192
    v_accvgpr_write_b32 a89, v193
    v_accvgpr_write_b32 a90, v194
    v_accvgpr_write_b32 a91, v195
    v_accvgpr_write_b32 a92, v196
    v_accvgpr_write_b32 a93, v197
    v_accvgpr_write_b32 a94, v198
    v_accvgpr_write_b32 a95, v199
    v_accvgpr_read_b32 v192, a96
    v_accvgpr_read_b32 v193, a97
    v_accvgpr_read_b32 v194, a98
    v_accvgpr_read_b32 v195, a99
    v_accvgpr_read_b32 v196, a100
    v_accvgpr_read_b32 v197, a101
    v_accvgpr_read_b32 v198, a102
    v_accvgpr_read_b32 v199, a103
    v_mul_f32 v192, v192, v13
    v_mul_f32 v193, v193, v13
    v_mul_f32 v194, v194, v13
    v_mul_f32 v195, v195, v13
    v_mul_f32 v196, v196, v13
    v_mul_f32 v197, v197, v13
    v_mul_f32 v198, v198, v13
    v_mul_f32 v199, v199, v13
    v_accvgpr_write_b32 a96, v192
    v_accvgpr_write_b32 a97, v193
    v_accvgpr_write_b32 a98, v194
    v_accvgpr_write_b32 a99, v195
    v_accvgpr_write_b32 a100, v196
    v_accvgpr_write_b32 a101, v197
    v_accvgpr_write_b32 a102, v198
    v_accvgpr_write_b32 a103, v199
    v_accvgpr_read_b32 v192, a104
    v_accvgpr_read_b32 v193, a105
    v_accvgpr_read_b32 v194, a106
    v_accvgpr_read_b32 v195, a107
    v_accvgpr_read_b32 v196, a108
    v_accvgpr_read_b32 v197, a109
    v_accvgpr_read_b32 v198, a110
    v_accvgpr_read_b32 v199, a111
    v_mul_f32 v192, v192, v13
    v_mul_f32 v193, v193, v13
    v_mul_f32 v194, v194, v13
    v_mul_f32 v195, v195, v13
    v_mul_f32 v196, v196, v13
    v_mul_f32 v197, v197, v13
    v_mul_f32 v198, v198, v13
    v_mul_f32 v199, v199, v13
    v_accvgpr_write_b32 a104, v192
    v_accvgpr_write_b32 a105, v193
    v_accvgpr_write_b32 a106, v194
    v_accvgpr_write_b32 a107, v195
    v_accvgpr_write_b32 a108, v196
    v_accvgpr_write_b32 a109, v197
    v_accvgpr_write_b32 a110, v198
    v_accvgpr_write_b32 a111, v199
    v_accvgpr_read_b32 v192, a112
    v_accvgpr_read_b32 v193, a113
    v_accvgpr_read_b32 v194, a114
    v_accvgpr_read_b32 v195, a115
    v_accvgpr_read_b32 v196, a116
    v_accvgpr_read_b32 v197, a117
    v_accvgpr_read_b32 v198, a118
    v_accvgpr_read_b32 v199, a119
    v_mul_f32 v192, v192, v13
    v_mul_f32 v193, v193, v13
    v_mul_f32 v194, v194, v13
    v_mul_f32 v195, v195, v13
    v_mul_f32 v196, v196, v13
    v_mul_f32 v197, v197, v13
    v_mul_f32 v198, v198, v13
    v_mul_f32 v199, v199, v13
    v_accvgpr_write_b32 a112, v192
    v_accvgpr_write_b32 a113, v193
    v_accvgpr_write_b32 a114, v194
    v_accvgpr_write_b32 a115, v195
    v_accvgpr_write_b32 a116, v196
    v_accvgpr_write_b32 a117, v197
    v_accvgpr_write_b32 a118, v198
    v_accvgpr_write_b32 a119, v199
    v_accvgpr_read_b32 v192, a120
    v_accvgpr_read_b32 v193, a121
    v_accvgpr_read_b32 v194, a122
    v_accvgpr_read_b32 v195, a123
    v_accvgpr_read_b32 v196, a124
    v_accvgpr_read_b32 v197, a125
    v_accvgpr_read_b32 v198, a126
    v_accvgpr_read_b32 v199, a127
    v_mul_f32 v192, v192, v13
    v_mul_f32 v193, v193, v13
    v_mul_f32 v194, v194, v13
    v_mul_f32 v195, v195, v13
    v_mul_f32 v196, v196, v13
    v_mul_f32 v197, v197, v13
    v_mul_f32 v198, v198, v13
    v_mul_f32 v199, v199, v13
    v_accvgpr_write_b32 a120, v192
    v_accvgpr_write_b32 a121, v193
    v_accvgpr_write_b32 a122, v194
    v_accvgpr_write_b32 a123, v195
    v_accvgpr_write_b32 a124, v196
    v_accvgpr_write_b32 a125, v197
    v_accvgpr_write_b32 a126, v198
    v_accvgpr_write_b32 a127, v199
slow_p1_s0_norescale:
    s_mov_b64 s[48:49], 0
    s_mov_b32 s50, 0
    v_exp_f32 v112, v64
    v_exp_f32 v113, v65
    v_exp_f32 v114, v66
    v_exp_f32 v115, v67
    v_add_f32 v7, v112, v113
    v_cvt_pk_bf16_f32 v96, v112, v113
    v_exp_f32 v116, v68
    v_add_f32 v8, v114, v115
    v_cvt_pk_bf16_f32 v97, v114, v115
    v_exp_f32 v117, v69
    v_exp_f32 v118, v70
    v_add_f32 v7, v7, v116
    v_exp_f32 v119, v71
    v_add_f32 v7, v7, v117
    v_cvt_pk_bf16_f32 v98, v116, v117
    v_exp_f32 v120, v72
    v_add_f32 v8, v8, v118
    v_exp_f32 v121, v73
    v_add_f32 v8, v8, v119
    v_cvt_pk_bf16_f32 v99, v118, v119
    v_exp_f32 v122, v74
    v_add_f32 v7, v7, v120
    v_exp_f32 v123, v75
    v_add_f32 v7, v7, v121
    v_cvt_pk_bf16_f32 v100, v120, v121
    v_exp_f32 v124, v76
    v_add_f32 v8, v8, v122
    v_exp_f32 v125, v77
    v_add_f32 v8, v8, v123
    v_cvt_pk_bf16_f32 v101, v122, v123
    v_exp_f32 v126, v78
    v_add_f32 v7, v7, v124
    v_exp_f32 v127, v79
    v_add_f32 v7, v7, v125
    v_cvt_pk_bf16_f32 v102, v124, v125
    v_add_f32 v8, v8, v126
    v_add_f32 v8, v8, v127
    v_cvt_pk_bf16_f32 v103, v126, v127
    v_add_f32 v7, v7, v8
    s_nop 1
    s_setpc_b64 s[56:57]
slow_p1_s1:
    s_nop 15
    s_nop 3
    v_max3_f32 v12, v80, v81, v82
    v_max3_f32 v12, v12, v83, v84
    v_max3_f32 v12, v12, v85, v86
    v_max3_f32 v12, v12, v87, v88
    v_max3_f32 v12, v12, v89, v90
    v_max3_f32 v12, v12, v91, v92
    v_max3_f32 v12, v12, v93, v94
    v_max_f32 v12, v12, v95
    v_mov_b32 v13, v12
    s_nop 1
    v_permlane32_swap_b32 v12, v13
    s_nop 1
    v_max_f32 v12, v12, v13
    v_max_f32 v12, s50, v12
    s_mov_b32 s66, 0xff61b1e6
    v_cmp_ge_f32 vcc, s66, v12
    s_nop 1
    v_cndmask_b32 v12, v12, 0, vcc
    v_add_f32 v5, v5, v12
    v_mul_f32 v14, s51, v12
    v_sub_f32 v80, v80, v12
    v_sub_f32 v81, v81, v12
    v_sub_f32 v82, v82, v12
    v_sub_f32 v83, v83, v12
    v_sub_f32 v84, v84, v12
    v_sub_f32 v85, v85, v12
    v_sub_f32 v86, v86, v12
    v_sub_f32 v87, v87, v12
    v_sub_f32 v88, v88, v12
    v_sub_f32 v89, v89, v12
    v_sub_f32 v90, v90, v12
    v_sub_f32 v91, v91, v12
    v_sub_f32 v92, v92, v12
    v_sub_f32 v93, v93, v12
    v_sub_f32 v94, v94, v12
    v_sub_f32 v95, v95, v12
    v_sub_f32 v32, v32, v14
    v_sub_f32 v33, v33, v14
    v_sub_f32 v34, v34, v14
    v_sub_f32 v35, v35, v14
    v_sub_f32 v36, v36, v14
    v_sub_f32 v37, v37, v14
    v_sub_f32 v38, v38, v14
    v_sub_f32 v39, v39, v14
    v_sub_f32 v40, v40, v14
    v_sub_f32 v41, v41, v14
    v_sub_f32 v42, v42, v14
    v_sub_f32 v43, v43, v14
    v_sub_f32 v44, v44, v14
    v_sub_f32 v45, v45, v14
    v_sub_f32 v46, v46, v14
    v_sub_f32 v47, v47, v14
    v_sub_f32 v48, v48, v14
    v_sub_f32 v49, v49, v14
    v_sub_f32 v50, v50, v14
    v_sub_f32 v51, v51, v14
    v_sub_f32 v52, v52, v14
    v_sub_f32 v53, v53, v14
    v_sub_f32 v54, v54, v14
    v_sub_f32 v55, v55, v14
    v_sub_f32 v56, v56, v14
    v_sub_f32 v57, v57, v14
    v_sub_f32 v58, v58, v14
    v_sub_f32 v59, v59, v14
    v_sub_f32 v60, v60, v14
    v_sub_f32 v61, v61, v14
    v_sub_f32 v62, v62, v14
    v_sub_f32 v63, v63, v14
    v_sub_f32 v16, v16, v14
    v_sub_f32 v17, v17, v14
    v_sub_f32 v18, v18, v14
    v_sub_f32 v19, v19, v14
    v_sub_f32 v20, v20, v14
    v_sub_f32 v21, v21, v14
    v_sub_f32 v22, v22, v14
    v_sub_f32 v23, v23, v14
    v_sub_f32 v24, v24, v14
    v_sub_f32 v25, v25, v14
    v_sub_f32 v26, v26, v14
    v_sub_f32 v27, v27, v14
    v_sub_f32 v28, v28, v14
    v_sub_f32 v29, v29, v14
    v_sub_f32 v30, v30, v14
    v_sub_f32 v31, v31, v14
    s_cmp_lg_u64 s[48:49], 0
    s_cbranch_scc1 slow_p1_s1_norescale
    v_exp_f32 v13, -v12
    s_nop 0
    v_mul_f32 v6, v6, v13
    v_accvgpr_read_b32 v192, a0
    v_accvgpr_read_b32 v193, a1
    v_accvgpr_read_b32 v194, a2
    v_accvgpr_read_b32 v195, a3
    v_accvgpr_read_b32 v196, a4
    v_accvgpr_read_b32 v197, a5
    v_accvgpr_read_b32 v198, a6
    v_accvgpr_read_b32 v199, a7
    v_mul_f32 v192, v192, v13
    v_mul_f32 v193, v193, v13
    v_mul_f32 v194, v194, v13
    v_mul_f32 v195, v195, v13
    v_mul_f32 v196, v196, v13
    v_mul_f32 v197, v197, v13
    v_mul_f32 v198, v198, v13
    v_mul_f32 v199, v199, v13
    v_accvgpr_write_b32 a0, v192
    v_accvgpr_write_b32 a1, v193
    v_accvgpr_write_b32 a2, v194
    v_accvgpr_write_b32 a3, v195
    v_accvgpr_write_b32 a4, v196
    v_accvgpr_write_b32 a5, v197
    v_accvgpr_write_b32 a6, v198
    v_accvgpr_write_b32 a7, v199
    v_accvgpr_read_b32 v192, a8
    v_accvgpr_read_b32 v193, a9
    v_accvgpr_read_b32 v194, a10
    v_accvgpr_read_b32 v195, a11
    v_accvgpr_read_b32 v196, a12
    v_accvgpr_read_b32 v197, a13
    v_accvgpr_read_b32 v198, a14
    v_accvgpr_read_b32 v199, a15
    v_mul_f32 v192, v192, v13
    v_mul_f32 v193, v193, v13
    v_mul_f32 v194, v194, v13
    v_mul_f32 v195, v195, v13
    v_mul_f32 v196, v196, v13
    v_mul_f32 v197, v197, v13
    v_mul_f32 v198, v198, v13
    v_mul_f32 v199, v199, v13
    v_accvgpr_write_b32 a8, v192
    v_accvgpr_write_b32 a9, v193
    v_accvgpr_write_b32 a10, v194
    v_accvgpr_write_b32 a11, v195
    v_accvgpr_write_b32 a12, v196
    v_accvgpr_write_b32 a13, v197
    v_accvgpr_write_b32 a14, v198
    v_accvgpr_write_b32 a15, v199
    v_accvgpr_read_b32 v192, a16
    v_accvgpr_read_b32 v193, a17
    v_accvgpr_read_b32 v194, a18
    v_accvgpr_read_b32 v195, a19
    v_accvgpr_read_b32 v196, a20
    v_accvgpr_read_b32 v197, a21
    v_accvgpr_read_b32 v198, a22
    v_accvgpr_read_b32 v199, a23
    v_mul_f32 v192, v192, v13
    v_mul_f32 v193, v193, v13
    v_mul_f32 v194, v194, v13
    v_mul_f32 v195, v195, v13
    v_mul_f32 v196, v196, v13
    v_mul_f32 v197, v197, v13
    v_mul_f32 v198, v198, v13
    v_mul_f32 v199, v199, v13
    v_accvgpr_write_b32 a16, v192
    v_accvgpr_write_b32 a17, v193
    v_accvgpr_write_b32 a18, v194
    v_accvgpr_write_b32 a19, v195
    v_accvgpr_write_b32 a20, v196
    v_accvgpr_write_b32 a21, v197
    v_accvgpr_write_b32 a22, v198
    v_accvgpr_write_b32 a23, v199
    v_accvgpr_read_b32 v192, a24
    v_accvgpr_read_b32 v193, a25
    v_accvgpr_read_b32 v194, a26
    v_accvgpr_read_b32 v195, a27
    v_accvgpr_read_b32 v196, a28
    v_accvgpr_read_b32 v197, a29
    v_accvgpr_read_b32 v198, a30
    v_accvgpr_read_b32 v199, a31
    v_mul_f32 v192, v192, v13
    v_mul_f32 v193, v193, v13
    v_mul_f32 v194, v194, v13
    v_mul_f32 v195, v195, v13
    v_mul_f32 v196, v196, v13
    v_mul_f32 v197, v197, v13
    v_mul_f32 v198, v198, v13
    v_mul_f32 v199, v199, v13
    v_accvgpr_write_b32 a24, v192
    v_accvgpr_write_b32 a25, v193
    v_accvgpr_write_b32 a26, v194
    v_accvgpr_write_b32 a27, v195
    v_accvgpr_write_b32 a28, v196
    v_accvgpr_write_b32 a29, v197
    v_accvgpr_write_b32 a30, v198
    v_accvgpr_write_b32 a31, v199
    v_accvgpr_read_b32 v192, a32
    v_accvgpr_read_b32 v193, a33
    v_accvgpr_read_b32 v194, a34
    v_accvgpr_read_b32 v195, a35
    v_accvgpr_read_b32 v196, a36
    v_accvgpr_read_b32 v197, a37
    v_accvgpr_read_b32 v198, a38
    v_accvgpr_read_b32 v199, a39
    v_mul_f32 v192, v192, v13
    v_mul_f32 v193, v193, v13
    v_mul_f32 v194, v194, v13
    v_mul_f32 v195, v195, v13
    v_mul_f32 v196, v196, v13
    v_mul_f32 v197, v197, v13
    v_mul_f32 v198, v198, v13
    v_mul_f32 v199, v199, v13
    v_accvgpr_write_b32 a32, v192
    v_accvgpr_write_b32 a33, v193
    v_accvgpr_write_b32 a34, v194
    v_accvgpr_write_b32 a35, v195
    v_accvgpr_write_b32 a36, v196
    v_accvgpr_write_b32 a37, v197
    v_accvgpr_write_b32 a38, v198
    v_accvgpr_write_b32 a39, v199
    v_accvgpr_read_b32 v192, a40
    v_accvgpr_read_b32 v193, a41
    v_accvgpr_read_b32 v194, a42
    v_accvgpr_read_b32 v195, a43
    v_accvgpr_read_b32 v196, a44
    v_accvgpr_read_b32 v197, a45
    v_accvgpr_read_b32 v198, a46
    v_accvgpr_read_b32 v199, a47
    v_mul_f32 v192, v192, v13
    v_mul_f32 v193, v193, v13
    v_mul_f32 v194, v194, v13
    v_mul_f32 v195, v195, v13
    v_mul_f32 v196, v196, v13
    v_mul_f32 v197, v197, v13
    v_mul_f32 v198, v198, v13
    v_mul_f32 v199, v199, v13
    v_accvgpr_write_b32 a40, v192
    v_accvgpr_write_b32 a41, v193
    v_accvgpr_write_b32 a42, v194
    v_accvgpr_write_b32 a43, v195
    v_accvgpr_write_b32 a44, v196
    v_accvgpr_write_b32 a45, v197
    v_accvgpr_write_b32 a46, v198
    v_accvgpr_write_b32 a47, v199
    v_accvgpr_read_b32 v192, a48
    v_accvgpr_read_b32 v193, a49
    v_accvgpr_read_b32 v194, a50
    v_accvgpr_read_b32 v195, a51
    v_accvgpr_read_b32 v196, a52
    v_accvgpr_read_b32 v197, a53
    v_accvgpr_read_b32 v198, a54
    v_accvgpr_read_b32 v199, a55
    v_mul_f32 v192, v192, v13
    v_mul_f32 v193, v193, v13
    v_mul_f32 v194, v194, v13
    v_mul_f32 v195, v195, v13
    v_mul_f32 v196, v196, v13
    v_mul_f32 v197, v197, v13
    v_mul_f32 v198, v198, v13
    v_mul_f32 v199, v199, v13
    v_accvgpr_write_b32 a48, v192
    v_accvgpr_write_b32 a49, v193
    v_accvgpr_write_b32 a50, v194
    v_accvgpr_write_b32 a51, v195
    v_accvgpr_write_b32 a52, v196
    v_accvgpr_write_b32 a53, v197
    v_accvgpr_write_b32 a54, v198
    v_accvgpr_write_b32 a55, v199
    v_accvgpr_read_b32 v192, a56
    v_accvgpr_read_b32 v193, a57
    v_accvgpr_read_b32 v194, a58
    v_accvgpr_read_b32 v195, a59
    v_accvgpr_read_b32 v196, a60
    v_accvgpr_read_b32 v197, a61
    v_accvgpr_read_b32 v198, a62
    v_accvgpr_read_b32 v199, a63
    v_mul_f32 v192, v192, v13
    v_mul_f32 v193, v193, v13
    v_mul_f32 v194, v194, v13
    v_mul_f32 v195, v195, v13
    v_mul_f32 v196, v196, v13
    v_mul_f32 v197, v197, v13
    v_mul_f32 v198, v198, v13
    v_mul_f32 v199, v199, v13
    v_accvgpr_write_b32 a56, v192
    v_accvgpr_write_b32 a57, v193
    v_accvgpr_write_b32 a58, v194
    v_accvgpr_write_b32 a59, v195
    v_accvgpr_write_b32 a60, v196
    v_accvgpr_write_b32 a61, v197
    v_accvgpr_write_b32 a62, v198
    v_accvgpr_write_b32 a63, v199
    v_accvgpr_read_b32 v192, a64
    v_accvgpr_read_b32 v193, a65
    v_accvgpr_read_b32 v194, a66
    v_accvgpr_read_b32 v195, a67
    v_accvgpr_read_b32 v196, a68
    v_accvgpr_read_b32 v197, a69
    v_accvgpr_read_b32 v198, a70
    v_accvgpr_read_b32 v199, a71
    v_mul_f32 v192, v192, v13
    v_mul_f32 v193, v193, v13
    v_mul_f32 v194, v194, v13
    v_mul_f32 v195, v195, v13
    v_mul_f32 v196, v196, v13
    v_mul_f32 v197, v197, v13
    v_mul_f32 v198, v198, v13
    v_mul_f32 v199, v199, v13
    v_accvgpr_write_b32 a64, v192
    v_accvgpr_write_b32 a65, v193
    v_accvgpr_write_b32 a66, v194
    v_accvgpr_write_b32 a67, v195
    v_accvgpr_write_b32 a68, v196
    v_accvgpr_write_b32 a69, v197
    v_accvgpr_write_b32 a70, v198
    v_accvgpr_write_b32 a71, v199
    v_accvgpr_read_b32 v192, a72
    v_accvgpr_read_b32 v193, a73
    v_accvgpr_read_b32 v194, a74
    v_accvgpr_read_b32 v195, a75
    v_accvgpr_read_b32 v196, a76
    v_accvgpr_read_b32 v197, a77
    v_accvgpr_read_b32 v198, a78
    v_accvgpr_read_b32 v199, a79
    v_mul_f32 v192, v192, v13
    v_mul_f32 v193, v193, v13
    v_mul_f32 v194, v194, v13
    v_mul_f32 v195, v195, v13
    v_mul_f32 v196, v196, v13
    v_mul_f32 v197, v197, v13
    v_mul_f32 v198, v198, v13
    v_mul_f32 v199, v199, v13
    v_accvgpr_write_b32 a72, v192
    v_accvgpr_write_b32 a73, v193
    v_accvgpr_write_b32 a74, v194
    v_accvgpr_write_b32 a75, v195
    v_accvgpr_write_b32 a76, v196
    v_accvgpr_write_b32 a77, v197
    v_accvgpr_write_b32 a78, v198
    v_accvgpr_write_b32 a79, v199
    v_accvgpr_read_b32 v192, a80
    v_accvgpr_read_b32 v193, a81
    v_accvgpr_read_b32 v194, a82
    v_accvgpr_read_b32 v195, a83
    v_accvgpr_read_b32 v196, a84
    v_accvgpr_read_b32 v197, a85
    v_accvgpr_read_b32 v198, a86
    v_accvgpr_read_b32 v199, a87
    v_mul_f32 v192, v192, v13
    v_mul_f32 v193, v193, v13
    v_mul_f32 v194, v194, v13
    v_mul_f32 v195, v195, v13
    v_mul_f32 v196, v196, v13
    v_mul_f32 v197, v197, v13
    v_mul_f32 v198, v198, v13
    v_mul_f32 v199, v199, v13
    v_accvgpr_write_b32 a80, v192
    v_accvgpr_write_b32 a81, v193
    v_accvgpr_write_b32 a82, v194
    v_accvgpr_write_b32 a83, v195
    v_accvgpr_write_b32 a84, v196
    v_accvgpr_write_b32 a85, v197
    v_accvgpr_write_b32 a86, v198
    v_accvgpr_write_b32 a87, v199
    v_accvgpr_read_b32 v192, a88
    v_accvgpr_read_b32 v193, a89
    v_accvgpr_read_b32 v194, a90
    v_accvgpr_read_b32 v195, a91
    v_accvgpr_read_b32 v196, a92
    v_accvgpr_read_b32 v197, a93
    v_accvgpr_read_b32 v198, a94
    v_accvgpr_read_b32 v199, a95
    v_mul_f32 v192, v192, v13
    v_mul_f32 v193, v193, v13
    v_mul_f32 v194, v194, v13
    v_mul_f32 v195, v195, v13
    v_mul_f32 v196, v196, v13
    v_mul_f32 v197, v197, v13
    v_mul_f32 v198, v198, v13
    v_mul_f32 v199, v199, v13
    v_accvgpr_write_b32 a88, v192
    v_accvgpr_write_b32 a89, v193
    v_accvgpr_write_b32 a90, v194
    v_accvgpr_write_b32 a91, v195
    v_accvgpr_write_b32 a92, v196
    v_accvgpr_write_b32 a93, v197
    v_accvgpr_write_b32 a94, v198
    v_accvgpr_write_b32 a95, v199
    v_accvgpr_read_b32 v192, a96
    v_accvgpr_read_b32 v193, a97
    v_accvgpr_read_b32 v194, a98
    v_accvgpr_read_b32 v195, a99
    v_accvgpr_read_b32 v196, a100
    v_accvgpr_read_b32 v197, a101
    v_accvgpr_read_b32 v198, a102
    v_accvgpr_read_b32 v199, a103
    v_mul_f32 v192, v192, v13
    v_mul_f32 v193, v193, v13
    v_mul_f32 v194, v194, v13
    v_mul_f32 v195, v195, v13
    v_mul_f32 v196, v196, v13
    v_mul_f32 v197, v197, v13
    v_mul_f32 v198, v198, v13
    v_mul_f32 v199, v199, v13
    v_accvgpr_write_b32 a96, v192
    v_accvgpr_write_b32 a97, v193
    v_accvgpr_write_b32 a98, v194
    v_accvgpr_write_b32 a99, v195
    v_accvgpr_write_b32 a100, v196
    v_accvgpr_write_b32 a101, v197
    v_accvgpr_write_b32 a102, v198
    v_accvgpr_write_b32 a103, v199
    v_accvgpr_read_b32 v192, a104
    v_accvgpr_read_b32 v193, a105
    v_accvgpr_read_b32 v194, a106
    v_accvgpr_read_b32 v195, a107
    v_accvgpr_read_b32 v196, a108
    v_accvgpr_read_b32 v197, a109
    v_accvgpr_read_b32 v198, a110
    v_accvgpr_read_b32 v199, a111
    v_mul_f32 v192, v192, v13
    v_mul_f32 v193, v193, v13
    v_mul_f32 v194, v194, v13
    v_mul_f32 v195, v195, v13
    v_mul_f32 v196, v196, v13
    v_mul_f32 v197, v197, v13
    v_mul_f32 v198, v198, v13
    v_mul_f32 v199, v199, v13
    v_accvgpr_write_b32 a104, v192
    v_accvgpr_write_b32 a105, v193
    v_accvgpr_write_b32 a106, v194
    v_accvgpr_write_b32 a107, v195
    v_accvgpr_write_b32 a108, v196
    v_accvgpr_write_b32 a109, v197
    v_accvgpr_write_b32 a110, v198
    v_accvgpr_write_b32 a111, v199
    v_accvgpr_read_b32 v192, a112
    v_accvgpr_read_b32 v193, a113
    v_accvgpr_read_b32 v194, a114
    v_accvgpr_read_b32 v195, a115
    v_accvgpr_read_b32 v196, a116
    v_accvgpr_read_b32 v197, a117
    v_accvgpr_read_b32 v198, a118
    v_accvgpr_read_b32 v199, a119
    v_mul_f32 v192, v192, v13
    v_mul_f32 v193, v193, v13
    v_mul_f32 v194, v194, v13
    v_mul_f32 v195, v195, v13
    v_mul_f32 v196, v196, v13
    v_mul_f32 v197, v197, v13
    v_mul_f32 v198, v198, v13
    v_mul_f32 v199, v199, v13
    v_accvgpr_write_b32 a112, v192
    v_accvgpr_write_b32 a113, v193
    v_accvgpr_write_b32 a114, v194
    v_accvgpr_write_b32 a115, v195
    v_accvgpr_write_b32 a116, v196
    v_accvgpr_write_b32 a117, v197
    v_accvgpr_write_b32 a118, v198
    v_accvgpr_write_b32 a119, v199
    v_accvgpr_read_b32 v192, a120
    v_accvgpr_read_b32 v193, a121
    v_accvgpr_read_b32 v194, a122
    v_accvgpr_read_b32 v195, a123
    v_accvgpr_read_b32 v196, a124
    v_accvgpr_read_b32 v197, a125
    v_accvgpr_read_b32 v198, a126
    v_accvgpr_read_b32 v199, a127
    v_mul_f32 v192, v192, v13
    v_mul_f32 v193, v193, v13
    v_mul_f32 v194, v194, v13
    v_mul_f32 v195, v195, v13
    v_mul_f32 v196, v196, v13
    v_mul_f32 v197, v197, v13
    v_mul_f32 v198, v198, v13
    v_mul_f32 v199, v199, v13
    v_accvgpr_write_b32 a120, v192
    v_accvgpr_write_b32 a121, v193
    v_accvgpr_write_b32 a122, v194
    v_accvgpr_write_b32 a123, v195
    v_accvgpr_write_b32 a124, v196
    v_accvgpr_write_b32 a125, v197
    v_accvgpr_write_b32 a126, v198
    v_accvgpr_write_b32 a127, v199
slow_p1_s1_norescale:
    s_mov_b64 s[48:49], 0
    s_mov_b32 s50, 0
    v_exp_f32 v112, v80
    v_exp_f32 v113, v81
    v_exp_f32 v114, v82
    v_exp_f32 v115, v83
    v_add_f32 v7, v112, v113
    v_cvt_pk_bf16_f32 v104, v112, v113
    v_exp_f32 v116, v84
    v_add_f32 v8, v114, v115
    v_cvt_pk_bf16_f32 v105, v114, v115
    v_exp_f32 v117, v85
    v_exp_f32 v118, v86
    v_add_f32 v7, v7, v116
    v_exp_f32 v119, v87
    v_add_f32 v7, v7, v117
    v_cvt_pk_bf16_f32 v106, v116, v117
    v_exp_f32 v120, v88
    v_add_f32 v8, v8, v118
    v_exp_f32 v121, v89
    v_add_f32 v8, v8, v119
    v_cvt_pk_bf16_f32 v107, v118, v119
    v_exp_f32 v122, v90
    v_add_f32 v7, v7, v120
    v_exp_f32 v123, v91
    v_add_f32 v7, v7, v121
    v_cvt_pk_bf16_f32 v108, v120, v121
    v_exp_f32 v124, v92
    v_add_f32 v8, v8, v122
    v_exp_f32 v125, v93
    v_add_f32 v8, v8, v123
    v_cvt_pk_bf16_f32 v109, v122, v123
    v_exp_f32 v126, v94
    v_add_f32 v7, v7, v124
    v_exp_f32 v127, v95
    v_add_f32 v7, v7, v125
    v_cvt_pk_bf16_f32 v110, v124, v125
    v_add_f32 v8, v8, v126
    v_add_f32 v8, v8, v127
    v_cvt_pk_bf16_f32 v111, v126, v127
    v_add_f32 v7, v7, v8
    s_nop 1
    s_setpc_b64 s[56:57]
k2_segend:
    s_nop 15
    s_nop 3
    v_mov_b32 v12, v6
    v_mov_b32 v13, v6
    s_nop 1
    v_permlane32_swap_b32 v12, v13
    s_nop 1
    v_add_f32 v12, v12, v13
    v_log_f32 v13, v12
    v_cmp_eq_f32 vcc, 0, v12
    v_rcp_f32 v12, v12
    v_add_f32 v13, v13, v5
    v_cndmask_b32 v12, v12, 0, vcc
    s_lshl_b32 s66, s79, 2
    s_add_u32 s66, s66, s77
    s_and_b32 s67, s66, 1
    s_lshl_b32 s67, s67, 10
    s_lshr_b32 s66, s66, 1
    s_lshl_b32 s66, s66, 19
    s_add_u32 s66, s66, s67
    s_cmp_eq_u32 s44, 2
    s_cbranch_scc1 k2_merge
    s_cmp_eq_u32 s44, 1
    s_cbranch_scc1 k2_partial
    v_accvgpr_read_b32 v192, a0
    v_accvgpr_read_b32 v193, a1
    v_accvgpr_read_b32 v194, a2
    v_accvgpr_read_b32 v195, a3
    v_accvgpr_read_b32 v196, a4
    v_accvgpr_read_b32 v197, a5
    v_accvgpr_read_b32 v198, a6
    v_accvgpr_read_b32 v199, a7
    v_mul_f32 v192, v192, v12
    v_mul_f32 v193, v193, v12
    v_mul_f32 v194, v194, v12
    v_mul_f32 v195, v195, v12
    v_mul_f32 v196, v196, v12
    v_mul_f32 v197, v197, v12
    v_mul_f32 v198, v198, v12
    v_mul_f32 v199, v199, v12
    v_cvt_pk_bf16_f32 v208, v192, v193
    v_cvt_pk_bf16_f32 v209, v194, v195
    v_cvt_pk_bf16_f32 v210, v196, v197
    v_cvt_pk_bf16_f32 v211, v198, v199
    buffer_store_dwordx4 v[208:211], v1, s[20:23], s66 offen offset:0 sc1
    v_accvgpr_read_b32 v200, a8
    v_accvgpr_read_b32 v201, a9
    v_accvgpr_read_b32 v202, a10
    v_accvgpr_read_b32 v203, a11
    v_accvgpr_read_b32 v204, a12
    v_accvgpr_read_b32 v205, a13
    v_accvgpr_read_b32 v206, a14
    v_accvgpr_read_b32 v207, a15
    v_mul_f32 v200, v200, v12
    v_mul_f32 v201, v201, v12
    v_mul_f32 v202, v202, v12
    v_mul_f32 v203, v203, v12
    v_mul_f32 v204, v204, v12
    v_mul_f32 v205, v205, v12
    v_mul_f32 v206, v206, v12
    v_mul_f32 v207, v207, v12
    v_cvt_pk_bf16_f32 v212, v200, v201
    v_cvt_pk_bf16_f32 v213, v202, v203
    v_cvt_pk_bf16_f32 v214, v204, v205
    v_cvt_pk_bf16_f32 v215, v206, v207
    buffer_store_dwordx4 v[212:215], v1, s[20:23], s66 offen offset:2048 sc1
    v_accvgpr_read_b32 v192, a16
    v_accvgpr_read_b32 v193, a17
    v_accvgpr_read_b32 v194, a18
    v_accvgpr_read_b32 v195, a19
    v_accvgpr_read_b32 v196, a20
    v_accvgpr_read_b32 v197, a21
    v_accvgpr_read_b32 v198, a22
    v_accvgpr_read_b32 v199, a23
    v_mul_f32 v192, v192, v12
    v_mul_f32 v193, v193, v12
    v_mul_f32 v194, v194, v12
    v_mul_f32 v195, v195, v12
    v_mul_f32 v196, v196, v12
    v_mul_f32 v197, v197, v12
    v_mul_f32 v198, v198, v12
    v_mul_f32 v199, v199, v12
    v_cvt_pk_bf16_f32 v216, v192, v193
    v_cvt_pk_bf16_f32 v217, v194, v195
    v_cvt_pk_bf16_f32 v218, v196, v197
    v_cvt_pk_bf16_f32 v219, v198, v199
    s_add_u32 s66, s66, 4096
    buffer_store_dwordx4 v[216:219], v1, s[20:23], s66 offen offset:0 sc1
    v_accvgpr_read_b32 v200, a24
    v_accvgpr_read_b32 v201, a25
    v_accvgpr_read_b32 v202, a26
    v_accvgpr_read_b32 v203, a27
    v_accvgpr_read_b32 v204, a28
    v_accvgpr_read_b32 v205, a29
    v_accvgpr_read_b32 v206, a30
    v_accvgpr_read_b32 v207, a31
    v_mul_f32 v200, v200, v12
    v_mul_f32 v201, v201, v12
    v_mul_f32 v202, v202, v12
    v_mul_f32 v203, v203, v12
    v_mul_f32 v204, v204, v12
    v_mul_f32 v205, v205, v12
    v_mul_f32 v206, v206, v12
    v_mul_f32 v207, v207, v12
    v_cvt_pk_bf16_f32 v220, v200, v201
    v_cvt_pk_bf16_f32 v221, v202, v203
    v_cvt_pk_bf16_f32 v222, v204, v205
    v_cvt_pk_bf16_f32 v223, v206, v207
    buffer_store_dwordx4 v[220:223], v1, s[20:23], s66 offen offset:2048 sc1
    v_accvgpr_read_b32 v192, a32
    v_accvgpr_read_b32 v193, a33
    v_accvgpr_read_b32 v194, a34
    v_accvgpr_read_b32 v195, a35
    v_accvgpr_read_b32 v196, a36
    v_accvgpr_read_b32 v197, a37
    v_accvgpr_read_b32 v198, a38
    v_accvgpr_read_b32 v199, a39
    v_mul_f32 v192, v192, v12
    v_mul_f32 v193, v193, v12
    v_mul_f32 v194, v194, v12
    v_mul_f32 v195, v195, v12
    v_mul_f32 v196, v196, v12
    v_mul_f32 v197, v197, v12
    v_mul_f32 v198, v198, v12
    v_mul_f32 v199, v199, v12
    v_cvt_pk_bf16_f32 v208, v192, v193
    v_cvt_pk_bf16_f32 v209, v194, v195
    v_cvt_pk_bf16_f32 v210, v196, v197
    v_cvt_pk_bf16_f32 v211, v198, v199
    s_add_u32 s66, s66, 4096
    buffer_store_dwordx4 v[208:211], v1, s[20:23], s66 offen offset:0 sc1
    v_accvgpr_read_b32 v200, a40
    v_accvgpr_read_b32 v201, a41
    v_accvgpr_read_b32 v202, a42
    v_accvgpr_read_b32 v203, a43
    v_accvgpr_read_b32 v204, a44
    v_accvgpr_read_b32 v205, a45
    v_accvgpr_read_b32 v206, a46
    v_accvgpr_read_b32 v207, a47
    v_mul_f32 v200, v200, v12
    v_mul_f32 v201, v201, v12
    v_mul_f32 v202, v202, v12
    v_mul_f32 v203, v203, v12
    v_mul_f32 v204, v204, v12
    v_mul_f32 v205, v205, v12
    v_mul_f32 v206, v206, v12
    v_mul_f32 v207, v207, v12
    v_cvt_pk_bf16_f32 v212, v200, v201
    v_cvt_pk_bf16_f32 v213, v202, v203
    v_cvt_pk_bf16_f32 v214, v204, v205
    v_cvt_pk_bf16_f32 v215, v206, v207
    buffer_store_dwordx4 v[212:215], v1, s[20:23], s66 offen offset:2048 sc1
    v_accvgpr_read_b32 v192, a48
    v_accvgpr_read_b32 v193, a49
    v_accvgpr_read_b32 v194, a50
    v_accvgpr_read_b32 v195, a51
    v_accvgpr_read_b32 v196, a52
    v_accvgpr_read_b32 v197, a53
    v_accvgpr_read_b32 v198, a54
    v_accvgpr_read_b32 v199, a55
    v_mul_f32 v192, v192, v12
    v_mul_f32 v193, v193, v12
    v_mul_f32 v194, v194, v12
    v_mul_f32 v195, v195, v12
    v_mul_f32 v196, v196, v12
    v_mul_f32 v197, v197, v12
    v_mul_f32 v198, v198, v12
    v_mul_f32 v199, v199, v12
    v_cvt_pk_bf16_f32 v216, v192, v193
    v_cvt_pk_bf16_f32 v217, v194, v195
    v_cvt_pk_bf16_f32 v218, v196, v197
    v_cvt_pk_bf16_f32 v219, v198, v199
    s_add_u32 s66, s66, 4096
    buffer_store_dwordx4 v[216:219], v1, s[20:23], s66 offen offset:0 sc1
    v_accvgpr_read_b32 v200, a56
    v_accvgpr_read_b32 v201, a57
    v_accvgpr_read_b32 v202, a58
    v_accvgpr_read_b32 v203, a59
    v_accvgpr_read_b32 v204, a60
    v_accvgpr_read_b32 v205, a61
    v_accvgpr_read_b32 v206, a62
    v_accvgpr_read_b32 v207, a63
    v_mul_f32 v200, v200, v12
    v_mul_f32 v201, v201, v12
    v_mul_f32 v202, v202, v12
    v_mul_f32 v203, v203, v12
    v_mul_f32 v204, v204, v12
    v_mul_f32 v205, v205, v12
    v_mul_f32 v206, v206, v12
    v_mul_f32 v207, v207, v12
    v_cvt_pk_bf16_f32 v220, v200, v201
    v_cvt_pk_bf16_f32 v221, v202, v203
    v_cvt_pk_bf16_f32 v222, v204, v205
    v_cvt_pk_bf16_f32 v223, v206, v207
    buffer_store_dwordx4 v[220:223], v1, s[20:23], s66 offen offset:2048 sc1
    v_accvgpr_read_b32 v192, a64
    v_accvgpr_read_b32 v193, a65
    v_accvgpr_read_b32 v194, a66
    v_accvgpr_read_b32 v195, a67
    v_accvgpr_read_b32 v196, a68
    v_accvgpr_read_b32 v197, a69
    v_accvgpr_read_b32 v198, a70
    v_accvgpr_read_b32 v199, a71
    v_mul_f32 v192, v192, v12
    v_mul_f32 v193, v193, v12
    v_mul_f32 v194, v194, v12
    v_mul_f32 v195, v195, v12
    v_mul_f32 v196, v196, v12
    v_mul_f32 v197, v197, v12
    v_mul_f32 v198, v198, v12
    v_mul_f32 v199, v199, v12
    v_cvt_pk_bf16_f32 v208, v192, v193
    v_cvt_pk_bf16_f32 v209, v194, v195
    v_cvt_pk_bf16_f32 v210, v196, v197
    v_cvt_pk_bf16_f32 v211, v198, v199
    s_add_u32 s66, s66, 4096
    buffer_store_dwordx4 v[208:211], v1, s[20:23], s66 offen offset:0 sc1
    v_accvgpr_read_b32 v200, a72
    v_accvgpr_read_b32 v201, a73
    v_accvgpr_read_b32 v202, a74
    v_accvgpr_read_b32 v203, a75
    v_accvgpr_read_b32 v204, a76
    v_accvgpr_read_b32 v205, a77
    v_accvgpr_read_b32 v206, a78
    v_accvgpr_read_b32 v207, a79
    v_mul_f32 v200, v200, v12
    v_mul_f32 v201, v201, v12
    v_mul_f32 v202, v202, v12
    v_mul_f32 v203, v203, v12
    v_mul_f32 v204, v204, v12
    v_mul_f32 v205, v205, v12
    v_mul_f32 v206, v206, v12
    v_mul_f32 v207, v207, v12
    v_cvt_pk_bf16_f32 v212, v200, v201
    v_cvt_pk_bf16_f32 v213, v202, v203
    v_cvt_pk_bf16_f32 v214, v204, v205
    v_cvt_pk_bf16_f32 v215, v206, v207
    buffer_store_dwordx4 v[212:215], v1, s[20:23], s66 offen offset:2048 sc1
    v_accvgpr_read_b32 v192, a80
    v_accvgpr_read_b32 v193, a81
    v_accvgpr_read_b32 v194, a82
    v_accvgpr_read_b32 v195, a83
    v_accvgpr_read_b32 v196, a84
    v_accvgpr_read_b32 v197, a85
    v_accvgpr_read_b32 v198, a86
    v_accvgpr_read_b32 v199, a87
    v_mul_f32 v192, v192, v12
    v_mul_f32 v193, v193, v12
    v_mul_f32 v194, v194, v12
    v_mul_f32 v195, v195, v12
    v_mul_f32 v196, v196, v12
    v_mul_f32 v197, v197, v12
    v_mul_f32 v198, v198, v12
    v_mul_f32 v199, v199, v12
    v_cvt_pk_bf16_f32 v216, v192, v193
    v_cvt_pk_bf16_f32 v217, v194, v195
    v_cvt_pk_bf16_f32 v218, v196, v197
    v_cvt_pk_bf16_f32 v219, v198, v199
    s_add_u32 s66, s66, 4096
    buffer_store_dwordx4 v[216:219], v1, s[20:23], s66 offen offset:0 sc1
    v_accvgpr_read_b32 v200, a88
    v_accvgpr_read_b32 v201, a89
    v_accvgpr_read_b32 v202, a90
    v_accvgpr_read_b32 v203, a91
    v_accvgpr_read_b32 v204, a92
    v_accvgpr_read_b32 v205, a93
    v_accvgpr_read_b32 v206, a94
    v_accvgpr_read_b32 v207, a95
    v_mul_f32 v200, v200, v12
    v_mul_f32 v201, v201, v12
    v_mul_f32 v202, v202, v12
    v_mul_f32 v203, v203, v12
    v_mul_f32 v204, v204, v12
    v_mul_f32 v205, v205, v12
    v_mul_f32 v206, v206, v12
    v_mul_f32 v207, v207, v12
    v_cvt_pk_bf16_f32 v220, v200, v201
    v_cvt_pk_bf16_f32 v221, v202, v203
    v_cvt_pk_bf16_f32 v222, v204, v205
    v_cvt_pk_bf16_f32 v223, v206, v207
    buffer_store_dwordx4 v[220:223], v1, s[20:23], s66 offen offset:2048 sc1
    v_accvgpr_read_b32 v192, a96
    v_accvgpr_read_b32 v193, a97
    v_accvgpr_read_b32 v194, a98
    v_accvgpr_read_b32 v195, a99
    v_accvgpr_read_b32 v196, a100
    v_accvgpr_read_b32 v197, a101
    v_accvgpr_read_b32 v198, a102
    v_accvgpr_read_b32 v199, a103
    v_mul_f32 v192, v192, v12
    v_mul_f32 v193, v193, v12
    v_mul_f32 v194, v194, v12
    v_mul_f32 v195, v195, v12
    v_mul_f32 v196, v196, v12
    v_mul_f32 v197, v197, v12
    v_mul_f32 v198, v198, v12
    v_mul_f32 v199, v199, v12
    v_cvt_pk_bf16_f32 v208, v192, v193
    v_cvt_pk_bf16_f32 v209, v194, v195
    v_cvt_pk_bf16_f32 v210, v196, v197
    v_cvt_pk_bf16_f32 v211, v198, v199
    s_add_u32 s66, s66, 4096
    buffer_store_dwordx4 v[208:211], v1, s[20:23], s66 offen offset:0 sc1
    v_accvgpr_read_b32 v200, a104
    v_accvgpr_read_b32 v201, a105
    v_accvgpr_read_b32 v202, a106
    v_accvgpr_read_b32 v203, a107
    v_accvgpr_read_b32 v204, a108
    v_accvgpr_read_b32 v205, a109
    v_accvgpr_read_b32 v206, a110
    v_accvgpr_read_b32 v207, a111
    v_mul_f32 v200, v200, v12
    v_mul_f32 v201, v201, v12
    v_mul_f32 v202, v202, v12
    v_mul_f32 v203, v203, v12
    v_mul_f32 v204, v204, v12
    v_mul_f32 v205, v205, v12
    v_mul_f32 v206, v206, v12
    v_mul_f32 v207, v207, v12
    v_cvt_pk_bf16_f32 v212, v200, v201
    v_cvt_pk_bf16_f32 v213, v202, v203
    v_cvt_pk_bf16_f32 v214, v204, v205
    v_cvt_pk_bf16_f32 v215, v206, v207
    buffer_store_dwordx4 v[212:215], v1, s[20:23], s66 offen offset:2048 sc1
    v_accvgpr_read_b32 v192, a112
    v_accvgpr_read_b32 v193, a113
    v_accvgpr_read_b32 v194, a114
    v_accvgpr_read_b32 v195, a115
    v_accvgpr_read_b32 v196, a116
    v_accvgpr_read_b32 v197, a117
    v_accvgpr_read_b32 v198, a118
    v_accvgpr_read_b32 v199, a119
    v_mul_f32 v192, v192, v12
    v_mul_f32 v193, v193, v12
    v_mul_f32 v194, v194, v12
    v_mul_f32 v195, v195, v12
    v_mul_f32 v196, v196, v12
    v_mul_f32 v197, v197, v12
    v_mul_f32 v198, v198, v12
    v_mul_f32 v199, v199, v12
    v_cvt_pk_bf16_f32 v216, v192, v193
    v_cvt_pk_bf16_f32 v217, v194, v195
    v_cvt_pk_bf16_f32 v218, v196, v197
    v_cvt_pk_bf16_f32 v219, v198, v199
    s_add_u32 s66, s66, 4096
    buffer_store_dwordx4 v[216:219], v1, s[20:23], s66 offen offset:0 sc1
    v_accvgpr_read_b32 v200, a120
    v_accvgpr_read_b32 v201, a121
    v_accvgpr_read_b32 v202, a122
    v_accvgpr_read_b32 v203, a123
    v_accvgpr_read_b32 v204, a124
    v_accvgpr_read_b32 v205, a125
    v_accvgpr_read_b32 v206, a126
    v_accvgpr_read_b32 v207, a127
    v_mul_f32 v200, v200, v12
    v_mul_f32 v201, v201, v12
    v_mul_f32 v202, v202, v12
    v_mul_f32 v203, v203, v12
    v_mul_f32 v204, v204, v12
    v_mul_f32 v205, v205, v12
    v_mul_f32 v206, v206, v12
    v_mul_f32 v207, v207, v12
    v_cvt_pk_bf16_f32 v220, v200, v201
    v_cvt_pk_bf16_f32 v221, v202, v203
    v_cvt_pk_bf16_f32 v222, v204, v205
    v_cvt_pk_bf16_f32 v223, v206, v207
    buffer_store_dwordx4 v[220:223], v1, s[20:23], s66 offen offset:2048 sc1
    s_branch k2_end
k2_partial:
    v_lshrrev_b32 v14, 2, v1
    s_movk_i32 s66, 0x4000
    buffer_store_dword v13, v14, s[24:27], s66 offen sc1
    s_mov_b32 s66, 0
    v_accvgpr_read_b32 v192, a0
    v_accvgpr_read_b32 v193, a1
    v_accvgpr_read_b32 v194, a2
    v_accvgpr_read_b32 v195, a3
    v_accvgpr_read_b32 v196, a4
    v_accvgpr_read_b32 v197, a5
    v_accvgpr_read_b32 v198, a6
    v_accvgpr_read_b32 v199, a7
    v_mul_f32 v192, v192, v12
    v_mul_f32 v193, v193, v12
    v_mul_f32 v194, v194, v12
    v_mul_f32 v195, v195, v12
    v_mul_f32 v196, v196, v12
    v_mul_f32 v197, v197, v12
    v_mul_f32 v198, v198, v12
    v_mul_f32 v199, v199, v12
    v_cvt_pk_bf16_f32 v208, v192, v193
    v_cvt_pk_bf16_f32 v209, v194, v195
    v_cvt_pk_bf16_f32 v210, v196, v197
    v_cvt_pk_bf16_f32 v211, v198, v199
    buffer_store_dwordx4 v[208:211], v1, s[24:27], s66 offen offset:0 sc1
    v_accvgpr_read_b32 v200, a8
    v_accvgpr_read_b32 v201, a9
    v_accvgpr_read_b32 v202, a10
    v_accvgpr_read_b32 v203, a11
    v_accvgpr_read_b32 v204, a12
    v_accvgpr_read_b32 v205, a13
    v_accvgpr_read_b32 v206, a14
    v_accvgpr_read_b32 v207, a15
    v_mul_f32 v200, v200, v12
    v_mul_f32 v201, v201, v12
    v_mul_f32 v202, v202, v12
    v_mul_f32 v203, v203, v12
    v_mul_f32 v204, v204, v12
    v_mul_f32 v205, v205, v12
    v_mul_f32 v206, v206, v12
    v_mul_f32 v207, v207, v12
    v_cvt_pk_bf16_f32 v212, v200, v201
    v_cvt_pk_bf16_f32 v213, v202, v203
    v_cvt_pk_bf16_f32 v214, v204, v205
    v_cvt_pk_bf16_f32 v215, v206, v207
    buffer_store_dwordx4 v[212:215], v1, s[24:27], s66 offen offset:1024 sc1
    v_accvgpr_read_b32 v192, a16
    v_accvgpr_read_b32 v193, a17
    v_accvgpr_read_b32 v194, a18
    v_accvgpr_read_b32 v195, a19
    v_accvgpr_read_b32 v196, a20
    v_accvgpr_read_b32 v197, a21
    v_accvgpr_read_b32 v198, a22
    v_accvgpr_read_b32 v199, a23
    v_mul_f32 v192, v192, v12
    v_mul_f32 v193, v193, v12
    v_mul_f32 v194, v194, v12
    v_mul_f32 v195, v195, v12
    v_mul_f32 v196, v196, v12
    v_mul_f32 v197, v197, v12
    v_mul_f32 v198, v198, v12
    v_mul_f32 v199, v199, v12
    v_cvt_pk_bf16_f32 v216, v192, v193
    v_cvt_pk_bf16_f32 v217, v194, v195
    v_cvt_pk_bf16_f32 v218, v196, v197
    v_cvt_pk_bf16_f32 v219, v198, v199
    s_add_u32 s66, s66, 2048
    buffer_store_dwordx4 v[216:219], v1, s[24:27], s66 offen offset:0 sc1
    v_accvgpr_read_b32 v200, a24
    v_accvgpr_read_b32 v201, a25
    v_accvgpr_read_b32 v202, a26
    v_accvgpr_read_b32 v203, a27
    v_accvgpr_read_b32 v204, a28
    v_accvgpr_read_b32 v205, a29
    v_accvgpr_read_b32 v206, a30
    v_accvgpr_read_b32 v207, a31
    v_mul_f32 v200, v200, v12
    v_mul_f32 v201, v201, v12
    v_mul_f32 v202, v202, v12
    v_mul_f32 v203, v203, v12
    v_mul_f32 v204, v204, v12
    v_mul_f32 v205, v205, v12
    v_mul_f32 v206, v206, v12
    v_mul_f32 v207, v207, v12
    v_cvt_pk_bf16_f32 v220, v200, v201
    v_cvt_pk_bf16_f32 v221, v202, v203
    v_cvt_pk_bf16_f32 v222, v204, v205
    v_cvt_pk_bf16_f32 v223, v206, v207
    buffer_store_dwordx4 v[220:223], v1, s[24:27], s66 offen offset:1024 sc1
    v_accvgpr_read_b32 v192, a32
    v_accvgpr_read_b32 v193, a33
    v_accvgpr_read_b32 v194, a34
    v_accvgpr_read_b32 v195, a35
    v_accvgpr_read_b32 v196, a36
    v_accvgpr_read_b32 v197, a37
    v_accvgpr_read_b32 v198, a38
    v_accvgpr_read_b32 v199, a39
    v_mul_f32 v192, v192, v12
    v_mul_f32 v193, v193, v12
    v_mul_f32 v194, v194, v12
    v_mul_f32 v195, v195, v12
    v_mul_f32 v196, v196, v12
    v_mul_f32 v197, v197, v12
    v_mul_f32 v198, v198, v12
    v_mul_f32 v199, v199, v12
    v_cvt_pk_bf16_f32 v208, v192, v193
    v_cvt_pk_bf16_f32 v209, v194, v195
    v_cvt_pk_bf16_f32 v210, v196, v197
    v_cvt_pk_bf16_f32 v211, v198, v199
    s_add_u32 s66, s66, 2048
    buffer_store_dwordx4 v[208:211], v1, s[24:27], s66 offen offset:0 sc1
    v_accvgpr_read_b32 v200, a40
    v_accvgpr_read_b32 v201, a41
    v_accvgpr_read_b32 v202, a42
    v_accvgpr_read_b32 v203, a43
    v_accvgpr_read_b32 v204, a44
    v_accvgpr_read_b32 v205, a45
    v_accvgpr_read_b32 v206, a46
    v_accvgpr_read_b32 v207, a47
    v_mul_f32 v200, v200, v12
    v_mul_f32 v201, v201, v12
    v_mul_f32 v202, v202, v12
    v_mul_f32 v203, v203, v12
    v_mul_f32 v204, v204, v12
    v_mul_f32 v205, v205, v12
    v_mul_f32 v206, v206, v12
    v_mul_f32 v207, v207, v12
    v_cvt_pk_bf16_f32 v212, v200, v201
    v_cvt_pk_bf16_f32 v213, v202, v203
    v_cvt_pk_bf16_f32 v214, v204, v205
    v_cvt_pk_bf16_f32 v215, v206, v207
    buffer_store_dwordx4 v[212:215], v1, s[24:27], s66 offen offset:1024 sc1
    v_accvgpr_read_b32 v192, a48
    v_accvgpr_read_b32 v193, a49
    v_accvgpr_read_b32 v194, a50
    v_accvgpr_read_b32 v195, a51
    v_accvgpr_read_b32 v196, a52
    v_accvgpr_read_b32 v197, a53
    v_accvgpr_read_b32 v198, a54
    v_accvgpr_read_b32 v199, a55
    v_mul_f32 v192, v192, v12
    v_mul_f32 v193, v193, v12
    v_mul_f32 v194, v194, v12
    v_mul_f32 v195, v195, v12
    v_mul_f32 v196, v196, v12
    v_mul_f32 v197, v197, v12
    v_mul_f32 v198, v198, v12
    v_mul_f32 v199, v199, v12
    v_cvt_pk_bf16_f32 v216, v192, v193
    v_cvt_pk_bf16_f32 v217, v194, v195
    v_cvt_pk_bf16_f32 v218, v196, v197
    v_cvt_pk_bf16_f32 v219, v198, v199
    s_add_u32 s66, s66, 2048
    buffer_store_dwordx4 v[216:219], v1, s[24:27], s66 offen offset:0 sc1
    v_accvgpr_read_b32 v200, a56
    v_accvgpr_read_b32 v201, a57
    v_accvgpr_read_b32 v202, a58
    v_accvgpr_read_b32 v203, a59
    v_accvgpr_read_b32 v204, a60
    v_accvgpr_read_b32 v205, a61
    v_accvgpr_read_b32 v206, a62
    v_accvgpr_read_b32 v207, a63
    v_mul_f32 v200, v200, v12
    v_mul_f32 v201, v201, v12
    v_mul_f32 v202, v202, v12
    v_mul_f32 v203, v203, v12
    v_mul_f32 v204, v204, v12
    v_mul_f32 v205, v205, v12
    v_mul_f32 v206, v206, v12
    v_mul_f32 v207, v207, v12
    v_cvt_pk_bf16_f32 v220, v200, v201
    v_cvt_pk_bf16_f32 v221, v202, v203
    v_cvt_pk_bf16_f32 v222, v204, v205
    v_cvt_pk_bf16_f32 v223, v206, v207
    buffer_store_dwordx4 v[220:223], v1, s[24:27], s66 offen offset:1024 sc1
    v_accvgpr_read_b32 v192, a64
    v_accvgpr_read_b32 v193, a65
    v_accvgpr_read_b32 v194, a66
    v_accvgpr_read_b32 v195, a67
    v_accvgpr_read_b32 v196, a68
    v_accvgpr_read_b32 v197, a69
    v_accvgpr_read_b32 v198, a70
    v_accvgpr_read_b32 v199, a71
    v_mul_f32 v192, v192, v12
    v_mul_f32 v193, v193, v12
    v_mul_f32 v194, v194, v12
    v_mul_f32 v195, v195, v12
    v_mul_f32 v196, v196, v12
    v_mul_f32 v197, v197, v12
    v_mul_f32 v198, v198, v12
    v_mul_f32 v199, v199, v12
    v_cvt_pk_bf16_f32 v208, v192, v193
    v_cvt_pk_bf16_f32 v209, v194, v195
    v_cvt_pk_bf16_f32 v210, v196, v197
    v_cvt_pk_bf16_f32 v211, v198, v199
    s_add_u32 s66, s66, 2048
    buffer_store_dwordx4 v[208:211], v1, s[24:27], s66 offen offset:0 sc1
    v_accvgpr_read_b32 v200, a72
    v_accvgpr_read_b32 v201, a73
    v_accvgpr_read_b32 v202, a74
    v_accvgpr_read_b32 v203, a75
    v_accvgpr_read_b32 v204, a76
    v_accvgpr_read_b32 v205, a77
    v_accvgpr_read_b32 v206, a78
    v_accvgpr_read_b32 v207, a79
    v_mul_f32 v200, v200, v12
    v_mul_f32 v201, v201, v12
    v_mul_f32 v202, v202, v12
    v_mul_f32 v203, v203, v12
    v_mul_f32 v204, v204, v12
    v_mul_f32 v205, v205, v12
    v_mul_f32 v206, v206, v12
    v_mul_f32 v207, v207, v12
    v_cvt_pk_bf16_f32 v212, v200, v201
    v_cvt_pk_bf16_f32 v213, v202, v203
    v_cvt_pk_bf16_f32 v214, v204, v205
    v_cvt_pk_bf16_f32 v215, v206, v207
    buffer_store_dwordx4 v[212:215], v1, s[24:27], s66 offen offset:1024 sc1
    v_accvgpr_read_b32 v192, a80
    v_accvgpr_read_b32 v193, a81
    v_accvgpr_read_b32 v194, a82
    v_accvgpr_read_b32 v195, a83
    v_accvgpr_read_b32 v196, a84
    v_accvgpr_read_b32 v197, a85
    v_accvgpr_read_b32 v198, a86
    v_accvgpr_read_b32 v199, a87
    v_mul_f32 v192, v192, v12
    v_mul_f32 v193, v193, v12
    v_mul_f32 v194, v194, v12
    v_mul_f32 v195, v195, v12
    v_mul_f32 v196, v196, v12
    v_mul_f32 v197, v197, v12
    v_mul_f32 v198, v198, v12
    v_mul_f32 v199, v199, v12
    v_cvt_pk_bf16_f32 v216, v192, v193
    v_cvt_pk_bf16_f32 v217, v194, v195
    v_cvt_pk_bf16_f32 v218, v196, v197
    v_cvt_pk_bf16_f32 v219, v198, v199
    s_add_u32 s66, s66, 2048
    buffer_store_dwordx4 v[216:219], v1, s[24:27], s66 offen offset:0 sc1
    v_accvgpr_read_b32 v200, a88
    v_accvgpr_read_b32 v201, a89
    v_accvgpr_read_b32 v202, a90
    v_accvgpr_read_b32 v203, a91
    v_accvgpr_read_b32 v204, a92
    v_accvgpr_read_b32 v205, a93
    v_accvgpr_read_b32 v206, a94
    v_accvgpr_read_b32 v207, a95
    v_mul_f32 v200, v200, v12
    v_mul_f32 v201, v201, v12
    v_mul_f32 v202, v202, v12
    v_mul_f32 v203, v203, v12
    v_mul_f32 v204, v204, v12
    v_mul_f32 v205, v205, v12
    v_mul_f32 v206, v206, v12
    v_mul_f32 v207, v207, v12
    v_cvt_pk_bf16_f32 v220, v200, v201
    v_cvt_pk_bf16_f32 v221, v202, v203
    v_cvt_pk_bf16_f32 v222, v204, v205
    v_cvt_pk_bf16_f32 v223, v206, v207
    buffer_store_dwordx4 v[220:223], v1, s[24:27], s66 offen offset:1024 sc1
    v_accvgpr_read_b32 v192, a96
    v_accvgpr_read_b32 v193, a97
    v_accvgpr_read_b32 v194, a98
    v_accvgpr_read_b32 v195, a99
    v_accvgpr_read_b32 v196, a100
    v_accvgpr_read_b32 v197, a101
    v_accvgpr_read_b32 v198, a102
    v_accvgpr_read_b32 v199, a103
    v_mul_f32 v192, v192, v12
    v_mul_f32 v193, v193, v12
    v_mul_f32 v194, v194, v12
    v_mul_f32 v195, v195, v12
    v_mul_f32 v196, v196, v12
    v_mul_f32 v197, v197, v12
    v_mul_f32 v198, v198, v12
    v_mul_f32 v199, v199, v12
    v_cvt_pk_bf16_f32 v208, v192, v193
    v_cvt_pk_bf16_f32 v209, v194, v195
    v_cvt_pk_bf16_f32 v210, v196, v197
    v_cvt_pk_bf16_f32 v211, v198, v199
    s_add_u32 s66, s66, 2048
    buffer_store_dwordx4 v[208:211], v1, s[24:27], s66 offen offset:0 sc1
    v_accvgpr_read_b32 v200, a104
    v_accvgpr_read_b32 v201, a105
    v_accvgpr_read_b32 v202, a106
    v_accvgpr_read_b32 v203, a107
    v_accvgpr_read_b32 v204, a108
    v_accvgpr_read_b32 v205, a109
    v_accvgpr_read_b32 v206, a110
    v_accvgpr_read_b32 v207, a111
    v_mul_f32 v200, v200, v12
    v_mul_f32 v201, v201, v12
    v_mul_f32 v202, v202, v12
    v_mul_f32 v203, v203, v12
    v_mul_f32 v204, v204, v12
    v_mul_f32 v205, v205, v12
    v_mul_f32 v206, v206, v12
    v_mul_f32 v207, v207, v12
    v_cvt_pk_bf16_f32 v212, v200, v201
    v_cvt_pk_bf16_f32 v213, v202, v203
    v_cvt_pk_bf16_f32 v214, v204, v205
    v_cvt_pk_bf16_f32 v215, v206, v207
    buffer_store_dwordx4 v[212:215], v1, s[24:27], s66 offen offset:1024 sc1
    v_accvgpr_read_b32 v192, a112
    v_accvgpr_read_b32 v193, a113
    v_accvgpr_read_b32 v194, a114
    v_accvgpr_read_b32 v195, a115
    v_accvgpr_read_b32 v196, a116
    v_accvgpr_read_b32 v197, a117
    v_accvgpr_read_b32 v198, a118
    v_accvgpr_read_b32 v199, a119
    v_mul_f32 v192, v192, v12
    v_mul_f32 v193, v193, v12
    v_mul_f32 v194, v194, v12
    v_mul_f32 v195, v195, v12
    v_mul_f32 v196, v196, v12
    v_mul_f32 v197, v197, v12
    v_mul_f32 v198, v198, v12
    v_mul_f32 v199, v199, v12
    v_cvt_pk_bf16_f32 v216, v192, v193
    v_cvt_pk_bf16_f32 v217, v194, v195
    v_cvt_pk_bf16_f32 v218, v196, v197
    v_cvt_pk_bf16_f32 v219, v198, v199
    s_add_u32 s66, s66, 2048
    buffer_store_dwordx4 v[216:219], v1, s[24:27], s66 offen offset:0 sc1
    v_accvgpr_read_b32 v200, a120
    v_accvgpr_read_b32 v201, a121
    v_accvgpr_read_b32 v202, a122
    v_accvgpr_read_b32 v203, a123
    v_accvgpr_read_b32 v204, a124
    v_accvgpr_read_b32 v205, a125
    v_accvgpr_read_b32 v206, a126
    v_accvgpr_read_b32 v207, a127
    v_mul_f32 v200, v200, v12
    v_mul_f32 v201, v201, v12
    v_mul_f32 v202, v202, v12
    v_mul_f32 v203, v203, v12
    v_mul_f32 v204, v204, v12
    v_mul_f32 v205, v205, v12
    v_mul_f32 v206, v206, v12
    v_mul_f32 v207, v207, v12
    v_cvt_pk_bf16_f32 v220, v200, v201
    v_cvt_pk_bf16_f32 v221, v202, v203
    v_cvt_pk_bf16_f32 v222, v204, v205
    v_cvt_pk_bf16_f32 v223, v206, v207
    buffer_store_dwordx4 v[220:223], v1, s[24:27], s66 offen offset:1024 sc1
    s_mov_b32 s41, s45
    s_mov_b32 s45, 0
    s_mov_b32 s44, 0
    s_mov_b32 s95, 1
    s_mov_b32 s79, s46
    s_mov_b32 s40, 0
    s_lshl_b32 s42, s79, 1
    s_lshl_b32 s43, s79, 7
    s_lshl_b32 s66, s77, 5
    s_add_u32 s43, s43, s66
    s_mov_b64 s[48:49], -1
    s_mov_b32 s50, 0xff7843b0
    s_mov_b32 s51, 1.0
    v_mov_b32 v5, 0
    v_mov_b32 v6, 0
    v_accvgpr_write_b32 a0, 0
    v_accvgpr_write_b32 a1, 0
    v_accvgpr_write_b32 a2, 0
    v_accvgpr_write_b32 a3, 0
    v_accvgpr_write_b32 a4, 0
    v_accvgpr_write_b32 a5, 0
    v_accvgpr_write_b32 a6, 0
    v_accvgpr_write_b32 a7, 0
    v_accvgpr_write_b32 a8, 0
    v_accvgpr_write_b32 a9, 0
    v_accvgpr_write_b32 a10, 0
    v_accvgpr_write_b32 a11, 0
    v_accvgpr_write_b32 a12, 0
    v_accvgpr_write_b32 a13, 0
    v_accvgpr_write_b32 a14, 0
    v_accvgpr_write_b32 a15, 0
    v_accvgpr_write_b32 a16, 0
    v_accvgpr_write_b32 a17, 0
    v_accvgpr_write_b32 a18, 0
    v_accvgpr_write_b32 a19, 0
    v_accvgpr_write_b32 a20, 0
    v_accvgpr_write_b32 a21, 0
    v_accvgpr_write_b32 a22, 0
    v_accvgpr_write_b32 a23, 0
    v_accvgpr_write_b32 a24, 0
    v_accvgpr_write_b32 a25, 0
    v_accvgpr_write_b32 a26, 0
    v_accvgpr_write_b32 a27, 0
    v_accvgpr_write_b32 a28, 0
    v_accvgpr_write_b32 a29, 0
    v_accvgpr_write_b32 a30, 0
    v_accvgpr_write_b32 a31, 0
    v_accvgpr_write_b32 a32, 0
    v_accvgpr_write_b32 a33, 0
    v_accvgpr_write_b32 a34, 0
    v_accvgpr_write_b32 a35, 0
    v_accvgpr_write_b32 a36, 0
    v_accvgpr_write_b32 a37, 0
    v_accvgpr_write_b32 a38, 0
    v_accvgpr_write_b32 a39, 0
    v_accvgpr_write_b32 a40, 0
    v_accvgpr_write_b32 a41, 0
    v_accvgpr_write_b32 a42, 0
    v_accvgpr_write_b32 a43, 0
    v_accvgpr_write_b32 a44, 0
    v_accvgpr_write_b32 a45, 0
    v_accvgpr_write_b32 a46, 0
    v_accvgpr_write_b32 a47, 0
    v_accvgpr_write_b32 a48, 0
    v_accvgpr_write_b32 a49, 0
    v_accvgpr_write_b32 a50, 0
    v_accvgpr_write_b32 a51, 0
    v_accvgpr_write_b32 a52, 0
    v_accvgpr_write_b32 a53, 0
    v_accvgpr_write_b32 a54, 0
    v_accvgpr_write_b32 a55, 0
    v_accvgpr_write_b32 a56, 0
    v_accvgpr_write_b32 a57, 0
    v_accvgpr_write_b32 a58, 0
    v_accvgpr_write_b32 a59, 0
    v_accvgpr_write_b32 a60, 0
    v_accvgpr_write_b32 a61, 0
    v_accvgpr_write_b32 a62, 0
    v_accvgpr_write_b32 a63, 0
    v_accvgpr_write_b32 a64, 0
    v_accvgpr_write_b32 a65, 0
    v_accvgpr_write_b32 a66, 0
    v_accvgpr_write_b32 a67, 0
    v_accvgpr_write_b32 a68, 0
    v_accvgpr_write_b32 a69, 0
    v_accvgpr_write_b32 a70, 0
    v_accvgpr_write_b32 a71, 0
    v_accvgpr_write_b32 a72, 0
    v_accvgpr_write_b32 a73, 0
    v_accvgpr_write_b32 a74, 0
    v_accvgpr_write_b32 a75, 0
    v_accvgpr_write_b32 a76, 0
    v_accvgpr_write_b32 a77, 0
    v_accvgpr_write_b32 a78, 0
    v_accvgpr_write_b32 a79, 0
    v_accvgpr_write_b32 a80, 0
    v_accvgpr_write_b32 a81, 0
    v_accvgpr_write_b32 a82, 0
    v_accvgpr_write_b32 a83, 0
    v_accvgpr_write_b32 a84, 0
    v_accvgpr_write_b32 a85, 0
    v_accvgpr_write_b32 a86, 0
    v_accvgpr_write_b32 a87, 0
    v_accvgpr_write_b32 a88, 0
    v_accvgpr_write_b32 a89, 0
    v_accvgpr_write_b32 a90, 0
    v_accvgpr_write_b32 a91, 0
    v_accvgpr_write_b32 a92, 0
    v_accvgpr_write_b32 a93, 0
    v_accvgpr_write_b32 a94, 0
    v_accvgpr_write_b32 a95, 0
    v_accvgpr_write_b32 a96, 0
    v_accvgpr_write_b32 a97, 0
    v_accvgpr_write_b32 a98, 0
    v_accvgpr_write_b32 a99, 0
    v_accvgpr_write_b32 a100, 0
    v_accvgpr_write_b32 a101, 0
    v_accvgpr_write_b32 a102, 0
    v_accvgpr_write_b32 a103, 0
    v_accvgpr_write_b32 a104, 0
    v_accvgpr_write_b32 a105, 0
    v_accvgpr_write_b32 a106, 0
    v_accvgpr_write_b32 a107, 0
    v_accvgpr_write_b32 a108, 0
    v_accvgpr_write_b32 a109, 0
    v_accvgpr_write_b32 a110, 0
    v_accvgpr_write_b32 a111, 0
    v_accvgpr_write_b32 a112, 0
    v_accvgpr_write_b32 a113, 0
    v_accvgpr_write_b32 a114, 0
    v_accvgpr_write_b32 a115, 0
    v_accvgpr_write_b32 a116, 0
    v_accvgpr_write_b32 a117, 0
    v_accvgpr_write_b32 a118, 0
    v_accvgpr_write_b32 a119, 0
    v_accvgpr_write_b32 a120, 0
    v_accvgpr_write_b32 a121, 0
    v_accvgpr_write_b32 a122, 0
    v_accvgpr_write_b32 a123, 0
    v_accvgpr_write_b32 a124, 0
    v_accvgpr_write_b32 a125, 0
    v_accvgpr_write_b32 a126, 0
    v_accvgpr_write_b32 a127, 0
    s_nop 1
    s_branch k2_dispatch
k2_merge:
    s_waitcnt vmcnt(0)
    v_sub_f32 v14, v251, v13
    v_exp_f32 v15, v14
    v_exp_f32 v14, -v14
    s_nop 0
    v_add_f32 v15, 1.0, v15
    v_add_f32 v14, 1.0, v14
    v_rcp_f32 v15, v15
    v_rcp_f32 v14, v14
    s_nop 0
    v_mul_f32 v12, v12, v15
    v_accvgpr_read_b32 v192, a0
    v_accvgpr_read_b32 v193, a1
    v_accvgpr_read_b32 v194, a2
    v_accvgpr_read_b32 v195, a3
    v_accvgpr_read_b32 v196, a4
    v_accvgpr_read_b32 v197, a5
    v_accvgpr_read_b32 v198, a6
    v_accvgpr_read_b32 v199, a7
    v_accvgpr_read_b32 v224, a192
    v_accvgpr_read_b32 v225, a193
    v_accvgpr_read_b32 v226, a194
    v_accvgpr_read_b32 v227, a195
    v_mul_f32 v192, v192, v12
    v_mul_f32 v193, v193, v12
    v_mul_f32 v194, v194, v12
    v_mul_f32 v195, v195, v12
    v_mul_f32 v196, v196, v12
    v_mul_f32 v197, v197, v12
    v_mul_f32 v198, v198, v12
    v_mul_f32 v199, v199, v12
    v_lshlrev_b32 v228, 16, v224
    v_and_b32 v229, 0xffff0000, v224
    v_lshlrev_b32 v230, 16, v225
    v_and_b32 v231, 0xffff0000, v225
    v_lshlrev_b32 v232, 16, v226
    v_and_b32 v233, 0xffff0000, v226
    v_lshlrev_b32 v234, 16, v227
    v_and_b32 v235, 0xffff0000, v227
    v_fmac_f32 v192, v228, v14
    v_fmac_f32 v193, v229, v14
    v_fmac_f32 v194, v230, v14
    v_fmac_f32 v195, v231, v14
    v_fmac_f32 v196, v232, v14
    v_fmac_f32 v197, v233, v14
    v_fmac_f32 v198, v234, v14
    v_fmac_f32 v199, v235, v14
    v_cvt_pk_bf16_f32 v208, v192, v193
    v_cvt_pk_bf16_f32 v209, v194, v195
    v_cvt_pk_bf16_f32 v210, v196, v197
    v_cvt_pk_bf16_f32 v211, v198, v199
    buffer_store_dwordx4 v[208:211], v1, s[20:23], s66 offen offset:0 sc1
    v_accvgpr_read_b32 v200, a8
    v_accvgpr_read_b32 v201, a9
    v_accvgpr_read_b32 v202, a10
    v_accvgpr_read_b32 v203, a11
    v_accvgpr_read_b32 v204, a12
    v_accvgpr_read_b32 v205, a13
    v_accvgpr_read_b32 v206, a14
    v_accvgpr_read_b32 v207, a15
    v_accvgpr_read_b32 v224, a196
    v_accvgpr_read_b32 v225, a197
    v_accvgpr_read_b32 v226, a198
    v_accvgpr_read_b32 v227, a199
    v_mul_f32 v200, v200, v12
    v_mul_f32 v201, v201, v12
    v_mul_f32 v202, v202, v12
    v_mul_f32 v203, v203, v12
    v_mul_f32 v204, v204, v12
    v_mul_f32 v205, v205, v12
    v_mul_f32 v206, v206, v12
    v_mul_f32 v207, v207, v12
    v_lshlrev_b32 v228, 16, v224
    v_and_b32 v229, 0xffff0000, v224
    v_lshlrev_b32 v230, 16, v225
    v_and_b32 v231, 0xffff0000, v225
    v_lshlrev_b32 v232, 16, v226
    v_and_b32 v233, 0xffff0000, v226
    v_lshlrev_b32 v234, 16, v227
    v_and_b32 v235, 0xffff0000, v227
    v_fmac_f32 v200, v228, v14
    v_fmac_f32 v201, v229, v14
    v_fmac_f32 v202, v230, v14
    v_fmac_f32 v203, v231, v14
    v_fmac_f32 v204, v232, v14
    v_fmac_f32 v205, v233, v14
    v_fmac_f32 v206, v234, v14
    v_fmac_f32 v207, v235, v14
    v_cvt_pk_bf16_f32 v212, v200, v201
    v_cvt_pk_bf16_f32 v213, v202, v203
    v_cvt_pk_bf16_f32 v214, v204, v205
    v_cvt_pk_bf16_f32 v215, v206, v207
    buffer_store_dwordx4 v[212:215], v1, s[20:23], s66 offen offset:2048 sc1
    v_accvgpr_read_b32 v192, a16
    v_accvgpr_read_b32 v193, a17
    v_accvgpr_read_b32 v194, a18
    v_accvgpr_read_b32 v195, a19
    v_accvgpr_read_b32 v196, a20
    v_accvgpr_read_b32 v197, a21
    v_accvgpr_read_b32 v198, a22
    v_accvgpr_read_b32 v199, a23
    v_accvgpr_read_b32 v224, a200
    v_accvgpr_read_b32 v225, a201
    v_accvgpr_read_b32 v226, a202
    v_accvgpr_read_b32 v227, a203
    v_mul_f32 v192, v192, v12
    v_mul_f32 v193, v193, v12
    v_mul_f32 v194, v194, v12
    v_mul_f32 v195, v195, v12
    v_mul_f32 v196, v196, v12
    v_mul_f32 v197, v197, v12
    v_mul_f32 v198, v198, v12
    v_mul_f32 v199, v199, v12
    v_lshlrev_b32 v228, 16, v224
    v_and_b32 v229, 0xffff0000, v224
    v_lshlrev_b32 v230, 16, v225
    v_and_b32 v231, 0xffff0000, v225
    v_lshlrev_b32 v232, 16, v226
    v_and_b32 v233, 0xffff0000, v226
    v_lshlrev_b32 v234, 16, v227
    v_and_b32 v235, 0xffff0000, v227
    v_fmac_f32 v192, v228, v14
    v_fmac_f32 v193, v229, v14
    v_fmac_f32 v194, v230, v14
    v_fmac_f32 v195, v231, v14
    v_fmac_f32 v196, v232, v14
    v_fmac_f32 v197, v233, v14
    v_fmac_f32 v198, v234, v14
    v_fmac_f32 v199, v235, v14
    v_cvt_pk_bf16_f32 v216, v192, v193
    v_cvt_pk_bf16_f32 v217, v194, v195
    v_cvt_pk_bf16_f32 v218, v196, v197
    v_cvt_pk_bf16_f32 v219, v198, v199
    s_add_u32 s66, s66, 4096
    buffer_store_dwordx4 v[216:219], v1, s[20:23], s66 offen offset:0 sc1
    v_accvgpr_read_b32 v200, a24
    v_accvgpr_read_b32 v201, a25
    v_accvgpr_read_b32 v202, a26
    v_accvgpr_read_b32 v203, a27
    v_accvgpr_read_b32 v204, a28
    v_accvgpr_read_b32 v205, a29
    v_accvgpr_read_b32 v206, a30
    v_accvgpr_read_b32 v207, a31
    v_accvgpr_read_b32 v224, a204
    v_accvgpr_read_b32 v225, a205
    v_accvgpr_read_b32 v226, a206
    v_accvgpr_read_b32 v227, a207
    v_mul_f32 v200, v200, v12
    v_mul_f32 v201, v201, v12
    v_mul_f32 v202, v202, v12
    v_mul_f32 v203, v203, v12
    v_mul_f32 v204, v204, v12
    v_mul_f32 v205, v205, v12
    v_mul_f32 v206, v206, v12
    v_mul_f32 v207, v207, v12
    v_lshlrev_b32 v228, 16, v224
    v_and_b32 v229, 0xffff0000, v224
    v_lshlrev_b32 v230, 16, v225
    v_and_b32 v231, 0xffff0000, v225
    v_lshlrev_b32 v232, 16, v226
    v_and_b32 v233, 0xffff0000, v226
    v_lshlrev_b32 v234, 16, v227
    v_and_b32 v235, 0xffff0000, v227
    v_fmac_f32 v200, v228, v14
    v_fmac_f32 v201, v229, v14
    v_fmac_f32 v202, v230, v14
    v_fmac_f32 v203, v231, v14
    v_fmac_f32 v204, v232, v14
    v_fmac_f32 v205, v233, v14
    v_fmac_f32 v206, v234, v14
    v_fmac_f32 v207, v235, v14
    v_cvt_pk_bf16_f32 v220, v200, v201
    v_cvt_pk_bf16_f32 v221, v202, v203
    v_cvt_pk_bf16_f32 v222, v204, v205
    v_cvt_pk_bf16_f32 v223, v206, v207
    buffer_store_dwordx4 v[220:223], v1, s[20:23], s66 offen offset:2048 sc1
    v_accvgpr_read_b32 v192, a32
    v_accvgpr_read_b32 v193, a33
    v_accvgpr_read_b32 v194, a34
    v_accvgpr_read_b32 v195, a35
    v_accvgpr_read_b32 v196, a36
    v_accvgpr_read_b32 v197, a37
    v_accvgpr_read_b32 v198, a38
    v_accvgpr_read_b32 v199, a39
    v_accvgpr_read_b32 v224, a208
    v_accvgpr_read_b32 v225, a209
    v_accvgpr_read_b32 v226, a210
    v_accvgpr_read_b32 v227, a211
    v_mul_f32 v192, v192, v12
    v_mul_f32 v193, v193, v12
    v_mul_f32 v194, v194, v12
    v_mul_f32 v195, v195, v12
    v_mul_f32 v196, v196, v12
    v_mul_f32 v197, v197, v12
    v_mul_f32 v198, v198, v12
    v_mul_f32 v199, v199, v12
    v_lshlrev_b32 v228, 16, v224
    v_and_b32 v229, 0xffff0000, v224
    v_lshlrev_b32 v230, 16, v225
    v_and_b32 v231, 0xffff0000, v225
    v_lshlrev_b32 v232, 16, v226
    v_and_b32 v233, 0xffff0000, v226
    v_lshlrev_b32 v234, 16, v227
    v_and_b32 v235, 0xffff0000, v227
    v_fmac_f32 v192, v228, v14
    v_fmac_f32 v193, v229, v14
    v_fmac_f32 v194, v230, v14
    v_fmac_f32 v195, v231, v14
    v_fmac_f32 v196, v232, v14
    v_fmac_f32 v197, v233, v14
    v_fmac_f32 v198, v234, v14
    v_fmac_f32 v199, v235, v14
    v_cvt_pk_bf16_f32 v208, v192, v193
    v_cvt_pk_bf16_f32 v209, v194, v195
    v_cvt_pk_bf16_f32 v210, v196, v197
    v_cvt_pk_bf16_f32 v211, v198, v199
    s_add_u32 s66, s66, 4096
    buffer_store_dwordx4 v[208:211], v1, s[20:23], s66 offen offset:0 sc1
    v_accvgpr_read_b32 v200, a40
    v_accvgpr_read_b32 v201, a41
    v_accvgpr_read_b32 v202, a42
    v_accvgpr_read_b32 v203, a43
    v_accvgpr_read_b32 v204, a44
    v_accvgpr_read_b32 v205, a45
    v_accvgpr_read_b32 v206, a46
    v_accvgpr_read_b32 v207, a47
    v_accvgpr_read_b32 v224, a212
    v_accvgpr_read_b32 v225, a213
    v_accvgpr_read_b32 v226, a214
    v_accvgpr_read_b32 v227, a215
    v_mul_f32 v200, v200, v12
    v_mul_f32 v201, v201, v12
    v_mul_f32 v202, v202, v12
    v_mul_f32 v203, v203, v12
    v_mul_f32 v204, v204, v12
    v_mul_f32 v205, v205, v12
    v_mul_f32 v206, v206, v12
    v_mul_f32 v207, v207, v12
    v_lshlrev_b32 v228, 16, v224
    v_and_b32 v229, 0xffff0000, v224
    v_lshlrev_b32 v230, 16, v225
    v_and_b32 v231, 0xffff0000, v225
    v_lshlrev_b32 v232, 16, v226
    v_and_b32 v233, 0xffff0000, v226
    v_lshlrev_b32 v234, 16, v227
    v_and_b32 v235, 0xffff0000, v227
    v_fmac_f32 v200, v228, v14
    v_fmac_f32 v201, v229, v14
    v_fmac_f32 v202, v230, v14
    v_fmac_f32 v203, v231, v14
    v_fmac_f32 v204, v232, v14
    v_fmac_f32 v205, v233, v14
    v_fmac_f32 v206, v234, v14
    v_fmac_f32 v207, v235, v14
    v_cvt_pk_bf16_f32 v212, v200, v201
    v_cvt_pk_bf16_f32 v213, v202, v203
    v_cvt_pk_bf16_f32 v214, v204, v205
    v_cvt_pk_bf16_f32 v215, v206, v207
    buffer_store_dwordx4 v[212:215], v1, s[20:23], s66 offen offset:2048 sc1
    v_accvgpr_read_b32 v192, a48
    v_accvgpr_read_b32 v193, a49
    v_accvgpr_read_b32 v194, a50
    v_accvgpr_read_b32 v195, a51
    v_accvgpr_read_b32 v196, a52
    v_accvgpr_read_b32 v197, a53
    v_accvgpr_read_b32 v198, a54
    v_accvgpr_read_b32 v199, a55
    v_accvgpr_read_b32 v224, a216
    v_accvgpr_read_b32 v225, a217
    v_accvgpr_read_b32 v226, a218
    v_accvgpr_read_b32 v227, a219
    v_mul_f32 v192, v192, v12
    v_mul_f32 v193, v193, v12
    v_mul_f32 v194, v194, v12
    v_mul_f32 v195, v195, v12
    v_mul_f32 v196, v196, v12
    v_mul_f32 v197, v197, v12
    v_mul_f32 v198, v198, v12
    v_mul_f32 v199, v199, v12
    v_lshlrev_b32 v228, 16, v224
    v_and_b32 v229, 0xffff0000, v224
    v_lshlrev_b32 v230, 16, v225
    v_and_b32 v231, 0xffff0000, v225
    v_lshlrev_b32 v232, 16, v226
    v_and_b32 v233, 0xffff0000, v226
    v_lshlrev_b32 v234, 16, v227
    v_and_b32 v235, 0xffff0000, v227
    v_fmac_f32 v192, v228, v14
    v_fmac_f32 v193, v229, v14
    v_fmac_f32 v194, v230, v14
    v_fmac_f32 v195, v231, v14
    v_fmac_f32 v196, v232, v14
    v_fmac_f32 v197, v233, v14
    v_fmac_f32 v198, v234, v14
    v_fmac_f32 v199, v235, v14
    v_cvt_pk_bf16_f32 v216, v192, v193
    v_cvt_pk_bf16_f32 v217, v194, v195
    v_cvt_pk_bf16_f32 v218, v196, v197
    v_cvt_pk_bf16_f32 v219, v198, v199
    s_add_u32 s66, s66, 4096
    buffer_store_dwordx4 v[216:219], v1, s[20:23], s66 offen offset:0 sc1
    v_accvgpr_read_b32 v200, a56
    v_accvgpr_read_b32 v201, a57
    v_accvgpr_read_b32 v202, a58
    v_accvgpr_read_b32 v203, a59
    v_accvgpr_read_b32 v204, a60
    v_accvgpr_read_b32 v205, a61
    v_accvgpr_read_b32 v206, a62
    v_accvgpr_read_b32 v207, a63
    v_accvgpr_read_b32 v224, a220
    v_accvgpr_read_b32 v225, a221
    v_accvgpr_read_b32 v226, a222
    v_accvgpr_read_b32 v227, a223
    v_mul_f32 v200, v200, v12
    v_mul_f32 v201, v201, v12
    v_mul_f32 v202, v202, v12
    v_mul_f32 v203, v203, v12
    v_mul_f32 v204, v204, v12
    v_mul_f32 v205, v205, v12
    v_mul_f32 v206, v206, v12
    v_mul_f32 v207, v207, v12
    v_lshlrev_b32 v228, 16, v224
    v_and_b32 v229, 0xffff0000, v224
    v_lshlrev_b32 v230, 16, v225
    v_and_b32 v231, 0xffff0000, v225
    v_lshlrev_b32 v232, 16, v226
    v_and_b32 v233, 0xffff0000, v226
    v_lshlrev_b32 v234, 16, v227
    v_and_b32 v235, 0xffff0000, v227
    v_fmac_f32 v200, v228, v14
    v_fmac_f32 v201, v229, v14
    v_fmac_f32 v202, v230, v14
    v_fmac_f32 v203, v231, v14
    v_fmac_f32 v204, v232, v14
    v_fmac_f32 v205, v233, v14
    v_fmac_f32 v206, v234, v14
    v_fmac_f32 v207, v235, v14
    v_cvt_pk_bf16_f32 v220, v200, v201
    v_cvt_pk_bf16_f32 v221, v202, v203
    v_cvt_pk_bf16_f32 v222, v204, v205
    v_cvt_pk_bf16_f32 v223, v206, v207
    buffer_store_dwordx4 v[220:223], v1, s[20:23], s66 offen offset:2048 sc1
    v_accvgpr_read_b32 v192, a64
    v_accvgpr_read_b32 v193, a65
    v_accvgpr_read_b32 v194, a66
    v_accvgpr_read_b32 v195, a67
    v_accvgpr_read_b32 v196, a68
    v_accvgpr_read_b32 v197, a69
    v_accvgpr_read_b32 v198, a70
    v_accvgpr_read_b32 v199, a71
    v_accvgpr_read_b32 v224, a224
    v_accvgpr_read_b32 v225, a225
    v_accvgpr_read_b32 v226, a226
    v_accvgpr_read_b32 v227, a227
    v_mul_f32 v192, v192, v12
    v_mul_f32 v193, v193, v12
    v_mul_f32 v194, v194, v12
    v_mul_f32 v195, v195, v12
    v_mul_f32 v196, v196, v12
    v_mul_f32 v197, v197, v12
    v_mul_f32 v198, v198, v12
    v_mul_f32 v199, v199, v12
    v_lshlrev_b32 v228, 16, v224
    v_and_b32 v229, 0xffff0000, v224
    v_lshlrev_b32 v230, 16, v225
    v_and_b32 v231, 0xffff0000, v225
    v_lshlrev_b32 v232, 16, v226
    v_and_b32 v233, 0xffff0000, v226
    v_lshlrev_b32 v234, 16, v227
    v_and_b32 v235, 0xffff0000, v227
    v_fmac_f32 v192, v228, v14
    v_fmac_f32 v193, v229, v14
    v_fmac_f32 v194, v230, v14
    v_fmac_f32 v195, v231, v14
    v_fmac_f32 v196, v232, v14
    v_fmac_f32 v197, v233, v14
    v_fmac_f32 v198, v234, v14
    v_fmac_f32 v199, v235, v14
    v_cvt_pk_bf16_f32 v208, v192, v193
    v_cvt_pk_bf16_f32 v209, v194, v195
    v_cvt_pk_bf16_f32 v210, v196, v197
    v_cvt_pk_bf16_f32 v211, v198, v199
    s_add_u32 s66, s66, 4096
    buffer_store_dwordx4 v[208:211], v1, s[20:23], s66 offen offset:0 sc1
    v_accvgpr_read_b32 v200, a72
    v_accvgpr_read_b32 v201, a73
    v_accvgpr_read_b32 v202, a74
    v_accvgpr_read_b32 v203, a75
    v_accvgpr_read_b32 v204, a76
    v_accvgpr_read_b32 v205, a77
    v_accvgpr_read_b32 v206, a78
    v_accvgpr_read_b32 v207, a79
    v_accvgpr_read_b32 v224, a228
    v_accvgpr_read_b32 v225, a229
    v_accvgpr_read_b32 v226, a230
    v_accvgpr_read_b32 v227, a231
    v_mul_f32 v200, v200, v12
    v_mul_f32 v201, v201, v12
    v_mul_f32 v202, v202, v12
    v_mul_f32 v203, v203, v12
    v_mul_f32 v204, v204, v12
    v_mul_f32 v205, v205, v12
    v_mul_f32 v206, v206, v12
    v_mul_f32 v207, v207, v12
    v_lshlrev_b32 v228, 16, v224
    v_and_b32 v229, 0xffff0000, v224
    v_lshlrev_b32 v230, 16, v225
    v_and_b32 v231, 0xffff0000, v225
    v_lshlrev_b32 v232, 16, v226
    v_and_b32 v233, 0xffff0000, v226
    v_lshlrev_b32 v234, 16, v227
    v_and_b32 v235, 0xffff0000, v227
    v_fmac_f32 v200, v228, v14
    v_fmac_f32 v201, v229, v14
    v_fmac_f32 v202, v230, v14
    v_fmac_f32 v203, v231, v14
    v_fmac_f32 v204, v232, v14
    v_fmac_f32 v205, v233, v14
    v_fmac_f32 v206, v234, v14
    v_fmac_f32 v207, v235, v14
    v_cvt_pk_bf16_f32 v212, v200, v201
    v_cvt_pk_bf16_f32 v213, v202, v203
    v_cvt_pk_bf16_f32 v214, v204, v205
    v_cvt_pk_bf16_f32 v215, v206, v207
    buffer_store_dwordx4 v[212:215], v1, s[20:23], s66 offen offset:2048 sc1
    v_accvgpr_read_b32 v192, a80
    v_accvgpr_read_b32 v193, a81
    v_accvgpr_read_b32 v194, a82
    v_accvgpr_read_b32 v195, a83
    v_accvgpr_read_b32 v196, a84
    v_accvgpr_read_b32 v197, a85
    v_accvgpr_read_b32 v198, a86
    v_accvgpr_read_b32 v199, a87
    v_accvgpr_read_b32 v224, a232
    v_accvgpr_read_b32 v225, a233
    v_accvgpr_read_b32 v226, a234
    v_accvgpr_read_b32 v227, a235
    v_mul_f32 v192, v192, v12
    v_mul_f32 v193, v193, v12
    v_mul_f32 v194, v194, v12
    v_mul_f32 v195, v195, v12
    v_mul_f32 v196, v196, v12
    v_mul_f32 v197, v197, v12
    v_mul_f32 v198, v198, v12
    v_mul_f32 v199, v199, v12
    v_lshlrev_b32 v228, 16, v224
    v_and_b32 v229, 0xffff0000, v224
    v_lshlrev_b32 v230, 16, v225
    v_and_b32 v231, 0xffff0000, v225
    v_lshlrev_b32 v232, 16, v226
    v_and_b32 v233, 0xffff0000, v226
    v_lshlrev_b32 v234, 16, v227
    v_and_b32 v235, 0xffff0000, v227
    v_fmac_f32 v192, v228, v14
    v_fmac_f32 v193, v229, v14
    v_fmac_f32 v194, v230, v14
    v_fmac_f32 v195, v231, v14
    v_fmac_f32 v196, v232, v14
    v_fmac_f32 v197, v233, v14
    v_fmac_f32 v198, v234, v14
    v_fmac_f32 v199, v235, v14
    v_cvt_pk_bf16_f32 v216, v192, v193
    v_cvt_pk_bf16_f32 v217, v194, v195
    v_cvt_pk_bf16_f32 v218, v196, v197
    v_cvt_pk_bf16_f32 v219, v198, v199
    s_add_u32 s66, s66, 4096
    buffer_store_dwordx4 v[216:219], v1, s[20:23], s66 offen offset:0 sc1
    v_accvgpr_read_b32 v200, a88
    v_accvgpr_read_b32 v201, a89
    v_accvgpr_read_b32 v202, a90
    v_accvgpr_read_b32 v203, a91
    v_accvgpr_read_b32 v204, a92
    v_accvgpr_read_b32 v205, a93
    v_accvgpr_read_b32 v206, a94
    v_accvgpr_read_b32 v207, a95
    v_accvgpr_read_b32 v224, a236
    v_accvgpr_read_b32 v225, a237
    v_accvgpr_read_b32 v226, a238
    v_accvgpr_read_b32 v227, a239
    v_mul_f32 v200, v200, v12
    v_mul_f32 v201, v201, v12
    v_mul_f32 v202, v202, v12
    v_mul_f32 v203, v203, v12
    v_mul_f32 v204, v204, v12
    v_mul_f32 v205, v205, v12
    v_mul_f32 v206, v206, v12
    v_mul_f32 v207, v207, v12
    v_lshlrev_b32 v228, 16, v224
    v_and_b32 v229, 0xffff0000, v224
    v_lshlrev_b32 v230, 16, v225
    v_and_b32 v231, 0xffff0000, v225
    v_lshlrev_b32 v232, 16, v226
    v_and_b32 v233, 0xffff0000, v226
    v_lshlrev_b32 v234, 16, v227
    v_and_b32 v235, 0xffff0000, v227
    v_fmac_f32 v200, v228, v14
    v_fmac_f32 v201, v229, v14
    v_fmac_f32 v202, v230, v14
    v_fmac_f32 v203, v231, v14
    v_fmac_f32 v204, v232, v14
    v_fmac_f32 v205, v233, v14
    v_fmac_f32 v206, v234, v14
    v_fmac_f32 v207, v235, v14
    v_cvt_pk_bf16_f32 v220, v200, v201
    v_cvt_pk_bf16_f32 v221, v202, v203
    v_cvt_pk_bf16_f32 v222, v204, v205
    v_cvt_pk_bf16_f32 v223, v206, v207
    buffer_store_dwordx4 v[220:223], v1, s[20:23], s66 offen offset:2048 sc1
    v_accvgpr_read_b32 v192, a96
    v_accvgpr_read_b32 v193, a97
    v_accvgpr_read_b32 v194, a98
    v_accvgpr_read_b32 v195, a99
    v_accvgpr_read_b32 v196, a100
    v_accvgpr_read_b32 v197, a101
    v_accvgpr_read_b32 v198, a102
    v_accvgpr_read_b32 v199, a103
    v_accvgpr_read_b32 v224, a240
    v_accvgpr_read_b32 v225, a241
    v_accvgpr_read_b32 v226, a242
    v_accvgpr_read_b32 v227, a243
    v_mul_f32 v192, v192, v12
    v_mul_f32 v193, v193, v12
    v_mul_f32 v194, v194, v12
    v_mul_f32 v195, v195, v12
    v_mul_f32 v196, v196, v12
    v_mul_f32 v197, v197, v12
    v_mul_f32 v198, v198, v12
    v_mul_f32 v199, v199, v12
    v_lshlrev_b32 v228, 16, v224
    v_and_b32 v229, 0xffff0000, v224
    v_lshlrev_b32 v230, 16, v225
    v_and_b32 v231, 0xffff0000, v225
    v_lshlrev_b32 v232, 16, v226
    v_and_b32 v233, 0xffff0000, v226
    v_lshlrev_b32 v234, 16, v227
    v_and_b32 v235, 0xffff0000, v227
    v_fmac_f32 v192, v228, v14
    v_fmac_f32 v193, v229, v14
    v_fmac_f32 v194, v230, v14
    v_fmac_f32 v195, v231, v14
    v_fmac_f32 v196, v232, v14
    v_fmac_f32 v197, v233, v14
    v_fmac_f32 v198, v234, v14
    v_fmac_f32 v199, v235, v14
    v_cvt_pk_bf16_f32 v208, v192, v193
    v_cvt_pk_bf16_f32 v209, v194, v195
    v_cvt_pk_bf16_f32 v210, v196, v197
    v_cvt_pk_bf16_f32 v211, v198, v199
    s_add_u32 s66, s66, 4096
    buffer_store_dwordx4 v[208:211], v1, s[20:23], s66 offen offset:0 sc1
    v_accvgpr_read_b32 v200, a104
    v_accvgpr_read_b32 v201, a105
    v_accvgpr_read_b32 v202, a106
    v_accvgpr_read_b32 v203, a107
    v_accvgpr_read_b32 v204, a108
    v_accvgpr_read_b32 v205, a109
    v_accvgpr_read_b32 v206, a110
    v_accvgpr_read_b32 v207, a111
    v_accvgpr_read_b32 v224, a244
    v_accvgpr_read_b32 v225, a245
    v_accvgpr_read_b32 v226, a246
    v_accvgpr_read_b32 v227, a247
    v_mul_f32 v200, v200, v12
    v_mul_f32 v201, v201, v12
    v_mul_f32 v202, v202, v12
    v_mul_f32 v203, v203, v12
    v_mul_f32 v204, v204, v12
    v_mul_f32 v205, v205, v12
    v_mul_f32 v206, v206, v12
    v_mul_f32 v207, v207, v12
    v_lshlrev_b32 v228, 16, v224
    v_and_b32 v229, 0xffff0000, v224
    v_lshlrev_b32 v230, 16, v225
    v_and_b32 v231, 0xffff0000, v225
    v_lshlrev_b32 v232, 16, v226
    v_and_b32 v233, 0xffff0000, v226
    v_lshlrev_b32 v234, 16, v227
    v_and_b32 v235, 0xffff0000, v227
    v_fmac_f32 v200, v228, v14
    v_fmac_f32 v201, v229, v14
    v_fmac_f32 v202, v230, v14
    v_fmac_f32 v203, v231, v14
    v_fmac_f32 v204, v232, v14
    v_fmac_f32 v205, v233, v14
    v_fmac_f32 v206, v234, v14
    v_fmac_f32 v207, v235, v14
    v_cvt_pk_bf16_f32 v212, v200, v201
    v_cvt_pk_bf16_f32 v213, v202, v203
    v_cvt_pk_bf16_f32 v214, v204, v205
    v_cvt_pk_bf16_f32 v215, v206, v207
    buffer_store_dwordx4 v[212:215], v1, s[20:23], s66 offen offset:2048 sc1
    v_accvgpr_read_b32 v192, a112
    v_accvgpr_read_b32 v193, a113
    v_accvgpr_read_b32 v194, a114
    v_accvgpr_read_b32 v195, a115
    v_accvgpr_read_b32 v196, a116
    v_accvgpr_read_b32 v197, a117
    v_accvgpr_read_b32 v198, a118
    v_accvgpr_read_b32 v199, a119
    v_accvgpr_read_b32 v224, a248
    v_accvgpr_read_b32 v225, a249
    v_accvgpr_read_b32 v226, a250
    v_accvgpr_read_b32 v227, a251
    v_mul_f32 v192, v192, v12
    v_mul_f32 v193, v193, v12
    v_mul_f32 v194, v194, v12
    v_mul_f32 v195, v195, v12
    v_mul_f32 v196, v196, v12
    v_mul_f32 v197, v197, v12
    v_mul_f32 v198, v198, v12
    v_mul_f32 v199, v199, v12
    v_lshlrev_b32 v228, 16, v224
    v_and_b32 v229, 0xffff0000, v224
    v_lshlrev_b32 v230, 16, v225
    v_and_b32 v231, 0xffff0000, v225
    v_lshlrev_b32 v232, 16, v226
    v_and_b32 v233, 0xffff0000, v226
    v_lshlrev_b32 v234, 16, v227
    v_and_b32 v235, 0xffff0000, v227
    v_fmac_f32 v192, v228, v14
    v_fmac_f32 v193, v229, v14
    v_fmac_f32 v194, v230, v14
    v_fmac_f32 v195, v231, v14
    v_fmac_f32 v196, v232, v14
    v_fmac_f32 v197, v233, v14
    v_fmac_f32 v198, v234, v14
    v_fmac_f32 v199, v235, v14
    v_cvt_pk_bf16_f32 v216, v192, v193
    v_cvt_pk_bf16_f32 v217, v194, v195
    v_cvt_pk_bf16_f32 v218, v196, v197
    v_cvt_pk_bf16_f32 v219, v198, v199
    s_add_u32 s66, s66, 4096
    buffer_store_dwordx4 v[216:219], v1, s[20:23], s66 offen offset:0 sc1
    v_accvgpr_read_b32 v200, a120
    v_accvgpr_read_b32 v201, a121
    v_accvgpr_read_b32 v202, a122
    v_accvgpr_read_b32 v203, a123
    v_accvgpr_read_b32 v204, a124
    v_accvgpr_read_b32 v205, a125
    v_accvgpr_read_b32 v206, a126
    v_accvgpr_read_b32 v207, a127
    v_accvgpr_read_b32 v224, a252
    v_accvgpr_read_b32 v225, a253
    v_accvgpr_read_b32 v226, a254
    v_accvgpr_read_b32 v227, a255
    v_mul_f32 v200, v200, v12
    v_mul_f32 v201, v201, v12
    v_mul_f32 v202, v202, v12
    v_mul_f32 v203, v203, v12
    v_mul_f32 v204, v204, v12
    v_mul_f32 v205, v205, v12
    v_mul_f32 v206, v206, v12
    v_mul_f32 v207, v207, v12
    v_lshlrev_b32 v228, 16, v224
    v_and_b32 v229, 0xffff0000, v224
    v_lshlrev_b32 v230, 16, v225
    v_and_b32 v231, 0xffff0000, v225
    v_lshlrev_b32 v232, 16, v226
    v_and_b32 v233, 0xffff0000, v226
    v_lshlrev_b32 v234, 16, v227
    v_and_b32 v235, 0xffff0000, v227
    v_fmac_f32 v200, v228, v14
    v_fmac_f32 v201, v229, v14
    v_fmac_f32 v202, v230, v14
    v_fmac_f32 v203, v231, v14
    v_fmac_f32 v204, v232, v14
    v_fmac_f32 v205, v233, v14
    v_fmac_f32 v206, v234, v14
    v_fmac_f32 v207, v235, v14
    v_cvt_pk_bf16_f32 v220, v200, v201
    v_cvt_pk_bf16_f32 v221, v202, v203
    v_cvt_pk_bf16_f32 v222, v204, v205
    v_cvt_pk_bf16_f32 v223, v206, v207
    buffer_store_dwordx4 v[220:223], v1, s[20:23], s66 offen offset:2048 sc1
k2_end:
    s_waitcnt vmcnt(0) lgkmcnt(0)
    s_barrier
    s_lshl_b32 s66, s79, 7
    s_lshl_b32 s67, s94, 2
    s_add_u32 s66, s66, s67
    s_add_u32 s66, s66, 2048
    s_cmp_eq_u32 s77, 0
    s_cbranch_scc0 k2_sig2
    s_mov_b64 exec, 1
    v_mov_b32 v120, 0
    v_mov_b32 v121, 1
    buffer_store_dword v121, v120, s[84:87], s66 offen sc1
    s_mov_b64 exec, -1
k2_sig2:
    s_branch k3_entry
k3_entry:
    s_and_b32 s40, s2, 7
    s_lshr_b32 s41, s2, 3
    s_cmp_ge_u32 s41, 28
    s_cbranch_scc1 k3_b3
    s_load_dwordx2 s[6:7], s[0:1], 96
    s_load_dwordx2 s[28:29], s[0:1], 112
    s_and_b32 s42, s41, 3
    s_lshl_b32 s40, s40, 2
    s_add_u32 s42, s42, s40
    s_lshr_b32 s43, s41, 2
    v_lshrrev_b32 v16, 6, v0
    v_and_b32 v17, 63, v0
    v_lshlrev_b32 v1, 4, v17
    v_readfirstlane_b32 s32, v16
    s_waitcnt lgkmcnt(0)
    s_lshl_b32 s44, s32, 17
    s_lshl_b32 s45, s42, 19
    s_add_u32 s45, s45, s44
    s_add_u32 s45, s45, 50331648
    s_add_u32 s8, s28, s45
    s_addc_u32 s9, s29, 0
    s_mov_b32 s10, 131072
    s_mov_b32 s11, 0x20000
    s_lshl_b32 s45, s43, 19
    s_add_u32 s45, s45, s44
    s_add_u32 s45, s45, 100663296
    s_add_u32 s16, s28, s45
    s_addc_u32 s17, s29, 0
    s_mov_b32 s18, 131072
    s_mov_b32 s19, 0x20000
    s_mov_b32 s20, s6
    s_mov_b32 s21, s7
    s_mov_b32 s22, 3670016
    s_mov_b32 s23, 0x20000
    s_add_u32 s76, s28, 96468992
    s_addc_u32 s77, s29, 0
    s_mov_b32 s78, 8192
    s_mov_b32 s79, 0x20000
    v_lshlrev_b32 v16, 2, v0
    s_movk_i32 s47, 6144
    s_mov_b32 s46, 0
k3_pollc_loop:
    buffer_load_dword v17, v16, s[76:79], s47 offen sc1
    s_waitcnt vmcnt(0)
    v_cmp_ne_u32 s[44:45], 1, v17
    s_add_u32 s46, s46, 1
    s_cmp_eq_u64 s[44:45], 0
    s_cbranch_scc1 k3_pollc_done
    s_sleep 6
    s_cmp_lt_u32 s46, 400000
    s_cbranch_scc1 k3_pollc_loop
k3_pollc_done:
    s_barrier
    s_mov_b32 s35, 0
    buffer_load_dwordx4 v[40:43], v1, s[16:19], s35 offen offset:0
    s_mov_b32 s35, 0
    buffer_load_dwordx4 v[44:47], v1, s[16:19], s35 offen offset:1024
    s_mov_b32 s35, 2048
    buffer_load_dwordx4 v[56:59], v1, s[16:19], s35 offen offset:0
    s_mov_b32 s35, 2048
    buffer_load_dwordx4 v[60:63], v1, s[16:19], s35 offen offset:1024
    s_mov_b32 s35, 4096
    buffer_load_dwordx4 v[72:75], v1, s[16:19], s35 offen offset:0
    s_mov_b32 s35, 4096
    buffer_load_dwordx4 v[76:79], v1, s[16:19], s35 offen offset:1024
    s_mov_b32 s35, 6144
    buffer_load_dwordx4 v[88:91], v1, s[16:19], s35 offen offset:0
    s_mov_b32 s35, 6144
    buffer_load_dwordx4 v[92:95], v1, s[16:19], s35 offen offset:1024
    s_mov_b32 s35, 8192
    buffer_load_dwordx4 v[104:107], v1, s[16:19], s35 offen offset:0
    s_mov_b32 s35, 8192
    buffer_load_dwordx4 v[108:111], v1, s[16:19], s35 offen offset:1024
    s_mov_b32 s35, 10240
    buffer_load_dwordx4 v[120:123], v1, s[16:19], s35 offen offset:0
    s_mov_b32 s35, 10240
    buffer_load_dwordx4 v[124:127], v1, s[16:19], s35 offen offset:1024
    s_mov_b32 s35, 12288
    buffer_load_dwordx4 v[136:139], v1, s[16:19], s35 offen offset:0
    s_mov_b32 s35, 12288
    buffer_load_dwordx4 v[140:143], v1, s[16:19], s35 offen offset:1024
    s_mov_b32 s35, 14336
    buffer_load_dwordx4 v[152:155], v1, s[16:19], s35 offen offset:0
    s_mov_b32 s35, 14336
    buffer_load_dwordx4 v[156:159], v1, s[16:19], s35 offen offset:1024
    s_mov_b32 s35, 16384
    buffer_load_dwordx4 v[168:171], v1, s[16:19], s35 offen offset:0
    s_mov_b32 s35, 16384
    buffer_load_dwordx4 v[172:175], v1, s[16:19], s35 offen offset:1024
    s_mov_b32 s35, 18432
    buffer_load_dwordx4 v[184:187], v1, s[16:19], s35 offen offset:0
    s_mov_b32 s35, 18432
    buffer_load_dwordx4 v[188:191], v1, s[16:19], s35 offen offset:1024
    s_mov_b32 s35, 20480
    buffer_load_dwordx4 v[200:203], v1, s[16:19], s35 offen offset:0
    s_mov_b32 s35, 20480
    buffer_load_dwordx4 v[204:207], v1, s[16:19], s35 offen offset:1024
    s_lshr_b32 s47, s42, 1
    s_lshl_b32 s47, s47, 7
    s_add_u32 s47, s47, 2048
    v_and_b32 v16, 63, v0
    v_min_u32 v16, 15, v16
    v_lshlrev_b32 v16, 2, v16
    s_cmp_eq_u32 s32, 0
    s_cbranch_scc0 k3_poll_skip
    s_mov_b32 s46, 0
k3_poll_loop:
    buffer_load_dword v17, v16, s[76:79], s47 offen sc1
    s_waitcnt vmcnt(0)
    v_cmp_ne_u32 s[44:45], 1, v17
    s_add_u32 s46, s46, 1
    s_cmp_eq_u64 s[44:45], 0
    s_cbranch_scc1 k3_poll_done
    s_sleep 6
    s_cmp_lt_u32 s46, 400000
    s_cbranch_scc1 k3_poll_loop
k3_poll_done:
k3_poll_skip:
    s_barrier
    s_mov_b32 s35, 0
    buffer_load_dwordx4 v[32:35], v1, s[8:11], s35 offen offset:0
    s_mov_b32 s35, 0
    buffer_load_dwordx4 v[36:39], v1, s[8:11], s35 offen offset:1024
    s_mov_b32 s35, 2048
    buffer_load_dwordx4 v[48:51], v1, s[8:11], s35 offen offset:0
    s_mov_b32 s35, 2048
    buffer_load_dwordx4 v[52:55], v1, s[8:11], s35 offen offset:1024
    s_mov_b32 s35, 4096
    buffer_load_dwordx4 v[64:67], v1, s[8:11], s35 offen offset:0
    s_mov_b32 s35, 4096
    buffer_load_dwordx4 v[68:71], v1, s[8:11], s35 offen offset:1024
    s_mov_b32 s35, 6144
    buffer_load_dwordx4 v[80:83], v1, s[8:11], s35 offen offset:0
    s_mov_b32 s35, 6144
    buffer_load_dwordx4 v[84:87], v1, s[8:11], s35 offen offset:1024
    s_mov_b32 s35, 8192
    buffer_load_dwordx4 v[96:99], v1, s[8:11], s35 offen offset:0
    s_mov_b32 s35, 8192
    buffer_load_dwordx4 v[100:103], v1, s[8:11], s35 offen offset:1024
    s_mov_b32 s35, 10240
    buffer_load_dwordx4 v[112:115], v1, s[8:11], s35 offen offset:0
    s_mov_b32 s35, 10240
    buffer_load_dwordx4 v[116:119], v1, s[8:11], s35 offen offset:1024
    s_mov_b32 s35, 12288
    buffer_load_dwordx4 v[128:131], v1, s[8:11], s35 offen offset:0
    s_mov_b32 s35, 12288
    buffer_load_dwordx4 v[132:135], v1, s[8:11], s35 offen offset:1024
    s_mov_b32 s35, 14336
    buffer_load_dwordx4 v[144:147], v1, s[8:11], s35 offen offset:0
    s_mov_b32 s35, 14336
    buffer_load_dwordx4 v[148:151], v1, s[8:11], s35 offen offset:1024
    s_mov_b32 s35, 16384
    buffer_load_dwordx4 v[160:163], v1, s[8:11], s35 offen offset:0
    s_mov_b32 s35, 16384
    buffer_load_dwordx4 v[164:167], v1, s[8:11], s35 offen offset:1024
    s_mov_b32 s35, 18432
    buffer_load_dwordx4 v[176:179], v1, s[8:11], s35 offen offset:0
    s_mov_b32 s35, 18432
    buffer_load_dwordx4 v[180:183], v1, s[8:11], s35 offen offset:1024
    s_mov_b32 s35, 20480
    buffer_load_dwordx4 v[192:195], v1, s[8:11], s35 offen offset:0
    s_mov_b32 s35, 20480
    buffer_load_dwordx4 v[196:199], v1, s[8:11], s35 offen offset:1024
    s_waitcnt vmcnt(20)
    v_mfma_f32_32x32x16_bf16 a[0:15], v[40:43], v[32:35], 0
    s_mov_b32 s35, 22528
    buffer_load_dwordx4 v[208:211], v1, s[8:11], s35 offen offset:0
    v_mfma_f32_32x32x16_bf16 a[16:31], v[44:47], v[32:35], 0
    s_mov_b32 s35, 22528
    buffer_load_dwordx4 v[212:215], v1, s[8:11], s35 offen offset:1024
    v_mfma_f32_32x32x16_bf16 a[32:47], v[40:43], v[36:39], 0
    s_mov_b32 s35, 22528
    buffer_load_dwordx4 v[216:219], v1, s[16:19], s35 offen offset:0
    v_mfma_f32_32x32x16_bf16 a[48:63], v[44:47], v[36:39], 0
    s_mov_b32 s35, 22528
    buffer_load_dwordx4 v[220:223], v1, s[16:19], s35 offen offset:1024
    s_waitcnt vmcnt(22)
    v_mfma_f32_32x32x16_bf16 a[0:15], v[56:59], v[48:51], a[0:15]
    s_mov_b32 s35, 24576
    buffer_load_dwordx4 v[32:35], v1, s[8:11], s35 offen offset:0
    v_mfma_f32_32x32x16_bf16 a[16:31], v[60:63], v[48:51], a[16:31]
    s_mov_b32 s35, 24576
    buffer_load_dwordx4 v[36:39], v1, s[8:11], s35 offen offset:1024
    v_mfma_f32_32x32x16_bf16 a[32:47], v[56:59], v[52:55], a[32:47]
    s_mov_b32 s35, 24576
    buffer_load_dwordx4 v[40:43], v1, s[16:19], s35 offen offset:0
    v_mfma_f32_32x32x16_bf16 a[48:63], v[60:63], v[52:55], a[48:63]
    s_mov_b32 s35, 24576
    buffer_load_dwordx4 v[44:47], v1, s[16:19], s35 offen offset:1024
    s_waitcnt vmcnt(24)
    v_mfma_f32_32x32x16_bf16 a[0:15], v[72:75], v[64:67], a[0:15]
    s_mov_b32 s35, 26624
    buffer_load_dwordx4 v[48:51], v1, s[8:11], s35 offen offset:0
    v_mfma_f32_32x32x16_bf16 a[16:31], v[76:79], v[64:67], a[16:31]
    s_mov_b32 s35, 26624
    buffer_load_dwordx4 v[52:55], v1, s[8:11], s35 offen offset:1024
    v_mfma_f32_32x32x16_bf16 a[32:47], v[72:75], v[68:71], a[32:47]
    s_mov_b32 s35, 26624
    buffer_load_dwordx4 v[56:59], v1, s[16:19], s35 offen offset:0
    v_mfma_f32_32x32x16_bf16 a[48:63], v[76:79], v[68:71], a[48:63]
    s_mov_b32 s35, 26624
    buffer_load_dwordx4 v[60:63], v1, s[16:19], s35 offen offset:1024
    s_waitcnt vmcnt(26)
    v_mfma_f32_32x32x16_bf16 a[0:15], v[88:91], v[80:83], a[0:15]
    s_mov_b32 s35, 28672
    buffer_load_dwordx4 v[64:67], v1, s[8:11], s35 offen offset:0
    v_mfma_f32_32x32x16_bf16 a[16:31], v[92:95], v[80:83], a[16:31]
    s_mov_b32 s35, 28672
    buffer_load_dwordx4 v[68:71], v1, s[8:11], s35 offen offset:1024
    v_mfma_f32_32x32x16_bf16 a[32:47], v[88:91], v[84:87], a[32:47]
    s_mov_b32 s35, 28672
    buffer_load_dwordx4 v[72:75], v1, s[16:19], s35 offen offset:0
    v_mfma_f32_32x32x16_bf16 a[48:63], v[92:95], v[84:87], a[48:63]
    s_mov_b32 s35, 28672
    buffer_load_dwordx4 v[76:79], v1, s[16:19], s35 offen offset:1024
    s_waitcnt vmcnt(28)
    v_mfma_f32_32x32x16_bf16 a[0:15], v[104:107], v[96:99], a[0:15]
    s_mov_b32 s35, 30720
    buffer_load_dwordx4 v[80:83], v1, s[8:11], s35 offen offset:0
    v_mfma_f32_32x32x16_bf16 a[16:31], v[108:111], v[96:99], a[16:31]
    s_mov_b32 s35, 30720
    buffer_load_dwordx4 v[84:87], v1, s[8:11], s35 offen offset:1024
    v_mfma_f32_32x32x16_bf16 a[32:47], v[104:107], v[100:103], a[32:47]
    s_mov_b32 s35, 30720
    buffer_load_dwordx4 v[88:91], v1, s[16:19], s35 offen offset:0
    v_mfma_f32_32x32x16_bf16 a[48:63], v[108:111], v[100:103], a[48:63]
    s_mov_b32 s35, 30720
    buffer_load_dwordx4 v[92:95], v1, s[16:19], s35 offen offset:1024
    s_waitcnt vmcnt(30)
    v_mfma_f32_32x32x16_bf16 a[0:15], v[120:123], v[112:115], a[0:15]
    s_mov_b32 s35, 32768
    buffer_load_dwordx4 v[96:99], v1, s[8:11], s35 offen offset:0
    v_mfma_f32_32x32x16_bf16 a[16:31], v[124:127], v[112:115], a[16:31]
    s_mov_b32 s35, 32768
    buffer_load_dwordx4 v[100:103], v1, s[8:11], s35 offen offset:1024
    v_mfma_f32_32x32x16_bf16 a[32:47], v[120:123], v[116:119], a[32:47]
    s_mov_b32 s35, 32768
    buffer_load_dwordx4 v[104:107], v1, s[16:19], s35 offen offset:0
    v_mfma_f32_32x32x16_bf16 a[48:63], v[124:127], v[116:119], a[48:63]
    s_mov_b32 s35, 32768
    buffer_load_dwordx4 v[108:111], v1, s[16:19], s35 offen offset:1024
    s_waitcnt vmcnt(32)
    v_mfma_f32_32x32x16_bf16 a[0:15], v[136:139], v[128:131], a[0:15]
    s_mov_b32 s35, 34816
    buffer_load_dwordx4 v[112:115], v1, s[8:11], s35 offen offset:0
    v_mfma_f32_32x32x16_bf16 a[16:31], v[140:143], v[128:131], a[16:31]
    s_mov_b32 s35, 34816
    buffer_load_dwordx4 v[116:119], v1, s[8:11], s35 offen offset:1024
    v_mfma_f32_32x32x16_bf16 a[32:47], v[136:139], v[132:135], a[32:47]
    s_mov_b32 s35, 34816
    buffer_load_dwordx4 v[120:123], v1, s[16:19], s35 offen offset:0
    v_mfma_f32_32x32x16_bf16 a[48:63], v[140:143], v[132:135], a[48:63]
    s_mov_b32 s35, 34816
    buffer_load_dwordx4 v[124:127], v1, s[16:19], s35 offen offset:1024
    s_waitcnt vmcnt(34)
    v_mfma_f32_32x32x16_bf16 a[0:15], v[152:155], v[144:147], a[0:15]
    s_mov_b32 s35, 36864
    buffer_load_dwordx4 v[128:131], v1, s[8:11], s35 offen offset:0
    v_mfma_f32_32x32x16_bf16 a[16:31], v[156:159], v[144:147], a[16:31]
    s_mov_b32 s35, 36864
    buffer_load_dwordx4 v[132:135], v1, s[8:11], s35 offen offset:1024
    v_mfma_f32_32x32x16_bf16 a[32:47], v[152:155], v[148:151], a[32:47]
    s_mov_b32 s35, 36864
    buffer_load_dwordx4 v[136:139], v1, s[16:19], s35 offen offset:0
    v_mfma_f32_32x32x16_bf16 a[48:63], v[156:159], v[148:151], a[48:63]
    s_mov_b32 s35, 36864
    buffer_load_dwordx4 v[140:143], v1, s[16:19], s35 offen offset:1024
    s_waitcnt vmcnt(36)
    v_mfma_f32_32x32x16_bf16 a[0:15], v[168:171], v[160:163], a[0:15]
    s_mov_b32 s35, 38912
    buffer_load_dwordx4 v[144:147], v1, s[8:11], s35 offen offset:0
    v_mfma_f32_32x32x16_bf16 a[16:31], v[172:175], v[160:163], a[16:31]
    s_mov_b32 s35, 38912
    buffer_load_dwordx4 v[148:151], v1, s[8:11], s35 offen offset:1024
    v_mfma_f32_32x32x16_bf16 a[32:47], v[168:171], v[164:167], a[32:47]
    s_mov_b32 s35, 38912
    buffer_load_dwordx4 v[152:155], v1, s[16:19], s35 offen offset:0
    v_mfma_f32_32x32x16_bf16 a[48:63], v[172:175], v[164:167], a[48:63]
    s_mov_b32 s35, 38912
    buffer_load_dwordx4 v[156:159], v1, s[16:19], s35 offen offset:1024
    s_waitcnt vmcnt(38)
    v_mfma_f32_32x32x16_bf16 a[0:15], v[184:187], v[176:179], a[0:15]
    s_mov_b32 s35, 40960
    buffer_load_dwordx4 v[160:163], v1, s[8:11], s35 offen offset:0
    v_mfma_f32_32x32x16_bf16 a[16:31], v[188:191], v[176:179], a[16:31]
    s_mov_b32 s35, 40960
    buffer_load_dwordx4 v[164:167], v1, s[8:11], s35 offen offset:1024
    v_mfma_f32_32x32x16_bf16 a[32:47], v[184:187], v[180:183], a[32:47]
    s_mov_b32 s35, 40960
    buffer_load_dwordx4 v[168:171], v1, s[16:19], s35 offen offset:0
    v_mfma_f32_32x32x16_bf16 a[48:63], v[188:191], v[180:183], a[48:63]
    s_mov_b32 s35, 40960
    buffer_load_dwordx4 v[172:175], v1, s[16:19], s35 offen offset:1024
    s_waitcnt vmcnt(40)
    v_mfma_f32_32x32x16_bf16 a[0:15], v[200:203], v[192:195], a[0:15]
    s_mov_b32 s35, 43008
    buffer_load_dwordx4 v[176:179], v1, s[8:11], s35 offen offset:0
    v_mfma_f32_32x32x16_bf16 a[16:31], v[204:207], v[192:195], a[16:31]
    s_mov_b32 s35, 43008
    buffer_load_dwordx4 v[180:183], v1, s[8:11], s35 offen offset:1024
    v_mfma_f32_32x32x16_bf16 a[32:47], v[200:203], v[196:199], a[32:47]
    s_mov_b32 s35, 43008
    buffer_load_dwordx4 v[184:187], v1, s[16:19], s35 offen offset:0
    v_mfma_f32_32x32x16_bf16 a[48:63], v[204:207], v[196:199], a[48:63]
    s_mov_b32 s35, 43008
    buffer_load_dwordx4 v[188:191], v1, s[16:19], s35 offen offset:1024
    s_waitcnt vmcnt(40)
    v_mfma_f32_32x32x16_bf16 a[0:15], v[216:219], v[208:211], a[0:15]
    s_mov_b32 s35, 45056
    buffer_load_dwordx4 v[192:195], v1, s[8:11], s35 offen offset:0
    v_mfma_f32_32x32x16_bf16 a[16:31], v[220:223], v[208:211], a[16:31]
    s_mov_b32 s35, 45056
    buffer_load_dwordx4 v[196:199], v1, s[8:11], s35 offen offset:1024
    v_mfma_f32_32x32x16_bf16 a[32:47], v[216:219], v[212:215], a[32:47]
    s_mov_b32 s35, 45056
    buffer_load_dwordx4 v[200:203], v1, s[16:19], s35 offen offset:0
    v_mfma_f32_32x32x16_bf16 a[48:63], v[220:223], v[212:215], a[48:63]
    s_mov_b32 s35, 45056
    buffer_load_dwordx4 v[204:207], v1, s[16:19], s35 offen offset:1024
    s_waitcnt vmcnt(40)
    v_mfma_f32_32x32x16_bf16 a[0:15], v[40:43], v[32:35], a[0:15]
    s_mov_b32 s35, 47104
    buffer_load_dwordx4 v[208:211], v1, s[8:11], s35 offen offset:0
    v_mfma_f32_32x32x16_bf16 a[16:31], v[44:47], v[32:35], a[16:31]
    s_mov_b32 s35, 47104
    buffer_load_dwordx4 v[212:215], v1, s[8:11], s35 offen offset:1024
    v_mfma_f32_32x32x16_bf16 a[32:47], v[40:43], v[36:39], a[32:47]
    s_mov_b32 s35, 47104
    buffer_load_dwordx4 v[216:219], v1, s[16:19], s35 offen offset:0
    v_mfma_f32_32x32x16_bf16 a[48:63], v[44:47], v[36:39], a[48:63]
    s_mov_b32 s35, 47104
    buffer_load_dwordx4 v[220:223], v1, s[16:19], s35 offen offset:1024
    s_waitcnt vmcnt(40)
    v_mfma_f32_32x32x16_bf16 a[0:15], v[56:59], v[48:51], a[0:15]
    s_mov_b32 s35, 49152
    buffer_load_dwordx4 v[32:35], v1, s[8:11], s35 offen offset:0
    v_mfma_f32_32x32x16_bf16 a[16:31], v[60:63], v[48:51], a[16:31]
    s_mov_b32 s35, 49152
    buffer_load_dwordx4 v[36:39], v1, s[8:11], s35 offen offset:1024
    v_mfma_f32_32x32x16_bf16 a[32:47], v[56:59], v[52:55], a[32:47]
    s_mov_b32 s35, 49152
    buffer_load_dwordx4 v[40:43], v1, s[16:19], s35 offen offset:0
    v_mfma_f32_32x32x16_bf16 a[48:63], v[60:63], v[52:55], a[48:63]
    s_mov_b32 s35, 49152
    buffer_load_dwordx4 v[44:47], v1, s[16:19], s35 offen offset:1024
    s_waitcnt vmcnt(40)
    v_mfma_f32_32x32x16_bf16 a[0:15], v[72:75], v[64:67], a[0:15]
    s_mov_b32 s35, 51200
    buffer_load_dwordx4 v[48:51], v1, s[8:11], s35 offen offset:0
    v_mfma_f32_32x32x16_bf16 a[16:31], v[76:79], v[64:67], a[16:31]
    s_mov_b32 s35, 51200
    buffer_load_dwordx4 v[52:55], v1, s[8:11], s35 offen offset:1024
    v_mfma_f32_32x32x16_bf16 a[32:47], v[72:75], v[68:71], a[32:47]
    s_mov_b32 s35, 51200
    buffer_load_dwordx4 v[56:59], v1, s[16:19], s35 offen offset:0
    v_mfma_f32_32x32x16_bf16 a[48:63], v[76:79], v[68:71], a[48:63]
    s_mov_b32 s35, 51200
    buffer_load_dwordx4 v[60:63], v1, s[16:19], s35 offen offset:1024
    s_waitcnt vmcnt(40)
    v_mfma_f32_32x32x16_bf16 a[0:15], v[88:91], v[80:83], a[0:15]
    s_mov_b32 s35, 53248
    buffer_load_dwordx4 v[64:67], v1, s[8:11], s35 offen offset:0
    v_mfma_f32_32x32x16_bf16 a[16:31], v[92:95], v[80:83], a[16:31]
    s_mov_b32 s35, 53248
    buffer_load_dwordx4 v[68:71], v1, s[8:11], s35 offen offset:1024
    v_mfma_f32_32x32x16_bf16 a[32:47], v[88:91], v[84:87], a[32:47]
    s_mov_b32 s35, 53248
    buffer_load_dwordx4 v[72:75], v1, s[16:19], s35 offen offset:0
    v_mfma_f32_32x32x16_bf16 a[48:63], v[92:95], v[84:87], a[48:63]
    s_mov_b32 s35, 53248
    buffer_load_dwordx4 v[76:79], v1, s[16:19], s35 offen offset:1024
    s_waitcnt vmcnt(40)
    v_mfma_f32_32x32x16_bf16 a[0:15], v[104:107], v[96:99], a[0:15]
    s_mov_b32 s35, 55296
    buffer_load_dwordx4 v[80:83], v1, s[8:11], s35 offen offset:0
    v_mfma_f32_32x32x16_bf16 a[16:31], v[108:111], v[96:99], a[16:31]
    s_mov_b32 s35, 55296
    buffer_load_dwordx4 v[84:87], v1, s[8:11], s35 offen offset:1024
    v_mfma_f32_32x32x16_bf16 a[32:47], v[104:107], v[100:103], a[32:47]
    s_mov_b32 s35, 55296
    buffer_load_dwordx4 v[88:91], v1, s[16:19], s35 offen offset:0
    v_mfma_f32_32x32x16_bf16 a[48:63], v[108:111], v[100:103], a[48:63]
    s_mov_b32 s35, 55296
    buffer_load_dwordx4 v[92:95], v1, s[16:19], s35 offen offset:1024
    s_waitcnt vmcnt(40)
    v_mfma_f32_32x32x16_bf16 a[0:15], v[120:123], v[112:115], a[0:15]
    s_mov_b32 s35, 57344
    buffer_load_dwordx4 v[96:99], v1, s[8:11], s35 offen offset:0
    v_mfma_f32_32x32x16_bf16 a[16:31], v[124:127], v[112:115], a[16:31]
    s_mov_b32 s35, 57344
    buffer_load_dwordx4 v[100:103], v1, s[8:11], s35 offen offset:1024
    v_mfma_f32_32x32x16_bf16 a[32:47], v[120:123], v[116:119], a[32:47]
    s_mov_b32 s35, 57344
    buffer_load_dwordx4 v[104:107], v1, s[16:19], s35 offen offset:0
    v_mfma_f32_32x32x16_bf16 a[48:63], v[124:127], v[116:119], a[48:63]
    s_mov_b32 s35, 57344
    buffer_load_dwordx4 v[108:111], v1, s[16:19], s35 offen offset:1024
    s_waitcnt vmcnt(40)
    v_mfma_f32_32x32x16_bf16 a[0:15], v[136:139], v[128:131], a[0:15]
    s_mov_b32 s35, 59392
    buffer_load_dwordx4 v[112:115], v1, s[8:11], s35 offen offset:0
    v_mfma_f32_32x32x16_bf16 a[16:31], v[140:143], v[128:131], a[16:31]
    s_mov_b32 s35, 59392
    buffer_load_dwordx4 v[116:119], v1, s[8:11], s35 offen offset:1024
    v_mfma_f32_32x32x16_bf16 a[32:47], v[136:139], v[132:135], a[32:47]
    s_mov_b32 s35, 59392
    buffer_load_dwordx4 v[120:123], v1, s[16:19], s35 offen offset:0
    v_mfma_f32_32x32x16_bf16 a[48:63], v[140:143], v[132:135], a[48:63]
    s_mov_b32 s35, 59392
    buffer_load_dwordx4 v[124:127], v1, s[16:19], s35 offen offset:1024
    s_waitcnt vmcnt(40)
    v_mfma_f32_32x32x16_bf16 a[0:15], v[152:155], v[144:147], a[0:15]
    s_mov_b32 s35, 61440
    buffer_load_dwordx4 v[128:131], v1, s[8:11], s35 offen offset:0
    v_mfma_f32_32x32x16_bf16 a[16:31], v[156:159], v[144:147], a[16:31]
    s_mov_b32 s35, 61440
    buffer_load_dwordx4 v[132:135], v1, s[8:11], s35 offen offset:1024
    v_mfma_f32_32x32x16_bf16 a[32:47], v[152:155], v[148:151], a[32:47]
    s_mov_b32 s35, 61440
    buffer_load_dwordx4 v[136:139], v1, s[16:19], s35 offen offset:0
    v_mfma_f32_32x32x16_bf16 a[48:63], v[156:159], v[148:151], a[48:63]
    s_mov_b32 s35, 61440
    buffer_load_dwordx4 v[140:143], v1, s[16:19], s35 offen offset:1024
    s_waitcnt vmcnt(40)
    v_mfma_f32_32x32x16_bf16 a[0:15], v[168:171], v[160:163], a[0:15]
    s_mov_b32 s35, 63488
    buffer_load_dwordx4 v[144:147], v1, s[8:11], s35 offen offset:0
    v_mfma_f32_32x32x16_bf16 a[16:31], v[172:175], v[160:163], a[16:31]
    s_mov_b32 s35, 63488
    buffer_load_dwordx4 v[148:151], v1, s[8:11], s35 offen offset:1024
    v_mfma_f32_32x32x16_bf16 a[32:47], v[168:171], v[164:167], a[32:47]
    s_mov_b32 s35, 63488
    buffer_load_dwordx4 v[152:155], v1, s[16:19], s35 offen offset:0
    v_mfma_f32_32x32x16_bf16 a[48:63], v[172:175], v[164:167], a[48:63]
    s_mov_b32 s35, 63488
    buffer_load_dwordx4 v[156:159], v1, s[16:19], s35 offen offset:1024
    s_waitcnt vmcnt(40)
    v_mfma_f32_32x32x16_bf16 a[0:15], v[184:187], v[176:179], a[0:15]
    s_mov_b32 s35, 65536
    buffer_load_dwordx4 v[160:163], v1, s[8:11], s35 offen offset:0
    v_mfma_f32_32x32x16_bf16 a[16:31], v[188:191], v[176:179], a[16:31]
    s_mov_b32 s35, 65536
    buffer_load_dwordx4 v[164:167], v1, s[8:11], s35 offen offset:1024
    v_mfma_f32_32x32x16_bf16 a[32:47], v[184:187], v[180:183], a[32:47]
    s_mov_b32 s35, 65536
    buffer_load_dwordx4 v[168:171], v1, s[16:19], s35 offen offset:0
    v_mfma_f32_32x32x16_bf16 a[48:63], v[188:191], v[180:183], a[48:63]
    s_mov_b32 s35, 65536
    buffer_load_dwordx4 v[172:175], v1, s[16:19], s35 offen offset:1024
    s_waitcnt vmcnt(40)
    v_mfma_f32_32x32x16_bf16 a[0:15], v[200:203], v[192:195], a[0:15]
    s_mov_b32 s35, 67584
    buffer_load_dwordx4 v[176:179], v1, s[8:11], s35 offen offset:0
    v_mfma_f32_32x32x16_bf16 a[16:31], v[204:207], v[192:195], a[16:31]
    s_mov_b32 s35, 67584
    buffer_load_dwordx4 v[180:183], v1, s[8:11], s35 offen offset:1024
    v_mfma_f32_32x32x16_bf16 a[32:47], v[200:203], v[196:199], a[32:47]
    s_mov_b32 s35, 67584
    buffer_load_dwordx4 v[184:187], v1, s[16:19], s35 offen offset:0
    v_mfma_f32_32x32x16_bf16 a[48:63], v[204:207], v[196:199], a[48:63]
    s_mov_b32 s35, 67584
    buffer_load_dwordx4 v[188:191], v1, s[16:19], s35 offen offset:1024
    s_waitcnt vmcnt(40)
    v_mfma_f32_32x32x16_bf16 a[0:15], v[216:219], v[208:211], a[0:15]
    s_mov_b32 s35, 69632
    buffer_load_dwordx4 v[192:195], v1, s[8:11], s35 offen offset:0
    v_mfma_f32_32x32x16_bf16 a[16:31], v[220:223], v[208:211], a[16:31]
    s_mov_b32 s35, 69632
    buffer_load_dwordx4 v[196:199], v1, s[8:11], s35 offen offset:1024
    v_mfma_f32_32x32x16_bf16 a[32:47], v[216:219], v[212:215], a[32:47]
    s_mov_b32 s35, 69632
    buffer_load_dwordx4 v[200:203], v1, s[16:19], s35 offen offset:0
    v_mfma_f32_32x32x16_bf16 a[48:63], v[220:223], v[212:215], a[48:63]
    s_mov_b32 s35, 69632
    buffer_load_dwordx4 v[204:207], v1, s[16:19], s35 offen offset:1024
    s_waitcnt vmcnt(40)
    v_mfma_f32_32x32x16_bf16 a[0:15], v[40:43], v[32:35], a[0:15]
    s_mov_b32 s35, 71680
    buffer_load_dwordx4 v[208:211], v1, s[8:11], s35 offen offset:0
    v_mfma_f32_32x32x16_bf16 a[16:31], v[44:47], v[32:35], a[16:31]
    s_mov_b32 s35, 71680
    buffer_load_dwordx4 v[212:215], v1, s[8:11], s35 offen offset:1024
    v_mfma_f32_32x32x16_bf16 a[32:47], v[40:43], v[36:39], a[32:47]
    s_mov_b32 s35, 71680
    buffer_load_dwordx4 v[216:219], v1, s[16:19], s35 offen offset:0
    v_mfma_f32_32x32x16_bf16 a[48:63], v[44:47], v[36:39], a[48:63]
    s_mov_b32 s35, 71680
    buffer_load_dwordx4 v[220:223], v1, s[16:19], s35 offen offset:1024
    s_waitcnt vmcnt(40)
    v_mfma_f32_32x32x16_bf16 a[0:15], v[56:59], v[48:51], a[0:15]
    s_mov_b32 s35, 73728
    buffer_load_dwordx4 v[32:35], v1, s[8:11], s35 offen offset:0
    v_mfma_f32_32x32x16_bf16 a[16:31], v[60:63], v[48:51], a[16:31]
    s_mov_b32 s35, 73728
    buffer_load_dwordx4 v[36:39], v1, s[8:11], s35 offen offset:1024
    v_mfma_f32_32x32x16_bf16 a[32:47], v[56:59], v[52:55], a[32:47]
    s_mov_b32 s35, 73728
    buffer_load_dwordx4 v[40:43], v1, s[16:19], s35 offen offset:0
    v_mfma_f32_32x32x16_bf16 a[48:63], v[60:63], v[52:55], a[48:63]
    s_mov_b32 s35, 73728
    buffer_load_dwordx4 v[44:47], v1, s[16:19], s35 offen offset:1024
    s_waitcnt vmcnt(40)
    v_mfma_f32_32x32x16_bf16 a[0:15], v[72:75], v[64:67], a[0:15]
    s_mov_b32 s35, 75776
    buffer_load_dwordx4 v[48:51], v1, s[8:11], s35 offen offset:0
    v_mfma_f32_32x32x16_bf16 a[16:31], v[76:79], v[64:67], a[16:31]
    s_mov_b32 s35, 75776
    buffer_load_dwordx4 v[52:55], v1, s[8:11], s35 offen offset:1024
    v_mfma_f32_32x32x16_bf16 a[32:47], v[72:75], v[68:71], a[32:47]
    s_mov_b32 s35, 75776
    buffer_load_dwordx4 v[56:59], v1, s[16:19], s35 offen offset:0
    v_mfma_f32_32x32x16_bf16 a[48:63], v[76:79], v[68:71], a[48:63]
    s_mov_b32 s35, 75776
    buffer_load_dwordx4 v[60:63], v1, s[16:19], s35 offen offset:1024
    s_waitcnt vmcnt(40)
    v_mfma_f32_32x32x16_bf16 a[0:15], v[88:91], v[80:83], a[0:15]
    s_mov_b32 s35, 77824
    buffer_load_dwordx4 v[64:67], v1, s[8:11], s35 offen offset:0
    v_mfma_f32_32x32x16_bf16 a[16:31], v[92:95], v[80:83], a[16:31]
    s_mov_b32 s35, 77824
    buffer_load_dwordx4 v[68:71], v1, s[8:11], s35 offen offset:1024
    v_mfma_f32_32x32x16_bf16 a[32:47], v[88:91], v[84:87], a[32:47]
    s_mov_b32 s35, 77824
    buffer_load_dwordx4 v[72:75], v1, s[16:19], s35 offen offset:0
    v_mfma_f32_32x32x16_bf16 a[48:63], v[92:95], v[84:87], a[48:63]
    s_mov_b32 s35, 77824
    buffer_load_dwordx4 v[76:79], v1, s[16:19], s35 offen offset:1024
    s_waitcnt vmcnt(40)
    v_mfma_f32_32x32x16_bf16 a[0:15], v[104:107], v[96:99], a[0:15]
    s_mov_b32 s35, 79872
    buffer_load_dwordx4 v[80:83], v1, s[8:11], s35 offen offset:0
    v_mfma_f32_32x32x16_bf16 a[16:31], v[108:111], v[96:99], a[16:31]
    s_mov_b32 s35, 79872
    buffer_load_dwordx4 v[84:87], v1, s[8:11], s35 offen offset:1024
    v_mfma_f32_32x32x16_bf16 a[32:47], v[104:107], v[100:103], a[32:47]
    s_mov_b32 s35, 79872
    buffer_load_dwordx4 v[88:91], v1, s[16:19], s35 offen offset:0
    v_mfma_f32_32x32x16_bf16 a[48:63], v[108:111], v[100:103], a[48:63]
    s_mov_b32 s35, 79872
    buffer_load_dwordx4 v[92:95], v1, s[16:19], s35 offen offset:1024
    s_waitcnt vmcnt(40)
    v_mfma_f32_32x32x16_bf16 a[0:15], v[120:123], v[112:115], a[0:15]
    s_mov_b32 s35, 81920
    buffer_load_dwordx4 v[96:99], v1, s[8:11], s35 offen offset:0
    v_mfma_f32_32x32x16_bf16 a[16:31], v[124:127], v[112:115], a[16:31]
    s_mov_b32 s35, 81920
    buffer_load_dwordx4 v[100:103], v1, s[8:11], s35 offen offset:1024
    v_mfma_f32_32x32x16_bf16 a[32:47], v[120:123], v[116:119], a[32:47]
    s_mov_b32 s35, 81920
    buffer_load_dwordx4 v[104:107], v1, s[16:19], s35 offen offset:0
    v_mfma_f32_32x32x16_bf16 a[48:63], v[124:127], v[116:119], a[48:63]
    s_mov_b32 s35, 81920
    buffer_load_dwordx4 v[108:111], v1, s[16:19], s35 offen offset:1024
    s_waitcnt vmcnt(40)
    v_mfma_f32_32x32x16_bf16 a[0:15], v[136:139], v[128:131], a[0:15]
    s_mov_b32 s35, 83968
    buffer_load_dwordx4 v[112:115], v1, s[8:11], s35 offen offset:0
    v_mfma_f32_32x32x16_bf16 a[16:31], v[140:143], v[128:131], a[16:31]
    s_mov_b32 s35, 83968
    buffer_load_dwordx4 v[116:119], v1, s[8:11], s35 offen offset:1024
    v_mfma_f32_32x32x16_bf16 a[32:47], v[136:139], v[132:135], a[32:47]
    s_mov_b32 s35, 83968
    buffer_load_dwordx4 v[120:123], v1, s[16:19], s35 offen offset:0
    v_mfma_f32_32x32x16_bf16 a[48:63], v[140:143], v[132:135], a[48:63]
    s_mov_b32 s35, 83968
    buffer_load_dwordx4 v[124:127], v1, s[16:19], s35 offen offset:1024
    s_waitcnt vmcnt(40)
    v_mfma_f32_32x32x16_bf16 a[0:15], v[152:155], v[144:147], a[0:15]
    s_mov_b32 s35, 86016
    buffer_load_dwordx4 v[128:131], v1, s[8:11], s35 offen offset:0
    v_mfma_f32_32x32x16_bf16 a[16:31], v[156:159], v[144:147], a[16:31]
    s_mov_b32 s35, 86016
    buffer_load_dwordx4 v[132:135], v1, s[8:11], s35 offen offset:1024
    v_mfma_f32_32x32x16_bf16 a[32:47], v[152:155], v[148:151], a[32:47]
    s_mov_b32 s35, 86016
    buffer_load_dwordx4 v[136:139], v1, s[16:19], s35 offen offset:0
    v_mfma_f32_32x32x16_bf16 a[48:63], v[156:159], v[148:151], a[48:63]
    s_mov_b32 s35, 86016
    buffer_load_dwordx4 v[140:143], v1, s[16:19], s35 offen offset:1024
    s_waitcnt vmcnt(40)
    v_mfma_f32_32x32x16_bf16 a[0:15], v[168:171], v[160:163], a[0:15]
    s_mov_b32 s35, 88064
    buffer_load_dwordx4 v[144:147], v1, s[8:11], s35 offen offset:0
    v_mfma_f32_32x32x16_bf16 a[16:31], v[172:175], v[160:163], a[16:31]
    s_mov_b32 s35, 88064
    buffer_load_dwordx4 v[148:151], v1, s[8:11], s35 offen offset:1024
    v_mfma_f32_32x32x16_bf16 a[32:47], v[168:171], v[164:167], a[32:47]
    s_mov_b32 s35, 88064
    buffer_load_dwordx4 v[152:155], v1, s[16:19], s35 offen offset:0
    v_mfma_f32_32x32x16_bf16 a[48:63], v[172:175], v[164:167], a[48:63]
    s_mov_b32 s35, 88064
    buffer_load_dwordx4 v[156:159], v1, s[16:19], s35 offen offset:1024
    s_waitcnt vmcnt(40)
    v_mfma_f32_32x32x16_bf16 a[0:15], v[184:187], v[176:179], a[0:15]
    s_mov_b32 s35, 90112
    buffer_load_dwordx4 v[160:163], v1, s[8:11], s35 offen offset:0
    v_mfma_f32_32x32x16_bf16 a[16:31], v[188:191], v[176:179], a[16:31]
    s_mov_b32 s35, 90112
    buffer_load_dwordx4 v[164:167], v1, s[8:11], s35 offen offset:1024
    v_mfma_f32_32x32x16_bf16 a[32:47], v[184:187], v[180:183], a[32:47]
    s_mov_b32 s35, 90112
    buffer_load_dwordx4 v[168:171], v1, s[16:19], s35 offen offset:0
    v_mfma_f32_32x32x16_bf16 a[48:63], v[188:191], v[180:183], a[48:63]
    s_mov_b32 s35, 90112
    buffer_load_dwordx4 v[172:175], v1, s[16:19], s35 offen offset:1024
    s_waitcnt vmcnt(40)
    v_mfma_f32_32x32x16_bf16 a[0:15], v[200:203], v[192:195], a[0:15]
    s_mov_b32 s35, 92160
    buffer_load_dwordx4 v[176:179], v1, s[8:11], s35 offen offset:0
    v_mfma_f32_32x32x16_bf16 a[16:31], v[204:207], v[192:195], a[16:31]
    s_mov_b32 s35, 92160
    buffer_load_dwordx4 v[180:183], v1, s[8:11], s35 offen offset:1024
    v_mfma_f32_32x32x16_bf16 a[32:47], v[200:203], v[196:199], a[32:47]
    s_mov_b32 s35, 92160
    buffer_load_dwordx4 v[184:187], v1, s[16:19], s35 offen offset:0
    v_mfma_f32_32x32x16_bf16 a[48:63], v[204:207], v[196:199], a[48:63]
    s_mov_b32 s35, 92160
    buffer_load_dwordx4 v[188:191], v1, s[16:19], s35 offen offset:1024
    s_waitcnt vmcnt(40)
    v_mfma_f32_32x32x16_bf16 a[0:15], v[216:219], v[208:211], a[0:15]
    s_mov_b32 s35, 94208
    buffer_load_dwordx4 v[192:195], v1, s[8:11], s35 offen offset:0
    v_mfma_f32_32x32x16_bf16 a[16:31], v[220:223], v[208:211], a[16:31]
    s_mov_b32 s35, 94208
    buffer_load_dwordx4 v[196:199], v1, s[8:11], s35 offen offset:1024
    v_mfma_f32_32x32x16_bf16 a[32:47], v[216:219], v[212:215], a[32:47]
    s_mov_b32 s35, 94208
    buffer_load_dwordx4 v[200:203], v1, s[16:19], s35 offen offset:0
    v_mfma_f32_32x32x16_bf16 a[48:63], v[220:223], v[212:215], a[48:63]
    s_mov_b32 s35, 94208
    buffer_load_dwordx4 v[204:207], v1, s[16:19], s35 offen offset:1024
    s_waitcnt vmcnt(40)
    v_mfma_f32_32x32x16_bf16 a[0:15], v[40:43], v[32:35], a[0:15]
    s_mov_b32 s35, 96256
    buffer_load_dwordx4 v[208:211], v1, s[8:11], s35 offen offset:0
    v_mfma_f32_32x32x16_bf16 a[16:31], v[44:47], v[32:35], a[16:31]
    s_mov_b32 s35, 96256
    buffer_load_dwordx4 v[212:215], v1, s[8:11], s35 offen offset:1024
    v_mfma_f32_32x32x16_bf16 a[32:47], v[40:43], v[36:39], a[32:47]
    s_mov_b32 s35, 96256
    buffer_load_dwordx4 v[216:219], v1, s[16:19], s35 offen offset:0
    v_mfma_f32_32x32x16_bf16 a[48:63], v[44:47], v[36:39], a[48:63]
    s_mov_b32 s35, 96256
    buffer_load_dwordx4 v[220:223], v1, s[16:19], s35 offen offset:1024
    s_waitcnt vmcnt(40)
    v_mfma_f32_32x32x16_bf16 a[0:15], v[56:59], v[48:51], a[0:15]
    s_mov_b32 s35, 98304
    buffer_load_dwordx4 v[32:35], v1, s[8:11], s35 offen offset:0
    v_mfma_f32_32x32x16_bf16 a[16:31], v[60:63], v[48:51], a[16:31]
    s_mov_b32 s35, 98304
    buffer_load_dwordx4 v[36:39], v1, s[8:11], s35 offen offset:1024
    v_mfma_f32_32x32x16_bf16 a[32:47], v[56:59], v[52:55], a[32:47]
    s_mov_b32 s35, 98304
    buffer_load_dwordx4 v[40:43], v1, s[16:19], s35 offen offset:0
    v_mfma_f32_32x32x16_bf16 a[48:63], v[60:63], v[52:55], a[48:63]
    s_mov_b32 s35, 98304
    buffer_load_dwordx4 v[44:47], v1, s[16:19], s35 offen offset:1024
    s_waitcnt vmcnt(40)
    v_mfma_f32_32x32x16_bf16 a[0:15], v[72:75], v[64:67], a[0:15]
    s_mov_b32 s35, 100352
    buffer_load_dwordx4 v[48:51], v1, s[8:11], s35 offen offset:0
    v_mfma_f32_32x32x16_bf16 a[16:31], v[76:79], v[64:67], a[16:31]
    s_mov_b32 s35, 100352
    buffer_load_dwordx4 v[52:55], v1, s[8:11], s35 offen offset:1024
    v_mfma_f32_32x32x16_bf16 a[32:47], v[72:75], v[68:71], a[32:47]
    s_mov_b32 s35, 100352
    buffer_load_dwordx4 v[56:59], v1, s[16:19], s35 offen offset:0
    v_mfma_f32_32x32x16_bf16 a[48:63], v[76:79], v[68:71], a[48:63]
    s_mov_b32 s35, 100352
    buffer_load_dwordx4 v[60:63], v1, s[16:19], s35 offen offset:1024
    s_waitcnt vmcnt(40)
    v_mfma_f32_32x32x16_bf16 a[0:15], v[88:91], v[80:83], a[0:15]
    s_mov_b32 s35, 102400
    buffer_load_dwordx4 v[64:67], v1, s[8:11], s35 offen offset:0
    v_mfma_f32_32x32x16_bf16 a[16:31], v[92:95], v[80:83], a[16:31]
    s_mov_b32 s35, 102400
    buffer_load_dwordx4 v[68:71], v1, s[8:11], s35 offen offset:1024
    v_mfma_f32_32x32x16_bf16 a[32:47], v[88:91], v[84:87], a[32:47]
    s_mov_b32 s35, 102400
    buffer_load_dwordx4 v[72:75], v1, s[16:19], s35 offen offset:0
    v_mfma_f32_32x32x16_bf16 a[48:63], v[92:95], v[84:87], a[48:63]
    s_mov_b32 s35, 102400
    buffer_load_dwordx4 v[76:79], v1, s[16:19], s35 offen offset:1024
    s_waitcnt vmcnt(40)
    v_mfma_f32_32x32x16_bf16 a[0:15], v[104:107], v[96:99], a[0:15]
    s_mov_b32 s35, 104448
    buffer_load_dwordx4 v[80:83], v1, s[8:11], s35 offen offset:0
    v_mfma_f32_32x32x16_bf16 a[16:31], v[108:111], v[96:99], a[16:31]
    s_mov_b32 s35, 104448
    buffer_load_dwordx4 v[84:87], v1, s[8:11], s35 offen offset:1024
    v_mfma_f32_32x32x16_bf16 a[32:47], v[104:107], v[100:103], a[32:47]
    s_mov_b32 s35, 104448
    buffer_load_dwordx4 v[88:91], v1, s[16:19], s35 offen offset:0
    v_mfma_f32_32x32x16_bf16 a[48:63], v[108:111], v[100:103], a[48:63]
    s_mov_b32 s35, 104448
    buffer_load_dwordx4 v[92:95], v1, s[16:19], s35 offen offset:1024
    s_waitcnt vmcnt(40)
    v_mfma_f32_32x32x16_bf16 a[0:15], v[120:123], v[112:115], a[0:15]
    s_mov_b32 s35, 106496
    buffer_load_dwordx4 v[96:99], v1, s[8:11], s35 offen offset:0
    v_mfma_f32_32x32x16_bf16 a[16:31], v[124:127], v[112:115], a[16:31]
    s_mov_b32 s35, 106496
    buffer_load_dwordx4 v[100:103], v1, s[8:11], s35 offen offset:1024
    v_mfma_f32_32x32x16_bf16 a[32:47], v[120:123], v[116:119], a[32:47]
    s_mov_b32 s35, 106496
    buffer_load_dwordx4 v[104:107], v1, s[16:19], s35 offen offset:0
    v_mfma_f32_32x32x16_bf16 a[48:63], v[124:127], v[116:119], a[48:63]
    s_mov_b32 s35, 106496
    buffer_load_dwordx4 v[108:111], v1, s[16:19], s35 offen offset:1024
    s_waitcnt vmcnt(40)
    v_mfma_f32_32x32x16_bf16 a[0:15], v[136:139], v[128:131], a[0:15]
    s_mov_b32 s35, 108544
    buffer_load_dwordx4 v[112:115], v1, s[8:11], s35 offen offset:0
    v_mfma_f32_32x32x16_bf16 a[16:31], v[140:143], v[128:131], a[16:31]
    s_mov_b32 s35, 108544
    buffer_load_dwordx4 v[116:119], v1, s[8:11], s35 offen offset:1024
    v_mfma_f32_32x32x16_bf16 a[32:47], v[136:139], v[132:135], a[32:47]
    s_mov_b32 s35, 108544
    buffer_load_dwordx4 v[120:123], v1, s[16:19], s35 offen offset:0
    v_mfma_f32_32x32x16_bf16 a[48:63], v[140:143], v[132:135], a[48:63]
    s_mov_b32 s35, 108544
    buffer_load_dwordx4 v[124:127], v1, s[16:19], s35 offen offset:1024
    s_waitcnt vmcnt(40)
    v_mfma_f32_32x32x16_bf16 a[0:15], v[152:155], v[144:147], a[0:15]
    s_mov_b32 s35, 110592
    buffer_load_dwordx4 v[128:131], v1, s[8:11], s35 offen offset:0
    v_mfma_f32_32x32x16_bf16 a[16:31], v[156:159], v[144:147], a[16:31]
    s_mov_b32 s35, 110592
    buffer_load_dwordx4 v[132:135], v1, s[8:11], s35 offen offset:1024
    v_mfma_f32_32x32x16_bf16 a[32:47], v[152:155], v[148:151], a[32:47]
    s_mov_b32 s35, 110592
    buffer_load_dwordx4 v[136:139], v1, s[16:19], s35 offen offset:0
    v_mfma_f32_32x32x16_bf16 a[48:63], v[156:159], v[148:151], a[48:63]
    s_mov_b32 s35, 110592
    buffer_load_dwordx4 v[140:143], v1, s[16:19], s35 offen offset:1024
    s_waitcnt vmcnt(40)
    v_mfma_f32_32x32x16_bf16 a[0:15], v[168:171], v[160:163], a[0:15]
    s_mov_b32 s35, 112640
    buffer_load_dwordx4 v[144:147], v1, s[8:11], s35 offen offset:0
    v_mfma_f32_32x32x16_bf16 a[16:31], v[172:175], v[160:163], a[16:31]
    s_mov_b32 s35, 112640
    buffer_load_dwordx4 v[148:151], v1, s[8:11], s35 offen offset:1024
    v_mfma_f32_32x32x16_bf16 a[32:47], v[168:171], v[164:167], a[32:47]
    s_mov_b32 s35, 112640
    buffer_load_dwordx4 v[152:155], v1, s[16:19], s35 offen offset:0
    v_mfma_f32_32x32x16_bf16 a[48:63], v[172:175], v[164:167], a[48:63]
    s_mov_b32 s35, 112640
    buffer_load_dwordx4 v[156:159], v1, s[16:19], s35 offen offset:1024
    s_waitcnt vmcnt(40)
    v_mfma_f32_32x32x16_bf16 a[0:15], v[184:187], v[176:179], a[0:15]
    s_mov_b32 s35, 114688
    buffer_load_dwordx4 v[160:163], v1, s[8:11], s35 offen offset:0
    v_mfma_f32_32x32x16_bf16 a[16:31], v[188:191], v[176:179], a[16:31]
    s_mov_b32 s35, 114688
    buffer_load_dwordx4 v[164:167], v1, s[8:11], s35 offen offset:1024
    v_mfma_f32_32x32x16_bf16 a[32:47], v[184:187], v[180:183], a[32:47]
    s_mov_b32 s35, 114688
    buffer_load_dwordx4 v[168:171], v1, s[16:19], s35 offen offset:0
    v_mfma_f32_32x32x16_bf16 a[48:63], v[188:191], v[180:183], a[48:63]
    s_mov_b32 s35, 114688
    buffer_load_dwordx4 v[172:175], v1, s[16:19], s35 offen offset:1024
    s_waitcnt vmcnt(40)
    v_mfma_f32_32x32x16_bf16 a[0:15], v[200:203], v[192:195], a[0:15]
    s_mov_b32 s35, 116736
    buffer_load_dwordx4 v[176:179], v1, s[8:11], s35 offen offset:0
    v_mfma_f32_32x32x16_bf16 a[16:31], v[204:207], v[192:195], a[16:31]
    s_mov_b32 s35, 116736
    buffer_load_dwordx4 v[180:183], v1, s[8:11], s35 offen offset:1024
    v_mfma_f32_32x32x16_bf16 a[32:47], v[200:203], v[196:199], a[32:47]
    s_mov_b32 s35, 116736
    buffer_load_dwordx4 v[184:187], v1, s[16:19], s35 offen offset:0
    v_mfma_f32_32x32x16_bf16 a[48:63], v[204:207], v[196:199], a[48:63]
    s_mov_b32 s35, 116736
    buffer_load_dwordx4 v[188:191], v1, s[16:19], s35 offen offset:1024
    s_waitcnt vmcnt(40)
    v_mfma_f32_32x32x16_bf16 a[0:15], v[216:219], v[208:211], a[0:15]
    s_mov_b32 s35, 118784
    buffer_load_dwordx4 v[192:195], v1, s[8:11], s35 offen offset:0
    v_mfma_f32_32x32x16_bf16 a[16:31], v[220:223], v[208:211], a[16:31]
    s_mov_b32 s35, 118784
    buffer_load_dwordx4 v[196:199], v1, s[8:11], s35 offen offset:1024
    v_mfma_f32_32x32x16_bf16 a[32:47], v[216:219], v[212:215], a[32:47]
    s_mov_b32 s35, 118784
    buffer_load_dwordx4 v[200:203], v1, s[16:19], s35 offen offset:0
    v_mfma_f32_32x32x16_bf16 a[48:63], v[220:223], v[212:215], a[48:63]
    s_mov_b32 s35, 118784
    buffer_load_dwordx4 v[204:207], v1, s[16:19], s35 offen offset:1024
    s_waitcnt vmcnt(40)
    v_mfma_f32_32x32x16_bf16 a[0:15], v[40:43], v[32:35], a[0:15]
    s_mov_b32 s35, 120832
    buffer_load_dwordx4 v[208:211], v1, s[8:11], s35 offen offset:0
    v_mfma_f32_32x32x16_bf16 a[16:31], v[44:47], v[32:35], a[16:31]
    s_mov_b32 s35, 120832
    buffer_load_dwordx4 v[212:215], v1, s[8:11], s35 offen offset:1024
    v_mfma_f32_32x32x16_bf16 a[32:47], v[40:43], v[36:39], a[32:47]
    s_mov_b32 s35, 120832
    buffer_load_dwordx4 v[216:219], v1, s[16:19], s35 offen offset:0
    v_mfma_f32_32x32x16_bf16 a[48:63], v[44:47], v[36:39], a[48:63]
    s_mov_b32 s35, 120832
    buffer_load_dwordx4 v[220:223], v1, s[16:19], s35 offen offset:1024
    s_waitcnt vmcnt(40)
    v_mfma_f32_32x32x16_bf16 a[0:15], v[56:59], v[48:51], a[0:15]
    s_mov_b32 s35, 122880
    buffer_load_dwordx4 v[32:35], v1, s[8:11], s35 offen offset:0
    v_mfma_f32_32x32x16_bf16 a[16:31], v[60:63], v[48:51], a[16:31]
    s_mov_b32 s35, 122880
    buffer_load_dwordx4 v[36:39], v1, s[8:11], s35 offen offset:1024
    v_mfma_f32_32x32x16_bf16 a[32:47], v[56:59], v[52:55], a[32:47]
    s_mov_b32 s35, 122880
    buffer_load_dwordx4 v[40:43], v1, s[16:19], s35 offen offset:0
    v_mfma_f32_32x32x16_bf16 a[48:63], v[60:63], v[52:55], a[48:63]
    s_mov_b32 s35, 122880
    buffer_load_dwordx4 v[44:47], v1, s[16:19], s35 offen offset:1024
    s_waitcnt vmcnt(40)
    v_mfma_f32_32x32x16_bf16 a[0:15], v[72:75], v[64:67], a[0:15]
    s_mov_b32 s35, 124928
    buffer_load_dwordx4 v[48:51], v1, s[8:11], s35 offen offset:0
    v_mfma_f32_32x32x16_bf16 a[16:31], v[76:79], v[64:67], a[16:31]
    s_mov_b32 s35, 124928
    buffer_load_dwordx4 v[52:55], v1, s[8:11], s35 offen offset:1024
    v_mfma_f32_32x32x16_bf16 a[32:47], v[72:75], v[68:71], a[32:47]
    s_mov_b32 s35, 124928
    buffer_load_dwordx4 v[56:59], v1, s[16:19], s35 offen offset:0
    v_mfma_f32_32x32x16_bf16 a[48:63], v[76:79], v[68:71], a[48:63]
    s_mov_b32 s35, 124928
    buffer_load_dwordx4 v[60:63], v1, s[16:19], s35 offen offset:1024
    s_waitcnt vmcnt(40)
    v_mfma_f32_32x32x16_bf16 a[0:15], v[88:91], v[80:83], a[0:15]
    s_mov_b32 s35, 126976
    buffer_load_dwordx4 v[64:67], v1, s[8:11], s35 offen offset:0
    v_mfma_f32_32x32x16_bf16 a[16:31], v[92:95], v[80:83], a[16:31]
    s_mov_b32 s35, 126976
    buffer_load_dwordx4 v[68:71], v1, s[8:11], s35 offen offset:1024
    v_mfma_f32_32x32x16_bf16 a[32:47], v[88:91], v[84:87], a[32:47]
    s_mov_b32 s35, 126976
    buffer_load_dwordx4 v[72:75], v1, s[16:19], s35 offen offset:0
    v_mfma_f32_32x32x16_bf16 a[48:63], v[92:95], v[84:87], a[48:63]
    s_mov_b32 s35, 126976
    buffer_load_dwordx4 v[76:79], v1, s[16:19], s35 offen offset:1024
    s_waitcnt vmcnt(40)
    v_mfma_f32_32x32x16_bf16 a[0:15], v[104:107], v[96:99], a[0:15]
    s_mov_b32 s35, 129024
    buffer_load_dwordx4 v[80:83], v1, s[8:11], s35 offen offset:0
    v_mfma_f32_32x32x16_bf16 a[16:31], v[108:111], v[96:99], a[16:31]
    s_mov_b32 s35, 129024
    buffer_load_dwordx4 v[84:87], v1, s[8:11], s35 offen offset:1024
    v_mfma_f32_32x32x16_bf16 a[32:47], v[104:107], v[100:103], a[32:47]
    s_mov_b32 s35, 129024
    buffer_load_dwordx4 v[88:91], v1, s[16:19], s35 offen offset:0
    v_mfma_f32_32x32x16_bf16 a[48:63], v[108:111], v[100:103], a[48:63]
    s_mov_b32 s35, 129024
    buffer_load_dwordx4 v[92:95], v1, s[16:19], s35 offen offset:1024
    s_waitcnt vmcnt(40)
    v_mfma_f32_32x32x16_bf16 a[0:15], v[120:123], v[112:115], a[0:15]
    v_mfma_f32_32x32x16_bf16 a[16:31], v[124:127], v[112:115], a[16:31]
    v_mfma_f32_32x32x16_bf16 a[32:47], v[120:123], v[116:119], a[32:47]
    v_mfma_f32_32x32x16_bf16 a[48:63], v[124:127], v[116:119], a[48:63]
    s_waitcnt vmcnt(36)
    v_mfma_f32_32x32x16_bf16 a[0:15], v[136:139], v[128:131], a[0:15]
    v_mfma_f32_32x32x16_bf16 a[16:31], v[140:143], v[128:131], a[16:31]
    v_mfma_f32_32x32x16_bf16 a[32:47], v[136:139], v[132:135], a[32:47]
    v_mfma_f32_32x32x16_bf16 a[48:63], v[140:143], v[132:135], a[48:63]
    s_waitcnt vmcnt(32)
    v_mfma_f32_32x32x16_bf16 a[0:15], v[152:155], v[144:147], a[0:15]
    v_mfma_f32_32x32x16_bf16 a[16:31], v[156:159], v[144:147], a[16:31]
    v_mfma_f32_32x32x16_bf16 a[32:47], v[152:155], v[148:151], a[32:47]
    v_mfma_f32_32x32x16_bf16 a[48:63], v[156:159], v[148:151], a[48:63]
    s_waitcnt vmcnt(28)
    v_mfma_f32_32x32x16_bf16 a[0:15], v[168:171], v[160:163], a[0:15]
    v_mfma_f32_32x32x16_bf16 a[16:31], v[172:175], v[160:163], a[16:31]
    v_mfma_f32_32x32x16_bf16 a[32:47], v[168:171], v[164:167], a[32:47]
    v_mfma_f32_32x32x16_bf16 a[48:63], v[172:175], v[164:167], a[48:63]
    s_waitcnt vmcnt(24)
    v_mfma_f32_32x32x16_bf16 a[0:15], v[184:187], v[176:179], a[0:15]
    v_mfma_f32_32x32x16_bf16 a[16:31], v[188:191], v[176:179], a[16:31]
    v_mfma_f32_32x32x16_bf16 a[32:47], v[184:187], v[180:183], a[32:47]
    v_mfma_f32_32x32x16_bf16 a[48:63], v[188:191], v[180:183], a[48:63]
    s_waitcnt vmcnt(20)
    v_mfma_f32_32x32x16_bf16 a[0:15], v[200:203], v[192:195], a[0:15]
    v_mfma_f32_32x32x16_bf16 a[16:31], v[204:207], v[192:195], a[16:31]
    v_mfma_f32_32x32x16_bf16 a[32:47], v[200:203], v[196:199], a[32:47]
    v_mfma_f32_32x32x16_bf16 a[48:63], v[204:207], v[196:199], a[48:63]
    s_waitcnt vmcnt(16)
    v_mfma_f32_32x32x16_bf16 a[0:15], v[216:219], v[208:211], a[0:15]
    v_mfma_f32_32x32x16_bf16 a[16:31], v[220:223], v[208:211], a[16:31]
    v_mfma_f32_32x32x16_bf16 a[32:47], v[216:219], v[212:215], a[32:47]
    v_mfma_f32_32x32x16_bf16 a[48:63], v[220:223], v[212:215], a[48:63]
    s_waitcnt vmcnt(12)
    v_mfma_f32_32x32x16_bf16 a[0:15], v[40:43], v[32:35], a[0:15]
    v_mfma_f32_32x32x16_bf16 a[16:31], v[44:47], v[32:35], a[16:31]
    v_mfma_f32_32x32x16_bf16 a[32:47], v[40:43], v[36:39], a[32:47]
    v_mfma_f32_32x32x16_bf16 a[48:63], v[44:47], v[36:39], a[48:63]
    s_waitcnt vmcnt(8)
    v_mfma_f32_32x32x16_bf16 a[0:15], v[56:59], v[48:51], a[0:15]
    v_mfma_f32_32x32x16_bf16 a[16:31], v[60:63], v[48:51], a[16:31]
    v_mfma_f32_32x32x16_bf16 a[32:47], v[56:59], v[52:55], a[32:47]
    v_mfma_f32_32x32x16_bf16 a[48:63], v[60:63], v[52:55], a[48:63]
    s_waitcnt vmcnt(4)
    v_mfma_f32_32x32x16_bf16 a[0:15], v[72:75], v[64:67], a[0:15]
    v_mfma_f32_32x32x16_bf16 a[16:31], v[76:79], v[64:67], a[16:31]
    v_mfma_f32_32x32x16_bf16 a[32:47], v[72:75], v[68:71], a[32:47]
    v_mfma_f32_32x32x16_bf16 a[48:63], v[76:79], v[68:71], a[48:63]
    s_waitcnt vmcnt(0)
    v_mfma_f32_32x32x16_bf16 a[0:15], v[88:91], v[80:83], a[0:15]
    v_mfma_f32_32x32x16_bf16 a[16:31], v[92:95], v[80:83], a[16:31]
    v_mfma_f32_32x32x16_bf16 a[32:47], v[88:91], v[84:87], a[32:47]
    v_mfma_f32_32x32x16_bf16 a[48:63], v[92:95], v[84:87], a[48:63]
    s_nop 15
    s_lshl_b32 s40, s32, 12
    v_add_u32 v16, s40, v1
    ds_write_b128 v16, a[0:3] offset:0
    ds_write_b128 v16, a[4:7] offset:1024
    ds_write_b128 v16, a[8:11] offset:2048
    ds_write_b128 v16, a[12:15] offset:3072
    ds_write_b128 v16, a[16:19] offset:16384
    ds_write_b128 v16, a[20:23] offset:17408
    ds_write_b128 v16, a[24:27] offset:18432
    ds_write_b128 v16, a[28:31] offset:19456
    ds_write_b128 v16, a[32:35] offset:32768
    ds_write_b128 v16, a[36:39] offset:33792
    ds_write_b128 v16, a[40:43] offset:34816
    ds_write_b128 v16, a[44:47] offset:35840
    ds_write_b128 v16, a[48:51] offset:49152
    ds_write_b128 v16, a[52:55] offset:50176
    ds_write_b128 v16, a[56:59] offset:51200
    ds_write_b128 v16, a[60:63] offset:52224
    s_lshr_b32 s41, s32, 1
    s_lshl_b32 s41, s41, 5
    s_lshl_b32 s44, s42, 6
    s_add_u32 s41, s41, s44
    v_and_b32 v17, 31, v0
    v_add_u32 v17, s41, v17
    v_mul_u32_u24 v17, 1792, v17
    v_bfe_u32 v18, v0, 5, 1
    v_lshlrev_b32 v18, 3, v18
    v_add_u32 v17, v17, v18
    s_and_b32 s46, s32, 1
    s_lshl_b32 s46, s46, 6
    s_lshl_b32 s44, s43, 7
    s_add_u32 s46, s46, s44
    s_lshl_b32 s40, s32, 14
    v_add_u32 v19, s40, v1
    s_waitcnt lgkmcnt(0)
    s_barrier
    ds_read_b128 v[48:51], v19 offset:0
    ds_read_b128 v[52:55], v19 offset:1024
    ds_read_b128 v[56:59], v19 offset:2048
    ds_read_b128 v[60:63], v19 offset:3072
    ds_read_b128 v[64:67], v19 offset:4096
    ds_read_b128 v[68:71], v19 offset:5120
    ds_read_b128 v[72:75], v19 offset:6144
    ds_read_b128 v[76:79], v19 offset:7168
    ds_read_b128 v[80:83], v19 offset:8192
    ds_read_b128 v[84:87], v19 offset:9216
    ds_read_b128 v[88:91], v19 offset:10240
    ds_read_b128 v[92:95], v19 offset:11264
    ds_read_b128 v[96:99], v19 offset:12288
    ds_read_b128 v[100:103], v19 offset:13312
    ds_read_b128 v[104:107], v19 offset:14336
    ds_read_b128 v[108:111], v19 offset:15360
    s_waitcnt lgkmcnt(8)
    v_add_f32 v48, v48, v64
    v_add_f32 v49, v49, v65
    v_add_f32 v50, v50, v66
    v_add_f32 v51, v51, v67
    v_add_f32 v52, v52, v68
    v_add_f32 v53, v53, v69
    v_add_f32 v54, v54, v70
    v_add_f32 v55, v55, v71
    v_add_f32 v56, v56, v72
    v_add_f32 v57, v57, v73
    v_add_f32 v58, v58, v74
    v_add_f32 v59, v59, v75
    v_add_f32 v60, v60, v76
    v_add_f32 v61, v61, v77
    v_add_f32 v62, v62, v78
    v_add_f32 v63, v63, v79
    s_waitcnt lgkmcnt(0)
    v_add_f32 v80, v80, v96
    v_add_f32 v81, v81, v97
    v_add_f32 v82, v82, v98
    v_add_f32 v83, v83, v99
    v_add_f32 v84, v84, v100
    v_add_f32 v85, v85, v101
    v_add_f32 v86, v86, v102
    v_add_f32 v87, v87, v103
    v_add_f32 v88, v88, v104
    v_add_f32 v89, v89, v105
    v_add_f32 v90, v90, v106
    v_add_f32 v91, v91, v107
    v_add_f32 v92, v92, v108
    v_add_f32 v93, v93, v109
    v_add_f32 v94, v94, v110
    v_add_f32 v95, v95, v111
    v_add_f32 v48, v48, v80
    v_add_f32 v49, v49, v81
    v_add_f32 v50, v50, v82
    v_add_f32 v51, v51, v83
    v_add_f32 v52, v52, v84
    v_add_f32 v53, v53, v85
    v_add_f32 v54, v54, v86
    v_add_f32 v55, v55, v87
    v_add_f32 v56, v56, v88
    v_add_f32 v57, v57, v89
    v_add_f32 v58, v58, v90
    v_add_f32 v59, v59, v91
    v_add_f32 v60, v60, v92
    v_add_f32 v61, v61, v93
    v_add_f32 v62, v62, v94
    v_add_f32 v63, v63, v95
    v_cvt_pk_bf16_f32 v112, v48, v49
    v_cvt_pk_bf16_f32 v113, v50, v51
    v_cvt_pk_bf16_f32 v114, v52, v53
    v_cvt_pk_bf16_f32 v115, v54, v55
    v_cvt_pk_bf16_f32 v116, v56, v57
    v_cvt_pk_bf16_f32 v117, v58, v59
    v_cvt_pk_bf16_f32 v118, v60, v61
    v_cvt_pk_bf16_f32 v119, v62, v63
    buffer_store_dwordx2 v[112:113], v17, s[20:23], s46 offen offset:0
    buffer_store_dwordx2 v[114:115], v17, s[20:23], s46 offen offset:16
    buffer_store_dwordx2 v[116:117], v17, s[20:23], s46 offen offset:32
    buffer_store_dwordx2 v[118:119], v17, s[20:23], s46 offen offset:48
    s_endpgm
k3_b3:
    s_load_dwordx2 s[4:5], s[0:1], 48
    s_load_dwordx4 s[28:31], s[0:1], 88
    s_load_dwordx2 s[6:7], s[0:1], 112
    s_sub_u32 s42, s41, 28
    s_lshl_b32 s42, s42, 3
    s_add_u32 s42, s42, s40
    s_waitcnt lgkmcnt(0)
    s_mov_b32 s8, s4
    s_mov_b32 s9, s5
    s_mov_b32 s10, 1835008
    s_mov_b32 s11, 0x20000
    s_add_u32 s12, s6, 88080384
    s_addc_u32 s13, s7, 0
    s_mov_b32 s14, 1835008
    s_mov_b32 s15, 0x20000
    s_add_u32 s16, s6, 92274688
    s_addc_u32 s17, s7, 0
    s_mov_b32 s18, 1835008
    s_mov_b32 s19, 0x20000
    s_mov_b32 s20, s28
    s_mov_b32 s21, s29
    s_mov_b32 s22, 896
    s_mov_b32 s23, 0x20000
    s_mov_b32 s24, s30
    s_mov_b32 s25, s31
    s_mov_b32 s26, 3670016
    s_mov_b32 s27, 0x20000
    s_add_u32 s48, s6, 96468992
    s_addc_u32 s49, s7, 0
    s_mov_b32 s50, 8192
    s_mov_b32 s51, 0x20000
    v_lshlrev_b32 v1, 2, v0
    s_movk_i32 s58, 6144
    s_mov_b32 s59, 0
b3_poll_loop:
    buffer_load_dword v2, v1, s[48:51], s58 offen sc1
    s_waitcnt vmcnt(0)
    v_cmp_ne_u32 s[60:61], 1, v2
    s_add_u32 s59, s59, 1
    s_cmp_eq_u64 s[60:61], 0
    s_cbranch_scc1 b3_poll_done
    s_sleep 6
    s_cmp_lt_u32 s59, 400000
    s_cbranch_scc1 b3_poll_loop
b3_poll_done:
    s_barrier
    s_load_dwordx2 s[56:57], s[0:1], 40
    v_lshrrev_b32 v1, 6, v0
    v_and_b32 v254, 63, v0
    v_lshlrev_b32 v254, 7, v254
    v_readfirstlane_b32 s58, v1
    s_waitcnt lgkmcnt(0)
    s_add_u32 s48, s6, 50331648
    s_addc_u32 s49, s7, 0
    s_mov_b32 s50, 33554432
    s_mov_b32 s51, 0x20000
    s_mov_b32 s52, s56
    s_mov_b32 s53, s57
    s_mov_b32 s54, 3670016
    s_mov_b32 s55, 0x20000
    s_sub_u32 s59, s41, 28
    s_lshl_b32 s60, s59, 22
    s_lshl_b32 s61, s40, 2
    s_add_u32 s61, s61, s58
    s_lshl_b32 s61, s61, 14
    s_add_u32 s60, s60, s61
    s_mul_i32 s61, s59, 917504
    s_mul_i32 s62, s58, 57344
    s_add_u32 s61, s61, s62
    v_lshrrev_b32 v1, 3, v0
    v_and_b32 v2, 7, v0
    v_lshlrev_b32 v2, 4, v2
    v_lshlrev_b32 v3, 12, v1
    s_lshl_b32 s43, s42, 7
    v_add3_u32 v3, v3, v2, s43
    s_mov_b32 s44, 0
    buffer_load_dwordx4 v[16:19], v3, s[16:19], s44 offen
    s_mov_b32 s44, 131072
    buffer_load_dwordx4 v[20:23], v3, s[16:19], s44 offen
    s_mov_b32 s44, 262144
    buffer_load_dwordx4 v[24:27], v3, s[16:19], s44 offen
    s_mov_b32 s44, 393216
    buffer_load_dwordx4 v[28:31], v3, s[16:19], s44 offen
    s_mov_b32 s44, 524288
    buffer_load_dwordx4 v[32:35], v3, s[16:19], s44 offen
    s_mov_b32 s44, 655360
    buffer_load_dwordx4 v[36:39], v3, s[16:19], s44 offen
    s_mov_b32 s44, 786432
    buffer_load_dwordx4 v[40:43], v3, s[16:19], s44 offen
    s_mov_b32 s44, 917504
    buffer_load_dwordx4 v[44:47], v3, s[16:19], s44 offen
    s_mov_b32 s44, 1048576
    buffer_load_dwordx4 v[48:51], v3, s[16:19], s44 offen
    s_mov_b32 s44, 1179648
    buffer_load_dwordx4 v[52:55], v3, s[16:19], s44 offen
    s_mov_b32 s44, 1310720
    buffer_load_dwordx4 v[56:59], v3, s[16:19], s44 offen
    s_mov_b32 s44, 1441792
    buffer_load_dwordx4 v[60:63], v3, s[16:19], s44 offen
    s_mov_b32 s44, 1572864
    buffer_load_dwordx4 v[64:67], v3, s[16:19], s44 offen
    s_mov_b32 s44, 1703936
    buffer_load_dwordx4 v[68:71], v3, s[16:19], s44 offen
    v_and_b32 v4, 15, v0
    v_lshrrev_b32 v5, 6, v0
    v_lshlrev_b32 v5, 4, v5
    v_add_u32 v4, v4, v5
    v_bfe_u32 v6, v0, 4, 2
    v_lshlrev_b32 v6, 4, v6
    s_lshl_b32 s43, s42, 6
    v_add_u32 v7, s43, v4
    v_mul_u32_u24 v8, 896, v7
    v_add_u32 v8, v8, v6
    v_mul_u32_u24 v9, 1792, v7
    v_add_u32 v9, v9, v6
    v_add_u32 v9, 896, v9
    v_lshlrev_b32 v10, 11, v6
    v_lshlrev_b32 v14, 4, v7
    v_add_u32 v10, v10, v14
    buffer_load_dwordx4 v[72:75], v8, s[8:11], 0 offen offset:0
    s_mov_b32 s44, 0
    buffer_load_dwordx4 v[128:131], v10, s[12:15], s44 offen
    buffer_load_dwordx4 v[184:187], v6, s[20:23], 0 offen offset:0
    buffer_load_dwordx4 v[76:79], v8, s[8:11], 0 offen offset:64
    s_mov_b32 s44, 131072
    buffer_load_dwordx4 v[132:135], v10, s[12:15], s44 offen
    buffer_load_dwordx4 v[188:191], v6, s[20:23], 0 offen offset:64
    buffer_load_dwordx4 v[80:83], v8, s[8:11], 0 offen offset:128
    s_mov_b32 s44, 262144
    buffer_load_dwordx4 v[136:139], v10, s[12:15], s44 offen
    buffer_load_dwordx4 v[192:195], v6, s[20:23], 0 offen offset:128
    buffer_load_dwordx4 v[84:87], v8, s[8:11], 0 offen offset:192
    s_mov_b32 s44, 393216
    buffer_load_dwordx4 v[140:143], v10, s[12:15], s44 offen
    buffer_load_dwordx4 v[196:199], v6, s[20:23], 0 offen offset:192
    buffer_load_dwordx4 v[88:91], v8, s[8:11], 0 offen offset:256
    s_mov_b32 s44, 524288
    buffer_load_dwordx4 v[144:147], v10, s[12:15], s44 offen
    buffer_load_dwordx4 v[200:203], v6, s[20:23], 0 offen offset:256
    buffer_load_dwordx4 v[92:95], v8, s[8:11], 0 offen offset:320
    s_mov_b32 s44, 655360
    buffer_load_dwordx4 v[148:151], v10, s[12:15], s44 offen
    buffer_load_dwordx4 v[204:207], v6, s[20:23], 0 offen offset:320
    buffer_load_dwordx4 v[96:99], v8, s[8:11], 0 offen offset:384
    s_mov_b32 s44, 786432
    buffer_load_dwordx4 v[152:155], v10, s[12:15], s44 offen
    buffer_load_dwordx4 v[208:211], v6, s[20:23], 0 offen offset:384
    buffer_load_dwordx4 v[100:103], v8, s[8:11], 0 offen offset:448
    s_mov_b32 s44, 917504
    buffer_load_dwordx4 v[156:159], v10, s[12:15], s44 offen
    buffer_load_dwordx4 v[212:215], v6, s[20:23], 0 offen offset:448
    buffer_load_dwordx4 v[104:107], v8, s[8:11], 0 offen offset:512
    s_mov_b32 s44, 1048576
    buffer_load_dwordx4 v[160:163], v10, s[12:15], s44 offen
    buffer_load_dwordx4 v[216:219], v6, s[20:23], 0 offen offset:512
    buffer_load_dwordx4 v[108:111], v8, s[8:11], 0 offen offset:576
    s_mov_b32 s44, 1179648
    buffer_load_dwordx4 v[164:167], v10, s[12:15], s44 offen
    buffer_load_dwordx4 v[220:223], v6, s[20:23], 0 offen offset:576
    buffer_load_dwordx4 v[112:115], v8, s[8:11], 0 offen offset:640
    s_mov_b32 s44, 1310720
    buffer_load_dwordx4 v[168:171], v10, s[12:15], s44 offen
    buffer_load_dwordx4 v[224:227], v6, s[20:23], 0 offen offset:640
    buffer_load_dwordx4 v[116:119], v8, s[8:11], 0 offen offset:704
    s_mov_b32 s44, 1441792
    buffer_load_dwordx4 v[172:175], v10, s[12:15], s44 offen
    buffer_load_dwordx4 v[228:231], v6, s[20:23], 0 offen offset:704
    buffer_load_dwordx4 v[120:123], v8, s[8:11], 0 offen offset:768
    s_mov_b32 s44, 1572864
    buffer_load_dwordx4 v[176:179], v10, s[12:15], s44 offen
    buffer_load_dwordx4 v[232:235], v6, s[20:23], 0 offen offset:768
    buffer_load_dwordx4 v[124:127], v8, s[8:11], 0 offen offset:832
    s_mov_b32 s44, 1703936
    buffer_load_dwordx4 v[180:183], v10, s[12:15], s44 offen
    buffer_load_dwordx4 v[236:239], v6, s[20:23], 0 offen offset:832
    v_mul_u32_u24 v11, 144, v1
    v_add_u32 v11, v11, v2
    s_waitcnt vmcnt(55)
    ds_write_b128 v11, v[16:19] offset:0
    s_waitcnt vmcnt(54)
    ds_write_b128 v11, v[20:23] offset:4608
    s_waitcnt vmcnt(53)
    ds_write_b128 v11, v[24:27] offset:9216
    s_waitcnt vmcnt(52)
    ds_write_b128 v11, v[28:31] offset:13824
    s_waitcnt vmcnt(51)
    ds_write_b128 v11, v[32:35] offset:18432
    s_waitcnt vmcnt(50)
    ds_write_b128 v11, v[36:39] offset:23040
    s_waitcnt vmcnt(49)
    ds_write_b128 v11, v[40:43] offset:27648
    s_waitcnt vmcnt(48)
    ds_write_b128 v11, v[44:47] offset:32256
    s_waitcnt vmcnt(47)
    ds_write_b128 v11, v[48:51] offset:36864
    s_waitcnt vmcnt(46)
    ds_write_b128 v11, v[52:55] offset:41472
    s_waitcnt vmcnt(45)
    ds_write_b128 v11, v[56:59] offset:46080
    s_waitcnt vmcnt(44)
    ds_write_b128 v11, v[60:63] offset:50688
    s_waitcnt vmcnt(43)
    ds_write_b128 v11, v[64:67] offset:55296
    s_waitcnt vmcnt(42)
    ds_write_b128 v11, v[68:71] offset:59904
    s_waitcnt lgkmcnt(0)
    s_barrier
    s_waitcnt vmcnt(0)
    v_bfe_u32 v12, v0, 4, 2
    v_lshlrev_b32 v12, 3, v12
    v_bfe_u32 v13, v0, 2, 2
    v_add_u32 v12, v12, v13
    v_mul_u32_u24 v12, 144, v12
    v_and_b32 v13, 3, v0
    v_lshlrev_b32 v13, 3, v13
    v_lshlrev_b32 v5, 1, v5
    v_add3_u32 v12, v12, v13, v5
    ds_read_b64_tr_b16 v[16:17], v12 offset:0
    ds_read_b64_tr_b16 v[18:19], v12 offset:576
    ds_read_b64_tr_b16 v[20:21], v12 offset:4608
    ds_read_b64_tr_b16 v[22:23], v12 offset:5184
    ds_read_b64_tr_b16 v[24:25], v12 offset:9216
    ds_read_b64_tr_b16 v[26:27], v12 offset:9792
    ds_read_b64_tr_b16 v[28:29], v12 offset:13824
    ds_read_b64_tr_b16 v[30:31], v12 offset:14400
    ds_read_b64_tr_b16 v[32:33], v12 offset:18432
    ds_read_b64_tr_b16 v[34:35], v12 offset:19008
    ds_read_b64_tr_b16 v[36:37], v12 offset:23040
    ds_read_b64_tr_b16 v[38:39], v12 offset:23616
    ds_read_b64_tr_b16 v[40:41], v12 offset:27648
    ds_read_b64_tr_b16 v[42:43], v12 offset:28224
    ds_read_b64_tr_b16 v[44:45], v12 offset:32256
    ds_read_b64_tr_b16 v[46:47], v12 offset:32832
    ds_read_b64_tr_b16 v[48:49], v12 offset:36864
    ds_read_b64_tr_b16 v[50:51], v12 offset:37440
    ds_read_b64_tr_b16 v[52:53], v12 offset:41472
    ds_read_b64_tr_b16 v[54:55], v12 offset:42048
    ds_read_b64_tr_b16 v[56:57], v12 offset:46080
    ds_read_b64_tr_b16 v[58:59], v12 offset:46656
    ds_read_b64_tr_b16 v[60:61], v12 offset:50688
    ds_read_b64_tr_b16 v[62:63], v12 offset:51264
    ds_read_b64_tr_b16 v[64:65], v12 offset:55296
    ds_read_b64_tr_b16 v[66:67], v12 offset:55872
    ds_read_b64_tr_b16 v[68:69], v12 offset:59904
    ds_read_b64_tr_b16 v[70:71], v12 offset:60480
    v_lshlrev_b32 v1, 16, v128
    v_and_b32 v2, 0xffff0000, v128
    v_lshlrev_b32 v3, 16, v184
    v_and_b32 v4, 0xffff0000, v184
    v_mul_f32 v1, v1, v3
    v_mul_f32 v2, v2, v4
    v_cvt_pk_bf16_f32 v5, v1, v2
    v_lshlrev_b32 v1, 16, v5
    v_and_b32 v2, 0xffff0000, v5
    s_waitcnt lgkmcnt(15)
    v_lshlrev_b32 v3, 16, v16
    v_and_b32 v4, 0xffff0000, v16
    v_add_f32 v1, v3, v1
    v_add_f32 v2, v4, v2
    v_cvt_pk_bf16_f32 v5, v1, v2
    v_lshlrev_b32 v1, 16, v5
    v_and_b32 v2, 0xffff0000, v5
    v_lshlrev_b32 v3, 16, v72
    v_and_b32 v4, 0xffff0000, v72
    v_mul_f32 v1, v1, v3
    v_mul_f32 v2, v2, v4
    v_cvt_pk_bf16_f32 v244, v1, v2
    v_lshlrev_b32 v1, 16, v129
    v_and_b32 v2, 0xffff0000, v129
    v_lshlrev_b32 v3, 16, v185
    v_and_b32 v4, 0xffff0000, v185
    v_mul_f32 v1, v1, v3
    v_mul_f32 v2, v2, v4
    v_cvt_pk_bf16_f32 v5, v1, v2
    v_lshlrev_b32 v1, 16, v5
    v_and_b32 v2, 0xffff0000, v5
    v_lshlrev_b32 v3, 16, v17
    v_and_b32 v4, 0xffff0000, v17
    v_add_f32 v1, v3, v1
    v_add_f32 v2, v4, v2
    v_cvt_pk_bf16_f32 v5, v1, v2
    v_lshlrev_b32 v1, 16, v5
    v_and_b32 v2, 0xffff0000, v5
    v_lshlrev_b32 v3, 16, v73
    v_and_b32 v4, 0xffff0000, v73
    v_mul_f32 v1, v1, v3
    v_mul_f32 v2, v2, v4
    v_cvt_pk_bf16_f32 v245, v1, v2
    v_lshlrev_b32 v1, 16, v130
    v_and_b32 v2, 0xffff0000, v130
    v_lshlrev_b32 v3, 16, v186
    v_and_b32 v4, 0xffff0000, v186
    v_mul_f32 v1, v1, v3
    v_mul_f32 v2, v2, v4
    v_cvt_pk_bf16_f32 v5, v1, v2
    v_lshlrev_b32 v1, 16, v5
    v_and_b32 v2, 0xffff0000, v5
    v_lshlrev_b32 v3, 16, v18
    v_and_b32 v4, 0xffff0000, v18
    v_add_f32 v1, v3, v1
    v_add_f32 v2, v4, v2
    v_cvt_pk_bf16_f32 v5, v1, v2
    v_lshlrev_b32 v1, 16, v5
    v_and_b32 v2, 0xffff0000, v5
    v_lshlrev_b32 v3, 16, v74
    v_and_b32 v4, 0xffff0000, v74
    v_mul_f32 v1, v1, v3
    v_mul_f32 v2, v2, v4
    v_cvt_pk_bf16_f32 v246, v1, v2
    v_lshlrev_b32 v1, 16, v131
    v_and_b32 v2, 0xffff0000, v131
    v_lshlrev_b32 v3, 16, v187
    v_and_b32 v4, 0xffff0000, v187
    v_mul_f32 v1, v1, v3
    v_mul_f32 v2, v2, v4
    v_cvt_pk_bf16_f32 v5, v1, v2
    v_lshlrev_b32 v1, 16, v5
    v_and_b32 v2, 0xffff0000, v5
    v_lshlrev_b32 v3, 16, v19
    v_and_b32 v4, 0xffff0000, v19
    v_add_f32 v1, v3, v1
    v_add_f32 v2, v4, v2
    v_cvt_pk_bf16_f32 v5, v1, v2
    v_lshlrev_b32 v1, 16, v5
    v_and_b32 v2, 0xffff0000, v5
    v_lshlrev_b32 v3, 16, v75
    v_and_b32 v4, 0xffff0000, v75
    v_mul_f32 v1, v1, v3
    v_mul_f32 v2, v2, v4
    v_cvt_pk_bf16_f32 v247, v1, v2
    buffer_store_dwordx4 v[244:247], v9, s[24:27], 0 offen offset:0
    v_lshlrev_b32 v1, 16, v132
    v_and_b32 v2, 0xffff0000, v132
    v_lshlrev_b32 v3, 16, v188
    v_and_b32 v4, 0xffff0000, v188
    v_mul_f32 v1, v1, v3
    v_mul_f32 v2, v2, v4
    v_cvt_pk_bf16_f32 v5, v1, v2
    v_lshlrev_b32 v1, 16, v5
    v_and_b32 v2, 0xffff0000, v5
    v_lshlrev_b32 v3, 16, v20
    v_and_b32 v4, 0xffff0000, v20
    v_add_f32 v1, v3, v1
    v_add_f32 v2, v4, v2
    v_cvt_pk_bf16_f32 v5, v1, v2
    v_lshlrev_b32 v1, 16, v5
    v_and_b32 v2, 0xffff0000, v5
    v_lshlrev_b32 v3, 16, v76
    v_and_b32 v4, 0xffff0000, v76
    v_mul_f32 v1, v1, v3
    v_mul_f32 v2, v2, v4
    v_cvt_pk_bf16_f32 v248, v1, v2
    v_lshlrev_b32 v1, 16, v133
    v_and_b32 v2, 0xffff0000, v133
    v_lshlrev_b32 v3, 16, v189
    v_and_b32 v4, 0xffff0000, v189
    v_mul_f32 v1, v1, v3
    v_mul_f32 v2, v2, v4
    v_cvt_pk_bf16_f32 v5, v1, v2
    v_lshlrev_b32 v1, 16, v5
    v_and_b32 v2, 0xffff0000, v5
    v_lshlrev_b32 v3, 16, v21
    v_and_b32 v4, 0xffff0000, v21
    v_add_f32 v1, v3, v1
    v_add_f32 v2, v4, v2
    v_cvt_pk_bf16_f32 v5, v1, v2
    v_lshlrev_b32 v1, 16, v5
    v_and_b32 v2, 0xffff0000, v5
    v_lshlrev_b32 v3, 16, v77
    v_and_b32 v4, 0xffff0000, v77
    v_mul_f32 v1, v1, v3
    v_mul_f32 v2, v2, v4
    v_cvt_pk_bf16_f32 v249, v1, v2
    v_lshlrev_b32 v1, 16, v134
    v_and_b32 v2, 0xffff0000, v134
    v_lshlrev_b32 v3, 16, v190
    v_and_b32 v4, 0xffff0000, v190
    v_mul_f32 v1, v1, v3
    v_mul_f32 v2, v2, v4
    v_cvt_pk_bf16_f32 v5, v1, v2
    v_lshlrev_b32 v1, 16, v5
    v_and_b32 v2, 0xffff0000, v5
    v_lshlrev_b32 v3, 16, v22
    v_and_b32 v4, 0xffff0000, v22
    v_add_f32 v1, v3, v1
    v_add_f32 v2, v4, v2
    v_cvt_pk_bf16_f32 v5, v1, v2
    v_lshlrev_b32 v1, 16, v5
    v_and_b32 v2, 0xffff0000, v5
    v_lshlrev_b32 v3, 16, v78
    v_and_b32 v4, 0xffff0000, v78
    v_mul_f32 v1, v1, v3
    v_mul_f32 v2, v2, v4
    v_cvt_pk_bf16_f32 v250, v1, v2
    v_lshlrev_b32 v1, 16, v135
    v_and_b32 v2, 0xffff0000, v135
    v_lshlrev_b32 v3, 16, v191
    v_and_b32 v4, 0xffff0000, v191
    v_mul_f32 v1, v1, v3
    v_mul_f32 v2, v2, v4
    v_cvt_pk_bf16_f32 v5, v1, v2
    v_lshlrev_b32 v1, 16, v5
    v_and_b32 v2, 0xffff0000, v5
    v_lshlrev_b32 v3, 16, v23
    v_and_b32 v4, 0xffff0000, v23
    v_add_f32 v1, v3, v1
    v_add_f32 v2, v4, v2
    v_cvt_pk_bf16_f32 v5, v1, v2
    v_lshlrev_b32 v1, 16, v5
    v_and_b32 v2, 0xffff0000, v5
    v_lshlrev_b32 v3, 16, v79
    v_and_b32 v4, 0xffff0000, v79
    v_mul_f32 v1, v1, v3
    v_mul_f32 v2, v2, v4
    v_cvt_pk_bf16_f32 v251, v1, v2
    buffer_store_dwordx4 v[248:251], v9, s[24:27], 0 offen offset:64
    v_lshlrev_b32 v1, 16, v136
    v_and_b32 v2, 0xffff0000, v136
    v_lshlrev_b32 v3, 16, v192
    v_and_b32 v4, 0xffff0000, v192
    v_mul_f32 v1, v1, v3
    v_mul_f32 v2, v2, v4
    v_cvt_pk_bf16_f32 v5, v1, v2
    v_lshlrev_b32 v1, 16, v5
    v_and_b32 v2, 0xffff0000, v5
    v_lshlrev_b32 v3, 16, v24
    v_and_b32 v4, 0xffff0000, v24
    v_add_f32 v1, v3, v1
    v_add_f32 v2, v4, v2
    v_cvt_pk_bf16_f32 v5, v1, v2
    v_lshlrev_b32 v1, 16, v5
    v_and_b32 v2, 0xffff0000, v5
    v_lshlrev_b32 v3, 16, v80
    v_and_b32 v4, 0xffff0000, v80
    v_mul_f32 v1, v1, v3
    v_mul_f32 v2, v2, v4
    v_cvt_pk_bf16_f32 v244, v1, v2
    v_lshlrev_b32 v1, 16, v137
    v_and_b32 v2, 0xffff0000, v137
    v_lshlrev_b32 v3, 16, v193
    v_and_b32 v4, 0xffff0000, v193
    v_mul_f32 v1, v1, v3
    v_mul_f32 v2, v2, v4
    v_cvt_pk_bf16_f32 v5, v1, v2
    v_lshlrev_b32 v1, 16, v5
    v_and_b32 v2, 0xffff0000, v5
    v_lshlrev_b32 v3, 16, v25
    v_and_b32 v4, 0xffff0000, v25
    v_add_f32 v1, v3, v1
    v_add_f32 v2, v4, v2
    v_cvt_pk_bf16_f32 v5, v1, v2
    v_lshlrev_b32 v1, 16, v5
    v_and_b32 v2, 0xffff0000, v5
    v_lshlrev_b32 v3, 16, v81
    v_and_b32 v4, 0xffff0000, v81
    v_mul_f32 v1, v1, v3
    v_mul_f32 v2, v2, v4
    v_cvt_pk_bf16_f32 v245, v1, v2
    v_lshlrev_b32 v1, 16, v138
    v_and_b32 v2, 0xffff0000, v138
    v_lshlrev_b32 v3, 16, v194
    v_and_b32 v4, 0xffff0000, v194
    v_mul_f32 v1, v1, v3
    v_mul_f32 v2, v2, v4
    v_cvt_pk_bf16_f32 v5, v1, v2
    v_lshlrev_b32 v1, 16, v5
    v_and_b32 v2, 0xffff0000, v5
    v_lshlrev_b32 v3, 16, v26
    v_and_b32 v4, 0xffff0000, v26
    v_add_f32 v1, v3, v1
    v_add_f32 v2, v4, v2
    v_cvt_pk_bf16_f32 v5, v1, v2
    v_lshlrev_b32 v1, 16, v5
    v_and_b32 v2, 0xffff0000, v5
    v_lshlrev_b32 v3, 16, v82
    v_and_b32 v4, 0xffff0000, v82
    v_mul_f32 v1, v1, v3
    v_mul_f32 v2, v2, v4
    v_cvt_pk_bf16_f32 v246, v1, v2
    v_lshlrev_b32 v1, 16, v139
    v_and_b32 v2, 0xffff0000, v139
    v_lshlrev_b32 v3, 16, v195
    v_and_b32 v4, 0xffff0000, v195
    v_mul_f32 v1, v1, v3
    v_mul_f32 v2, v2, v4
    v_cvt_pk_bf16_f32 v5, v1, v2
    v_lshlrev_b32 v1, 16, v5
    v_and_b32 v2, 0xffff0000, v5
    v_lshlrev_b32 v3, 16, v27
    v_and_b32 v4, 0xffff0000, v27
    v_add_f32 v1, v3, v1
    v_add_f32 v2, v4, v2
    v_cvt_pk_bf16_f32 v5, v1, v2
    v_lshlrev_b32 v1, 16, v5
    v_and_b32 v2, 0xffff0000, v5
    v_lshlrev_b32 v3, 16, v83
    v_and_b32 v4, 0xffff0000, v83
    v_mul_f32 v1, v1, v3
    v_mul_f32 v2, v2, v4
    v_cvt_pk_bf16_f32 v247, v1, v2
    buffer_store_dwordx4 v[244:247], v9, s[24:27], 0 offen offset:128
    v_lshlrev_b32 v1, 16, v140
    v_and_b32 v2, 0xffff0000, v140
    v_lshlrev_b32 v3, 16, v196
    v_and_b32 v4, 0xffff0000, v196
    v_mul_f32 v1, v1, v3
    v_mul_f32 v2, v2, v4
    v_cvt_pk_bf16_f32 v5, v1, v2
    v_lshlrev_b32 v1, 16, v5
    v_and_b32 v2, 0xffff0000, v5
    v_lshlrev_b32 v3, 16, v28
    v_and_b32 v4, 0xffff0000, v28
    v_add_f32 v1, v3, v1
    v_add_f32 v2, v4, v2
    v_cvt_pk_bf16_f32 v5, v1, v2
    v_lshlrev_b32 v1, 16, v5
    v_and_b32 v2, 0xffff0000, v5
    v_lshlrev_b32 v3, 16, v84
    v_and_b32 v4, 0xffff0000, v84
    v_mul_f32 v1, v1, v3
    v_mul_f32 v2, v2, v4
    v_cvt_pk_bf16_f32 v248, v1, v2
    v_lshlrev_b32 v1, 16, v141
    v_and_b32 v2, 0xffff0000, v141
    v_lshlrev_b32 v3, 16, v197
    v_and_b32 v4, 0xffff0000, v197
    v_mul_f32 v1, v1, v3
    v_mul_f32 v2, v2, v4
    v_cvt_pk_bf16_f32 v5, v1, v2
    v_lshlrev_b32 v1, 16, v5
    v_and_b32 v2, 0xffff0000, v5
    v_lshlrev_b32 v3, 16, v29
    v_and_b32 v4, 0xffff0000, v29
    v_add_f32 v1, v3, v1
    v_add_f32 v2, v4, v2
    v_cvt_pk_bf16_f32 v5, v1, v2
    v_lshlrev_b32 v1, 16, v5
    v_and_b32 v2, 0xffff0000, v5
    v_lshlrev_b32 v3, 16, v85
    v_and_b32 v4, 0xffff0000, v85
    v_mul_f32 v1, v1, v3
    v_mul_f32 v2, v2, v4
    v_cvt_pk_bf16_f32 v249, v1, v2
    v_lshlrev_b32 v1, 16, v142
    v_and_b32 v2, 0xffff0000, v142
    v_lshlrev_b32 v3, 16, v198
    v_and_b32 v4, 0xffff0000, v198
    v_mul_f32 v1, v1, v3
    v_mul_f32 v2, v2, v4
    v_cvt_pk_bf16_f32 v5, v1, v2
    v_lshlrev_b32 v1, 16, v5
    v_and_b32 v2, 0xffff0000, v5
    v_lshlrev_b32 v3, 16, v30
    v_and_b32 v4, 0xffff0000, v30
    v_add_f32 v1, v3, v1
    v_add_f32 v2, v4, v2
    v_cvt_pk_bf16_f32 v5, v1, v2
    v_lshlrev_b32 v1, 16, v5
    v_and_b32 v2, 0xffff0000, v5
    v_lshlrev_b32 v3, 16, v86
    v_and_b32 v4, 0xffff0000, v86
    v_mul_f32 v1, v1, v3
    v_mul_f32 v2, v2, v4
    v_cvt_pk_bf16_f32 v250, v1, v2
    v_lshlrev_b32 v1, 16, v143
    v_and_b32 v2, 0xffff0000, v143
    v_lshlrev_b32 v3, 16, v199
    v_and_b32 v4, 0xffff0000, v199
    v_mul_f32 v1, v1, v3
    v_mul_f32 v2, v2, v4
    v_cvt_pk_bf16_f32 v5, v1, v2
    v_lshlrev_b32 v1, 16, v5
    v_and_b32 v2, 0xffff0000, v5
    v_lshlrev_b32 v3, 16, v31
    v_and_b32 v4, 0xffff0000, v31
    v_add_f32 v1, v3, v1
    v_add_f32 v2, v4, v2
    v_cvt_pk_bf16_f32 v5, v1, v2
    v_lshlrev_b32 v1, 16, v5
    v_and_b32 v2, 0xffff0000, v5
    v_lshlrev_b32 v3, 16, v87
    v_and_b32 v4, 0xffff0000, v87
    v_mul_f32 v1, v1, v3
    v_mul_f32 v2, v2, v4
    v_cvt_pk_bf16_f32 v251, v1, v2
    buffer_store_dwordx4 v[248:251], v9, s[24:27], 0 offen offset:192
    v_lshlrev_b32 v1, 16, v144
    v_and_b32 v2, 0xffff0000, v144
    v_lshlrev_b32 v3, 16, v200
    v_and_b32 v4, 0xffff0000, v200
    v_mul_f32 v1, v1, v3
    v_mul_f32 v2, v2, v4
    v_cvt_pk_bf16_f32 v5, v1, v2
    v_lshlrev_b32 v1, 16, v5
    v_and_b32 v2, 0xffff0000, v5
    v_lshlrev_b32 v3, 16, v32
    v_and_b32 v4, 0xffff0000, v32
    v_add_f32 v1, v3, v1
    v_add_f32 v2, v4, v2
    v_cvt_pk_bf16_f32 v5, v1, v2
    v_lshlrev_b32 v1, 16, v5
    v_and_b32 v2, 0xffff0000, v5
    v_lshlrev_b32 v3, 16, v88
    v_and_b32 v4, 0xffff0000, v88
    v_mul_f32 v1, v1, v3
    v_mul_f32 v2, v2, v4
    v_cvt_pk_bf16_f32 v244, v1, v2
    v_lshlrev_b32 v1, 16, v145
    v_and_b32 v2, 0xffff0000, v145
    v_lshlrev_b32 v3, 16, v201
    v_and_b32 v4, 0xffff0000, v201
    v_mul_f32 v1, v1, v3
    v_mul_f32 v2, v2, v4
    v_cvt_pk_bf16_f32 v5, v1, v2
    v_lshlrev_b32 v1, 16, v5
    v_and_b32 v2, 0xffff0000, v5
    v_lshlrev_b32 v3, 16, v33
    v_and_b32 v4, 0xffff0000, v33
    v_add_f32 v1, v3, v1
    v_add_f32 v2, v4, v2
    v_cvt_pk_bf16_f32 v5, v1, v2
    v_lshlrev_b32 v1, 16, v5
    v_and_b32 v2, 0xffff0000, v5
    v_lshlrev_b32 v3, 16, v89
    v_and_b32 v4, 0xffff0000, v89
    v_mul_f32 v1, v1, v3
    v_mul_f32 v2, v2, v4
    v_cvt_pk_bf16_f32 v245, v1, v2
    v_lshlrev_b32 v1, 16, v146
    v_and_b32 v2, 0xffff0000, v146
    v_lshlrev_b32 v3, 16, v202
    v_and_b32 v4, 0xffff0000, v202
    v_mul_f32 v1, v1, v3
    v_mul_f32 v2, v2, v4
    v_cvt_pk_bf16_f32 v5, v1, v2
    v_lshlrev_b32 v1, 16, v5
    v_and_b32 v2, 0xffff0000, v5
    v_lshlrev_b32 v3, 16, v34
    v_and_b32 v4, 0xffff0000, v34
    v_add_f32 v1, v3, v1
    v_add_f32 v2, v4, v2
    v_cvt_pk_bf16_f32 v5, v1, v2
    v_lshlrev_b32 v1, 16, v5
    v_and_b32 v2, 0xffff0000, v5
    v_lshlrev_b32 v3, 16, v90
    v_and_b32 v4, 0xffff0000, v90
    v_mul_f32 v1, v1, v3
    v_mul_f32 v2, v2, v4
    v_cvt_pk_bf16_f32 v246, v1, v2
    v_lshlrev_b32 v1, 16, v147
    v_and_b32 v2, 0xffff0000, v147
    v_lshlrev_b32 v3, 16, v203
    v_and_b32 v4, 0xffff0000, v203
    v_mul_f32 v1, v1, v3
    v_mul_f32 v2, v2, v4
    v_cvt_pk_bf16_f32 v5, v1, v2
    v_lshlrev_b32 v1, 16, v5
    v_and_b32 v2, 0xffff0000, v5
    v_lshlrev_b32 v3, 16, v35
    v_and_b32 v4, 0xffff0000, v35
    v_add_f32 v1, v3, v1
    v_add_f32 v2, v4, v2
    v_cvt_pk_bf16_f32 v5, v1, v2
    v_lshlrev_b32 v1, 16, v5
    v_and_b32 v2, 0xffff0000, v5
    v_lshlrev_b32 v3, 16, v91
    v_and_b32 v4, 0xffff0000, v91
    v_mul_f32 v1, v1, v3
    v_mul_f32 v2, v2, v4
    v_cvt_pk_bf16_f32 v247, v1, v2
    buffer_store_dwordx4 v[244:247], v9, s[24:27], 0 offen offset:256
    v_lshlrev_b32 v1, 16, v148
    v_and_b32 v2, 0xffff0000, v148
    v_lshlrev_b32 v3, 16, v204
    v_and_b32 v4, 0xffff0000, v204
    v_mul_f32 v1, v1, v3
    v_mul_f32 v2, v2, v4
    v_cvt_pk_bf16_f32 v5, v1, v2
    v_lshlrev_b32 v1, 16, v5
    v_and_b32 v2, 0xffff0000, v5
    v_lshlrev_b32 v3, 16, v36
    v_and_b32 v4, 0xffff0000, v36
    v_add_f32 v1, v3, v1
    v_add_f32 v2, v4, v2
    v_cvt_pk_bf16_f32 v5, v1, v2
    v_lshlrev_b32 v1, 16, v5
    v_and_b32 v2, 0xffff0000, v5
    v_lshlrev_b32 v3, 16, v92
    v_and_b32 v4, 0xffff0000, v92
    v_mul_f32 v1, v1, v3
    v_mul_f32 v2, v2, v4
    v_cvt_pk_bf16_f32 v248, v1, v2
    v_lshlrev_b32 v1, 16, v149
    v_and_b32 v2, 0xffff0000, v149
    v_lshlrev_b32 v3, 16, v205
    v_and_b32 v4, 0xffff0000, v205
    v_mul_f32 v1, v1, v3
    v_mul_f32 v2, v2, v4
    v_cvt_pk_bf16_f32 v5, v1, v2
    v_lshlrev_b32 v1, 16, v5
    v_and_b32 v2, 0xffff0000, v5
    v_lshlrev_b32 v3, 16, v37
    v_and_b32 v4, 0xffff0000, v37
    v_add_f32 v1, v3, v1
    v_add_f32 v2, v4, v2
    v_cvt_pk_bf16_f32 v5, v1, v2
    v_lshlrev_b32 v1, 16, v5
    v_and_b32 v2, 0xffff0000, v5
    v_lshlrev_b32 v3, 16, v93
    v_and_b32 v4, 0xffff0000, v93
    v_mul_f32 v1, v1, v3
    v_mul_f32 v2, v2, v4
    v_cvt_pk_bf16_f32 v249, v1, v2
    v_lshlrev_b32 v1, 16, v150
    v_and_b32 v2, 0xffff0000, v150
    v_lshlrev_b32 v3, 16, v206
    v_and_b32 v4, 0xffff0000, v206
    v_mul_f32 v1, v1, v3
    v_mul_f32 v2, v2, v4
    v_cvt_pk_bf16_f32 v5, v1, v2
    v_lshlrev_b32 v1, 16, v5
    v_and_b32 v2, 0xffff0000, v5
    v_lshlrev_b32 v3, 16, v38
    v_and_b32 v4, 0xffff0000, v38
    v_add_f32 v1, v3, v1
    v_add_f32 v2, v4, v2
    v_cvt_pk_bf16_f32 v5, v1, v2
    v_lshlrev_b32 v1, 16, v5
    v_and_b32 v2, 0xffff0000, v5
    v_lshlrev_b32 v3, 16, v94
    v_and_b32 v4, 0xffff0000, v94
    v_mul_f32 v1, v1, v3
    v_mul_f32 v2, v2, v4
    v_cvt_pk_bf16_f32 v250, v1, v2
    v_lshlrev_b32 v1, 16, v151
    v_and_b32 v2, 0xffff0000, v151
    v_lshlrev_b32 v3, 16, v207
    v_and_b32 v4, 0xffff0000, v207
    v_mul_f32 v1, v1, v3
    v_mul_f32 v2, v2, v4
    v_cvt_pk_bf16_f32 v5, v1, v2
    v_lshlrev_b32 v1, 16, v5
    v_and_b32 v2, 0xffff0000, v5
    v_lshlrev_b32 v3, 16, v39
    v_and_b32 v4, 0xffff0000, v39
    v_add_f32 v1, v3, v1
    v_add_f32 v2, v4, v2
    v_cvt_pk_bf16_f32 v5, v1, v2
    v_lshlrev_b32 v1, 16, v5
    v_and_b32 v2, 0xffff0000, v5
    v_lshlrev_b32 v3, 16, v95
    v_and_b32 v4, 0xffff0000, v95
    v_mul_f32 v1, v1, v3
    v_mul_f32 v2, v2, v4
    v_cvt_pk_bf16_f32 v251, v1, v2
    buffer_store_dwordx4 v[248:251], v9, s[24:27], 0 offen offset:320
    v_lshlrev_b32 v1, 16, v152
    v_and_b32 v2, 0xffff0000, v152
    v_lshlrev_b32 v3, 16, v208
    v_and_b32 v4, 0xffff0000, v208
    v_mul_f32 v1, v1, v3
    v_mul_f32 v2, v2, v4
    v_cvt_pk_bf16_f32 v5, v1, v2
    v_lshlrev_b32 v1, 16, v5
    v_and_b32 v2, 0xffff0000, v5
    s_waitcnt lgkmcnt(14)
    v_lshlrev_b32 v3, 16, v40
    v_and_b32 v4, 0xffff0000, v40
    v_add_f32 v1, v3, v1
    v_add_f32 v2, v4, v2
    v_cvt_pk_bf16_f32 v5, v1, v2
    v_lshlrev_b32 v1, 16, v5
    v_and_b32 v2, 0xffff0000, v5
    v_lshlrev_b32 v3, 16, v96
    v_and_b32 v4, 0xffff0000, v96
    v_mul_f32 v1, v1, v3
    v_mul_f32 v2, v2, v4
    v_cvt_pk_bf16_f32 v244, v1, v2
    v_lshlrev_b32 v1, 16, v153
    v_and_b32 v2, 0xffff0000, v153
    v_lshlrev_b32 v3, 16, v209
    v_and_b32 v4, 0xffff0000, v209
    v_mul_f32 v1, v1, v3
    v_mul_f32 v2, v2, v4
    v_cvt_pk_bf16_f32 v5, v1, v2
    v_lshlrev_b32 v1, 16, v5
    v_and_b32 v2, 0xffff0000, v5
    v_lshlrev_b32 v3, 16, v41
    v_and_b32 v4, 0xffff0000, v41
    v_add_f32 v1, v3, v1
    v_add_f32 v2, v4, v2
    v_cvt_pk_bf16_f32 v5, v1, v2
    v_lshlrev_b32 v1, 16, v5
    v_and_b32 v2, 0xffff0000, v5
    v_lshlrev_b32 v3, 16, v97
    v_and_b32 v4, 0xffff0000, v97
    v_mul_f32 v1, v1, v3
    v_mul_f32 v2, v2, v4
    v_cvt_pk_bf16_f32 v245, v1, v2
    v_lshlrev_b32 v1, 16, v154
    v_and_b32 v2, 0xffff0000, v154
    v_lshlrev_b32 v3, 16, v210
    v_and_b32 v4, 0xffff0000, v210
    v_mul_f32 v1, v1, v3
    v_mul_f32 v2, v2, v4
    v_cvt_pk_bf16_f32 v5, v1, v2
    v_lshlrev_b32 v1, 16, v5
    v_and_b32 v2, 0xffff0000, v5
    v_lshlrev_b32 v3, 16, v42
    v_and_b32 v4, 0xffff0000, v42
    v_add_f32 v1, v3, v1
    v_add_f32 v2, v4, v2
    v_cvt_pk_bf16_f32 v5, v1, v2
    v_lshlrev_b32 v1, 16, v5
    v_and_b32 v2, 0xffff0000, v5
    v_lshlrev_b32 v3, 16, v98
    v_and_b32 v4, 0xffff0000, v98
    v_mul_f32 v1, v1, v3
    v_mul_f32 v2, v2, v4
    v_cvt_pk_bf16_f32 v246, v1, v2
    v_lshlrev_b32 v1, 16, v155
    v_and_b32 v2, 0xffff0000, v155
    v_lshlrev_b32 v3, 16, v211
    v_and_b32 v4, 0xffff0000, v211
    v_mul_f32 v1, v1, v3
    v_mul_f32 v2, v2, v4
    v_cvt_pk_bf16_f32 v5, v1, v2
    v_lshlrev_b32 v1, 16, v5
    v_and_b32 v2, 0xffff0000, v5
    v_lshlrev_b32 v3, 16, v43
    v_and_b32 v4, 0xffff0000, v43
    v_add_f32 v1, v3, v1
    v_add_f32 v2, v4, v2
    v_cvt_pk_bf16_f32 v5, v1, v2
    v_lshlrev_b32 v1, 16, v5
    v_and_b32 v2, 0xffff0000, v5
    v_lshlrev_b32 v3, 16, v99
    v_and_b32 v4, 0xffff0000, v99
    v_mul_f32 v1, v1, v3
    v_mul_f32 v2, v2, v4
    v_cvt_pk_bf16_f32 v247, v1, v2
    buffer_store_dwordx4 v[244:247], v9, s[24:27], 0 offen offset:384
    v_lshlrev_b32 v1, 16, v156
    v_and_b32 v2, 0xffff0000, v156
    v_lshlrev_b32 v3, 16, v212
    v_and_b32 v4, 0xffff0000, v212
    v_mul_f32 v1, v1, v3
    v_mul_f32 v2, v2, v4
    v_cvt_pk_bf16_f32 v5, v1, v2
    v_lshlrev_b32 v1, 16, v5
    v_and_b32 v2, 0xffff0000, v5
    s_waitcnt lgkmcnt(12)
    v_lshlrev_b32 v3, 16, v44
    v_and_b32 v4, 0xffff0000, v44
    v_add_f32 v1, v3, v1
    v_add_f32 v2, v4, v2
    v_cvt_pk_bf16_f32 v5, v1, v2
    v_lshlrev_b32 v1, 16, v5
    v_and_b32 v2, 0xffff0000, v5
    v_lshlrev_b32 v3, 16, v100
    v_and_b32 v4, 0xffff0000, v100
    v_mul_f32 v1, v1, v3
    v_mul_f32 v2, v2, v4
    v_cvt_pk_bf16_f32 v248, v1, v2
    v_lshlrev_b32 v1, 16, v157
    v_and_b32 v2, 0xffff0000, v157
    v_lshlrev_b32 v3, 16, v213
    v_and_b32 v4, 0xffff0000, v213
    v_mul_f32 v1, v1, v3
    v_mul_f32 v2, v2, v4
    v_cvt_pk_bf16_f32 v5, v1, v2
    v_lshlrev_b32 v1, 16, v5
    v_and_b32 v2, 0xffff0000, v5
    v_lshlrev_b32 v3, 16, v45
    v_and_b32 v4, 0xffff0000, v45
    v_add_f32 v1, v3, v1
    v_add_f32 v2, v4, v2
    v_cvt_pk_bf16_f32 v5, v1, v2
    v_lshlrev_b32 v1, 16, v5
    v_and_b32 v2, 0xffff0000, v5
    v_lshlrev_b32 v3, 16, v101
    v_and_b32 v4, 0xffff0000, v101
    v_mul_f32 v1, v1, v3
    v_mul_f32 v2, v2, v4
    v_cvt_pk_bf16_f32 v249, v1, v2
    v_lshlrev_b32 v1, 16, v158
    v_and_b32 v2, 0xffff0000, v158
    v_lshlrev_b32 v3, 16, v214
    v_and_b32 v4, 0xffff0000, v214
    v_mul_f32 v1, v1, v3
    v_mul_f32 v2, v2, v4
    v_cvt_pk_bf16_f32 v5, v1, v2
    v_lshlrev_b32 v1, 16, v5
    v_and_b32 v2, 0xffff0000, v5
    v_lshlrev_b32 v3, 16, v46
    v_and_b32 v4, 0xffff0000, v46
    v_add_f32 v1, v3, v1
    v_add_f32 v2, v4, v2
    v_cvt_pk_bf16_f32 v5, v1, v2
    v_lshlrev_b32 v1, 16, v5
    v_and_b32 v2, 0xffff0000, v5
    v_lshlrev_b32 v3, 16, v102
    v_and_b32 v4, 0xffff0000, v102
    v_mul_f32 v1, v1, v3
    v_mul_f32 v2, v2, v4
    v_cvt_pk_bf16_f32 v250, v1, v2
    v_lshlrev_b32 v1, 16, v159
    v_and_b32 v2, 0xffff0000, v159
    v_lshlrev_b32 v3, 16, v215
    v_and_b32 v4, 0xffff0000, v215
    v_mul_f32 v1, v1, v3
    v_mul_f32 v2, v2, v4
    v_cvt_pk_bf16_f32 v5, v1, v2
    v_lshlrev_b32 v1, 16, v5
    v_and_b32 v2, 0xffff0000, v5
    v_lshlrev_b32 v3, 16, v47
    v_and_b32 v4, 0xffff0000, v47
    v_add_f32 v1, v3, v1
    v_add_f32 v2, v4, v2
    v_cvt_pk_bf16_f32 v5, v1, v2
    v_lshlrev_b32 v1, 16, v5
    v_and_b32 v2, 0xffff0000, v5
    v_lshlrev_b32 v3, 16, v103
    v_and_b32 v4, 0xffff0000, v103
    v_mul_f32 v1, v1, v3
    v_mul_f32 v2, v2, v4
    v_cvt_pk_bf16_f32 v251, v1, v2
    buffer_store_dwordx4 v[248:251], v9, s[24:27], 0 offen offset:448
    v_lshlrev_b32 v1, 16, v160
    v_and_b32 v2, 0xffff0000, v160
    v_lshlrev_b32 v3, 16, v216
    v_and_b32 v4, 0xffff0000, v216
    v_mul_f32 v1, v1, v3
    v_mul_f32 v2, v2, v4
    v_cvt_pk_bf16_f32 v5, v1, v2
    v_lshlrev_b32 v1, 16, v5
    v_and_b32 v2, 0xffff0000, v5
    s_waitcnt lgkmcnt(10)
    v_lshlrev_b32 v3, 16, v48
    v_and_b32 v4, 0xffff0000, v48
    v_add_f32 v1, v3, v1
    v_add_f32 v2, v4, v2
    v_cvt_pk_bf16_f32 v5, v1, v2
    v_lshlrev_b32 v1, 16, v5
    v_and_b32 v2, 0xffff0000, v5
    v_lshlrev_b32 v3, 16, v104
    v_and_b32 v4, 0xffff0000, v104
    v_mul_f32 v1, v1, v3
    v_mul_f32 v2, v2, v4
    v_cvt_pk_bf16_f32 v244, v1, v2
    v_lshlrev_b32 v1, 16, v161
    v_and_b32 v2, 0xffff0000, v161
    v_lshlrev_b32 v3, 16, v217
    v_and_b32 v4, 0xffff0000, v217
    v_mul_f32 v1, v1, v3
    v_mul_f32 v2, v2, v4
    v_cvt_pk_bf16_f32 v5, v1, v2
    v_lshlrev_b32 v1, 16, v5
    v_and_b32 v2, 0xffff0000, v5
    v_lshlrev_b32 v3, 16, v49
    v_and_b32 v4, 0xffff0000, v49
    v_add_f32 v1, v3, v1
    v_add_f32 v2, v4, v2
    v_cvt_pk_bf16_f32 v5, v1, v2
    v_lshlrev_b32 v1, 16, v5
    v_and_b32 v2, 0xffff0000, v5
    v_lshlrev_b32 v3, 16, v105
    v_and_b32 v4, 0xffff0000, v105
    v_mul_f32 v1, v1, v3
    v_mul_f32 v2, v2, v4
    v_cvt_pk_bf16_f32 v245, v1, v2
    v_lshlrev_b32 v1, 16, v162
    v_and_b32 v2, 0xffff0000, v162
    v_lshlrev_b32 v3, 16, v218
    v_and_b32 v4, 0xffff0000, v218
    v_mul_f32 v1, v1, v3
    v_mul_f32 v2, v2, v4
    v_cvt_pk_bf16_f32 v5, v1, v2
    v_lshlrev_b32 v1, 16, v5
    v_and_b32 v2, 0xffff0000, v5
    v_lshlrev_b32 v3, 16, v50
    v_and_b32 v4, 0xffff0000, v50
    v_add_f32 v1, v3, v1
    v_add_f32 v2, v4, v2
    v_cvt_pk_bf16_f32 v5, v1, v2
    v_lshlrev_b32 v1, 16, v5
    v_and_b32 v2, 0xffff0000, v5
    v_lshlrev_b32 v3, 16, v106
    v_and_b32 v4, 0xffff0000, v106
    v_mul_f32 v1, v1, v3
    v_mul_f32 v2, v2, v4
    v_cvt_pk_bf16_f32 v246, v1, v2
    v_lshlrev_b32 v1, 16, v163
    v_and_b32 v2, 0xffff0000, v163
    v_lshlrev_b32 v3, 16, v219
    v_and_b32 v4, 0xffff0000, v219
    v_mul_f32 v1, v1, v3
    v_mul_f32 v2, v2, v4
    v_cvt_pk_bf16_f32 v5, v1, v2
    v_lshlrev_b32 v1, 16, v5
    v_and_b32 v2, 0xffff0000, v5
    v_lshlrev_b32 v3, 16, v51
    v_and_b32 v4, 0xffff0000, v51
    v_add_f32 v1, v3, v1
    v_add_f32 v2, v4, v2
    v_cvt_pk_bf16_f32 v5, v1, v2
    v_lshlrev_b32 v1, 16, v5
    v_and_b32 v2, 0xffff0000, v5
    v_lshlrev_b32 v3, 16, v107
    v_and_b32 v4, 0xffff0000, v107
    v_mul_f32 v1, v1, v3
    v_mul_f32 v2, v2, v4
    v_cvt_pk_bf16_f32 v247, v1, v2
    buffer_store_dwordx4 v[244:247], v9, s[24:27], 0 offen offset:512
    v_lshlrev_b32 v1, 16, v164
    v_and_b32 v2, 0xffff0000, v164
    v_lshlrev_b32 v3, 16, v220
    v_and_b32 v4, 0xffff0000, v220
    v_mul_f32 v1, v1, v3
    v_mul_f32 v2, v2, v4
    v_cvt_pk_bf16_f32 v5, v1, v2
    v_lshlrev_b32 v1, 16, v5
    v_and_b32 v2, 0xffff0000, v5
    s_waitcnt lgkmcnt(8)
    v_lshlrev_b32 v3, 16, v52
    v_and_b32 v4, 0xffff0000, v52
    v_add_f32 v1, v3, v1
    v_add_f32 v2, v4, v2
    v_cvt_pk_bf16_f32 v5, v1, v2
    v_lshlrev_b32 v1, 16, v5
    v_and_b32 v2, 0xffff0000, v5
    v_lshlrev_b32 v3, 16, v108
    v_and_b32 v4, 0xffff0000, v108
    v_mul_f32 v1, v1, v3
    v_mul_f32 v2, v2, v4
    v_cvt_pk_bf16_f32 v248, v1, v2
    v_lshlrev_b32 v1, 16, v165
    v_and_b32 v2, 0xffff0000, v165
    v_lshlrev_b32 v3, 16, v221
    v_and_b32 v4, 0xffff0000, v221
    v_mul_f32 v1, v1, v3
    v_mul_f32 v2, v2, v4
    v_cvt_pk_bf16_f32 v5, v1, v2
    v_lshlrev_b32 v1, 16, v5
    v_and_b32 v2, 0xffff0000, v5
    v_lshlrev_b32 v3, 16, v53
    v_and_b32 v4, 0xffff0000, v53
    v_add_f32 v1, v3, v1
    v_add_f32 v2, v4, v2
    v_cvt_pk_bf16_f32 v5, v1, v2
    v_lshlrev_b32 v1, 16, v5
    v_and_b32 v2, 0xffff0000, v5
    v_lshlrev_b32 v3, 16, v109
    v_and_b32 v4, 0xffff0000, v109
    v_mul_f32 v1, v1, v3
    v_mul_f32 v2, v2, v4
    v_cvt_pk_bf16_f32 v249, v1, v2
    v_lshlrev_b32 v1, 16, v166
    v_and_b32 v2, 0xffff0000, v166
    v_lshlrev_b32 v3, 16, v222
    v_and_b32 v4, 0xffff0000, v222
    v_mul_f32 v1, v1, v3
    v_mul_f32 v2, v2, v4
    v_cvt_pk_bf16_f32 v5, v1, v2
    v_lshlrev_b32 v1, 16, v5
    v_and_b32 v2, 0xffff0000, v5
    v_lshlrev_b32 v3, 16, v54
    v_and_b32 v4, 0xffff0000, v54
    v_add_f32 v1, v3, v1
    v_add_f32 v2, v4, v2
    v_cvt_pk_bf16_f32 v5, v1, v2
    v_lshlrev_b32 v1, 16, v5
    v_and_b32 v2, 0xffff0000, v5
    v_lshlrev_b32 v3, 16, v110
    v_and_b32 v4, 0xffff0000, v110
    v_mul_f32 v1, v1, v3
    v_mul_f32 v2, v2, v4
    v_cvt_pk_bf16_f32 v250, v1, v2
    v_lshlrev_b32 v1, 16, v167
    v_and_b32 v2, 0xffff0000, v167
    v_lshlrev_b32 v3, 16, v223
    v_and_b32 v4, 0xffff0000, v223
    v_mul_f32 v1, v1, v3
    v_mul_f32 v2, v2, v4
    v_cvt_pk_bf16_f32 v5, v1, v2
    v_lshlrev_b32 v1, 16, v5
    v_and_b32 v2, 0xffff0000, v5
    v_lshlrev_b32 v3, 16, v55
    v_and_b32 v4, 0xffff0000, v55
    v_add_f32 v1, v3, v1
    v_add_f32 v2, v4, v2
    v_cvt_pk_bf16_f32 v5, v1, v2
    v_lshlrev_b32 v1, 16, v5
    v_and_b32 v2, 0xffff0000, v5
    v_lshlrev_b32 v3, 16, v111
    v_and_b32 v4, 0xffff0000, v111
    v_mul_f32 v1, v1, v3
    v_mul_f32 v2, v2, v4
    v_cvt_pk_bf16_f32 v251, v1, v2
    buffer_store_dwordx4 v[248:251], v9, s[24:27], 0 offen offset:576
    v_lshlrev_b32 v1, 16, v168
    v_and_b32 v2, 0xffff0000, v168
    v_lshlrev_b32 v3, 16, v224
    v_and_b32 v4, 0xffff0000, v224
    v_mul_f32 v1, v1, v3
    v_mul_f32 v2, v2, v4
    v_cvt_pk_bf16_f32 v5, v1, v2
    v_lshlrev_b32 v1, 16, v5
    v_and_b32 v2, 0xffff0000, v5
    s_waitcnt lgkmcnt(6)
    v_lshlrev_b32 v3, 16, v56
    v_and_b32 v4, 0xffff0000, v56
    v_add_f32 v1, v3, v1
    v_add_f32 v2, v4, v2
    v_cvt_pk_bf16_f32 v5, v1, v2
    v_lshlrev_b32 v1, 16, v5
    v_and_b32 v2, 0xffff0000, v5
    v_lshlrev_b32 v3, 16, v112
    v_and_b32 v4, 0xffff0000, v112
    v_mul_f32 v1, v1, v3
    v_mul_f32 v2, v2, v4
    v_cvt_pk_bf16_f32 v244, v1, v2
    v_lshlrev_b32 v1, 16, v169
    v_and_b32 v2, 0xffff0000, v169
    v_lshlrev_b32 v3, 16, v225
    v_and_b32 v4, 0xffff0000, v225
    v_mul_f32 v1, v1, v3
    v_mul_f32 v2, v2, v4
    v_cvt_pk_bf16_f32 v5, v1, v2
    v_lshlrev_b32 v1, 16, v5
    v_and_b32 v2, 0xffff0000, v5
    v_lshlrev_b32 v3, 16, v57
    v_and_b32 v4, 0xffff0000, v57
    v_add_f32 v1, v3, v1
    v_add_f32 v2, v4, v2
    v_cvt_pk_bf16_f32 v5, v1, v2
    v_lshlrev_b32 v1, 16, v5
    v_and_b32 v2, 0xffff0000, v5
    v_lshlrev_b32 v3, 16, v113
    v_and_b32 v4, 0xffff0000, v113
    v_mul_f32 v1, v1, v3
    v_mul_f32 v2, v2, v4
    v_cvt_pk_bf16_f32 v245, v1, v2
    v_lshlrev_b32 v1, 16, v170
    v_and_b32 v2, 0xffff0000, v170
    v_lshlrev_b32 v3, 16, v226
    v_and_b32 v4, 0xffff0000, v226
    v_mul_f32 v1, v1, v3
    v_mul_f32 v2, v2, v4
    v_cvt_pk_bf16_f32 v5, v1, v2
    v_lshlrev_b32 v1, 16, v5
    v_and_b32 v2, 0xffff0000, v5
    v_lshlrev_b32 v3, 16, v58
    v_and_b32 v4, 0xffff0000, v58
    v_add_f32 v1, v3, v1
    v_add_f32 v2, v4, v2
    v_cvt_pk_bf16_f32 v5, v1, v2
    v_lshlrev_b32 v1, 16, v5
    v_and_b32 v2, 0xffff0000, v5
    v_lshlrev_b32 v3, 16, v114
    v_and_b32 v4, 0xffff0000, v114
    v_mul_f32 v1, v1, v3
    v_mul_f32 v2, v2, v4
    v_cvt_pk_bf16_f32 v246, v1, v2
    v_lshlrev_b32 v1, 16, v171
    v_and_b32 v2, 0xffff0000, v171
    v_lshlrev_b32 v3, 16, v227
    v_and_b32 v4, 0xffff0000, v227
    v_mul_f32 v1, v1, v3
    v_mul_f32 v2, v2, v4
    v_cvt_pk_bf16_f32 v5, v1, v2
    v_lshlrev_b32 v1, 16, v5
    v_and_b32 v2, 0xffff0000, v5
    v_lshlrev_b32 v3, 16, v59
    v_and_b32 v4, 0xffff0000, v59
    v_add_f32 v1, v3, v1
    v_add_f32 v2, v4, v2
    v_cvt_pk_bf16_f32 v5, v1, v2
    v_lshlrev_b32 v1, 16, v5
    v_and_b32 v2, 0xffff0000, v5
    v_lshlrev_b32 v3, 16, v115
    v_and_b32 v4, 0xffff0000, v115
    v_mul_f32 v1, v1, v3
    v_mul_f32 v2, v2, v4
    v_cvt_pk_bf16_f32 v247, v1, v2
    buffer_store_dwordx4 v[244:247], v9, s[24:27], 0 offen offset:640
    v_lshlrev_b32 v1, 16, v172
    v_and_b32 v2, 0xffff0000, v172
    v_lshlrev_b32 v3, 16, v228
    v_and_b32 v4, 0xffff0000, v228
    v_mul_f32 v1, v1, v3
    v_mul_f32 v2, v2, v4
    v_cvt_pk_bf16_f32 v5, v1, v2
    v_lshlrev_b32 v1, 16, v5
    v_and_b32 v2, 0xffff0000, v5
    s_waitcnt lgkmcnt(4)
    v_lshlrev_b32 v3, 16, v60
    v_and_b32 v4, 0xffff0000, v60
    v_add_f32 v1, v3, v1
    v_add_f32 v2, v4, v2
    v_cvt_pk_bf16_f32 v5, v1, v2
    v_lshlrev_b32 v1, 16, v5
    v_and_b32 v2, 0xffff0000, v5
    v_lshlrev_b32 v3, 16, v116
    v_and_b32 v4, 0xffff0000, v116
    v_mul_f32 v1, v1, v3
    v_mul_f32 v2, v2, v4
    v_cvt_pk_bf16_f32 v248, v1, v2
    v_lshlrev_b32 v1, 16, v173
    v_and_b32 v2, 0xffff0000, v173
    v_lshlrev_b32 v3, 16, v229
    v_and_b32 v4, 0xffff0000, v229
    v_mul_f32 v1, v1, v3
    v_mul_f32 v2, v2, v4
    v_cvt_pk_bf16_f32 v5, v1, v2
    v_lshlrev_b32 v1, 16, v5
    v_and_b32 v2, 0xffff0000, v5
    v_lshlrev_b32 v3, 16, v61
    v_and_b32 v4, 0xffff0000, v61
    v_add_f32 v1, v3, v1
    v_add_f32 v2, v4, v2
    v_cvt_pk_bf16_f32 v5, v1, v2
    v_lshlrev_b32 v1, 16, v5
    v_and_b32 v2, 0xffff0000, v5
    v_lshlrev_b32 v3, 16, v117
    v_and_b32 v4, 0xffff0000, v117
    v_mul_f32 v1, v1, v3
    v_mul_f32 v2, v2, v4
    v_cvt_pk_bf16_f32 v249, v1, v2
    v_lshlrev_b32 v1, 16, v174
    v_and_b32 v2, 0xffff0000, v174
    v_lshlrev_b32 v3, 16, v230
    v_and_b32 v4, 0xffff0000, v230
    v_mul_f32 v1, v1, v3
    v_mul_f32 v2, v2, v4
    v_cvt_pk_bf16_f32 v5, v1, v2
    v_lshlrev_b32 v1, 16, v5
    v_and_b32 v2, 0xffff0000, v5
    v_lshlrev_b32 v3, 16, v62
    v_and_b32 v4, 0xffff0000, v62
    v_add_f32 v1, v3, v1
    v_add_f32 v2, v4, v2
    v_cvt_pk_bf16_f32 v5, v1, v2
    v_lshlrev_b32 v1, 16, v5
    v_and_b32 v2, 0xffff0000, v5
    v_lshlrev_b32 v3, 16, v118
    v_and_b32 v4, 0xffff0000, v118
    v_mul_f32 v1, v1, v3
    v_mul_f32 v2, v2, v4
    v_cvt_pk_bf16_f32 v250, v1, v2
    v_lshlrev_b32 v1, 16, v175
    v_and_b32 v2, 0xffff0000, v175
    v_lshlrev_b32 v3, 16, v231
    v_and_b32 v4, 0xffff0000, v231
    v_mul_f32 v1, v1, v3
    v_mul_f32 v2, v2, v4
    v_cvt_pk_bf16_f32 v5, v1, v2
    v_lshlrev_b32 v1, 16, v5
    v_and_b32 v2, 0xffff0000, v5
    v_lshlrev_b32 v3, 16, v63
    v_and_b32 v4, 0xffff0000, v63
    v_add_f32 v1, v3, v1
    v_add_f32 v2, v4, v2
    v_cvt_pk_bf16_f32 v5, v1, v2
    v_lshlrev_b32 v1, 16, v5
    v_and_b32 v2, 0xffff0000, v5
    v_lshlrev_b32 v3, 16, v119
    v_and_b32 v4, 0xffff0000, v119
    v_mul_f32 v1, v1, v3
    v_mul_f32 v2, v2, v4
    v_cvt_pk_bf16_f32 v251, v1, v2
    buffer_store_dwordx4 v[248:251], v9, s[24:27], 0 offen offset:704
    v_lshlrev_b32 v1, 16, v176
    v_and_b32 v2, 0xffff0000, v176
    v_lshlrev_b32 v3, 16, v232
    v_and_b32 v4, 0xffff0000, v232
    v_mul_f32 v1, v1, v3
    v_mul_f32 v2, v2, v4
    v_cvt_pk_bf16_f32 v5, v1, v2
    v_lshlrev_b32 v1, 16, v5
    v_and_b32 v2, 0xffff0000, v5
    s_waitcnt lgkmcnt(2)
    v_lshlrev_b32 v3, 16, v64
    v_and_b32 v4, 0xffff0000, v64
    v_add_f32 v1, v3, v1
    v_add_f32 v2, v4, v2
    v_cvt_pk_bf16_f32 v5, v1, v2
    v_lshlrev_b32 v1, 16, v5
    v_and_b32 v2, 0xffff0000, v5
    v_lshlrev_b32 v3, 16, v120
    v_and_b32 v4, 0xffff0000, v120
    v_mul_f32 v1, v1, v3
    v_mul_f32 v2, v2, v4
    v_cvt_pk_bf16_f32 v244, v1, v2
    v_lshlrev_b32 v1, 16, v177
    v_and_b32 v2, 0xffff0000, v177
    v_lshlrev_b32 v3, 16, v233
    v_and_b32 v4, 0xffff0000, v233
    v_mul_f32 v1, v1, v3
    v_mul_f32 v2, v2, v4
    v_cvt_pk_bf16_f32 v5, v1, v2
    v_lshlrev_b32 v1, 16, v5
    v_and_b32 v2, 0xffff0000, v5
    v_lshlrev_b32 v3, 16, v65
    v_and_b32 v4, 0xffff0000, v65
    v_add_f32 v1, v3, v1
    v_add_f32 v2, v4, v2
    v_cvt_pk_bf16_f32 v5, v1, v2
    v_lshlrev_b32 v1, 16, v5
    v_and_b32 v2, 0xffff0000, v5
    v_lshlrev_b32 v3, 16, v121
    v_and_b32 v4, 0xffff0000, v121
    v_mul_f32 v1, v1, v3
    v_mul_f32 v2, v2, v4
    v_cvt_pk_bf16_f32 v245, v1, v2
    v_lshlrev_b32 v1, 16, v178
    v_and_b32 v2, 0xffff0000, v178
    v_lshlrev_b32 v3, 16, v234
    v_and_b32 v4, 0xffff0000, v234
    v_mul_f32 v1, v1, v3
    v_mul_f32 v2, v2, v4
    v_cvt_pk_bf16_f32 v5, v1, v2
    v_lshlrev_b32 v1, 16, v5
    v_and_b32 v2, 0xffff0000, v5
    v_lshlrev_b32 v3, 16, v66
    v_and_b32 v4, 0xffff0000, v66
    v_add_f32 v1, v3, v1
    v_add_f32 v2, v4, v2
    v_cvt_pk_bf16_f32 v5, v1, v2
    v_lshlrev_b32 v1, 16, v5
    v_and_b32 v2, 0xffff0000, v5
    v_lshlrev_b32 v3, 16, v122
    v_and_b32 v4, 0xffff0000, v122
    v_mul_f32 v1, v1, v3
    v_mul_f32 v2, v2, v4
    v_cvt_pk_bf16_f32 v246, v1, v2
    v_lshlrev_b32 v1, 16, v179
    v_and_b32 v2, 0xffff0000, v179
    v_lshlrev_b32 v3, 16, v235
    v_and_b32 v4, 0xffff0000, v235
    v_mul_f32 v1, v1, v3
    v_mul_f32 v2, v2, v4
    v_cvt_pk_bf16_f32 v5, v1, v2
    v_lshlrev_b32 v1, 16, v5
    v_and_b32 v2, 0xffff0000, v5
    v_lshlrev_b32 v3, 16, v67
    v_and_b32 v4, 0xffff0000, v67
    v_add_f32 v1, v3, v1
    v_add_f32 v2, v4, v2
    v_cvt_pk_bf16_f32 v5, v1, v2
    v_lshlrev_b32 v1, 16, v5
    v_and_b32 v2, 0xffff0000, v5
    v_lshlrev_b32 v3, 16, v123
    v_and_b32 v4, 0xffff0000, v123
    v_mul_f32 v1, v1, v3
    v_mul_f32 v2, v2, v4
    v_cvt_pk_bf16_f32 v247, v1, v2
    buffer_store_dwordx4 v[244:247], v9, s[24:27], 0 offen offset:768
    v_lshlrev_b32 v1, 16, v180
    v_and_b32 v2, 0xffff0000, v180
    v_lshlrev_b32 v3, 16, v236
    v_and_b32 v4, 0xffff0000, v236
    v_mul_f32 v1, v1, v3
    v_mul_f32 v2, v2, v4
    v_cvt_pk_bf16_f32 v5, v1, v2
    v_lshlrev_b32 v1, 16, v5
    v_and_b32 v2, 0xffff0000, v5
    s_waitcnt lgkmcnt(0)
    v_lshlrev_b32 v3, 16, v68
    v_and_b32 v4, 0xffff0000, v68
    v_add_f32 v1, v3, v1
    v_add_f32 v2, v4, v2
    v_cvt_pk_bf16_f32 v5, v1, v2
    v_lshlrev_b32 v1, 16, v5
    v_and_b32 v2, 0xffff0000, v5
    v_lshlrev_b32 v3, 16, v124
    v_and_b32 v4, 0xffff0000, v124
    v_mul_f32 v1, v1, v3
    v_mul_f32 v2, v2, v4
    v_cvt_pk_bf16_f32 v248, v1, v2
    v_lshlrev_b32 v1, 16, v181
    v_and_b32 v2, 0xffff0000, v181
    v_lshlrev_b32 v3, 16, v237
    v_and_b32 v4, 0xffff0000, v237
    v_mul_f32 v1, v1, v3
    v_mul_f32 v2, v2, v4
    v_cvt_pk_bf16_f32 v5, v1, v2
    v_lshlrev_b32 v1, 16, v5
    v_and_b32 v2, 0xffff0000, v5
    v_lshlrev_b32 v3, 16, v69
    v_and_b32 v4, 0xffff0000, v69
    v_add_f32 v1, v3, v1
    v_add_f32 v2, v4, v2
    v_cvt_pk_bf16_f32 v5, v1, v2
    v_lshlrev_b32 v1, 16, v5
    v_and_b32 v2, 0xffff0000, v5
    v_lshlrev_b32 v3, 16, v125
    v_and_b32 v4, 0xffff0000, v125
    v_mul_f32 v1, v1, v3
    v_mul_f32 v2, v2, v4
    v_cvt_pk_bf16_f32 v249, v1, v2
    v_lshlrev_b32 v1, 16, v182
    v_and_b32 v2, 0xffff0000, v182
    v_lshlrev_b32 v3, 16, v238
    v_and_b32 v4, 0xffff0000, v238
    v_mul_f32 v1, v1, v3
    v_mul_f32 v2, v2, v4
    v_cvt_pk_bf16_f32 v5, v1, v2
    v_lshlrev_b32 v1, 16, v5
    v_and_b32 v2, 0xffff0000, v5
    v_lshlrev_b32 v3, 16, v70
    v_and_b32 v4, 0xffff0000, v70
    v_add_f32 v1, v3, v1
    v_add_f32 v2, v4, v2
    v_cvt_pk_bf16_f32 v5, v1, v2
    v_lshlrev_b32 v1, 16, v5
    v_and_b32 v2, 0xffff0000, v5
    v_lshlrev_b32 v3, 16, v126
    v_and_b32 v4, 0xffff0000, v126
    v_mul_f32 v1, v1, v3
    v_mul_f32 v2, v2, v4
    v_cvt_pk_bf16_f32 v250, v1, v2
    v_lshlrev_b32 v1, 16, v183
    v_and_b32 v2, 0xffff0000, v183
    v_lshlrev_b32 v3, 16, v239
    v_and_b32 v4, 0xffff0000, v239
    v_mul_f32 v1, v1, v3
    v_mul_f32 v2, v2, v4
    v_cvt_pk_bf16_f32 v5, v1, v2
    v_lshlrev_b32 v1, 16, v5
    v_and_b32 v2, 0xffff0000, v5
    v_lshlrev_b32 v3, 16, v71
    v_and_b32 v4, 0xffff0000, v71
    v_add_f32 v1, v3, v1
    v_add_f32 v2, v4, v2
    v_cvt_pk_bf16_f32 v5, v1, v2
    v_lshlrev_b32 v1, 16, v5
    v_and_b32 v2, 0xffff0000, v5
    v_lshlrev_b32 v3, 16, v127
    v_and_b32 v4, 0xffff0000, v127
    v_mul_f32 v1, v1, v3
    v_mul_f32 v2, v2, v4
    v_cvt_pk_bf16_f32 v251, v1, v2
    buffer_store_dwordx4 v[248:251], v9, s[24:27], 0 offen offset:832
    s_endpgm
k3_done:
    s_endpgm
k1_done:
    s_endpgm
.section .rodata,"a"
.p2align 6
.amdhsa_kernel concat_heads__compressed_kv_cla__ssm_conv_h3__prompt_kernel
  .amdhsa_next_free_vgpr 512
  .amdhsa_next_free_sgpr 102
  .amdhsa_accum_offset 256
  .amdhsa_group_segment_fixed_size 0
  .amdhsa_kernarg_size 120
  .amdhsa_user_sgpr_count 2
  .amdhsa_user_sgpr_kernarg_segment_ptr 1
  .amdhsa_system_sgpr_workgroup_id_x 1
.end_amdhsa_kernel
```
